```python
import torch

def _softmax(x, axis=-1):
    return torch.softmax(x, dim=axis)
def _gelu(x):
    return torch.nn.functional.gelu(x, approximate="tanh")
def _silu(x):
    return torch.nn.functional.silu(x)
def _sigmoid(x):
    return torch.sigmoid(x)
def _layernorm(x, axis=-1, eps=1e-5):
    m = x.mean(dim=axis, keepdim=True)
    v = x.var(dim=axis, keepdim=True, unbiased=False)
    return (x - m) / torch.sqrt(v + eps)
def _scatter_add(tgt, idx, src, axis=0):
    return tgt.clone().index_add_(axis, idx, src)
def _segment_sum(src, seg, n):
    out = torch.zeros((n,) + src.shape[1:], dtype=src.dtype)
    return out.index_add_(0, seg, src)
def _pad(x, pw):
    flat = tuple(v for pair in reversed(pw) for v in pair)
    return torch.nn.functional.pad(x, flat)

kernel_name = 'interleave_layers__sliding_block__mixer_token_mlp__prompt'

def setup_inputs():

    _w = (lambda a: (lambda t: t.to(torch.bfloat16) if t.is_floating_point() else t)(torch.as_tensor(a)))
    def _A_setup():
        B, S, D = 1, 2048, 512
        return {
            "x": _w((lambda *s: torch.randn(*s, dtype=torch.bfloat16) * 0.05)(B, S, D)),
            "wqkv": _w((lambda *s: torch.randn(*s, dtype=torch.bfloat16) * 0.05)(D, 3 * D)),
            "wo": _w((lambda *s: torch.randn(*s, dtype=torch.bfloat16) * 0.05)(D, D)),
        }
    _A_in = _A_setup()

    def _B_setup():
        B, S, D, F = 1, 2048, 512, 1376
        return {
            "x": _w((lambda *s: torch.randn(*s, dtype=torch.bfloat16) * 0.05)(B, S, D)),
            "w1": _w((lambda *s: torch.randn(*s, dtype=torch.bfloat16) * 0.8)(S, F) * (S ** -0.5)),
            "b1": _w((lambda *s: torch.randn(*s, dtype=torch.bfloat16) * 0.8)(F) * 0.02),
            "w2": _w((lambda *s: torch.randn(*s, dtype=torch.bfloat16) * 0.8)(F, S) * (F ** -0.5)),
            "b2": _w((lambda *s: torch.randn(*s, dtype=torch.bfloat16) * 0.8)(S) * 0.02),
        }
    _B_in = _B_setup()

    return {
        "A_x": _A_in["x"],
        "A_wqkv": _A_in["wqkv"],
        "A_wo": _A_in["wo"],
        "B_x": _B_in["x"],
        "B_w1": _B_in["w1"],
        "B_b1": _B_in["b1"],
        "B_w2": _B_in["w2"],
        "B_b2": _B_in["b2"],
    }

def reference(A_x, A_wqkv, A_wo, B_x, B_w1, B_b1, B_w2, B_b2):
    def _A_ref(x, wqkv, wo):
        B, S, D = x.shape
        H = 32; Dh = D // H; W = 256
        qkv = (lambda x, *d: x.permute(*d))((x @ wqkv).reshape(B, S, 3, H, Dh), 2, 0, 3, 1, 4)
        q, k, v = qkv[0], qkv[1], qkv[2]
        scores = torch.einsum("bhqd,bhkd->bhqk", q, k) * (Dh ** -0.5)
        idx = torch.arange(S)
        mask = (idx[:, None] - idx[None, :] >= 0) & (idx[:, None] - idx[None, :] < W)
        scores = torch.where(mask[None, None], scores, -1e9)
        p = _softmax(scores, axis=-1)
        o = torch.einsum("bhqk,bhkd->bhqd", p, v)
        return (lambda x, *d: x.permute(*d))(o, 0, 2, 1, 3).reshape(B, S, D) @ wo

    def _B_ref(x, w1, b1, w2, b2):
        B, S, D = x.shape
        h = _layernorm(x, axis=-1)
        u = torch.einsum("bsd,sf->bdf", h, w1) + b1
        u = _gelu(u)
        y = torch.einsum("bdf,fs->bds", u, w2) + b2
        return (lambda x, *d: x.permute(*d))(y, 0, 2, 1)

    x = A_x
    x = x + _A_ref(_layernorm(x, axis=-1), A_wqkv, A_wo)
    x = x + _B_ref(_layernorm(x, axis=-1), B_w1, B_b1, B_w2, B_b2)
    x = x + _A_ref(_layernorm(x, axis=-1), A_wqkv, A_wo)
    x = x + _B_ref(_layernorm(x, axis=-1), B_w1, B_b1, B_w2, B_b2)
    return x
```

```asm
; @launch grid=(256,1,1) block=(256,1,1) lds=163840
.amdgcn_target "amdgcn-amd-amdhsa--gfx950"
.text
.globl interleave_layers__sliding_block__mixer_token_mlp__prompt_kernel
.p2align 8
.type interleave_layers__sliding_block__mixer_token_mlp__prompt_kernel,@function
interleave_layers__sliding_block__mixer_token_mlp__prompt_kernel:
    s_cmp_ge_u32 s2, 256
    s_cbranch_scc1 L_END
    s_load_dwordx2 s[4:5], s[0:1], 0
    s_load_dwordx2 s[8:9], s[0:1], 8
    s_load_dwordx2 s[40:41], s[0:1], 80
    s_load_dwordx2 s[12:13], s[0:1], 16
    s_load_dwordx2 s[16:17], s[0:1], 32
    s_load_dwordx2 s[20:21], s[0:1], 40
    s_load_dwordx2 s[24:25], s[0:1], 48
    s_load_dwordx2 s[28:29], s[0:1], 56
    s_load_dwordx2 s[32:33], s[0:1], 64
    s_load_dwordx2 s[36:37], s[0:1], 72
    v_lshrrev_b32 v1, 6, v0
    v_and_b32 v0, 63, v0
    v_readfirstlane_b32 s76, v1
    s_and_b32 s89, s2, 7
    s_lshr_b32 s90, s2, 3
    s_lshr_b32 s91, s90, 4
    s_lshl_b32 s77, s89, 1
    s_add_u32 s77, s77, s91
    s_and_b32 s78, s90, 15
    s_mov_b32 s6, 0x200000
    s_mov_b32 s7, 0x00020000
    s_mov_b32 s10, 0x180000
    s_mov_b32 s11, 0x00020000
    s_mov_b32 s42, 0x2800000
    s_mov_b32 s43, 0x00020000
    s_getpc_b64 s[94:95]
L_PC:
    s_sub_u32 s96, s94, L_PC-interleave_layers__sliding_block__mixer_token_mlp__prompt_kernel
    s_subb_u32 s97, s95, 0
    s_mov_b32 s98, L_WARM_END-interleave_layers__sliding_block__mixer_token_mlp__prompt_kernel
    s_mov_b32 s99, 0x00020000
    s_lshl_b32 s91, s90, 2
    s_add_u32 s91, s91, s76
    s_lshl_b32 s91, s91, 13
    v_lshlrev_b32 v1, 7, v0
    buffer_load_dword v1, v1, s[96:99], s91 offen
    s_waitcnt lgkmcnt(0)
    s_lshl_b32 s91, s2, 2
    s_add_u32 s91, s91, s76
    s_lshl_b32 s91, s91, 13
    v_lshlrev_b32 v2, 7, v0
    buffer_load_dword v2, v2, s[8:11], s91 offen
    v_lshrrev_b32 v132, 5, v0
    v_and_b32 v232, 31, v0
    v_xor_b32 v232, v232, v132
    v_lshlrev_b32 v232, 4, v232
    v_lshlrev_b32 v132, 10, v132
    v_add_u32 v232, v232, v132
    v_xor_b32 v233, 32, v232
    v_xor_b32 v234, 64, v232
    v_xor_b32 v235, 96, v232
    v_xor_b32 v236, 128, v232
    v_xor_b32 v237, 160, v232
    v_xor_b32 v238, 192, v232
    v_xor_b32 v239, 224, v232
    s_lshl_b32 s86, s77, 7
    s_lshl_b32 s90, s76, 5
    s_add_u32 s86, s86, s90
    s_lshl_b32 s86, s86, 10
    s_lshl_b32 s87, s76, 14
    s_add_u32 s87, s87, 0xf000
    s_add_u32 s89, s86, 0x0
    s_add_u32 m0, s87, 0
    s_nop 0
    buffer_load_dwordx4 v232, s[4:7], s89 offen nt lds
    s_add_u32 s89, s86, 0x800
    s_add_u32 m0, s87, 1024
    s_nop 0
    buffer_load_dwordx4 v233, s[4:7], s89 offen nt lds
    s_add_u32 s89, s86, 0x1000
    s_add_u32 m0, s87, 2048
    s_nop 0
    buffer_load_dwordx4 v234, s[4:7], s89 offen nt lds
    s_add_u32 s89, s86, 0x1800
    s_add_u32 m0, s87, 3072
    s_nop 0
    buffer_load_dwordx4 v235, s[4:7], s89 offen nt lds
    s_add_u32 s89, s86, 0x2000
    s_add_u32 m0, s87, 4096
    s_nop 0
    buffer_load_dwordx4 v236, s[4:7], s89 offen nt lds
    s_add_u32 s89, s86, 0x2800
    s_add_u32 m0, s87, 5120
    s_nop 0
    buffer_load_dwordx4 v237, s[4:7], s89 offen nt lds
    s_add_u32 s89, s86, 0x3000
    s_add_u32 m0, s87, 6144
    s_nop 0
    buffer_load_dwordx4 v238, s[4:7], s89 offen nt lds
    s_add_u32 s89, s86, 0x3800
    s_add_u32 m0, s87, 7168
    s_nop 0
    buffer_load_dwordx4 v239, s[4:7], s89 offen nt lds
    s_add_u32 s89, s86, 0x4000
    s_add_u32 m0, s87, 8192
    s_nop 0
    buffer_load_dwordx4 v232, s[4:7], s89 offen nt lds
    s_add_u32 s89, s86, 0x4800
    s_add_u32 m0, s87, 9216
    s_nop 0
    buffer_load_dwordx4 v233, s[4:7], s89 offen nt lds
    s_add_u32 s89, s86, 0x5000
    s_add_u32 m0, s87, 10240
    s_nop 0
    buffer_load_dwordx4 v234, s[4:7], s89 offen nt lds
    s_add_u32 s89, s86, 0x5800
    s_add_u32 m0, s87, 11264
    s_nop 0
    buffer_load_dwordx4 v235, s[4:7], s89 offen nt lds
    s_add_u32 s89, s86, 0x6000
    s_add_u32 m0, s87, 12288
    s_nop 0
    buffer_load_dwordx4 v236, s[4:7], s89 offen nt lds
    s_add_u32 s89, s86, 0x6800
    s_add_u32 m0, s87, 13312
    s_nop 0
    buffer_load_dwordx4 v237, s[4:7], s89 offen nt lds
    s_add_u32 s89, s86, 0x7000
    s_add_u32 m0, s87, 14336
    s_nop 0
    buffer_load_dwordx4 v238, s[4:7], s89 offen nt lds
    s_add_u32 s89, s86, 0x7800
    s_add_u32 m0, s87, 15360
    s_nop 0
    buffer_load_dwordx4 v239, s[4:7], s89 offen nt lds
    s_add_u32 s89, s86, 0x0
    buffer_load_dwordx4 v[144:147], v232, s[4:7], s89 offen offset:512 nt
    s_add_u32 s89, s86, 0x800
    buffer_load_dwordx4 v[148:151], v233, s[4:7], s89 offen offset:512 nt
    s_add_u32 s89, s86, 0x1000
    buffer_load_dwordx4 v[152:155], v234, s[4:7], s89 offen offset:512 nt
    s_add_u32 s89, s86, 0x1800
    buffer_load_dwordx4 v[156:159], v235, s[4:7], s89 offen offset:512 nt
    s_add_u32 s89, s86, 0x2000
    buffer_load_dwordx4 v[160:163], v236, s[4:7], s89 offen offset:512 nt
    s_add_u32 s89, s86, 0x2800
    buffer_load_dwordx4 v[164:167], v237, s[4:7], s89 offen offset:512 nt
    s_add_u32 s89, s86, 0x3000
    buffer_load_dwordx4 v[168:171], v238, s[4:7], s89 offen offset:512 nt
    s_add_u32 s89, s86, 0x3800
    buffer_load_dwordx4 v[172:175], v239, s[4:7], s89 offen offset:512 nt
    s_add_u32 s89, s86, 0x4000
    buffer_load_dwordx4 v[176:179], v232, s[4:7], s89 offen offset:512 nt
    s_add_u32 s89, s86, 0x4800
    buffer_load_dwordx4 v[180:183], v233, s[4:7], s89 offen offset:512 nt
    s_add_u32 s89, s86, 0x5000
    buffer_load_dwordx4 v[184:187], v234, s[4:7], s89 offen offset:512 nt
    s_add_u32 s89, s86, 0x5800
    buffer_load_dwordx4 v[188:191], v235, s[4:7], s89 offen offset:512 nt
    s_add_u32 s89, s86, 0x6000
    buffer_load_dwordx4 v[192:195], v236, s[4:7], s89 offen offset:512 nt
    s_add_u32 s89, s86, 0x6800
    buffer_load_dwordx4 v[196:199], v237, s[4:7], s89 offen offset:512 nt
    s_add_u32 s89, s86, 0x7000
    buffer_load_dwordx4 v[200:203], v238, s[4:7], s89 offen offset:512 nt
    s_add_u32 s89, s86, 0x7800
    buffer_load_dwordx4 v[204:207], v239, s[4:7], s89 offen offset:512 nt
    s_mov_b32 s14, 0x80000
    s_mov_b32 s15, 0x00020000
    s_mov_b32 s18, 0x560000
    s_mov_b32 s19, 0x00020000
    s_mov_b32 s22, 0xac0
    s_mov_b32 s23, 0x00020000
    s_mov_b32 s26, 0x560000
    s_mov_b32 s27, 0x00020000
    s_mov_b32 s30, 0x1000
    s_mov_b32 s31, 0x00020000
    s_mov_b32 s34, 0x200000
    s_mov_b32 s35, 0x00020000
    s_mov_b32 s38, 0x100
    s_mov_b32 s39, 0x00020000
    s_lshl_b32 s91, s2, 2
    s_add_u32 s91, s91, s76
    s_lshl_b32 s91, s91, 13
    v_lshlrev_b32 v3, 7, v0
    buffer_load_dword v3, v3, s[12:15], s91 offen
    s_and_b32 s89, s2, 7
    s_lshr_b32 s90, s2, 3
    s_lshr_b32 s91, s90, 3
    s_lshl_b32 s79, s89, 2
    s_add_u32 s79, s79, s91
    s_mul_i32 s0, s91, 0
    s_and_b32 s80, s90, 7
    s_and_b32 s91, s89, 1
    s_lshl_b32 s81, s91, 2
    s_and_b32 s91, s90, 3
    s_add_u32 s81, s81, s91
    s_lshr_b32 s82, s89, 1
    s_lshl_b32 s82, s82, 3
    s_lshr_b32 s91, s90, 2
    s_add_u32 s82, s82, s91
    s_mul_i32 s3, s91, 0
    s_lshr_b32 s100, s76, 1
    s_and_b32 s101, s76, 1
    s_lshl_b32 s91, s77, 2
    s_add_u32 s91, s91, s76
    s_min_u32 s91, s91, 8
    s_sub_u32 s83, 8, s91
    s_mov_b32 s84, 100000
    s_mov_b32 s85, 0x3f803f80
    s_mov_b32 s93, 0
    v_add_u32 v139, 0, v0
    v_mul_u32_u24 v140, 171, v139
    v_lshrrev_b32 v140, 11, v140
    v_mul_u32_u24 v141, 12, v140
    v_sub_u32 v141, v139, v141
    v_mul_u32_u24 v136, 0xac0, v140
    v_lshlrev_b32 v141, 4, v141
    v_add_u32 v136, v136, v141
    v_add_u32 v139, 64, v0
    v_mul_u32_u24 v140, 171, v139
    v_lshrrev_b32 v140, 11, v140
    v_mul_u32_u24 v141, 12, v140
    v_sub_u32 v141, v139, v141
    v_mul_u32_u24 v137, 0xac0, v140
    v_lshlrev_b32 v141, 4, v141
    v_add_u32 v137, v137, v141
    v_add_u32 v139, 128, v0
    v_mul_u32_u24 v140, 171, v139
    v_lshrrev_b32 v140, 11, v140
    v_mul_u32_u24 v141, 12, v140
    v_sub_u32 v141, v139, v141
    v_mul_u32_u24 v138, 0xac0, v140
    v_lshlrev_b32 v141, 4, v141
    v_add_u32 v138, v138, v141
    s_and_b32 s89, s2, 63
    s_mul_i32 s89, s89, 88064
    s_lshr_b32 s90, s2, 6
    s_lshl_b32 s90, s90, 2
    s_add_u32 s90, s90, s76
    s_mul_i32 s90, s90, 192
    s_add_u32 s89, s89, s90
    s_add_u32 s90, s89, 0x0
    buffer_load_dwordx4 a[0:3], v136, s[16:19], s90 offen nt
    buffer_load_dwordx4 a[4:7], v137, s[16:19], s90 offen nt
    buffer_load_dwordx4 a[8:11], v138, s[16:19], s90 offen nt
    s_add_u32 s90, s89, 0xac00
    buffer_load_dwordx4 a[12:15], v136, s[16:19], s90 offen nt
    buffer_load_dwordx4 a[16:19], v137, s[16:19], s90 offen nt
    buffer_load_dwordx4 a[20:23], v138, s[16:19], s90 offen nt
    v_mov_b32 v246, -1
    v_mov_b32 v247, -1
    v_mov_b32 v248, -1
    v_mov_b32 v249, -1
    v_lshlrev_b32 v250, 4, v0
    v_lshlrev_b32 v251, 3, v0
    v_and_b32 v252, 31, v0
    v_lshlrev_b32 v252, 3, v252
    s_lshl_b32 s96, s78, 18
    s_lshl_b32 s92, s77, 12
    s_add_u32 s96, s96, s92
    s_lshl_b32 s92, s76, 10
    s_add_u32 s96, s96, s92
    buffer_store_dwordx4 v[246:249], v250, s[40:43], s96 offen offset:0 sc1
    s_add_u32 s97, s96, 0x10000
    buffer_store_dwordx4 v[246:249], v250, s[40:43], s97 offen offset:0 sc1
    s_add_u32 s97, s96, 0x20000
    buffer_store_dwordx4 v[246:249], v250, s[40:43], s97 offen offset:0 sc1
    s_add_u32 s97, s96, 0x30000
    buffer_store_dwordx4 v[246:249], v250, s[40:43], s97 offen offset:0 sc1
    s_lshl_b32 s96, s2, 7
    s_add_u32 s96, s96, 0x1900000
    v_mov_b32 v254, 0
    v_mov_b32 v255, 0
    buffer_store_dwordx2 v[254:255], v254, s[40:43], s96 offen offset:0 sc1
    v_add_u32 v243, 0, v0
    v_mul_u32_u24 v244, 171, v243
    v_lshrrev_b32 v244, 11, v244
    v_mul_u32_u24 v245, 12, v244
    v_sub_u32 v245, v243, v245
    v_mul_u32_u24 v240, 0xc00, v244
    v_lshrrev_b32 v243, 2, v245
    v_lshlrev_b32 v243, 10, v243
    v_add_u32 v240, v240, v243
    v_and_b32 v245, 3, v245
    v_lshlrev_b32 v245, 4, v245
    v_add_u32 v240, v240, v245
    v_add_u32 v243, 64, v0
    v_mul_u32_u24 v244, 171, v243
    v_lshrrev_b32 v244, 11, v244
    v_mul_u32_u24 v245, 12, v244
    v_sub_u32 v245, v243, v245
    v_mul_u32_u24 v241, 0xc00, v244
    v_lshrrev_b32 v243, 2, v245
    v_lshlrev_b32 v243, 10, v243
    v_add_u32 v241, v241, v243
    v_and_b32 v245, 3, v245
    v_lshlrev_b32 v245, 4, v245
    v_add_u32 v241, v241, v245
    v_add_u32 v243, 128, v0
    v_mul_u32_u24 v244, 171, v243
    v_lshrrev_b32 v244, 11, v244
    v_mul_u32_u24 v245, 12, v244
    v_sub_u32 v245, v243, v245
    v_mul_u32_u24 v242, 0xc00, v244
    v_lshrrev_b32 v243, 2, v245
    v_lshlrev_b32 v243, 10, v243
    v_add_u32 v242, v242, v243
    v_and_b32 v245, 3, v245
    v_lshlrev_b32 v245, 4, v245
    v_add_u32 v242, v242, v245
    s_mul_i32 s96, s76, 393216
    s_lshl_b32 s97, s78, 6
    s_add_u32 s96, s96, s97
    s_mul_i32 s97, s76, 24576
    s_add_u32 s92, s77, 0
    s_and_b32 s92, s92, 7
    s_mul_i32 s1, s92, 3072
    s_add_u32 s1, s1, s97
    s_cmp_lt_u32 s1, 36864
    s_mov_b32 s91, 0xffff7000
    s_cselect_b32 s91, 0x1f000, s91
    s_add_u32 s1, s1, s91
    s_mul_i32 s92, s92, 49152
    s_add_u32 s92, s92, s96
    s_add_u32 m0, s1, 0
    s_nop 0
    buffer_load_dwordx4 v240, s[8:11], s92 offen lds
    v_and_b32 v232, 31, v0
    v_lshrrev_b32 v132, 5, v0
    v_and_b32 v233, 15, v232
    v_xor_b32 v132, v132, v233
    v_lshlrev_b32 v132, 4, v132
    v_lshlrev_b32 v232, 9, v232
    v_add_u32 v232, v232, v132
    v_add_u32 v232, s87, v232
    v_xor_b32 v233, 32, v232
    v_xor_b32 v234, 64, v232
    v_xor_b32 v235, 96, v232
    v_xor_b32 v236, 128, v232
    v_xor_b32 v237, 160, v232
    v_xor_b32 v238, 192, v232
    v_xor_b32 v239, 224, v232
    v_lshlrev_b32 v141, 4, v0
    v_add_u32 v141, s87, v141
    v_mov_b32 v122, 0
    v_mov_b32 v123, 0
    v_mov_b32 v124, 0
    v_mov_b32 v125, 0
    v_mov_b32 v126, 0
    v_mov_b32 v127, 0
    v_mov_b32 v128, 0
    s_waitcnt vmcnt(29)
    ds_read_b128 v[58:61], v232 offset:0
    ds_read_b128 v[62:65], v233 offset:0
    ds_read_b128 v[66:69], v234 offset:0
    ds_read_b128 v[70:73], v235 offset:0
    ds_read_b128 v[74:77], v236 offset:0
    ds_read_b128 v[78:81], v237 offset:0
    ds_read_b128 v[82:85], v238 offset:0
    ds_read_b128 v[86:89], v239 offset:0
    s_add_u32 m0, s1, 1024
    s_nop 0
    buffer_load_dwordx4 v241, s[8:11], s92 offen lds
    ds_read_b128 v[90:93], v232 offset:256
    ds_read_b128 v[94:97], v233 offset:256
    ds_read_b128 v[98:101], v234 offset:256
    ds_read_b128 v[102:105], v235 offset:256
    ds_read_b128 v[106:109], v236 offset:256
    s_waitcnt lgkmcnt(11)
    ds_read_b128 v[110:113], v237 offset:256
    ds_read_b128 v[114:117], v238 offset:256
    s_waitcnt lgkmcnt(11)
    ds_read_b128 v[118:121], v239 offset:256
    s_add_u32 m0, s1, 2048
    s_nop 0
    buffer_load_dwordx4 v242, s[8:11], s92 offen lds
    s_waitcnt lgkmcnt(0)
    s_waitcnt vmcnt(30)
    ds_write_b128 v141, v[144:147] offset:0
    s_waitcnt vmcnt(29)
    ds_write_b128 v141, v[148:151] offset:1024
    s_waitcnt vmcnt(28)
    ds_write_b128 v141, v[152:155] offset:2048
    s_waitcnt vmcnt(27)
    ds_write_b128 v141, v[156:159] offset:3072
    s_waitcnt vmcnt(26)
    ds_write_b128 v141, v[160:163] offset:4096
    s_waitcnt vmcnt(25)
    ds_write_b128 v141, v[164:167] offset:5120
    s_waitcnt vmcnt(24)
    ds_write_b128 v141, v[168:171] offset:6144
    s_waitcnt vmcnt(23)
    ds_write_b128 v141, v[172:175] offset:7168
    s_waitcnt vmcnt(22)
    ds_write_b128 v141, v[176:179] offset:8192
    s_waitcnt lgkmcnt(7)
    s_waitcnt vmcnt(21)
    ds_write_b128 v141, v[180:183] offset:9216
    s_waitcnt vmcnt(20)
    ds_write_b128 v141, v[184:187] offset:10240
    s_waitcnt lgkmcnt(7)
    s_waitcnt vmcnt(19)
    ds_write_b128 v141, v[188:191] offset:11264
    s_waitcnt vmcnt(18)
    ds_write_b128 v141, v[192:195] offset:12288
    s_waitcnt lgkmcnt(7)
    s_waitcnt vmcnt(17)
    ds_write_b128 v141, v[196:199] offset:13312
    s_waitcnt vmcnt(16)
    ds_write_b128 v141, v[200:203] offset:14336
    s_waitcnt lgkmcnt(7)
    s_waitcnt vmcnt(15)
    ds_write_b128 v141, v[204:207] offset:15360
    v_dot2_f32_bf16 v122, v58, s85, v122
    v_dot2_f32_bf16 v124, v58, v58, v124
    v_dot2_f32_bf16 v123, v59, s85, v123
    v_dot2_f32_bf16 v125, v59, v59, v125
    v_dot2_f32_bf16 v122, v60, s85, v122
    v_dot2_f32_bf16 v124, v60, v60, v124
    v_dot2_f32_bf16 v123, v61, s85, v123
    v_dot2_f32_bf16 v125, v61, v61, v125
    v_dot2_f32_bf16 v122, v62, s85, v122
    v_dot2_f32_bf16 v124, v62, v62, v124
    v_dot2_f32_bf16 v123, v63, s85, v123
    v_dot2_f32_bf16 v125, v63, v63, v125
    s_add_u32 s92, s77, 1
    s_and_b32 s92, s92, 7
    s_mul_i32 s1, s92, 3072
    s_add_u32 s1, s1, s97
    s_cmp_lt_u32 s1, 36864
    s_mov_b32 s91, 0xffff7000
    s_cselect_b32 s91, 0x1f000, s91
    s_add_u32 s1, s1, s91
    s_mul_i32 s92, s92, 49152
    s_add_u32 s92, s92, s96
    s_add_u32 m0, s1, 0
    s_nop 0
    buffer_load_dwordx4 v240, s[8:11], s92 offen lds
    v_dot2_f32_bf16 v122, v64, s85, v122
    v_dot2_f32_bf16 v124, v64, v64, v124
    v_dot2_f32_bf16 v123, v65, s85, v123
    v_dot2_f32_bf16 v125, v65, v65, v125
    v_dot2_f32_bf16 v122, v66, s85, v122
    v_dot2_f32_bf16 v124, v66, v66, v124
    v_dot2_f32_bf16 v123, v67, s85, v123
    v_dot2_f32_bf16 v125, v67, v67, v125
    v_dot2_f32_bf16 v122, v68, s85, v122
    v_dot2_f32_bf16 v124, v68, v68, v124
    v_dot2_f32_bf16 v123, v69, s85, v123
    v_dot2_f32_bf16 v125, v69, v69, v125
    s_add_u32 m0, s1, 1024
    s_nop 0
    buffer_load_dwordx4 v241, s[8:11], s92 offen lds
    v_dot2_f32_bf16 v122, v70, s85, v122
    v_dot2_f32_bf16 v124, v70, v70, v124
    v_dot2_f32_bf16 v123, v71, s85, v123
    v_dot2_f32_bf16 v125, v71, v71, v125
    v_dot2_f32_bf16 v122, v72, s85, v122
    v_dot2_f32_bf16 v124, v72, v72, v124
    v_dot2_f32_bf16 v123, v73, s85, v123
    v_dot2_f32_bf16 v125, v73, v73, v125
    v_dot2_f32_bf16 v122, v74, s85, v122
    v_dot2_f32_bf16 v124, v74, v74, v124
    v_dot2_f32_bf16 v123, v75, s85, v123
    v_dot2_f32_bf16 v125, v75, v75, v125
    s_add_u32 m0, s1, 2048
    s_nop 0
    buffer_load_dwordx4 v242, s[8:11], s92 offen lds
    v_dot2_f32_bf16 v122, v76, s85, v122
    v_dot2_f32_bf16 v124, v76, v76, v124
    v_dot2_f32_bf16 v123, v77, s85, v123
    v_dot2_f32_bf16 v125, v77, v77, v125
    v_dot2_f32_bf16 v122, v78, s85, v122
    v_dot2_f32_bf16 v124, v78, v78, v124
    v_dot2_f32_bf16 v123, v79, s85, v123
    v_dot2_f32_bf16 v125, v79, v79, v125
    v_dot2_f32_bf16 v122, v80, s85, v122
    v_dot2_f32_bf16 v124, v80, v80, v124
    v_dot2_f32_bf16 v123, v81, s85, v123
    v_dot2_f32_bf16 v125, v81, v81, v125
    s_add_u32 s92, s77, 2
    s_and_b32 s92, s92, 7
    s_mul_i32 s1, s92, 3072
    s_add_u32 s1, s1, s97
    s_cmp_lt_u32 s1, 36864
    s_mov_b32 s91, 0xffff7000
    s_cselect_b32 s91, 0x1f000, s91
    s_add_u32 s1, s1, s91
    s_mul_i32 s92, s92, 49152
    s_add_u32 s92, s92, s96
    s_add_u32 m0, s1, 0
    s_nop 0
    buffer_load_dwordx4 v240, s[8:11], s92 offen lds
    v_dot2_f32_bf16 v122, v82, s85, v122
    v_dot2_f32_bf16 v124, v82, v82, v124
    v_dot2_f32_bf16 v123, v83, s85, v123
    v_dot2_f32_bf16 v125, v83, v83, v125
    v_dot2_f32_bf16 v122, v84, s85, v122
    v_dot2_f32_bf16 v124, v84, v84, v124
    v_dot2_f32_bf16 v123, v85, s85, v123
    v_dot2_f32_bf16 v125, v85, v85, v125
    v_dot2_f32_bf16 v122, v86, s85, v122
    v_dot2_f32_bf16 v124, v86, v86, v124
    v_dot2_f32_bf16 v123, v87, s85, v123
    v_dot2_f32_bf16 v125, v87, v87, v125
    s_add_u32 m0, s1, 1024
    s_nop 0
    buffer_load_dwordx4 v241, s[8:11], s92 offen lds
    v_dot2_f32_bf16 v122, v88, s85, v122
    v_dot2_f32_bf16 v124, v88, v88, v124
    v_dot2_f32_bf16 v123, v89, s85, v123
    v_dot2_f32_bf16 v125, v89, v89, v125
    v_dot2_f32_bf16 v122, v90, s85, v122
    v_dot2_f32_bf16 v124, v90, v90, v124
    v_dot2_f32_bf16 v123, v91, s85, v123
    v_dot2_f32_bf16 v125, v91, v91, v125
    v_dot2_f32_bf16 v122, v92, s85, v122
    v_dot2_f32_bf16 v124, v92, v92, v124
    v_dot2_f32_bf16 v123, v93, s85, v123
    v_dot2_f32_bf16 v125, v93, v93, v125
    s_add_u32 m0, s1, 2048
    s_nop 0
    buffer_load_dwordx4 v242, s[8:11], s92 offen lds
    v_dot2_f32_bf16 v122, v94, s85, v122
    v_dot2_f32_bf16 v124, v94, v94, v124
    v_dot2_f32_bf16 v123, v95, s85, v123
    v_dot2_f32_bf16 v125, v95, v95, v125
    v_dot2_f32_bf16 v122, v96, s85, v122
    v_dot2_f32_bf16 v124, v96, v96, v124
    v_dot2_f32_bf16 v123, v97, s85, v123
    v_dot2_f32_bf16 v125, v97, v97, v125
    v_dot2_f32_bf16 v122, v98, s85, v122
    v_dot2_f32_bf16 v124, v98, v98, v124
    v_dot2_f32_bf16 v123, v99, s85, v123
    v_dot2_f32_bf16 v125, v99, v99, v125
    s_add_u32 s92, s77, 3
    s_and_b32 s92, s92, 7
    s_mul_i32 s1, s92, 3072
    s_add_u32 s1, s1, s97
    s_cmp_lt_u32 s1, 36864
    s_mov_b32 s91, 0xffff7000
    s_cselect_b32 s91, 0x1f000, s91
    s_add_u32 s1, s1, s91
    s_mul_i32 s92, s92, 49152
    s_add_u32 s92, s92, s96
    s_add_u32 m0, s1, 0
    s_nop 0
    buffer_load_dwordx4 v240, s[8:11], s92 offen lds
    v_dot2_f32_bf16 v122, v100, s85, v122
    v_dot2_f32_bf16 v124, v100, v100, v124
    v_dot2_f32_bf16 v123, v101, s85, v123
    v_dot2_f32_bf16 v125, v101, v101, v125
    v_dot2_f32_bf16 v122, v102, s85, v122
    v_dot2_f32_bf16 v124, v102, v102, v124
    v_dot2_f32_bf16 v123, v103, s85, v123
    v_dot2_f32_bf16 v125, v103, v103, v125
    v_dot2_f32_bf16 v122, v104, s85, v122
    v_dot2_f32_bf16 v124, v104, v104, v124
    v_dot2_f32_bf16 v123, v105, s85, v123
    v_dot2_f32_bf16 v125, v105, v105, v125
    s_add_u32 m0, s1, 1024
    s_nop 0
    buffer_load_dwordx4 v241, s[8:11], s92 offen lds
    v_dot2_f32_bf16 v122, v106, s85, v122
    v_dot2_f32_bf16 v124, v106, v106, v124
    v_dot2_f32_bf16 v123, v107, s85, v123
    v_dot2_f32_bf16 v125, v107, v107, v125
    v_dot2_f32_bf16 v122, v108, s85, v122
    v_dot2_f32_bf16 v124, v108, v108, v124
    v_dot2_f32_bf16 v123, v109, s85, v123
    v_dot2_f32_bf16 v125, v109, v109, v125
    v_dot2_f32_bf16 v122, v110, s85, v122
    v_dot2_f32_bf16 v124, v110, v110, v124
    v_dot2_f32_bf16 v123, v111, s85, v123
    v_dot2_f32_bf16 v125, v111, v111, v125
    s_add_u32 m0, s1, 2048
    s_nop 0
    buffer_load_dwordx4 v242, s[8:11], s92 offen lds
    v_dot2_f32_bf16 v122, v112, s85, v122
    v_dot2_f32_bf16 v124, v112, v112, v124
    v_dot2_f32_bf16 v123, v113, s85, v123
    v_dot2_f32_bf16 v125, v113, v113, v125
    v_dot2_f32_bf16 v122, v114, s85, v122
    v_dot2_f32_bf16 v124, v114, v114, v124
    v_dot2_f32_bf16 v123, v115, s85, v123
    v_dot2_f32_bf16 v125, v115, v115, v125
    v_dot2_f32_bf16 v122, v116, s85, v122
    v_dot2_f32_bf16 v124, v116, v116, v124
    v_dot2_f32_bf16 v123, v117, s85, v123
    v_dot2_f32_bf16 v125, v117, v117, v125
    s_add_u32 s92, s77, 4
    s_and_b32 s92, s92, 7
    s_mul_i32 s1, s92, 3072
    s_add_u32 s1, s1, s97
    s_cmp_lt_u32 s1, 36864
    s_mov_b32 s91, 0xffff7000
    s_cselect_b32 s91, 0x1f000, s91
    s_add_u32 s1, s1, s91
    s_mul_i32 s92, s92, 49152
    s_add_u32 s92, s92, s96
    s_add_u32 m0, s1, 0
    s_nop 0
    buffer_load_dwordx4 v240, s[8:11], s92 offen lds
    v_dot2_f32_bf16 v122, v118, s85, v122
    v_dot2_f32_bf16 v124, v118, v118, v124
    v_dot2_f32_bf16 v123, v119, s85, v123
    v_dot2_f32_bf16 v125, v119, v119, v125
    v_dot2_f32_bf16 v122, v120, s85, v122
    v_dot2_f32_bf16 v124, v120, v120, v124
    v_dot2_f32_bf16 v123, v121, s85, v123
    v_dot2_f32_bf16 v125, v121, v121, v125
    ds_read_b128 v[144:147], v232 offset:0
    ds_read_b128 v[148:151], v233 offset:0
    ds_read_b128 v[152:155], v234 offset:0
    ds_read_b128 v[156:159], v235 offset:0
    ds_read_b128 v[160:163], v236 offset:0
    s_waitcnt lgkmcnt(11)
    ds_read_b128 v[164:167], v237 offset:0
    ds_read_b128 v[168:171], v238 offset:0
    s_waitcnt lgkmcnt(11)
    ds_read_b128 v[172:175], v239 offset:0
    s_add_u32 m0, s1, 1024
    s_nop 0
    buffer_load_dwordx4 v241, s[8:11], s92 offen lds
    ds_read_b128 v[176:179], v232 offset:256
    s_waitcnt lgkmcnt(11)
    ds_read_b128 v[180:183], v233 offset:256
    ds_read_b128 v[184:187], v234 offset:256
    s_waitcnt lgkmcnt(11)
    ds_read_b128 v[188:191], v235 offset:256
    ds_read_b128 v[192:195], v236 offset:256
    s_waitcnt lgkmcnt(11)
    ds_read_b128 v[196:199], v237 offset:256
    ds_read_b128 v[200:203], v238 offset:256
    s_waitcnt lgkmcnt(11)
    ds_read_b128 v[204:207], v239 offset:256
    s_add_u32 m0, s1, 2048
    s_nop 0
    buffer_load_dwordx4 v242, s[8:11], s92 offen lds
    s_waitcnt lgkmcnt(0)
    v_dot2_f32_bf16 v122, v144, s85, v122
    v_dot2_f32_bf16 v124, v144, v144, v124
    v_dot2_f32_bf16 v123, v145, s85, v123
    v_dot2_f32_bf16 v125, v145, v145, v125
    v_dot2_f32_bf16 v122, v146, s85, v122
    v_dot2_f32_bf16 v124, v146, v146, v124
    v_dot2_f32_bf16 v123, v147, s85, v123
    v_dot2_f32_bf16 v125, v147, v147, v125
    v_dot2_f32_bf16 v122, v148, s85, v122
    v_dot2_f32_bf16 v124, v148, v148, v124
    v_dot2_f32_bf16 v123, v149, s85, v123
    v_dot2_f32_bf16 v125, v149, v149, v125
    s_add_u32 s92, s77, 5
    s_and_b32 s92, s92, 7
    s_mul_i32 s1, s92, 3072
    s_add_u32 s1, s1, s97
    s_cmp_lt_u32 s1, 36864
    s_mov_b32 s91, 0xffff7000
    s_cselect_b32 s91, 0x1f000, s91
    s_add_u32 s1, s1, s91
    s_mul_i32 s92, s92, 49152
    s_add_u32 s92, s92, s96
    s_add_u32 m0, s1, 0
    s_nop 0
    buffer_load_dwordx4 v240, s[8:11], s92 offen lds
    v_dot2_f32_bf16 v122, v150, s85, v122
    v_dot2_f32_bf16 v124, v150, v150, v124
    v_dot2_f32_bf16 v123, v151, s85, v123
    v_dot2_f32_bf16 v125, v151, v151, v125
    v_dot2_f32_bf16 v122, v152, s85, v122
    v_dot2_f32_bf16 v124, v152, v152, v124
    v_dot2_f32_bf16 v123, v153, s85, v123
    v_dot2_f32_bf16 v125, v153, v153, v125
    v_dot2_f32_bf16 v122, v154, s85, v122
    v_dot2_f32_bf16 v124, v154, v154, v124
    v_dot2_f32_bf16 v123, v155, s85, v123
    v_dot2_f32_bf16 v125, v155, v155, v125
    s_add_u32 m0, s1, 1024
    s_nop 0
    buffer_load_dwordx4 v241, s[8:11], s92 offen lds
    v_dot2_f32_bf16 v122, v156, s85, v122
    v_dot2_f32_bf16 v124, v156, v156, v124
    v_dot2_f32_bf16 v123, v157, s85, v123
    v_dot2_f32_bf16 v125, v157, v157, v125
    v_dot2_f32_bf16 v122, v158, s85, v122
    v_dot2_f32_bf16 v124, v158, v158, v124
    v_dot2_f32_bf16 v123, v159, s85, v123
    v_dot2_f32_bf16 v125, v159, v159, v125
    v_dot2_f32_bf16 v122, v160, s85, v122
    v_dot2_f32_bf16 v124, v160, v160, v124
    v_dot2_f32_bf16 v123, v161, s85, v123
    v_dot2_f32_bf16 v125, v161, v161, v125
    s_add_u32 m0, s1, 2048
    s_nop 0
    buffer_load_dwordx4 v242, s[8:11], s92 offen lds
    v_dot2_f32_bf16 v122, v162, s85, v122
    v_dot2_f32_bf16 v124, v162, v162, v124
    v_dot2_f32_bf16 v123, v163, s85, v123
    v_dot2_f32_bf16 v125, v163, v163, v125
    v_dot2_f32_bf16 v122, v164, s85, v122
    v_dot2_f32_bf16 v124, v164, v164, v124
    v_dot2_f32_bf16 v123, v165, s85, v123
    v_dot2_f32_bf16 v125, v165, v165, v125
    v_dot2_f32_bf16 v122, v166, s85, v122
    v_dot2_f32_bf16 v124, v166, v166, v124
    v_dot2_f32_bf16 v123, v167, s85, v123
    v_dot2_f32_bf16 v125, v167, v167, v125
    s_add_u32 s92, s77, 6
    s_and_b32 s92, s92, 7
    s_mul_i32 s1, s92, 3072
    s_add_u32 s1, s1, s97
    s_cmp_lt_u32 s1, 36864
    s_mov_b32 s91, 0xffff7000
    s_cselect_b32 s91, 0x1f000, s91
    s_add_u32 s1, s1, s91
    s_mul_i32 s92, s92, 49152
    s_add_u32 s92, s92, s96
    s_add_u32 m0, s1, 0
    s_nop 0
    buffer_load_dwordx4 v240, s[8:11], s92 offen lds
    v_dot2_f32_bf16 v122, v168, s85, v122
    v_dot2_f32_bf16 v124, v168, v168, v124
    v_dot2_f32_bf16 v123, v169, s85, v123
    v_dot2_f32_bf16 v125, v169, v169, v125
    v_dot2_f32_bf16 v122, v170, s85, v122
    v_dot2_f32_bf16 v124, v170, v170, v124
    v_dot2_f32_bf16 v123, v171, s85, v123
    v_dot2_f32_bf16 v125, v171, v171, v125
    v_dot2_f32_bf16 v122, v172, s85, v122
    v_dot2_f32_bf16 v124, v172, v172, v124
    v_dot2_f32_bf16 v123, v173, s85, v123
    v_dot2_f32_bf16 v125, v173, v173, v125
    s_add_u32 m0, s1, 1024
    s_nop 0
    buffer_load_dwordx4 v241, s[8:11], s92 offen lds
    v_dot2_f32_bf16 v122, v174, s85, v122
    v_dot2_f32_bf16 v124, v174, v174, v124
    v_dot2_f32_bf16 v123, v175, s85, v123
    v_dot2_f32_bf16 v125, v175, v175, v125
    v_dot2_f32_bf16 v122, v176, s85, v122
    v_dot2_f32_bf16 v124, v176, v176, v124
    v_dot2_f32_bf16 v123, v177, s85, v123
    v_dot2_f32_bf16 v125, v177, v177, v125
    v_dot2_f32_bf16 v122, v178, s85, v122
    v_dot2_f32_bf16 v124, v178, v178, v124
    v_dot2_f32_bf16 v123, v179, s85, v123
    v_dot2_f32_bf16 v125, v179, v179, v125
    s_add_u32 m0, s1, 2048
    s_nop 0
    buffer_load_dwordx4 v242, s[8:11], s92 offen lds
    v_dot2_f32_bf16 v122, v180, s85, v122
    v_dot2_f32_bf16 v124, v180, v180, v124
    v_dot2_f32_bf16 v123, v181, s85, v123
    v_dot2_f32_bf16 v125, v181, v181, v125
    v_dot2_f32_bf16 v122, v182, s85, v122
    v_dot2_f32_bf16 v124, v182, v182, v124
    v_dot2_f32_bf16 v123, v183, s85, v123
    v_dot2_f32_bf16 v125, v183, v183, v125
    v_dot2_f32_bf16 v122, v184, s85, v122
    v_dot2_f32_bf16 v124, v184, v184, v124
    v_dot2_f32_bf16 v123, v185, s85, v123
    v_dot2_f32_bf16 v125, v185, v185, v125
    s_add_u32 s92, s77, 7
    s_and_b32 s92, s92, 7
    s_mul_i32 s1, s92, 3072
    s_add_u32 s1, s1, s97
    s_cmp_lt_u32 s1, 36864
    s_mov_b32 s91, 0xffff7000
    s_cselect_b32 s91, 0x1f000, s91
    s_add_u32 s1, s1, s91
    s_mul_i32 s92, s92, 49152
    s_add_u32 s92, s92, s96
    s_add_u32 m0, s1, 0
    s_nop 0
    buffer_load_dwordx4 v240, s[8:11], s92 offen lds
    v_dot2_f32_bf16 v122, v186, s85, v122
    v_dot2_f32_bf16 v124, v186, v186, v124
    v_dot2_f32_bf16 v123, v187, s85, v123
    v_dot2_f32_bf16 v125, v187, v187, v125
    v_dot2_f32_bf16 v122, v188, s85, v122
    v_dot2_f32_bf16 v124, v188, v188, v124
    v_dot2_f32_bf16 v123, v189, s85, v123
    v_dot2_f32_bf16 v125, v189, v189, v125
    v_dot2_f32_bf16 v122, v190, s85, v122
    v_dot2_f32_bf16 v124, v190, v190, v124
    v_dot2_f32_bf16 v123, v191, s85, v123
    v_dot2_f32_bf16 v125, v191, v191, v125
    s_add_u32 m0, s1, 1024
    s_nop 0
    buffer_load_dwordx4 v241, s[8:11], s92 offen lds
    v_dot2_f32_bf16 v122, v192, s85, v122
    v_dot2_f32_bf16 v124, v192, v192, v124
    v_dot2_f32_bf16 v123, v193, s85, v123
    v_dot2_f32_bf16 v125, v193, v193, v125
    v_dot2_f32_bf16 v122, v194, s85, v122
    v_dot2_f32_bf16 v124, v194, v194, v124
    v_dot2_f32_bf16 v123, v195, s85, v123
    v_dot2_f32_bf16 v125, v195, v195, v125
    v_dot2_f32_bf16 v122, v196, s85, v122
    v_dot2_f32_bf16 v124, v196, v196, v124
    v_dot2_f32_bf16 v123, v197, s85, v123
    v_dot2_f32_bf16 v125, v197, v197, v125
    s_add_u32 m0, s1, 2048
    s_nop 0
    buffer_load_dwordx4 v242, s[8:11], s92 offen lds
    v_dot2_f32_bf16 v122, v198, s85, v122
    v_dot2_f32_bf16 v124, v198, v198, v124
    v_dot2_f32_bf16 v123, v199, s85, v123
    v_dot2_f32_bf16 v125, v199, v199, v125
    v_dot2_f32_bf16 v122, v200, s85, v122
    v_dot2_f32_bf16 v124, v200, v200, v124
    v_dot2_f32_bf16 v123, v201, s85, v123
    v_dot2_f32_bf16 v125, v201, v201, v125
    v_dot2_f32_bf16 v122, v202, s85, v122
    v_dot2_f32_bf16 v124, v202, v202, v124
    v_dot2_f32_bf16 v123, v203, s85, v123
    v_dot2_f32_bf16 v125, v203, v203, v125
    v_and_b32 v253, 31, v0
    s_lshl_b32 s96, s79, 6
    s_lshl_b32 s97, s101, 5
    s_add_u32 s96, s96, s97
    v_add_u32 v253, s96, v253
    v_lshlrev_b32 v254, 1, v253
    buffer_load_ushort v1, v254, s[28:31], 0 offen
    v_lshlrev_b32 v253, 10, v253
    v_lshrrev_b32 v254, 5, v0
    v_lshlrev_b32 v254, 3, v254
    v_add_u32 v253, v253, v254
    s_lshl_b32 s96, s80, 7
    s_lshl_b32 s97, s100, 6
    s_add_u32 s96, s96, s97
    buffer_load_dwordx2 v[2:3], v253, s[4:7], s96 offen offset:0
    buffer_load_dwordx2 v[4:5], v253, s[4:7], s96 offen offset:16
    buffer_load_dwordx2 v[6:7], v253, s[4:7], s96 offen offset:32
    buffer_load_dwordx2 v[8:9], v253, s[4:7], s96 offen offset:48
    v_dot2_f32_bf16 v122, v204, s85, v122
    v_dot2_f32_bf16 v124, v204, v204, v124
    v_dot2_f32_bf16 v123, v205, s85, v123
    v_dot2_f32_bf16 v125, v205, v205, v125
    v_dot2_f32_bf16 v122, v206, s85, v122
    v_dot2_f32_bf16 v124, v206, v206, v124
    v_dot2_f32_bf16 v123, v207, s85, v123
    v_dot2_f32_bf16 v125, v207, v207, v125
    s_waitcnt vmcnt(29)
    s_barrier
    s_cmp_lg_u32 s76, 0
    s_cbranch_scc1 Lnosig_1
    s_getreg_b32 s89, hwreg(HW_REG_XCC_ID, 0, 4)
    s_lshl_b32 s89, s89, 4
    s_or_b32 s89, s89, 1
    v_mov_b32 v132, s2
    v_mov_b32 v141, s89
    buffer_store_byte v141, v132, s[36:39], 0 offen sc1
Lnosig_1:
    v_lshlrev_b32 v136, 4, v0
    s_mul_i32 s96, s76, 16384
    s_add_u32 s96, s96, 0xf000
    v_add_u32 v133, s96, v136
    v_lshrrev_b32 v134, 4, v0
    v_lshlrev_b32 v134, 3, v134
    v_bfe_u32 v137, v0, 2, 2
    v_add_u32 v134, v134, v137
    v_mul_u32_u24 v134, 192, v134
    v_and_b32 v137, 3, v0
    v_lshlrev_b32 v137, 3, v137
    v_add_u32 v134, v134, v137
    v_add_u32 v134, s96, v134
    ds_write_b128 v133, a[0:3] offset:0
    ds_write_b128 v133, a[4:7] offset:1024
    ds_write_b128 v133, a[8:11] offset:2048
    ds_write_b128 v133, a[12:15] offset:3072
    ds_write_b128 v133, a[16:19] offset:4096
    ds_write_b128 v133, a[20:23] offset:5120
    ds_read_b64_tr_b16 a[0:1], v134 offset:0
    ds_read_b64_tr_b16 a[2:3], v134 offset:768
    ds_read_b64_tr_b16 a[4:5], v134 offset:32
    ds_read_b64_tr_b16 a[6:7], v134 offset:800
    ds_read_b64_tr_b16 a[8:9], v134 offset:64
    ds_read_b64_tr_b16 a[10:11], v134 offset:832
    ds_read_b64_tr_b16 a[12:13], v134 offset:96
    ds_read_b64_tr_b16 a[14:15], v134 offset:864
    ds_read_b64_tr_b16 a[16:17], v134 offset:128
    ds_read_b64_tr_b16 a[18:19], v134 offset:896
    ds_read_b64_tr_b16 a[20:21], v134 offset:160
    ds_read_b64_tr_b16 a[22:23], v134 offset:928
    s_lshr_b32 s96, s2, 6
    s_lshl_b32 s96, s96, 2
    s_add_u32 s96, s96, s76
    s_lshl_b32 s96, s96, 1
    s_add_u32 s96, s96, 0
    s_lshl_b32 s96, s96, 6
    s_and_b32 s97, s2, 63
    s_add_u32 s96, s96, s97
    s_mul_i32 s96, s96, 3072
    s_add_u32 s96, s96, 0x1a00000
    s_waitcnt lgkmcnt(6)
    buffer_store_dwordx4 a[0:3], v136, s[40:43], s96 offen offset:0 sc1
    buffer_store_dwordx4 a[4:7], v136, s[40:43], s96 offen offset:1024 sc1
    buffer_store_dwordx4 a[8:11], v136, s[40:43], s96 offen offset:2048 sc1
    s_lshr_b32 s96, s2, 6
    s_lshl_b32 s96, s96, 2
    s_add_u32 s96, s96, s76
    s_lshl_b32 s96, s96, 1
    s_add_u32 s96, s96, 1
    s_lshl_b32 s96, s96, 6
    s_and_b32 s97, s2, 63
    s_add_u32 s96, s96, s97
    s_mul_i32 s96, s96, 3072
    s_add_u32 s96, s96, 0x1a00000
    s_waitcnt lgkmcnt(0)
    buffer_store_dwordx4 a[12:15], v136, s[40:43], s96 offen offset:0 sc1
    buffer_store_dwordx4 a[16:19], v136, s[40:43], s96 offen offset:1024 sc1
    buffer_store_dwordx4 a[20:23], v136, s[40:43], s96 offen offset:2048 sc1
    v_lshrrev_b32 v129, 5, v0
    v_mul_u32_u24 v129, 8, v129
    v_bfe_u32 v132, v0, 2, 2
    v_add_u32 v129, v129, v132
    v_mul_u32_u24 v129, 192, v129
    v_bfe_u32 v132, v0, 4, 1
    v_lshlrev_b32 v132, 5, v132
    v_add_u32 v129, v129, v132
    v_and_b32 v132, 3, v0
    v_lshlrev_b32 v132, 3, v132
    v_add_u32 v129, v129, v132
    v_mov_b32 v130, v129
    v_add_u32 v129, 0x1f000, v129
    s_add_u32 s89, s77, 0
    s_and_b32 s89, s89, 7
    s_lshl_b32 s90, s76, 3
    s_add_u32 s89, s89, s90
    s_mul_i32 s89, s89, 3072
    s_cmp_lt_u32 s89, 36864
    s_mov_b32 s90, 0xffff7000
    s_cselect_b32 s90, 0x1f000, s90
    s_add_u32 s89, s89, s90
    v_add_u32 v132, s89, v130
    s_waitcnt vmcnt(32)
    ds_read_b64_tr_b16 v[208:209], v132 offset:0
    ds_read_b64_tr_b16 v[210:211], v132 offset:768
    ds_read_b64_tr_b16 v[212:213], v132 offset:64
    ds_read_b64_tr_b16 v[214:215], v132 offset:832
    ds_read_b64_tr_b16 v[216:217], v132 offset:128
    ds_read_b64_tr_b16 v[218:219], v132 offset:896
    s_add_u32 s89, s77, 1
    s_and_b32 s89, s89, 7
    s_lshl_b32 s90, s76, 3
    s_add_u32 s89, s89, s90
    s_mul_i32 s89, s89, 3072
    s_cmp_lt_u32 s89, 36864
    s_mov_b32 s90, 0xffff7000
    s_cselect_b32 s90, 0x1f000, s90
    s_add_u32 s89, s89, s90
    v_add_u32 v132, s89, v130
    s_waitcnt vmcnt(29)
    ds_read_b64_tr_b16 v[220:221], v132 offset:0
    ds_read_b64_tr_b16 v[222:223], v132 offset:768
    ds_read_b64_tr_b16 v[224:225], v132 offset:64
    ds_read_b64_tr_b16 v[226:227], v132 offset:832
    ds_read_b64_tr_b16 v[228:229], v132 offset:128
    ds_read_b64_tr_b16 v[230:231], v132 offset:896
    s_waitcnt lgkmcnt(6)
    v_dot2_f32_bf16 v126, v208, s85, v126
    v_dot2_f32_bf16 v127, v212, s85, v127
    v_dot2_f32_bf16 v128, v216, s85, v128
    v_dot2_f32_bf16 v126, v209, s85, v126
    v_dot2_f32_bf16 v127, v213, s85, v127
    v_dot2_f32_bf16 v128, v217, s85, v128
    v_dot2_f32_bf16 v126, v210, s85, v126
    v_dot2_f32_bf16 v127, v214, s85, v127
    v_dot2_f32_bf16 v128, v218, s85, v128
    v_dot2_f32_bf16 v126, v211, s85, v126
    v_dot2_f32_bf16 v127, v215, s85, v127
    v_dot2_f32_bf16 v128, v219, s85, v128
    s_add_u32 s89, s77, 2
    s_and_b32 s89, s89, 7
    s_lshl_b32 s90, s76, 3
    s_add_u32 s89, s89, s90
    s_mul_i32 s89, s89, 3072
    s_cmp_lt_u32 s89, 36864
    s_mov_b32 s90, 0xffff7000
    s_cselect_b32 s90, 0x1f000, s90
    s_add_u32 s89, s89, s90
    v_add_u32 v132, s89, v130
    s_waitcnt vmcnt(26)
    ds_read_b64_tr_b16 v[208:209], v132 offset:0
    ds_read_b64_tr_b16 v[210:211], v132 offset:768
    ds_read_b64_tr_b16 v[212:213], v132 offset:64
    ds_read_b64_tr_b16 v[214:215], v132 offset:832
    ds_read_b64_tr_b16 v[216:217], v132 offset:128
    ds_read_b64_tr_b16 v[218:219], v132 offset:896
    s_waitcnt lgkmcnt(6)
    v_dot2_f32_bf16 v126, v220, s85, v126
    v_dot2_f32_bf16 v127, v224, s85, v127
    v_dot2_f32_bf16 v128, v228, s85, v128
    v_dot2_f32_bf16 v126, v221, s85, v126
    v_dot2_f32_bf16 v127, v225, s85, v127
    v_dot2_f32_bf16 v128, v229, s85, v128
    v_dot2_f32_bf16 v126, v222, s85, v126
    v_dot2_f32_bf16 v127, v226, s85, v127
    v_dot2_f32_bf16 v128, v230, s85, v128
    v_dot2_f32_bf16 v126, v223, s85, v126
    v_dot2_f32_bf16 v127, v227, s85, v127
    v_dot2_f32_bf16 v128, v231, s85, v128
    s_add_u32 s89, s77, 3
    s_and_b32 s89, s89, 7
    s_lshl_b32 s90, s76, 3
    s_add_u32 s89, s89, s90
    s_mul_i32 s89, s89, 3072
    s_cmp_lt_u32 s89, 36864
    s_mov_b32 s90, 0xffff7000
    s_cselect_b32 s90, 0x1f000, s90
    s_add_u32 s89, s89, s90
    v_add_u32 v132, s89, v130
    s_waitcnt vmcnt(23)
    ds_read_b64_tr_b16 v[220:221], v132 offset:0
    ds_read_b64_tr_b16 v[222:223], v132 offset:768
    ds_read_b64_tr_b16 v[224:225], v132 offset:64
    ds_read_b64_tr_b16 v[226:227], v132 offset:832
    ds_read_b64_tr_b16 v[228:229], v132 offset:128
    ds_read_b64_tr_b16 v[230:231], v132 offset:896
    s_waitcnt lgkmcnt(6)
    v_dot2_f32_bf16 v126, v208, s85, v126
    v_dot2_f32_bf16 v127, v212, s85, v127
    v_dot2_f32_bf16 v128, v216, s85, v128
    v_dot2_f32_bf16 v126, v209, s85, v126
    v_dot2_f32_bf16 v127, v213, s85, v127
    v_dot2_f32_bf16 v128, v217, s85, v128
    v_dot2_f32_bf16 v126, v210, s85, v126
    v_dot2_f32_bf16 v127, v214, s85, v127
    v_dot2_f32_bf16 v128, v218, s85, v128
    v_dot2_f32_bf16 v126, v211, s85, v126
    v_dot2_f32_bf16 v127, v215, s85, v127
    v_dot2_f32_bf16 v128, v219, s85, v128
    s_add_u32 s89, s77, 4
    s_and_b32 s89, s89, 7
    s_lshl_b32 s90, s76, 3
    s_add_u32 s89, s89, s90
    s_mul_i32 s89, s89, 3072
    s_cmp_lt_u32 s89, 36864
    s_mov_b32 s90, 0xffff7000
    s_cselect_b32 s90, 0x1f000, s90
    s_add_u32 s89, s89, s90
    v_add_u32 v132, s89, v130
    s_waitcnt vmcnt(20)
    ds_read_b64_tr_b16 v[208:209], v132 offset:0
    ds_read_b64_tr_b16 v[210:211], v132 offset:768
    ds_read_b64_tr_b16 v[212:213], v132 offset:64
    ds_read_b64_tr_b16 v[214:215], v132 offset:832
    ds_read_b64_tr_b16 v[216:217], v132 offset:128
    ds_read_b64_tr_b16 v[218:219], v132 offset:896
    s_waitcnt lgkmcnt(6)
    v_dot2_f32_bf16 v126, v220, s85, v126
    v_dot2_f32_bf16 v127, v224, s85, v127
    v_dot2_f32_bf16 v128, v228, s85, v128
    v_dot2_f32_bf16 v126, v221, s85, v126
    v_dot2_f32_bf16 v127, v225, s85, v127
    v_dot2_f32_bf16 v128, v229, s85, v128
    v_dot2_f32_bf16 v126, v222, s85, v126
    v_dot2_f32_bf16 v127, v226, s85, v127
    v_dot2_f32_bf16 v128, v230, s85, v128
    v_dot2_f32_bf16 v126, v223, s85, v126
    v_dot2_f32_bf16 v127, v227, s85, v127
    v_dot2_f32_bf16 v128, v231, s85, v128
    s_add_u32 s89, s77, 5
    s_and_b32 s89, s89, 7
    s_lshl_b32 s90, s76, 3
    s_add_u32 s89, s89, s90
    s_mul_i32 s89, s89, 3072
    s_cmp_lt_u32 s89, 36864
    s_mov_b32 s90, 0xffff7000
    s_cselect_b32 s90, 0x1f000, s90
    s_add_u32 s89, s89, s90
    v_add_u32 v132, s89, v130
    s_waitcnt vmcnt(17)
    ds_read_b64_tr_b16 v[220:221], v132 offset:0
    ds_read_b64_tr_b16 v[222:223], v132 offset:768
    ds_read_b64_tr_b16 v[224:225], v132 offset:64
    ds_read_b64_tr_b16 v[226:227], v132 offset:832
    ds_read_b64_tr_b16 v[228:229], v132 offset:128
    ds_read_b64_tr_b16 v[230:231], v132 offset:896
    s_waitcnt lgkmcnt(6)
    v_dot2_f32_bf16 v126, v208, s85, v126
    v_dot2_f32_bf16 v127, v212, s85, v127
    v_dot2_f32_bf16 v128, v216, s85, v128
    v_dot2_f32_bf16 v126, v209, s85, v126
    v_dot2_f32_bf16 v127, v213, s85, v127
    v_dot2_f32_bf16 v128, v217, s85, v128
    v_dot2_f32_bf16 v126, v210, s85, v126
    v_dot2_f32_bf16 v127, v214, s85, v127
    v_dot2_f32_bf16 v128, v218, s85, v128
    v_dot2_f32_bf16 v126, v211, s85, v126
    v_dot2_f32_bf16 v127, v215, s85, v127
    v_dot2_f32_bf16 v128, v219, s85, v128
    s_add_u32 s89, s77, 6
    s_and_b32 s89, s89, 7
    s_lshl_b32 s90, s76, 3
    s_add_u32 s89, s89, s90
    s_mul_i32 s89, s89, 3072
    s_cmp_lt_u32 s89, 36864
    s_mov_b32 s90, 0xffff7000
    s_cselect_b32 s90, 0x1f000, s90
    s_add_u32 s89, s89, s90
    v_add_u32 v132, s89, v130
    s_waitcnt vmcnt(14)
    ds_read_b64_tr_b16 v[208:209], v132 offset:0
    ds_read_b64_tr_b16 v[210:211], v132 offset:768
    ds_read_b64_tr_b16 v[212:213], v132 offset:64
    ds_read_b64_tr_b16 v[214:215], v132 offset:832
    ds_read_b64_tr_b16 v[216:217], v132 offset:128
    ds_read_b64_tr_b16 v[218:219], v132 offset:896
    s_waitcnt lgkmcnt(6)
    v_dot2_f32_bf16 v126, v220, s85, v126
    v_dot2_f32_bf16 v127, v224, s85, v127
    v_dot2_f32_bf16 v128, v228, s85, v128
    v_dot2_f32_bf16 v126, v221, s85, v126
    v_dot2_f32_bf16 v127, v225, s85, v127
    v_dot2_f32_bf16 v128, v229, s85, v128
    v_dot2_f32_bf16 v126, v222, s85, v126
    v_dot2_f32_bf16 v127, v226, s85, v127
    v_dot2_f32_bf16 v128, v230, s85, v128
    v_dot2_f32_bf16 v126, v223, s85, v126
    v_dot2_f32_bf16 v127, v227, s85, v127
    v_dot2_f32_bf16 v128, v231, s85, v128
    s_add_u32 s89, s77, 7
    s_and_b32 s89, s89, 7
    s_lshl_b32 s90, s76, 3
    s_add_u32 s89, s89, s90
    s_mul_i32 s89, s89, 3072
    s_cmp_lt_u32 s89, 36864
    s_mov_b32 s90, 0xffff7000
    s_cselect_b32 s90, 0x1f000, s90
    s_add_u32 s89, s89, s90
    v_add_u32 v132, s89, v130
    s_waitcnt vmcnt(11)
    ds_read_b64_tr_b16 v[220:221], v132 offset:0
    ds_read_b64_tr_b16 v[222:223], v132 offset:768
    ds_read_b64_tr_b16 v[224:225], v132 offset:64
    ds_read_b64_tr_b16 v[226:227], v132 offset:832
    ds_read_b64_tr_b16 v[228:229], v132 offset:128
    ds_read_b64_tr_b16 v[230:231], v132 offset:896
    s_waitcnt lgkmcnt(6)
    v_dot2_f32_bf16 v126, v208, s85, v126
    v_dot2_f32_bf16 v127, v212, s85, v127
    v_dot2_f32_bf16 v128, v216, s85, v128
    v_dot2_f32_bf16 v126, v209, s85, v126
    v_dot2_f32_bf16 v127, v213, s85, v127
    v_dot2_f32_bf16 v128, v217, s85, v128
    v_dot2_f32_bf16 v126, v210, s85, v126
    v_dot2_f32_bf16 v127, v214, s85, v127
    v_dot2_f32_bf16 v128, v218, s85, v128
    v_dot2_f32_bf16 v126, v211, s85, v126
    v_dot2_f32_bf16 v127, v215, s85, v127
    v_dot2_f32_bf16 v128, v219, s85, v128
    s_waitcnt lgkmcnt(0)
    v_dot2_f32_bf16 v126, v220, s85, v126
    v_dot2_f32_bf16 v127, v224, s85, v127
    v_dot2_f32_bf16 v128, v228, s85, v128
    v_dot2_f32_bf16 v126, v221, s85, v126
    v_dot2_f32_bf16 v127, v225, s85, v127
    v_dot2_f32_bf16 v128, v229, s85, v128
    v_dot2_f32_bf16 v126, v222, s85, v126
    v_dot2_f32_bf16 v127, v226, s85, v127
    v_dot2_f32_bf16 v128, v230, s85, v128
    v_dot2_f32_bf16 v126, v223, s85, v126
    v_dot2_f32_bf16 v127, v227, s85, v127
    v_dot2_f32_bf16 v128, v231, s85, v128
    s_waitcnt vmcnt(0)
    s_barrier
    s_cmp_lg_u32 s76, 0
    s_cbranch_scc1 Lnoflag_2
    s_lshl_b32 s89, s2, 7
    s_add_u32 s89, s89, 0x1900000
    v_mov_b32 v132, 0
    v_mov_b32 v141, 1
    buffer_store_dword v141, v132, s[40:43], s89 offen offset:0 sc1
Lnoflag_2:
    s_lshl_b32 s90, s2, 2
    s_add_u32 s90, s90, s76
    s_min_u32 s90, s90, 967
    s_mul_i32 s89, s90, 745
    s_lshr_b32 s89, s89, 13
    s_mul_i32 s1, s89, 11
    s_sub_u32 s90, s90, s1
    s_lshl_b32 s89, s89, 16
    s_mul_i32 s90, s90, 384
    s_add_u32 s89, s89, s90
    v_add_u32 v235, 0, v0
    v_mul_u32_u24 v236, 683, v235
    v_lshrrev_b32 v236, 14, v236
    v_mul_u32_u24 v237, 24, v236
    v_sub_u32 v237, v235, v237
    v_lshlrev_b32 v236, 12, v236
    v_lshlrev_b32 v237, 4, v237
    v_add_u32 v232, v236, v237
    buffer_load_dwordx4 a[24:27], v232, s[24:27], s89 offen nt
    v_add_u32 v235, 64, v0
    v_mul_u32_u24 v236, 683, v235
    v_lshrrev_b32 v236, 14, v236
    v_mul_u32_u24 v237, 24, v236
    v_sub_u32 v237, v235, v237
    v_lshlrev_b32 v236, 12, v236
    v_lshlrev_b32 v237, 4, v237
    v_add_u32 v233, v236, v237
    buffer_load_dwordx4 a[28:31], v233, s[24:27], s89 offen nt
    v_add_u32 v235, 128, v0
    v_mul_u32_u24 v236, 683, v235
    v_lshrrev_b32 v236, 14, v236
    v_mul_u32_u24 v237, 24, v236
    v_sub_u32 v237, v235, v237
    v_lshlrev_b32 v236, 12, v236
    v_lshlrev_b32 v237, 4, v237
    v_add_u32 v232, v236, v237
    buffer_load_dwordx4 a[32:35], v232, s[24:27], s89 offen nt
    v_add_u32 v235, 192, v0
    v_mul_u32_u24 v236, 683, v235
    v_lshrrev_b32 v236, 14, v236
    v_mul_u32_u24 v237, 24, v236
    v_sub_u32 v237, v235, v237
    v_lshlrev_b32 v236, 12, v236
    v_lshlrev_b32 v237, 4, v237
    v_add_u32 v233, v236, v237
    buffer_load_dwordx4 a[36:39], v233, s[24:27], s89 offen nt
    v_add_u32 v235, 256, v0
    v_mul_u32_u24 v236, 683, v235
    v_lshrrev_b32 v236, 14, v236
    v_mul_u32_u24 v237, 24, v236
    v_sub_u32 v237, v235, v237
    v_lshlrev_b32 v236, 12, v236
    v_lshlrev_b32 v237, 4, v237
    v_add_u32 v232, v236, v237
    buffer_load_dwordx4 a[40:43], v232, s[24:27], s89 offen nt
    v_add_u32 v235, 320, v0
    v_mul_u32_u24 v236, 683, v235
    v_lshrrev_b32 v236, 14, v236
    v_mul_u32_u24 v237, 24, v236
    v_sub_u32 v237, v235, v237
    v_lshlrev_b32 v236, 12, v236
    v_lshlrev_b32 v237, 4, v237
    v_add_u32 v233, v236, v237
    buffer_load_dwordx4 a[44:47], v233, s[24:27], s89 offen nt
    ds_read_b64_tr_b16 v[208:209], v129 offset:0
    ds_read_b64_tr_b16 v[210:211], v129 offset:768
    ds_read_b64_tr_b16 v[212:213], v129 offset:64
    ds_read_b64_tr_b16 v[214:215], v129 offset:832
    ds_read_b64_tr_b16 v[216:217], v129 offset:128
    ds_read_b64_tr_b16 v[218:219], v129 offset:896
    s_waitcnt lgkmcnt(4)
    v_mfma_f32_32x32x16_bf16 v[10:25], v[208:211], v[58:61], 0
    ds_read_b64_tr_b16 v[220:221], v129 offset:3072
    ds_read_b64_tr_b16 v[222:223], v129 offset:3840
    v_mov_b32 v246, -1
    v_mov_b32 v247, -1
    v_mov_b32 v248, -1
    v_mov_b32 v249, -1
    v_lshlrev_b32 v250, 4, v0
    v_lshlrev_b32 v251, 3, v0
    v_and_b32 v252, 31, v0
    v_lshlrev_b32 v252, 3, v252
    s_waitcnt lgkmcnt(4)
    v_mfma_f32_32x32x16_bf16 v[26:41], v[212:215], v[58:61], 0
    ds_read_b64_tr_b16 v[224:225], v129 offset:3136
    ds_read_b64_tr_b16 v[226:227], v129 offset:3904
    s_waitcnt lgkmcnt(4)
    v_mfma_f32_32x32x16_bf16 v[42:57], v[216:219], v[58:61], 0
    ds_read_b64_tr_b16 v[228:229], v129 offset:3200
    ds_read_b64_tr_b16 v[230:231], v129 offset:3968
    s_waitcnt lgkmcnt(4)
    v_mfma_f32_32x32x16_bf16 v[10:25], v[220:223], v[62:65], v[10:25]
    ds_read_b64_tr_b16 v[208:209], v129 offset:6144
    ds_read_b64_tr_b16 v[210:211], v129 offset:6912
    s_waitcnt lgkmcnt(4)
    v_mfma_f32_32x32x16_bf16 v[26:41], v[224:227], v[62:65], v[26:41]
    ds_read_b64_tr_b16 v[212:213], v129 offset:6208
    ds_read_b64_tr_b16 v[214:215], v129 offset:6976
    s_waitcnt lgkmcnt(4)
    v_mfma_f32_32x32x16_bf16 v[42:57], v[228:231], v[62:65], v[42:57]
    ds_read_b64_tr_b16 v[216:217], v129 offset:6272
    ds_read_b64_tr_b16 v[218:219], v129 offset:7040
    s_waitcnt lgkmcnt(4)
    v_mfma_f32_32x32x16_bf16 v[10:25], v[208:211], v[66:69], v[10:25]
    ds_read_b64_tr_b16 v[220:221], v129 offset:9216
    ds_read_b64_tr_b16 v[222:223], v129 offset:9984
    s_waitcnt lgkmcnt(4)
    v_mfma_f32_32x32x16_bf16 v[26:41], v[212:215], v[66:69], v[26:41]
    ds_read_b64_tr_b16 v[224:225], v129 offset:9280
    ds_read_b64_tr_b16 v[226:227], v129 offset:10048
    s_waitcnt lgkmcnt(4)
    v_mfma_f32_32x32x16_bf16 v[42:57], v[216:219], v[66:69], v[42:57]
    ds_read_b64_tr_b16 v[228:229], v129 offset:9344
    ds_read_b64_tr_b16 v[230:231], v129 offset:10112
    s_waitcnt lgkmcnt(4)
    v_mfma_f32_32x32x16_bf16 v[10:25], v[220:223], v[70:73], v[10:25]
    ds_read_b64_tr_b16 v[208:209], v129 offset:12288
    ds_read_b64_tr_b16 v[210:211], v129 offset:13056
    s_waitcnt lgkmcnt(4)
    v_mfma_f32_32x32x16_bf16 v[26:41], v[224:227], v[70:73], v[26:41]
    ds_read_b64_tr_b16 v[212:213], v129 offset:12352
    ds_read_b64_tr_b16 v[214:215], v129 offset:13120
    s_lshl_b32 s96, s77, 2
    s_add_u32 s96, s96, s76
    s_lshl_b32 s96, s96, 15
    s_lshl_b32 s92, s78, 11
    s_add_u32 s96, s96, s92
    s_add_u32 s96, s96, 0x800000
    buffer_store_dwordx4 v[246:249], v250, s[40:43], s96 offen offset:0 sc1
    s_waitcnt lgkmcnt(4)
    v_mfma_f32_32x32x16_bf16 v[42:57], v[228:231], v[70:73], v[42:57]
    ds_read_b64_tr_b16 v[216:217], v129 offset:12416
    ds_read_b64_tr_b16 v[218:219], v129 offset:13184
    s_waitcnt lgkmcnt(4)
    v_mfma_f32_32x32x16_bf16 v[10:25], v[208:211], v[74:77], v[10:25]
    ds_read_b64_tr_b16 v[220:221], v129 offset:15360
    ds_read_b64_tr_b16 v[222:223], v129 offset:16128
    s_waitcnt lgkmcnt(4)
    v_mfma_f32_32x32x16_bf16 v[26:41], v[212:215], v[74:77], v[26:41]
    ds_read_b64_tr_b16 v[224:225], v129 offset:15424
    ds_read_b64_tr_b16 v[226:227], v129 offset:16192
    s_waitcnt lgkmcnt(4)
    v_mfma_f32_32x32x16_bf16 v[42:57], v[216:219], v[74:77], v[42:57]
    ds_read_b64_tr_b16 v[228:229], v129 offset:15488
    ds_read_b64_tr_b16 v[230:231], v129 offset:16256
    s_waitcnt lgkmcnt(4)
    v_mfma_f32_32x32x16_bf16 v[10:25], v[220:223], v[78:81], v[10:25]
    ds_read_b64_tr_b16 v[208:209], v129 offset:18432
    ds_read_b64_tr_b16 v[210:211], v129 offset:19200
    s_waitcnt lgkmcnt(4)
    v_mfma_f32_32x32x16_bf16 v[26:41], v[224:227], v[78:81], v[26:41]
    ds_read_b64_tr_b16 v[212:213], v129 offset:18496
    ds_read_b64_tr_b16 v[214:215], v129 offset:19264
    s_waitcnt lgkmcnt(4)
    v_mfma_f32_32x32x16_bf16 v[42:57], v[228:231], v[78:81], v[42:57]
    ds_read_b64_tr_b16 v[216:217], v129 offset:18560
    ds_read_b64_tr_b16 v[218:219], v129 offset:19328
    s_waitcnt lgkmcnt(4)
    v_mfma_f32_32x32x16_bf16 v[10:25], v[208:211], v[82:85], v[10:25]
    ds_read_b64_tr_b16 v[220:221], v129 offset:21504
    ds_read_b64_tr_b16 v[222:223], v129 offset:22272
    s_waitcnt lgkmcnt(4)
    v_mfma_f32_32x32x16_bf16 v[26:41], v[212:215], v[82:85], v[26:41]
    ds_read_b64_tr_b16 v[224:225], v129 offset:21568
    ds_read_b64_tr_b16 v[226:227], v129 offset:22336
    s_waitcnt lgkmcnt(4)
    v_mfma_f32_32x32x16_bf16 v[42:57], v[216:219], v[82:85], v[42:57]
    ds_read_b64_tr_b16 v[228:229], v129 offset:21632
    ds_read_b64_tr_b16 v[230:231], v129 offset:22400
    buffer_store_dwordx4 v[246:249], v250, s[40:43], s96 offen offset:1024 sc1
    s_waitcnt lgkmcnt(4)
    v_mfma_f32_32x32x16_bf16 v[10:25], v[220:223], v[86:89], v[10:25]
    ds_read_b64_tr_b16 v[208:209], v129 offset:24576
    ds_read_b64_tr_b16 v[210:211], v129 offset:25344
    s_waitcnt lgkmcnt(4)
    v_mfma_f32_32x32x16_bf16 v[26:41], v[224:227], v[86:89], v[26:41]
    ds_read_b64_tr_b16 v[212:213], v129 offset:24640
    ds_read_b64_tr_b16 v[214:215], v129 offset:25408
    s_waitcnt lgkmcnt(4)
    v_mfma_f32_32x32x16_bf16 v[42:57], v[228:231], v[86:89], v[42:57]
    ds_read_b64_tr_b16 v[216:217], v129 offset:24704
    ds_read_b64_tr_b16 v[218:219], v129 offset:25472
    s_waitcnt lgkmcnt(4)
    v_mfma_f32_32x32x16_bf16 v[10:25], v[208:211], v[90:93], v[10:25]
    ds_read_b64_tr_b16 v[220:221], v129 offset:27648
    ds_read_b64_tr_b16 v[222:223], v129 offset:28416
    s_waitcnt lgkmcnt(4)
    v_mfma_f32_32x32x16_bf16 v[26:41], v[212:215], v[90:93], v[26:41]
    ds_read_b64_tr_b16 v[224:225], v129 offset:27712
    ds_read_b64_tr_b16 v[226:227], v129 offset:28480
    s_waitcnt lgkmcnt(4)
    v_mfma_f32_32x32x16_bf16 v[42:57], v[216:219], v[90:93], v[42:57]
    ds_read_b64_tr_b16 v[228:229], v129 offset:27776
    ds_read_b64_tr_b16 v[230:231], v129 offset:28544
    s_waitcnt lgkmcnt(4)
    v_mfma_f32_32x32x16_bf16 v[10:25], v[220:223], v[94:97], v[10:25]
    ds_read_b64_tr_b16 v[208:209], v129 offset:30720
    ds_read_b64_tr_b16 v[210:211], v129 offset:31488
    s_waitcnt lgkmcnt(4)
    v_mfma_f32_32x32x16_bf16 v[26:41], v[224:227], v[94:97], v[26:41]
    ds_read_b64_tr_b16 v[212:213], v129 offset:30784
    ds_read_b64_tr_b16 v[214:215], v129 offset:31552
    s_waitcnt lgkmcnt(4)
    v_mfma_f32_32x32x16_bf16 v[42:57], v[228:231], v[94:97], v[42:57]
    ds_read_b64_tr_b16 v[216:217], v129 offset:30848
    ds_read_b64_tr_b16 v[218:219], v129 offset:31616
    s_waitcnt lgkmcnt(4)
    v_mfma_f32_32x32x16_bf16 v[10:25], v[208:211], v[98:101], v[10:25]
    ds_read_b64_tr_b16 v[220:221], v129 offset:33792
    ds_read_b64_tr_b16 v[222:223], v129 offset:34560
    s_lshl_b32 s96, s79, 3
    s_add_u32 s96, s96, s80
    s_lshl_b32 s96, s96, 1
    s_add_u32 s96, s96, s100
    s_lshl_b32 s96, s96, 9
    s_lshl_b32 s92, s101, 8
    s_add_u32 s96, s96, s92
    s_add_u32 s96, s96, 0x1600000
    buffer_store_dwordx2 v[246:247], v252, s[40:43], s96 offen offset:0 sc1
    s_waitcnt lgkmcnt(4)
    v_mfma_f32_32x32x16_bf16 v[26:41], v[212:215], v[98:101], v[26:41]
    ds_read_b64_tr_b16 v[224:225], v129 offset:33856
    ds_read_b64_tr_b16 v[226:227], v129 offset:34624
    s_waitcnt lgkmcnt(4)
    v_mfma_f32_32x32x16_bf16 v[42:57], v[216:219], v[98:101], v[42:57]
    ds_read_b64_tr_b16 v[228:229], v129 offset:33920
    ds_read_b64_tr_b16 v[230:231], v129 offset:34688
    s_waitcnt lgkmcnt(4)
    v_mfma_f32_32x32x16_bf16 v[10:25], v[220:223], v[102:105], v[10:25]
    ds_read_b64_tr_b16 v[208:209], v130 offset:0
    ds_read_b64_tr_b16 v[210:211], v130 offset:768
    s_waitcnt lgkmcnt(4)
    v_mfma_f32_32x32x16_bf16 v[26:41], v[224:227], v[102:105], v[26:41]
    ds_read_b64_tr_b16 v[212:213], v130 offset:64
    ds_read_b64_tr_b16 v[214:215], v130 offset:832
    s_waitcnt lgkmcnt(4)
    v_mfma_f32_32x32x16_bf16 v[42:57], v[228:231], v[102:105], v[42:57]
    ds_read_b64_tr_b16 v[216:217], v130 offset:128
    ds_read_b64_tr_b16 v[218:219], v130 offset:896
    s_waitcnt lgkmcnt(4)
    v_mfma_f32_32x32x16_bf16 v[10:25], v[208:211], v[106:109], v[10:25]
    ds_read_b64_tr_b16 v[220:221], v130 offset:3072
    ds_read_b64_tr_b16 v[222:223], v130 offset:3840
    s_waitcnt lgkmcnt(4)
    v_mfma_f32_32x32x16_bf16 v[26:41], v[212:215], v[106:109], v[26:41]
    ds_read_b64_tr_b16 v[224:225], v130 offset:3136
    ds_read_b64_tr_b16 v[226:227], v130 offset:3904
    s_waitcnt lgkmcnt(4)
    v_mfma_f32_32x32x16_bf16 v[42:57], v[216:219], v[106:109], v[42:57]
    ds_read_b64_tr_b16 v[228:229], v130 offset:3200
    ds_read_b64_tr_b16 v[230:231], v130 offset:3968
    s_waitcnt lgkmcnt(4)
    v_mfma_f32_32x32x16_bf16 v[10:25], v[220:223], v[110:113], v[10:25]
    ds_read_b64_tr_b16 v[208:209], v130 offset:6144
    ds_read_b64_tr_b16 v[210:211], v130 offset:6912
    s_waitcnt lgkmcnt(4)
    v_mfma_f32_32x32x16_bf16 v[26:41], v[224:227], v[110:113], v[26:41]
    ds_read_b64_tr_b16 v[212:213], v130 offset:6208
    ds_read_b64_tr_b16 v[214:215], v130 offset:6976
    s_waitcnt lgkmcnt(4)
    v_mfma_f32_32x32x16_bf16 v[42:57], v[228:231], v[110:113], v[42:57]
    ds_read_b64_tr_b16 v[216:217], v130 offset:6272
    ds_read_b64_tr_b16 v[218:219], v130 offset:7040
    s_lshl_b32 s96, s80, 6
    s_lshl_b32 s92, s79, 1
    s_add_u32 s96, s96, s92
    s_add_u32 s96, s96, s100
    s_lshl_b32 s96, s96, 12
    s_lshl_b32 s92, s101, 11
    s_add_u32 s96, s96, s92
    s_add_u32 s96, s96, 0xc00000
    buffer_store_dwordx4 v[246:249], v250, s[40:43], s96 offen offset:0 sc1
    s_waitcnt lgkmcnt(4)
    v_mfma_f32_32x32x16_bf16 v[10:25], v[208:211], v[114:117], v[10:25]
    ds_read_b64_tr_b16 v[220:221], v130 offset:9216
    ds_read_b64_tr_b16 v[222:223], v130 offset:9984
    s_waitcnt lgkmcnt(4)
    v_mfma_f32_32x32x16_bf16 v[26:41], v[212:215], v[114:117], v[26:41]
    ds_read_b64_tr_b16 v[224:225], v130 offset:9280
    ds_read_b64_tr_b16 v[226:227], v130 offset:10048
    s_waitcnt lgkmcnt(4)
    v_mfma_f32_32x32x16_bf16 v[42:57], v[216:219], v[114:117], v[42:57]
    ds_read_b64_tr_b16 v[228:229], v130 offset:9344
    ds_read_b64_tr_b16 v[230:231], v130 offset:10112
    s_waitcnt lgkmcnt(4)
    v_mfma_f32_32x32x16_bf16 v[10:25], v[220:223], v[118:121], v[10:25]
    ds_read_b64_tr_b16 v[208:209], v130 offset:12288
    ds_read_b64_tr_b16 v[210:211], v130 offset:13056
    s_waitcnt lgkmcnt(4)
    v_mfma_f32_32x32x16_bf16 v[26:41], v[224:227], v[118:121], v[26:41]
    ds_read_b64_tr_b16 v[212:213], v130 offset:12352
    ds_read_b64_tr_b16 v[214:215], v130 offset:13120
    s_waitcnt lgkmcnt(4)
    v_mfma_f32_32x32x16_bf16 v[42:57], v[228:231], v[118:121], v[42:57]
    ds_read_b64_tr_b16 v[216:217], v130 offset:12416
    ds_read_b64_tr_b16 v[218:219], v130 offset:13184
    s_waitcnt lgkmcnt(4)
    v_mfma_f32_32x32x16_bf16 v[10:25], v[208:211], v[144:147], v[10:25]
    ds_read_b64_tr_b16 v[220:221], v130 offset:15360
    ds_read_b64_tr_b16 v[222:223], v130 offset:16128
    s_waitcnt lgkmcnt(4)
    v_mfma_f32_32x32x16_bf16 v[26:41], v[212:215], v[144:147], v[26:41]
    ds_read_b64_tr_b16 v[224:225], v130 offset:15424
    ds_read_b64_tr_b16 v[226:227], v130 offset:16192
    s_waitcnt lgkmcnt(4)
    v_mfma_f32_32x32x16_bf16 v[42:57], v[216:219], v[144:147], v[42:57]
    ds_read_b64_tr_b16 v[228:229], v130 offset:15488
    ds_read_b64_tr_b16 v[230:231], v130 offset:16256
    s_waitcnt lgkmcnt(4)
    v_mfma_f32_32x32x16_bf16 v[10:25], v[220:223], v[148:151], v[10:25]
    ds_read_b64_tr_b16 v[208:209], v130 offset:18432
    ds_read_b64_tr_b16 v[210:211], v130 offset:19200
    buffer_store_dwordx4 v[246:249], v250, s[40:43], s96 offen offset:1024 sc1
    s_waitcnt lgkmcnt(4)
    v_mfma_f32_32x32x16_bf16 v[26:41], v[224:227], v[148:151], v[26:41]
    ds_read_b64_tr_b16 v[212:213], v130 offset:18496
    ds_read_b64_tr_b16 v[214:215], v130 offset:19264
    s_waitcnt lgkmcnt(4)
    v_mfma_f32_32x32x16_bf16 v[42:57], v[228:231], v[148:151], v[42:57]
    ds_read_b64_tr_b16 v[216:217], v130 offset:18560
    ds_read_b64_tr_b16 v[218:219], v130 offset:19328
    s_waitcnt lgkmcnt(4)
    v_mfma_f32_32x32x16_bf16 v[10:25], v[208:211], v[152:155], v[10:25]
    ds_read_b64_tr_b16 v[220:221], v130 offset:21504
    ds_read_b64_tr_b16 v[222:223], v130 offset:22272
    s_waitcnt lgkmcnt(4)
    v_mfma_f32_32x32x16_bf16 v[26:41], v[212:215], v[152:155], v[26:41]
    ds_read_b64_tr_b16 v[224:225], v130 offset:21568
    ds_read_b64_tr_b16 v[226:227], v130 offset:22336
    s_waitcnt lgkmcnt(4)
    v_mfma_f32_32x32x16_bf16 v[42:57], v[216:219], v[152:155], v[42:57]
    ds_read_b64_tr_b16 v[228:229], v130 offset:21632
    ds_read_b64_tr_b16 v[230:231], v130 offset:22400
    s_waitcnt lgkmcnt(4)
    v_mfma_f32_32x32x16_bf16 v[10:25], v[220:223], v[156:159], v[10:25]
    ds_read_b64_tr_b16 v[208:209], v130 offset:24576
    ds_read_b64_tr_b16 v[210:211], v130 offset:25344
    s_waitcnt lgkmcnt(4)
    v_mfma_f32_32x32x16_bf16 v[26:41], v[224:227], v[156:159], v[26:41]
    ds_read_b64_tr_b16 v[212:213], v130 offset:24640
    ds_read_b64_tr_b16 v[214:215], v130 offset:25408
    s_waitcnt lgkmcnt(4)
    v_mfma_f32_32x32x16_bf16 v[42:57], v[228:231], v[156:159], v[42:57]
    ds_read_b64_tr_b16 v[216:217], v130 offset:24704
    ds_read_b64_tr_b16 v[218:219], v130 offset:25472
    s_waitcnt lgkmcnt(4)
    v_mfma_f32_32x32x16_bf16 v[10:25], v[208:211], v[160:163], v[10:25]
    ds_read_b64_tr_b16 v[220:221], v130 offset:27648
    ds_read_b64_tr_b16 v[222:223], v130 offset:28416
    s_waitcnt lgkmcnt(4)
    v_mfma_f32_32x32x16_bf16 v[26:41], v[212:215], v[160:163], v[26:41]
    ds_read_b64_tr_b16 v[224:225], v130 offset:27712
    ds_read_b64_tr_b16 v[226:227], v130 offset:28480
    s_mul_i32 s96, s77, 6144
    s_lshl_b32 s97, s76, 1
    s_add_u32 s97, s97, 0
    s_min_u32 s97, s97, 5
    s_lshl_b32 s97, s97, 10
    s_add_u32 s97, s97, s96
    s_cmp_lt_u32 s97, 36864
    s_mov_b32 s1, 0xffff7000
    s_cselect_b32 s1, 0x1f000, s1
    s_add_u32 s97, s97, s1
    v_add_u32 v137, s97, v136
    ds_read_b128 a[48:51], v137 offset:0
    s_lshl_b32 s97, s76, 1
    s_add_u32 s97, s97, 1
    s_min_u32 s97, s97, 5
    s_lshl_b32 s97, s97, 10
    s_add_u32 s97, s97, s96
    s_cmp_lt_u32 s97, 36864
    s_mov_b32 s1, 0xffff7000
    s_cselect_b32 s1, 0x1f000, s1
    s_add_u32 s97, s97, s1
    v_add_u32 v137, s97, v136
    ds_read_b128 a[52:55], v137 offset:0
    s_waitcnt lgkmcnt(6)
    v_mfma_f32_32x32x16_bf16 v[42:57], v[216:219], v[160:163], v[42:57]
    ds_read_b64_tr_b16 v[228:229], v130 offset:27776
    ds_read_b64_tr_b16 v[230:231], v130 offset:28544
    s_waitcnt lgkmcnt(6)
    v_mfma_f32_32x32x16_bf16 v[10:25], v[220:223], v[164:167], v[10:25]
    ds_read_b64_tr_b16 v[208:209], v130 offset:30720
    ds_read_b64_tr_b16 v[210:211], v130 offset:31488
    s_waitcnt lgkmcnt(6)
    v_mfma_f32_32x32x16_bf16 v[26:41], v[224:227], v[164:167], v[26:41]
    ds_read_b64_tr_b16 v[212:213], v130 offset:30784
    ds_read_b64_tr_b16 v[214:215], v130 offset:31552
    s_waitcnt lgkmcnt(4)
    v_mfma_f32_32x32x16_bf16 v[42:57], v[228:231], v[164:167], v[42:57]
    ds_read_b64_tr_b16 v[216:217], v130 offset:30848
    ds_read_b64_tr_b16 v[218:219], v130 offset:31616
    s_waitcnt lgkmcnt(4)
    v_mfma_f32_32x32x16_bf16 v[10:25], v[208:211], v[168:171], v[10:25]
    ds_read_b64_tr_b16 v[220:221], v130 offset:33792
    ds_read_b64_tr_b16 v[222:223], v130 offset:34560
    s_waitcnt lgkmcnt(4)
    v_mfma_f32_32x32x16_bf16 v[26:41], v[212:215], v[168:171], v[26:41]
    ds_read_b64_tr_b16 v[224:225], v130 offset:33856
    ds_read_b64_tr_b16 v[226:227], v130 offset:34624
    s_waitcnt lgkmcnt(4)
    v_mfma_f32_32x32x16_bf16 v[42:57], v[216:219], v[168:171], v[42:57]
    ds_read_b64_tr_b16 v[228:229], v130 offset:33920
    ds_read_b64_tr_b16 v[230:231], v130 offset:34688
    s_waitcnt lgkmcnt(4)
    v_mfma_f32_32x32x16_bf16 v[10:25], v[220:223], v[172:175], v[10:25]
    ds_read_b64_tr_b16 v[208:209], v130 offset:36864
    ds_read_b64_tr_b16 v[210:211], v130 offset:37632
    s_waitcnt lgkmcnt(4)
    v_mfma_f32_32x32x16_bf16 v[26:41], v[224:227], v[172:175], v[26:41]
    ds_read_b64_tr_b16 v[212:213], v130 offset:36928
    ds_read_b64_tr_b16 v[214:215], v130 offset:37696
    s_waitcnt lgkmcnt(4)
    v_mfma_f32_32x32x16_bf16 v[42:57], v[228:231], v[172:175], v[42:57]
    ds_read_b64_tr_b16 v[216:217], v130 offset:36992
    ds_read_b64_tr_b16 v[218:219], v130 offset:37760
    s_waitcnt lgkmcnt(4)
    v_mfma_f32_32x32x16_bf16 v[10:25], v[208:211], v[176:179], v[10:25]
    ds_read_b64_tr_b16 v[220:221], v130 offset:39936
    ds_read_b64_tr_b16 v[222:223], v130 offset:40704
    s_waitcnt lgkmcnt(4)
    v_mfma_f32_32x32x16_bf16 v[26:41], v[212:215], v[176:179], v[26:41]
    ds_read_b64_tr_b16 v[224:225], v130 offset:40000
    ds_read_b64_tr_b16 v[226:227], v130 offset:40768
    s_waitcnt lgkmcnt(4)
    v_mfma_f32_32x32x16_bf16 v[42:57], v[216:219], v[176:179], v[42:57]
    ds_read_b64_tr_b16 v[228:229], v130 offset:40064
    ds_read_b64_tr_b16 v[230:231], v130 offset:40832
    s_waitcnt lgkmcnt(4)
    v_mfma_f32_32x32x16_bf16 v[10:25], v[220:223], v[180:183], v[10:25]
    ds_read_b64_tr_b16 v[208:209], v130 offset:43008
    ds_read_b64_tr_b16 v[210:211], v130 offset:43776
    s_waitcnt lgkmcnt(4)
    v_mfma_f32_32x32x16_bf16 v[26:41], v[224:227], v[180:183], v[26:41]
    ds_read_b64_tr_b16 v[212:213], v130 offset:43072
    ds_read_b64_tr_b16 v[214:215], v130 offset:43840
    s_waitcnt lgkmcnt(4)
    v_mfma_f32_32x32x16_bf16 v[42:57], v[228:231], v[180:183], v[42:57]
    ds_read_b64_tr_b16 v[216:217], v130 offset:43136
    ds_read_b64_tr_b16 v[218:219], v130 offset:43904
    s_waitcnt lgkmcnt(4)
    v_mfma_f32_32x32x16_bf16 v[10:25], v[208:211], v[184:187], v[10:25]
    ds_read_b64_tr_b16 v[220:221], v130 offset:46080
    ds_read_b64_tr_b16 v[222:223], v130 offset:46848
    s_waitcnt lgkmcnt(4)
    v_mfma_f32_32x32x16_bf16 v[26:41], v[212:215], v[184:187], v[26:41]
    ds_read_b64_tr_b16 v[224:225], v130 offset:46144
    ds_read_b64_tr_b16 v[226:227], v130 offset:46912
    s_waitcnt lgkmcnt(4)
    v_mfma_f32_32x32x16_bf16 v[42:57], v[216:219], v[184:187], v[42:57]
    ds_read_b64_tr_b16 v[228:229], v130 offset:46208
    ds_read_b64_tr_b16 v[230:231], v130 offset:46976
    s_waitcnt lgkmcnt(4)
    v_mfma_f32_32x32x16_bf16 v[10:25], v[220:223], v[188:191], v[10:25]
    ds_read_b64_tr_b16 v[208:209], v130 offset:49152
    ds_read_b64_tr_b16 v[210:211], v130 offset:49920
    s_waitcnt lgkmcnt(4)
    v_mfma_f32_32x32x16_bf16 v[26:41], v[224:227], v[188:191], v[26:41]
    ds_read_b64_tr_b16 v[212:213], v130 offset:49216
    ds_read_b64_tr_b16 v[214:215], v130 offset:49984
    s_waitcnt lgkmcnt(4)
    v_mfma_f32_32x32x16_bf16 v[42:57], v[228:231], v[188:191], v[42:57]
    ds_read_b64_tr_b16 v[216:217], v130 offset:49280
    ds_read_b64_tr_b16 v[218:219], v130 offset:50048
    s_waitcnt lgkmcnt(4)
    v_mfma_f32_32x32x16_bf16 v[10:25], v[208:211], v[192:195], v[10:25]
    ds_read_b64_tr_b16 v[220:221], v130 offset:52224
    ds_read_b64_tr_b16 v[222:223], v130 offset:52992
    s_waitcnt lgkmcnt(4)
    v_mfma_f32_32x32x16_bf16 v[26:41], v[212:215], v[192:195], v[26:41]
    ds_read_b64_tr_b16 v[224:225], v130 offset:52288
    ds_read_b64_tr_b16 v[226:227], v130 offset:53056
    s_waitcnt lgkmcnt(4)
    v_mfma_f32_32x32x16_bf16 v[42:57], v[216:219], v[192:195], v[42:57]
    ds_read_b64_tr_b16 v[228:229], v130 offset:52352
    ds_read_b64_tr_b16 v[230:231], v130 offset:53120
    s_waitcnt lgkmcnt(4)
    v_mfma_f32_32x32x16_bf16 v[10:25], v[220:223], v[196:199], v[10:25]
    ds_read_b64_tr_b16 v[208:209], v130 offset:55296
    ds_read_b64_tr_b16 v[210:211], v130 offset:56064
    s_waitcnt lgkmcnt(4)
    v_mfma_f32_32x32x16_bf16 v[26:41], v[224:227], v[196:199], v[26:41]
    ds_read_b64_tr_b16 v[212:213], v130 offset:55360
    ds_read_b64_tr_b16 v[214:215], v130 offset:56128
    s_waitcnt lgkmcnt(4)
    v_mfma_f32_32x32x16_bf16 v[42:57], v[228:231], v[196:199], v[42:57]
    ds_read_b64_tr_b16 v[216:217], v130 offset:55424
    ds_read_b64_tr_b16 v[218:219], v130 offset:56192
    s_waitcnt lgkmcnt(4)
    v_mfma_f32_32x32x16_bf16 v[10:25], v[208:211], v[200:203], v[10:25]
    ds_read_b64_tr_b16 v[220:221], v130 offset:58368
    ds_read_b64_tr_b16 v[222:223], v130 offset:59136
    s_waitcnt lgkmcnt(4)
    v_mfma_f32_32x32x16_bf16 v[26:41], v[212:215], v[200:203], v[26:41]
    ds_read_b64_tr_b16 v[224:225], v130 offset:58432
    ds_read_b64_tr_b16 v[226:227], v130 offset:59200
    s_waitcnt lgkmcnt(4)
    v_mfma_f32_32x32x16_bf16 v[42:57], v[216:219], v[200:203], v[42:57]
    ds_read_b64_tr_b16 v[228:229], v130 offset:58496
    ds_read_b64_tr_b16 v[230:231], v130 offset:59264
    s_waitcnt lgkmcnt(4)
    v_mfma_f32_32x32x16_bf16 v[10:25], v[220:223], v[204:207], v[10:25]
    s_waitcnt lgkmcnt(2)
    v_mfma_f32_32x32x16_bf16 v[26:41], v[224:227], v[204:207], v[26:41]
    s_waitcnt lgkmcnt(0)
    v_mfma_f32_32x32x16_bf16 v[42:57], v[228:231], v[204:207], v[42:57]
    s_cmp_lg_u32 s76, 0
    s_cbranch_scc1 Linitother_5
    v_lshlrev_b32 v60, 2, v0
Linit_3:
    buffer_load_dword v61, v60, s[36:39], 0 offen sc1
    s_waitcnt vmcnt(0)
    v_and_b32 v62, 0x01010101, v61
    v_cmp_ne_u32 vcc, 0x01010101, v62
    s_cbranch_vccz Linitdone_4
    s_cmp_eq_u32 s84, 0
    s_cbranch_scc1 Linitdone_4
    s_sub_u32 s84, s84, 1
    s_sleep 4
    s_branch Linit_3
Linitdone_4:
    s_and_b32 s89, s2, 3
    s_lshl_b32 s89, s89, 3
    v_lshrrev_b32 v61, s89, v61
    v_and_b32 v61, 0xf0, v61
    s_getreg_b32 s89, hwreg(HW_REG_XCC_ID, 0, 4)
    s_lshl_b32 s89, s89, 4
    v_cmp_ne_u32 vcc, s89, v61
    s_bitcmp1_b32 s2, 2
    s_mov_b32 s89, 0x55555555
    s_cselect_b32 s89, 0xaaaaaaaa, s89
    s_and_b32 s90, vcc_lo, s89
    s_and_b32 s91, vcc_hi, s89
    s_or_b32 s90, s90, s91
    s_cmp_eq_u32 s90, 0
    s_cselect_b32 s89, 1, 0
    v_mov_b32 v61, s89
    v_mov_b32 v60, 0x1e800
    ds_write_b32 v60, v61
    s_waitcnt lgkmcnt(0)
Linitother_5:
    s_nop 3
    v_mov_b32 v58, v126
    s_nop 1
    v_permlane32_swap_b32 v126, v58
    v_add_f32 v126, v126, v58
    v_mov_b32 v58, v127
    s_nop 1
    v_permlane32_swap_b32 v127, v58
    v_add_f32 v127, v127, v58
    v_mov_b32 v58, v128
    s_nop 1
    v_permlane32_swap_b32 v128, v58
    v_add_f32 v128, v128, v58
    v_and_b32 v58, 31, v0
    v_lshlrev_b32 v58, 2, v58
    v_add_u32 v58, 0x1e000, v58
    s_mul_i32 s89, s76, 384
    v_add_u32 v59, s89, v58
    ds_write_b32 v59, v126 offset:0
    ds_write_b32 v59, v127 offset:128
    ds_write_b32 v59, v128 offset:256
    s_waitcnt lgkmcnt(0)
    s_barrier
    v_mov_b32 v60, 0x1e800
    ds_read_b32 v61, v60
    s_waitcnt lgkmcnt(0)
    v_readfirstlane_b32 s93, v61
    ds_read_b32 v62, v58 offset:0
    ds_read_b32 v63, v58 offset:128
    ds_read_b32 v64, v58 offset:256
    ds_read_b32 v65, v58 offset:384
    ds_read_b32 v66, v58 offset:512
    ds_read_b32 v67, v58 offset:640
    ds_read_b32 v68, v58 offset:768
    ds_read_b32 v69, v58 offset:896
    ds_read_b32 v70, v58 offset:1024
    ds_read_b32 v71, v58 offset:1152
    ds_read_b32 v72, v58 offset:1280
    ds_read_b32 v73, v58 offset:1408
    v_add_f32 v122, v122, v123
    v_add_f32 v124, v124, v125
    v_mov_b32 v59, v122
    s_nop 1
    v_permlane32_swap_b32 v122, v59
    v_add_f32 v122, v122, v59
    v_mov_b32 v59, v124
    s_nop 1
    v_permlane32_swap_b32 v124, v59
    v_add_f32 v124, v124, v59
    s_waitcnt lgkmcnt(0)
    v_add_f32 v62, v62, v65
    v_add_f32 v68, v68, v71
    v_add_f32 v62, v62, v68
    ds_write_b32 v58, v62 offset:1536
    v_add_f32 v63, v63, v66
    v_add_f32 v69, v69, v72
    v_add_f32 v63, v63, v69
    ds_write_b32 v58, v63 offset:1664
    v_add_f32 v64, v64, v67
    v_add_f32 v70, v70, v73
    v_add_f32 v64, v64, v70
    ds_write_b32 v58, v64 offset:1792
    s_waitcnt lgkmcnt(0)
    v_lshrrev_b32 v107, 5, v0
    v_lshlrev_b32 v107, 4, v107
    v_add_u32 v107, 0x1e600, v107
    ds_read_b128 v[74:77], v107 offset:128
    ds_read_b128 v[78:81], v107 offset:160
    ds_read_b128 v[82:85], v107 offset:192
    ds_read_b128 v[86:89], v107 offset:224
    v_mul_f32 v108, 0x3b000000, v122
    v_mul_f32 v106, 0x3b000000, v124
    v_fma_f32 v106, -v108, v108, v106
    v_max_f32 v106, 0, v106
    v_add_f32 v106, 0x3727c5ac, v106
    v_rsq_f32 v109, v106
    s_nop 0
    v_mul_f32 v110, 0x3eb8aa3b, v109
    v_lshlrev_b32 v111, 4, v0
    v_mul_f32 v114, -1.0, v108
    v_mul_f32 v115, -1.0, v108
    v_mov_b32 v116, v109
    v_mov_b32 v118, v110
    v_mov_b32 v117, v109
    v_mov_b32 v119, v110
    s_lshl_b32 s89, s78, 18
    s_lshl_b32 s92, s77, 12
    s_add_u32 s89, s89, s92
    s_lshl_b32 s92, s76, 10
    s_add_u32 s89, s89, s92
    s_waitcnt lgkmcnt(0)
    v_pk_fma_f32 v[26:27], v[114:115], v[74:75], v[26:27]
    v_pk_fma_f32 v[28:29], v[114:115], v[76:77], v[28:29]
    v_pk_fma_f32 v[30:31], v[114:115], v[78:79], v[30:31]
    v_pk_fma_f32 v[32:33], v[114:115], v[80:81], v[32:33]
    v_pk_fma_f32 v[34:35], v[114:115], v[82:83], v[34:35]
    v_pk_fma_f32 v[36:37], v[114:115], v[84:85], v[36:37]
    v_pk_fma_f32 v[38:39], v[114:115], v[86:87], v[38:39]
    v_pk_fma_f32 v[40:41], v[114:115], v[88:89], v[40:41]
    ds_read_b128 v[74:77], v107 offset:256
    ds_read_b128 v[78:81], v107 offset:288
    ds_read_b128 v[82:85], v107 offset:320
    ds_read_b128 v[86:89], v107 offset:352
    v_pk_mul_f32 v[26:27], v[26:27], v[116:117]
    v_pk_mul_f32 v[28:29], v[28:29], v[116:117]
    v_pk_mul_f32 v[30:31], v[30:31], v[116:117]
    v_pk_mul_f32 v[32:33], v[32:33], v[116:117]
    v_pk_mul_f32 v[34:35], v[34:35], v[116:117]
    v_pk_mul_f32 v[36:37], v[36:37], v[116:117]
    v_pk_mul_f32 v[38:39], v[38:39], v[116:117]
    v_pk_mul_f32 v[40:41], v[40:41], v[116:117]
    v_cvt_pk_bf16_f32 v90, v26, v27
    v_cvt_pk_bf16_f32 v91, v28, v29
    v_cvt_pk_bf16_f32 v92, v30, v31
    v_cvt_pk_bf16_f32 v93, v32, v33
    v_cvt_pk_bf16_f32 v94, v34, v35
    v_cvt_pk_bf16_f32 v95, v36, v37
    v_cvt_pk_bf16_f32 v96, v38, v39
    v_cvt_pk_bf16_f32 v97, v40, v41
    s_add_u32 s90, s89, 0x0
    buffer_store_dwordx4 v[90:93], v111, s[40:43], s90 offen offset:0 sc1
    s_add_u32 s90, s89, 0x10000
    buffer_store_dwordx4 v[94:97], v111, s[40:43], s90 offen offset:0 sc1
    s_waitcnt lgkmcnt(0)
    v_pk_fma_f32 v[42:43], v[114:115], v[74:75], v[42:43]
    v_pk_fma_f32 v[44:45], v[114:115], v[76:77], v[44:45]
    v_pk_fma_f32 v[46:47], v[114:115], v[78:79], v[46:47]
    v_pk_fma_f32 v[48:49], v[114:115], v[80:81], v[48:49]
    v_pk_fma_f32 v[50:51], v[114:115], v[82:83], v[50:51]
    v_pk_fma_f32 v[52:53], v[114:115], v[84:85], v[52:53]
    v_pk_fma_f32 v[54:55], v[114:115], v[86:87], v[54:55]
    v_pk_fma_f32 v[56:57], v[114:115], v[88:89], v[56:57]
    ds_read_b128 v[74:77], v107 offset:0
    ds_read_b128 v[78:81], v107 offset:32
    ds_read_b128 v[82:85], v107 offset:64
    ds_read_b128 v[86:89], v107 offset:96
    v_pk_mul_f32 v[42:43], v[42:43], v[116:117]
    v_pk_mul_f32 v[44:45], v[44:45], v[116:117]
    v_pk_mul_f32 v[46:47], v[46:47], v[116:117]
    v_pk_mul_f32 v[48:49], v[48:49], v[116:117]
    v_pk_mul_f32 v[50:51], v[50:51], v[116:117]
    v_pk_mul_f32 v[52:53], v[52:53], v[116:117]
    v_pk_mul_f32 v[54:55], v[54:55], v[116:117]
    v_pk_mul_f32 v[56:57], v[56:57], v[116:117]
    v_cvt_pk_bf16_f32 v98, v42, v43
    v_cvt_pk_bf16_f32 v99, v44, v45
    v_cvt_pk_bf16_f32 v100, v46, v47
    v_cvt_pk_bf16_f32 v101, v48, v49
    v_cvt_pk_bf16_f32 v102, v50, v51
    v_cvt_pk_bf16_f32 v103, v52, v53
    v_cvt_pk_bf16_f32 v104, v54, v55
    v_cvt_pk_bf16_f32 v105, v56, v57
    s_add_u32 s90, s89, 0x20000
    buffer_store_dwordx4 v[98:101], v111, s[40:43], s90 offen offset:0 sc1
    s_add_u32 s90, s89, 0x30000
    buffer_store_dwordx4 v[102:105], v111, s[40:43], s90 offen offset:0 sc1
    s_add_u32 s89, s76, 8
    s_mul_i32 s89, s89, 1152
    v_add_u32 v112, s89, v111
    v_lshrrev_b32 v113, 5, v0
    v_mul_u32_u24 v113, 576, v113
    v_and_b32 v106, 31, v0
    v_lshlrev_b32 v106, 4, v106
    v_add_u32 v113, v113, v106
    v_add_u32 v113, s89, v113
    s_waitcnt lgkmcnt(0)
    ds_write_b128 v112, v[90:93] offset:0
    ds_write_b128 v112, v[94:97] offset:13824
    ds_write_b128 v113, v[98:101] offset:27648
    ds_write_b128 v113, v[102:105] offset:41472
    v_pk_fma_f32 v[10:11], v[114:115], v[74:75], v[10:11]
    v_pk_fma_f32 v[12:13], v[114:115], v[76:77], v[12:13]
    v_pk_fma_f32 v[14:15], v[114:115], v[78:79], v[14:15]
    v_pk_fma_f32 v[16:17], v[114:115], v[80:81], v[16:17]
    v_pk_fma_f32 v[18:19], v[114:115], v[82:83], v[18:19]
    v_pk_fma_f32 v[20:21], v[114:115], v[84:85], v[20:21]
    v_pk_fma_f32 v[22:23], v[114:115], v[86:87], v[22:23]
    v_pk_fma_f32 v[24:25], v[114:115], v[88:89], v[24:25]
    v_pk_mul_f32 v[10:11], v[10:11], v[118:119]
    v_pk_mul_f32 v[12:13], v[12:13], v[118:119]
    v_pk_mul_f32 v[14:15], v[14:15], v[118:119]
    v_pk_mul_f32 v[16:17], v[16:17], v[118:119]
    v_pk_mul_f32 v[18:19], v[18:19], v[118:119]
    v_pk_mul_f32 v[20:21], v[20:21], v[118:119]
    v_pk_mul_f32 v[22:23], v[22:23], v[118:119]
    v_pk_mul_f32 v[24:25], v[24:25], v[118:119]
    v_cvt_pk_bf16_f32 v10, v10, v11
    v_cvt_pk_bf16_f32 v11, v12, v13
    v_cvt_pk_bf16_f32 v12, v14, v15
    v_cvt_pk_bf16_f32 v13, v16, v17
    v_cvt_pk_bf16_f32 v14, v18, v19
    v_cvt_pk_bf16_f32 v15, v20, v21
    v_cvt_pk_bf16_f32 v16, v22, v23
    v_cvt_pk_bf16_f32 v17, v24, v25
    v_mov_b32 v74, s85
    v_mov_b32 v75, s85
    v_mov_b32 v76, s85
    v_mov_b32 v77, s85
    ds_write_b128 v111, v[74:77] offset:55296
    v_lshlrev_b32 v1, 16, v1
    s_mov_b32 s44, 0xffffffff
    s_mov_b32 s45, 0xfffffff0
    s_mov_b32 s46, 0xfffffffe
    s_mov_b32 s47, 0xffffffe0
    s_mov_b32 s48, 0xfffffffc
    s_mov_b32 s49, 0xffffffc0
    s_mov_b32 s50, 0xfffffff8
    s_mov_b32 s51, 0xffffff80
    s_mov_b32 s52, 0xffffff00
    s_mov_b32 s53, 0xfffff000
    s_mov_b32 s54, 0xfffffe00
    s_mov_b32 s55, 0xffffe000
    s_mov_b32 s56, 0xfffffc00
    s_mov_b32 s57, 0xffffc000
    s_mov_b32 s58, 0xfffff800
    s_mov_b32 s59, 0xffff8000
    s_mov_b32 s60, 0xffff0000
    s_mov_b32 s61, 0xfff00000
    s_mov_b32 s62, 0xfffe0000
    s_mov_b32 s63, 0xffe00000
    s_mov_b32 s64, 0xfffc0000
    s_mov_b32 s65, 0xffc00000
    s_mov_b32 s66, 0xfff80000
    s_mov_b32 s67, 0xff800000
    s_mov_b32 s68, 0xff000000
    s_mov_b32 s69, 0xf0000000
    s_mov_b32 s70, 0xfe000000
    s_mov_b32 s71, 0xe0000000
    s_mov_b32 s72, 0xfc000000
    s_mov_b32 s73, 0xc0000000
    s_mov_b32 s74, 0xf8000000
    s_mov_b32 s75, 0x80000000
    v_lshlrev_b32 v124, 4, v0
    s_lshl_b32 s86, s78, 2
    s_add_u32 s86, s86, s76
    s_lshl_b32 s86, s86, 16
    s_lshl_b32 s87, s77, 2
    v_lshlrev_b32 v125, 7, v0
    s_lshl_b32 s89, s76, 13
    s_add_u32 s89, s89, 0x1900000
    buffer_load_dword v119, v125, s[40:43], s89 offen offset:0 sc1
    s_add_u32 s89, s87, 0
    s_max_u32 s89, s89, 8
    s_sub_u32 s89, s89, 8
    s_lshl_b32 s89, s89, 10
    s_add_u32 s89, s89, s86
    buffer_load_dwordx4 v[18:21], v124, s[40:43], s89 offen offset:0 sc1
    s_add_u32 s89, s87, 1
    s_max_u32 s89, s89, 8
    s_sub_u32 s89, s89, 8
    s_lshl_b32 s89, s89, 10
    s_add_u32 s89, s89, s86
    buffer_load_dwordx4 v[22:25], v124, s[40:43], s89 offen offset:0 sc1
    s_add_u32 s89, s87, 2
    s_max_u32 s89, s89, 8
    s_sub_u32 s89, s89, 8
    s_lshl_b32 s89, s89, 10
    s_add_u32 s89, s89, s86
    buffer_load_dwordx4 v[26:29], v124, s[40:43], s89 offen offset:0 sc1
    s_add_u32 s89, s87, 3
    s_max_u32 s89, s89, 8
    s_sub_u32 s89, s89, 8
    s_lshl_b32 s89, s89, 10
    s_add_u32 s89, s89, s86
    buffer_load_dwordx4 v[30:33], v124, s[40:43], s89 offen offset:0 sc1
    s_add_u32 s89, s87, 4
    s_max_u32 s89, s89, 8
    s_sub_u32 s89, s89, 8
    s_lshl_b32 s89, s89, 10
    s_add_u32 s89, s89, s86
    buffer_load_dwordx4 v[34:37], v124, s[40:43], s89 offen offset:0 sc1
    s_add_u32 s89, s87, 5
    s_max_u32 s89, s89, 8
    s_sub_u32 s89, s89, 8
    s_lshl_b32 s89, s89, 10
    s_add_u32 s89, s89, s86
    buffer_load_dwordx4 v[38:41], v124, s[40:43], s89 offen offset:0 sc1
    s_add_u32 s89, s87, 6
    s_max_u32 s89, s89, 8
    s_sub_u32 s89, s89, 8
    s_lshl_b32 s89, s89, 10
    s_add_u32 s89, s89, s86
    buffer_load_dwordx4 v[42:45], v124, s[40:43], s89 offen offset:0 sc1
    s_add_u32 s89, s87, 7
    s_max_u32 s89, s89, 8
    s_sub_u32 s89, s89, 8
    s_lshl_b32 s89, s89, 10
    s_add_u32 s89, s89, s86
    buffer_load_dwordx4 v[46:49], v124, s[40:43], s89 offen offset:0 sc1
    v_lshlrev_b32 v136, 4, v0
    s_mul_i32 s96, s76, 6144
    s_add_u32 s96, s96, 0xf000
    v_add_u32 v133, s96, v136
    v_lshrrev_b32 v134, 4, v0
    v_lshlrev_b32 v134, 3, v134
    v_bfe_u32 v137, v0, 2, 2
    v_add_u32 v134, v134, v137
    v_mul_u32_u24 v134, 192, v134
    v_and_b32 v137, 3, v0
    v_lshlrev_b32 v137, 3, v137
    v_add_u32 v134, v134, v137
    v_add_u32 v134, s96, v134
    v_lshrrev_b32 v135, 5, v0
    v_lshlrev_b32 v135, 3, v135
    v_bfe_u32 v137, v0, 2, 2
    v_add_u32 v135, v135, v137
    v_mul_u32_u24 v135, 384, v135
    v_bfe_u32 v137, v0, 4, 1
    v_lshlrev_b32 v137, 5, v137
    v_add_u32 v135, v135, v137
    v_and_b32 v137, 3, v0
    v_lshlrev_b32 v137, 3, v137
    v_add_u32 v135, v135, v137
    s_mul_i32 s96, s76, 6144
    s_add_u32 s96, s96, 0xf000
    v_add_u32 v135, s96, v135
    s_waitcnt vmcnt(18)
    ds_write_b128 v133, a[24:27] offset:0
    ds_write_b128 v133, a[28:31] offset:1024
    ds_write_b128 v133, a[32:35] offset:2048
    ds_write_b128 v133, a[36:39] offset:3072
    ds_write_b128 v133, a[40:43] offset:4096
    ds_write_b128 v133, a[44:47] offset:5120
    ds_read_b64_tr_b16 a[24:25], v135 offset:0
    ds_read_b64_tr_b16 a[26:27], v135 offset:1536
    s_waitcnt lgkmcnt(9)
    ds_read_b64_tr_b16 a[28:29], v135 offset:64
    ds_read_b64_tr_b16 a[30:31], v135 offset:1600
    s_waitcnt lgkmcnt(9)
    ds_read_b64_tr_b16 a[32:33], v135 offset:128
    ds_read_b64_tr_b16 a[34:35], v135 offset:1664
    s_waitcnt lgkmcnt(9)
    ds_read_b64_tr_b16 a[36:37], v135 offset:192
    ds_read_b64_tr_b16 a[38:39], v135 offset:1728
    s_waitcnt lgkmcnt(9)
    ds_read_b64_tr_b16 a[40:41], v135 offset:256
    ds_read_b64_tr_b16 a[42:43], v135 offset:1792
    s_waitcnt lgkmcnt(9)
    ds_read_b64_tr_b16 a[44:45], v135 offset:320
    ds_read_b64_tr_b16 a[46:47], v135 offset:1856
    s_waitcnt lgkmcnt(9)
    s_lshl_b32 s97, s2, 2
    s_add_u32 s97, s97, s76
    s_min_u32 s97, s97, 967
    s_mul_i32 s96, s97, 745
    s_lshr_b32 s96, s96, 13
    s_mul_i32 s1, s96, 11
    s_sub_u32 s97, s97, s1
    s_mul_i32 s97, s97, 264
    s_add_u32 s96, s96, s97
    s_lshl_b32 s96, s96, 11
    s_add_u32 s96, s96, 0x2000000
    s_waitcnt lgkmcnt(0)
    buffer_store_dwordx4 a[24:27], v136, s[40:43], s96 offen offset:0 sc1
    buffer_store_dwordx4 a[28:31], v136, s[40:43], s96 offen offset:1024 sc1
    s_add_u32 s96, s96, 0x2c000
    buffer_store_dwordx4 a[32:35], v136, s[40:43], s96 offen offset:0 sc1
    buffer_store_dwordx4 a[36:39], v136, s[40:43], s96 offen offset:1024 sc1
    s_add_u32 s96, s96, 0x2c000
    buffer_store_dwordx4 a[40:43], v136, s[40:43], s96 offen offset:0 sc1
    buffer_store_dwordx4 a[44:47], v136, s[40:43], s96 offen offset:1024 sc1
    s_mul_i32 s96, s77, 6144
    s_lshl_b32 s97, s76, 1
    s_add_u32 s97, s97, 0
    s_min_u32 s97, s97, 5
    s_lshl_b32 s97, s97, 10
    s_add_u32 s97, s97, s96
    s_mul_i32 s1, s78, 98304
    s_add_u32 s97, s97, s1
    s_add_u32 s97, s97, 0x2600000
    buffer_store_dwordx4 a[48:51], v136, s[40:43], s97 offen offset:0 sc1
    s_lshl_b32 s97, s76, 1
    s_add_u32 s97, s97, 1
    s_min_u32 s97, s97, 5
    s_lshl_b32 s97, s97, 10
    s_add_u32 s97, s97, s96
    s_mul_i32 s1, s78, 98304
    s_add_u32 s97, s97, s1
    s_add_u32 s97, s97, 0x2600000
    buffer_store_dwordx4 a[52:55], v136, s[40:43], s97 offen offset:0 sc1
    v_lshrrev_b32 v121, 5, v0
    v_mul_u32_u24 v121, 576, v121
    v_and_b32 v116, 31, v0
    v_lshlrev_b32 v116, 4, v116
    v_add_u32 v121, v121, v116
    s_cmp_lt_u32 s76, 2
    s_cselect_b64 vcc, -1, 0
    v_cndmask_b32 v115, v121, v124, vcc
    s_mul_i32 s89, s76, 13824
    v_add_u32 v115, s89, v115
    s_mul_i32 s88, s76, 1152
    v_add_u32 v120, s88, v124
    v_bfe_u32 v123, v0, 1, 1
    v_mul_u32_u24 v123, 576, v123
    v_lshrrev_b32 v116, 5, v0
    v_lshlrev_b32 v116, 2, v116
    v_bfe_u32 v117, v0, 2, 2
    v_add_u32 v116, v116, v117
    v_lshlrev_b32 v116, 4, v116
    v_add_u32 v123, v123, v116
    v_and_b32 v116, 1, v0
    v_lshlrev_b32 v116, 3, v116
    v_add_u32 v123, v123, v116
    s_mul_i32 s89, s83, 1152
    s_add_u32 s89, s89, s88
    s_add_u32 s89, s89, 27648
    v_add_u32 v123, s89, v123
    v_bfe_u32 v116, v0, 4, 1
    v_cmp_eq_u32 vcc, 1, v116
    v_mov_b32 v117, 55296
    s_nop 0
    v_cndmask_b32 v123, v123, v117, vcc
    v_mov_b32 v116, 1152
    v_mov_b32 v117, 0
    v_cndmask_b32 v122, v116, v117, vcc
    v_mov_b32 v118, 0xff800000
    v_mov_b32 v116, 0
    v_mov_b32 v117, 0xffff
    v_mov_b32 v82, 0xffff0000
    v_cndmask_b32 v144, v116, v117, s[44:45]
    v_cndmask_b32 v83, v116, v82, s[46:47]
    v_or_b32 v144, v144, v83
    v_cndmask_b32 v145, v116, v117, s[48:49]
    v_cndmask_b32 v83, v116, v82, s[50:51]
    v_or_b32 v145, v145, v83
    v_cndmask_b32 v146, v116, v117, s[52:53]
    v_cndmask_b32 v83, v116, v82, s[54:55]
    v_or_b32 v146, v146, v83
    v_cndmask_b32 v147, v116, v117, s[56:57]
    v_cndmask_b32 v83, v116, v82, s[58:59]
    v_or_b32 v147, v147, v83
    v_cndmask_b32 v148, v116, v117, s[60:61]
    v_cndmask_b32 v83, v116, v82, s[62:63]
    v_or_b32 v148, v148, v83
    v_cndmask_b32 v149, v116, v117, s[64:65]
    v_cndmask_b32 v83, v116, v82, s[66:67]
    v_or_b32 v149, v149, v83
    v_cndmask_b32 v150, v116, v117, s[68:69]
    v_cndmask_b32 v83, v116, v82, s[70:71]
    v_or_b32 v150, v150, v83
    v_cndmask_b32 v151, v116, v117, s[72:73]
    v_cndmask_b32 v83, v116, v82, s[74:75]
    v_or_b32 v151, v151, v83
    ds_read_b128 v[90:93], v120 offset:9216
    ds_read_b128 v[94:97], v120 offset:23040
    s_waitcnt lgkmcnt(0)
    v_mfma_f32_32x32x16_bf16 v[50:65], v[90:93], v[10:13], 0
    v_mfma_f32_32x32x16_bf16 v[66:81], v[94:97], v[14:17], 0
    s_nop 10
    v_cndmask_b32 v50, v118, v50, s[44:45]
    v_cndmask_b32 v51, v118, v51, s[46:47]
    v_cndmask_b32 v52, v118, v52, s[48:49]
    v_cndmask_b32 v53, v118, v53, s[50:51]
    v_cndmask_b32 v54, v118, v54, s[52:53]
    v_cndmask_b32 v55, v118, v55, s[54:55]
    v_cndmask_b32 v56, v118, v56, s[56:57]
    v_cndmask_b32 v57, v118, v57, s[58:59]
    v_cndmask_b32 v58, v118, v58, s[60:61]
    v_cndmask_b32 v59, v118, v59, s[62:63]
    v_cndmask_b32 v60, v118, v60, s[64:65]
    v_cndmask_b32 v61, v118, v61, s[66:67]
    v_cndmask_b32 v62, v118, v62, s[68:69]
    v_cndmask_b32 v63, v118, v63, s[70:71]
    v_cndmask_b32 v64, v118, v64, s[72:73]
    v_cndmask_b32 v65, v118, v65, s[74:75]
    v_max3_f32 v82, v50, v51, v52
    v_max3_f32 v83, v53, v54, v55
    v_max3_f32 v82, v82, v56, v57
    v_max3_f32 v83, v83, v58, v59
    v_max3_f32 v82, v82, v60, v61
    v_max3_f32 v83, v83, v62, v63
    v_max3_f32 v82, v82, v64, v65
    v_max_f32 v82, v82, v83
    v_mov_b32 v83, v82
    s_nop 1
    v_permlane32_swap_b32 v82, v83
    v_max_f32 v114, v82, v83
    v_cndmask_b32 v66, v118, v66, s[44:45]
    v_cndmask_b32 v67, v118, v67, s[46:47]
    v_cndmask_b32 v68, v118, v68, s[48:49]
    v_cndmask_b32 v69, v118, v69, s[50:51]
    v_cndmask_b32 v70, v118, v70, s[52:53]
    v_cndmask_b32 v71, v118, v71, s[54:55]
    v_cndmask_b32 v72, v118, v72, s[56:57]
    v_cndmask_b32 v73, v118, v73, s[58:59]
    v_cndmask_b32 v74, v118, v74, s[60:61]
    v_cndmask_b32 v75, v118, v75, s[62:63]
    v_cndmask_b32 v76, v118, v76, s[64:65]
    v_cndmask_b32 v77, v118, v77, s[66:67]
    v_cndmask_b32 v78, v118, v78, s[68:69]
    v_cndmask_b32 v79, v118, v79, s[70:71]
    v_cndmask_b32 v80, v118, v80, s[72:73]
    v_cndmask_b32 v81, v118, v81, s[74:75]
    v_max3_f32 v82, v66, v67, v68
    v_max3_f32 v83, v69, v70, v71
    v_max3_f32 v82, v82, v72, v73
    v_max3_f32 v83, v83, v74, v75
    v_max3_f32 v82, v82, v76, v77
    v_max3_f32 v83, v83, v78, v79
    v_max3_f32 v82, v82, v80, v81
    v_max_f32 v82, v82, v83
    v_mov_b32 v83, v82
    s_nop 1
    v_permlane32_swap_b32 v82, v83
    v_max_f32 v141, v82, v83
    s_waitcnt vmcnt(8)
    v_max3_u32 v116, v21, v25, v29
    v_max3_u32 v116, v116, v33, v37
    v_max3_u32 v116, v116, v41, v45
    v_max_u32 v116, v116, v49
    v_cmp_eq_u32 vcc, -1, v116
    s_cbranch_vccnz Lrt_halo_6
Lbk_halo_7:
    ds_write_b128 v115, v[18:21] offset:0
    ds_write_b128 v115, v[22:25] offset:1152
    ds_write_b128 v115, v[26:29] offset:2304
    ds_write_b128 v115, v[30:33] offset:3456
    ds_write_b128 v115, v[34:37] offset:4608
    ds_write_b128 v115, v[38:41] offset:5760
    ds_write_b128 v115, v[42:45] offset:6912
    ds_write_b128 v115, v[46:49] offset:8064
    s_waitcnt vmcnt(0)
    s_lshl_b32 s89, s76, 13
    s_add_u32 s89, s89, 0x1900000
    s_branch Lflchk_10
Lfl_8:
    buffer_load_dword v119, v125, s[40:43], s89 offen offset:0 sc1
    s_waitcnt vmcnt(0)
Lflchk_10:
    v_cmp_ne_u32 vcc, 1, v119
    s_cbranch_vccz Lfldone_9
    s_cmp_eq_u32 s84, 0
    s_cbranch_scc1 Lfldone_9
    s_sub_u32 s84, s84, 1
    s_sleep 2
    s_branch Lfl_8
Lfldone_9:
    s_waitcnt lgkmcnt(0)
    s_barrier
    s_cmp_lg_u32 s76, 0
    s_cbranch_scc1 Lnoflag_11
    s_lshl_b32 s89, s2, 7
    s_add_u32 s89, s89, 0x1900000
    v_mov_b32 v116, 0
    v_mov_b32 v117, 1
    buffer_store_dword v117, v116, s[40:43], s89 offen offset:4 sc1
Lnoflag_11:
    v_mov_b32 v121, v123
    s_cmp_lg_u32 s83, 0
    s_cbranch_scc1 La2s_12
    ds_read_b128 v[90:93], v120 offset:0
    ds_read_b128 v[94:97], v120 offset:1152
    ds_read_b64_tr_b16 v[98:99], v121 offset:0
    ds_read_b64_tr_b16 v[100:101], v121 offset:128
    ds_read_b64_tr_b16 v[102:103], v121 offset:256
    ds_read_b64_tr_b16 v[104:105], v121 offset:384
    v_mul_f32 v66, -1.0, v114
    v_mul_f32 v67, -1.0, v114
    v_mul_f32 v68, -1.0, v114
    v_mul_f32 v69, -1.0, v114
    v_mul_f32 v70, -1.0, v114
    v_mul_f32 v71, -1.0, v114
    v_mul_f32 v72, -1.0, v114
    v_mul_f32 v73, -1.0, v114
    v_mul_f32 v74, -1.0, v114
    v_mul_f32 v75, -1.0, v114
    v_mul_f32 v76, -1.0, v114
    v_mul_f32 v77, -1.0, v114
    v_mul_f32 v78, -1.0, v114
    v_mul_f32 v79, -1.0, v114
    v_mul_f32 v80, -1.0, v114
    v_mul_f32 v81, -1.0, v114
    s_waitcnt lgkmcnt(5)
    s_nop 0
    v_mfma_f32_32x32x16_bf16 v[18:33], v[90:93], v[10:13], v[66:81]
    s_nop 7
    s_nop 3
La2b_21:
    v_exp_f32 v18, v18
    v_exp_f32 v19, v19
    v_exp_f32 v20, v20
    v_exp_f32 v21, v21
    s_waitcnt lgkmcnt(4)
    v_mfma_f32_32x32x16_bf16 v[34:49], v[94:97], v[10:13], v[66:81]
    v_exp_f32 v22, v22
    v_exp_f32 v23, v23
    v_exp_f32 v24, v24
    v_exp_f32 v25, v25
    ds_read_b128 v[90:93], v120 offset:2304
    v_cvt_pk_bf16_f32 v82, v18, v19
    v_cvt_pk_bf16_f32 v83, v20, v21
    v_cvt_pk_bf16_f32 v84, v22, v23
    v_cvt_pk_bf16_f32 v85, v24, v25
    v_bfi_b32 v82, v144, 0, v82
    v_bfi_b32 v83, v145, 0, v83
    v_bfi_b32 v84, v146, 0, v84
    v_bfi_b32 v85, v147, 0, v85
    v_exp_f32 v26, v26
    v_exp_f32 v27, v27
    s_waitcnt lgkmcnt(1)
    v_mfma_f32_32x32x16_bf16 v[50:65], v[98:101], v[82:85], 0
    v_mov_b32 v126, -1
    v_mov_b32 v127, -1
    v_mov_b32 v128, -1
    v_mov_b32 v129, -1
    v_lshlrev_b32 v130, 4, v0
    v_lshlrev_b32 v131, 3, v0
    v_and_b32 v132, 31, v0
    v_lshlrev_b32 v132, 3, v132
    s_lshl_b32 s88, s81, 1
    s_add_u32 s88, s88, s100
    s_mul_i32 s88, s88, 96
    s_mul_i32 s92, s82, 3
    s_add_u32 s88, s88, s92
    s_lshl_b32 s88, s88, 10
    s_add_u32 s88, s88, 0x1000000
    s_lshl_b32 s92, s101, 9
    s_add_u32 s88, s88, s92
    buffer_store_dwordx2 v[126:127], v131, s[40:43], s88 offen offset:0 sc1
    buffer_store_dwordx2 v[126:127], v131, s[40:43], s88 offen offset:1024 sc1
    v_exp_f32 v28, v28
    v_exp_f32 v29, v29
    v_exp_f32 v30, v30
    v_add_u32 v121, v121, v122
    ds_read_b64_tr_b16 v[106:107], v121 offset:0
    ds_read_b64_tr_b16 v[108:109], v121 offset:128
    v_exp_f32 v31, v31
    v_exp_f32 v32, v32
    v_exp_f32 v33, v33
    buffer_store_dwordx2 v[126:127], v131, s[40:43], s88 offen offset:2048 sc1
    s_lshl_b32 s88, s79, 1
    s_add_u32 s88, s88, s101
    s_lshl_b32 s88, s88, 5
    s_lshl_b32 s92, s80, 2
    s_add_u32 s88, s88, s92
    s_lshl_b32 s92, s100, 1
    s_add_u32 s88, s88, s92
    s_lshl_b32 s88, s88, 10
    s_add_u32 s88, s88, 0x1400000
    buffer_store_dwordx4 v[126:129], v130, s[40:43], s88 offen offset:0 sc1
    buffer_store_dwordx4 v[126:129], v130, s[40:43], s88 offen offset:1024 sc1
    v_cvt_pk_bf16_f32 v86, v26, v27
    v_cvt_pk_bf16_f32 v87, v28, v29
    v_cvt_pk_bf16_f32 v88, v30, v31
    v_cvt_pk_bf16_f32 v89, v32, v33
    v_bfi_b32 v86, v148, 0, v86
    v_bfi_b32 v87, v149, 0, v87
    v_bfi_b32 v88, v150, 0, v88
    v_bfi_b32 v89, v151, 0, v89
    ds_read_b64_tr_b16 v[110:111], v121 offset:256
    ds_read_b64_tr_b16 v[112:113], v121 offset:384
    v_mfma_f32_32x32x16_bf16 v[50:65], v[102:105], v[86:89], v[50:65]
La2b_22:
    v_exp_f32 v34, v34
    v_exp_f32 v35, v35
    v_exp_f32 v36, v36
    v_exp_f32 v37, v37
    s_waitcnt lgkmcnt(4)
    v_mfma_f32_32x32x16_bf16 v[18:33], v[90:93], v[10:13], v[66:81]
    v_exp_f32 v38, v38
    v_exp_f32 v39, v39
    v_exp_f32 v40, v40
    v_exp_f32 v41, v41
    ds_read_b128 v[94:97], v120 offset:3456
    v_cvt_pk_bf16_f32 v82, v34, v35
    v_cvt_pk_bf16_f32 v83, v36, v37
    v_cvt_pk_bf16_f32 v84, v38, v39
    v_cvt_pk_bf16_f32 v85, v40, v41
    v_exp_f32 v42, v42
    v_exp_f32 v43, v43
    s_waitcnt lgkmcnt(1)
    v_mfma_f32_32x32x16_bf16 v[50:65], v[106:109], v[82:85], v[50:65]
    s_lshl_b32 s88, s79, 3
    s_add_u32 s88, s88, s80
    s_lshl_b32 s88, s88, 1
    s_add_u32 s88, s88, s100
    s_lshl_b32 s88, s88, 9
    s_lshl_b32 s92, s101, 8
    s_add_u32 s88, s88, s92
    s_add_u32 s88, s88, 0x1680000
    buffer_store_dwordx2 v[126:127], v132, s[40:43], s88 offen offset:0 sc1
    v_lshrrev_b32 v138, 3, v0
    v_lshlrev_b32 v138, 10, v138
    v_and_b32 v139, 7, v0
    v_lshrrev_b32 v140, 4, v0
    v_and_b32 v140, 1, v140
    v_lshlrev_b32 v140, 2, v140
    v_xor_b32 v139, v139, v140
    v_lshlrev_b32 v139, 4, v139
    v_add_u32 v138, v138, v139
    s_lshl_b32 s96, s76, 17
    s_lshl_b32 s97, s80, 7
    s_add_u32 s96, s96, s97
    s_lshl_b32 s97, s76, 14
    v_exp_f32 v44, v44
    v_exp_f32 v45, v45
    v_exp_f32 v46, v46
    v_add_u32 v121, v121, v122
    ds_read_b64_tr_b16 v[98:99], v121 offset:0
    ds_read_b64_tr_b16 v[100:101], v121 offset:128
    v_exp_f32 v47, v47
    v_exp_f32 v48, v48
    v_exp_f32 v49, v49
    s_add_u32 s92, s96, 0x0
    s_add_u32 m0, s97, 57344
    s_nop 0
    buffer_load_dwordx4 v138, s[12:15], s92 offen lds
    s_add_u32 s92, s96, 0x2000
    s_add_u32 m0, s97, 58368
    s_nop 0
    buffer_load_dwordx4 v138, s[12:15], s92 offen lds
    s_add_u32 s92, s96, 0x4000
    s_add_u32 m0, s97, 59392
    s_nop 0
    buffer_load_dwordx4 v138, s[12:15], s92 offen lds
    v_cvt_pk_bf16_f32 v86, v42, v43
    v_cvt_pk_bf16_f32 v87, v44, v45
    v_cvt_pk_bf16_f32 v88, v46, v47
    v_cvt_pk_bf16_f32 v89, v48, v49
    ds_read_b64_tr_b16 v[102:103], v121 offset:256
    ds_read_b64_tr_b16 v[104:105], v121 offset:384
    v_mfma_f32_32x32x16_bf16 v[50:65], v[110:113], v[86:89], v[50:65]
La2b_23:
    v_exp_f32 v18, v18
    v_exp_f32 v19, v19
    v_exp_f32 v20, v20
    v_exp_f32 v21, v21
    s_waitcnt lgkmcnt(4)
    v_mfma_f32_32x32x16_bf16 v[34:49], v[94:97], v[10:13], v[66:81]
    v_exp_f32 v22, v22
    v_exp_f32 v23, v23
    v_exp_f32 v24, v24
    v_exp_f32 v25, v25
    ds_read_b128 v[90:93], v120 offset:4608
    v_cvt_pk_bf16_f32 v82, v18, v19
    v_cvt_pk_bf16_f32 v83, v20, v21
    v_cvt_pk_bf16_f32 v84, v22, v23
    v_cvt_pk_bf16_f32 v85, v24, v25
    v_exp_f32 v26, v26
    v_exp_f32 v27, v27
    s_waitcnt lgkmcnt(1)
    v_mfma_f32_32x32x16_bf16 v[50:65], v[98:101], v[82:85], v[50:65]
    s_add_u32 s92, s96, 0x6000
    s_add_u32 m0, s97, 60416
    s_nop 0
    buffer_load_dwordx4 v138, s[12:15], s92 offen lds
    s_add_u32 s92, s96, 0x8000
    s_add_u32 m0, s97, 61440
    s_nop 0
    buffer_load_dwordx4 v138, s[12:15], s92 offen lds
    s_add_u32 s92, s96, 0xa000
    s_add_u32 m0, s97, 62464
    s_nop 0
    buffer_load_dwordx4 v138, s[12:15], s92 offen lds
    v_exp_f32 v28, v28
    v_exp_f32 v29, v29
    v_exp_f32 v30, v30
    v_add_u32 v121, v121, v122
    ds_read_b64_tr_b16 v[106:107], v121 offset:0
    ds_read_b64_tr_b16 v[108:109], v121 offset:128
    v_exp_f32 v31, v31
    v_exp_f32 v32, v32
    v_exp_f32 v33, v33
    s_add_u32 s92, s96, 0xc000
    s_add_u32 m0, s97, 63488
    s_nop 0
    buffer_load_dwordx4 v138, s[12:15], s92 offen lds
    s_add_u32 s92, s96, 0xe000
    s_add_u32 m0, s97, 64512
    s_nop 0
    buffer_load_dwordx4 v138, s[12:15], s92 offen lds
    s_add_u32 s92, s96, 0x10000
    s_add_u32 m0, s97, 65536
    s_nop 0
    buffer_load_dwordx4 v138, s[12:15], s92 offen lds
    v_cvt_pk_bf16_f32 v86, v26, v27
    v_cvt_pk_bf16_f32 v87, v28, v29
    v_cvt_pk_bf16_f32 v88, v30, v31
    v_cvt_pk_bf16_f32 v89, v32, v33
    ds_read_b64_tr_b16 v[110:111], v121 offset:256
    ds_read_b64_tr_b16 v[112:113], v121 offset:384
    v_mfma_f32_32x32x16_bf16 v[50:65], v[102:105], v[86:89], v[50:65]
La2b_24:
    v_exp_f32 v34, v34
    v_exp_f32 v35, v35
    v_exp_f32 v36, v36
    v_exp_f32 v37, v37
    s_waitcnt lgkmcnt(4)
    v_mfma_f32_32x32x16_bf16 v[18:33], v[90:93], v[10:13], v[66:81]
    v_exp_f32 v38, v38
    v_exp_f32 v39, v39
    v_exp_f32 v40, v40
    v_exp_f32 v41, v41
    ds_read_b128 v[94:97], v120 offset:5760
    v_cvt_pk_bf16_f32 v82, v34, v35
    v_cvt_pk_bf16_f32 v83, v36, v37
    v_cvt_pk_bf16_f32 v84, v38, v39
    v_cvt_pk_bf16_f32 v85, v40, v41
    v_exp_f32 v42, v42
    v_exp_f32 v43, v43
    s_waitcnt lgkmcnt(1)
    v_mfma_f32_32x32x16_bf16 v[50:65], v[106:109], v[82:85], v[50:65]
    s_add_u32 s92, s96, 0x12000
    s_add_u32 m0, s97, 66560
    s_nop 0
    buffer_load_dwordx4 v138, s[12:15], s92 offen lds
    s_add_u32 s92, s96, 0x14000
    s_add_u32 m0, s97, 67584
    s_nop 0
    buffer_load_dwordx4 v138, s[12:15], s92 offen lds
    s_add_u32 s92, s96, 0x16000
    s_add_u32 m0, s97, 68608
    s_nop 0
    buffer_load_dwordx4 v138, s[12:15], s92 offen lds
    v_exp_f32 v44, v44
    v_exp_f32 v45, v45
    v_exp_f32 v46, v46
    v_add_u32 v121, v121, v122
    ds_read_b64_tr_b16 v[98:99], v121 offset:0
    ds_read_b64_tr_b16 v[100:101], v121 offset:128
    v_exp_f32 v47, v47
    v_exp_f32 v48, v48
    v_exp_f32 v49, v49
    s_add_u32 s92, s96, 0x18000
    s_add_u32 m0, s97, 69632
    s_nop 0
    buffer_load_dwordx4 v138, s[12:15], s92 offen lds
    s_add_u32 s92, s96, 0x1a000
    s_add_u32 m0, s97, 70656
    s_nop 0
    buffer_load_dwordx4 v138, s[12:15], s92 offen lds
    s_add_u32 s92, s96, 0x1c000
    s_add_u32 m0, s97, 71680
    s_nop 0
    buffer_load_dwordx4 v138, s[12:15], s92 offen lds
    v_cvt_pk_bf16_f32 v86, v42, v43
    v_cvt_pk_bf16_f32 v87, v44, v45
    v_cvt_pk_bf16_f32 v88, v46, v47
    v_cvt_pk_bf16_f32 v89, v48, v49
    ds_read_b64_tr_b16 v[102:103], v121 offset:256
    ds_read_b64_tr_b16 v[104:105], v121 offset:384
    v_mfma_f32_32x32x16_bf16 v[50:65], v[110:113], v[86:89], v[50:65]
La2b_25:
    v_exp_f32 v18, v18
    v_exp_f32 v19, v19
    v_exp_f32 v20, v20
    v_exp_f32 v21, v21
    s_waitcnt lgkmcnt(4)
    v_mfma_f32_32x32x16_bf16 v[34:49], v[94:97], v[10:13], v[66:81]
    v_exp_f32 v22, v22
    v_exp_f32 v23, v23
    v_exp_f32 v24, v24
    v_exp_f32 v25, v25
    ds_read_b128 v[90:93], v120 offset:6912
    v_cvt_pk_bf16_f32 v82, v18, v19
    v_cvt_pk_bf16_f32 v83, v20, v21
    v_cvt_pk_bf16_f32 v84, v22, v23
    v_cvt_pk_bf16_f32 v85, v24, v25
    v_exp_f32 v26, v26
    v_exp_f32 v27, v27
    s_waitcnt lgkmcnt(1)
    v_mfma_f32_32x32x16_bf16 v[50:65], v[98:101], v[82:85], v[50:65]
    s_add_u32 s92, s96, 0x1e000
    s_add_u32 m0, s97, 72704
    s_nop 0
    buffer_load_dwordx4 v138, s[12:15], s92 offen lds
    v_lshlrev_b32 v136, 4, v0
    s_lshl_b32 s96, s82, 6
    s_lshl_b32 s97, s76, 4
    s_add_u32 s96, s96, s97
    s_mul_i32 s96, s96, 3072
    s_add_u32 s96, s96, 0x1a00000
    s_add_u32 s97, s96, 0x0
    buffer_load_dwordx4 a[0:3], v136, s[40:43], s97 offen offset:0 sc1
    v_exp_f32 v28, v28
    v_exp_f32 v29, v29
    v_exp_f32 v30, v30
    v_add_u32 v121, v121, v122
    ds_read_b64_tr_b16 v[106:107], v121 offset:0
    ds_read_b64_tr_b16 v[108:109], v121 offset:128
    v_exp_f32 v31, v31
    v_exp_f32 v32, v32
    v_exp_f32 v33, v33
    buffer_load_dwordx4 a[4:7], v136, s[40:43], s97 offen offset:1024 sc1
    buffer_load_dwordx4 a[8:11], v136, s[40:43], s97 offen offset:2048 sc1
    s_add_u32 s97, s96, 0xc00
    buffer_load_dwordx4 a[12:15], v136, s[40:43], s97 offen offset:0 sc1
    v_cvt_pk_bf16_f32 v86, v26, v27
    v_cvt_pk_bf16_f32 v87, v28, v29
    v_cvt_pk_bf16_f32 v88, v30, v31
    v_cvt_pk_bf16_f32 v89, v32, v33
    ds_read_b64_tr_b16 v[110:111], v121 offset:256
    ds_read_b64_tr_b16 v[112:113], v121 offset:384
    v_mfma_f32_32x32x16_bf16 v[50:65], v[102:105], v[86:89], v[50:65]
La2b_26:
    v_exp_f32 v34, v34
    v_exp_f32 v35, v35
    v_exp_f32 v36, v36
    v_exp_f32 v37, v37
    s_waitcnt lgkmcnt(4)
    v_mfma_f32_32x32x16_bf16 v[18:33], v[90:93], v[10:13], v[66:81]
    v_exp_f32 v38, v38
    v_exp_f32 v39, v39
    v_exp_f32 v40, v40
    v_exp_f32 v41, v41
    ds_read_b128 v[94:97], v120 offset:8064
    v_cvt_pk_bf16_f32 v82, v34, v35
    v_cvt_pk_bf16_f32 v83, v36, v37
    v_cvt_pk_bf16_f32 v84, v38, v39
    v_cvt_pk_bf16_f32 v85, v40, v41
    v_exp_f32 v42, v42
    v_exp_f32 v43, v43
    s_waitcnt lgkmcnt(1)
    v_mfma_f32_32x32x16_bf16 v[50:65], v[106:109], v[82:85], v[50:65]
    buffer_load_dwordx4 a[16:19], v136, s[40:43], s97 offen offset:1024 sc1
    buffer_load_dwordx4 a[20:23], v136, s[40:43], s97 offen offset:2048 sc1
    s_add_u32 s97, s96, 0x1800
    buffer_load_dwordx4 a[24:27], v136, s[40:43], s97 offen offset:0 sc1
    v_exp_f32 v44, v44
    v_exp_f32 v45, v45
    v_exp_f32 v46, v46
    v_add_u32 v121, v121, v122
    ds_read_b64_tr_b16 v[98:99], v121 offset:0
    ds_read_b64_tr_b16 v[100:101], v121 offset:128
    v_exp_f32 v47, v47
    v_exp_f32 v48, v48
    v_exp_f32 v49, v49
    buffer_load_dwordx4 a[28:31], v136, s[40:43], s97 offen offset:1024 sc1
    buffer_load_dwordx4 a[32:35], v136, s[40:43], s97 offen offset:2048 sc1
    s_add_u32 s97, s96, 0x2400
    buffer_load_dwordx4 a[36:39], v136, s[40:43], s97 offen offset:0 sc1
    v_cvt_pk_bf16_f32 v86, v42, v43
    v_cvt_pk_bf16_f32 v87, v44, v45
    v_cvt_pk_bf16_f32 v88, v46, v47
    v_cvt_pk_bf16_f32 v89, v48, v49
    ds_read_b64_tr_b16 v[102:103], v121 offset:256
    ds_read_b64_tr_b16 v[104:105], v121 offset:384
    v_mfma_f32_32x32x16_bf16 v[50:65], v[110:113], v[86:89], v[50:65]
La2b_27:
    v_exp_f32 v18, v18
    v_exp_f32 v19, v19
    v_exp_f32 v20, v20
    v_exp_f32 v21, v21
    s_waitcnt lgkmcnt(4)
    v_mfma_f32_32x32x16_bf16 v[34:49], v[94:97], v[10:13], v[66:81]
    v_exp_f32 v22, v22
    v_exp_f32 v23, v23
    v_exp_f32 v24, v24
    v_exp_f32 v25, v25
    ds_read_b128 v[90:93], v120 offset:9216
    v_cvt_pk_bf16_f32 v82, v18, v19
    v_cvt_pk_bf16_f32 v83, v20, v21
    v_cvt_pk_bf16_f32 v84, v22, v23
    v_cvt_pk_bf16_f32 v85, v24, v25
    v_exp_f32 v26, v26
    v_exp_f32 v27, v27
    s_waitcnt lgkmcnt(1)
    v_mfma_f32_32x32x16_bf16 v[50:65], v[98:101], v[82:85], v[50:65]
    buffer_load_dwordx4 a[40:43], v136, s[40:43], s97 offen offset:1024 sc1
    buffer_load_dwordx4 a[44:47], v136, s[40:43], s97 offen offset:2048 sc1
    s_add_u32 s97, s96, 0x3000
    buffer_load_dwordx4 a[48:51], v136, s[40:43], s97 offen offset:0 sc1
    v_exp_f32 v28, v28
    v_exp_f32 v29, v29
    v_exp_f32 v30, v30
    v_add_u32 v121, v121, v122
    ds_read_b64_tr_b16 v[106:107], v121 offset:0
    ds_read_b64_tr_b16 v[108:109], v121 offset:128
    v_exp_f32 v31, v31
    v_exp_f32 v32, v32
    v_exp_f32 v33, v33
    buffer_load_dwordx4 a[52:55], v136, s[40:43], s97 offen offset:1024 sc1
    buffer_load_dwordx4 a[56:59], v136, s[40:43], s97 offen offset:2048 sc1
    s_add_u32 s97, s96, 0x3c00
    buffer_load_dwordx4 a[60:63], v136, s[40:43], s97 offen offset:0 sc1
    v_cvt_pk_bf16_f32 v86, v26, v27
    v_cvt_pk_bf16_f32 v87, v28, v29
    v_cvt_pk_bf16_f32 v88, v30, v31
    v_cvt_pk_bf16_f32 v89, v32, v33
    ds_read_b64_tr_b16 v[110:111], v121 offset:256
    ds_read_b64_tr_b16 v[112:113], v121 offset:384
    v_mfma_f32_32x32x16_bf16 v[50:65], v[102:105], v[86:89], v[50:65]
La2b_28:
    v_exp_f32 v34, v34
    v_exp_f32 v35, v35
    v_exp_f32 v36, v36
    v_exp_f32 v37, v37
    s_waitcnt lgkmcnt(4)
    v_mfma_f32_32x32x16_bf16 v[18:33], v[90:93], v[10:13], v[66:81]
    v_exp_f32 v38, v38
    v_exp_f32 v39, v39
    v_exp_f32 v40, v40
    v_exp_f32 v41, v41
    v_cvt_pk_bf16_f32 v82, v34, v35
    v_cvt_pk_bf16_f32 v83, v36, v37
    v_cvt_pk_bf16_f32 v84, v38, v39
    v_cvt_pk_bf16_f32 v85, v40, v41
    v_exp_f32 v42, v42
    v_exp_f32 v43, v43
    s_waitcnt lgkmcnt(0)
    v_mfma_f32_32x32x16_bf16 v[50:65], v[106:109], v[82:85], v[50:65]
    buffer_load_dwordx4 a[64:67], v136, s[40:43], s97 offen offset:1024 sc1
    buffer_load_dwordx4 a[68:71], v136, s[40:43], s97 offen offset:2048 sc1
    s_add_u32 s97, s96, 0x4800
    buffer_load_dwordx4 a[72:75], v136, s[40:43], s97 offen offset:0 sc1
    v_exp_f32 v44, v44
    v_exp_f32 v45, v45
    v_exp_f32 v46, v46
    v_add_u32 v121, v121, v122
    ds_read_b64_tr_b16 v[98:99], v121 offset:0
    ds_read_b64_tr_b16 v[100:101], v121 offset:128
    v_exp_f32 v47, v47
    v_exp_f32 v48, v48
    v_exp_f32 v49, v49
    buffer_load_dwordx4 a[76:79], v136, s[40:43], s97 offen offset:1024 sc1
    buffer_load_dwordx4 a[80:83], v136, s[40:43], s97 offen offset:2048 sc1
    s_add_u32 s97, s96, 0x5400
    buffer_load_dwordx4 a[84:87], v136, s[40:43], s97 offen offset:0 sc1
    v_cvt_pk_bf16_f32 v86, v42, v43
    v_cvt_pk_bf16_f32 v87, v44, v45
    v_cvt_pk_bf16_f32 v88, v46, v47
    v_cvt_pk_bf16_f32 v89, v48, v49
    ds_read_b64_tr_b16 v[102:103], v121 offset:256
    ds_read_b64_tr_b16 v[104:105], v121 offset:384
    v_mfma_f32_32x32x16_bf16 v[50:65], v[110:113], v[86:89], v[50:65]
La2b_29:
    v_exp_f32 v18, v18
    v_exp_f32 v19, v19
    v_exp_f32 v20, v20
    v_exp_f32 v21, v21
    v_exp_f32 v22, v22
    v_exp_f32 v23, v23
    v_exp_f32 v24, v24
    v_exp_f32 v25, v25
    v_cvt_pk_bf16_f32 v82, v18, v19
    v_cvt_pk_bf16_f32 v83, v20, v21
    v_cvt_pk_bf16_f32 v84, v22, v23
    v_cvt_pk_bf16_f32 v85, v24, v25
    v_and_b32 v82, v144, v82
    v_and_b32 v83, v145, v83
    v_and_b32 v84, v146, v84
    v_and_b32 v85, v147, v85
    v_exp_f32 v26, v26
    v_exp_f32 v27, v27
    s_waitcnt lgkmcnt(0)
    v_mfma_f32_32x32x16_bf16 v[50:65], v[98:101], v[82:85], v[50:65]
    buffer_load_dwordx4 a[88:91], v136, s[40:43], s97 offen offset:1024 sc1
    buffer_load_dwordx4 a[92:95], v136, s[40:43], s97 offen offset:2048 sc1
    s_add_u32 s97, s96, 0x6000
    buffer_load_dwordx4 a[96:99], v136, s[40:43], s97 offen offset:0 sc1
    v_exp_f32 v28, v28
    v_exp_f32 v29, v29
    v_exp_f32 v30, v30
    v_exp_f32 v31, v31
    v_exp_f32 v32, v32
    v_exp_f32 v33, v33
    buffer_load_dwordx4 a[100:103], v136, s[40:43], s97 offen offset:1024 sc1
    buffer_load_dwordx4 a[104:107], v136, s[40:43], s97 offen offset:2048 sc1
    s_add_u32 s97, s96, 0x6c00
    buffer_load_dwordx4 a[108:111], v136, s[40:43], s97 offen offset:0 sc1
    v_cvt_pk_bf16_f32 v86, v26, v27
    v_cvt_pk_bf16_f32 v87, v28, v29
    v_cvt_pk_bf16_f32 v88, v30, v31
    v_cvt_pk_bf16_f32 v89, v32, v33
    v_and_b32 v86, v148, v86
    v_and_b32 v87, v149, v87
    v_and_b32 v88, v150, v88
    v_and_b32 v89, v151, v89
    s_nop 1
    v_mfma_f32_32x32x16_bf16 v[50:65], v[102:105], v[86:89], v[50:65]
    s_waitcnt lgkmcnt(0)
    s_nop 10
    v_cmp_ngt_f32 vcc, 0x4e800000, v58
    s_cbranch_vccnz Lredo_30
Lredone_31:
    v_rcp_f32 v116, v58
    s_nop 0
    v_mov_b32 v117, v116
    v_pk_mul_f32 v[50:51], v[50:51], v[116:117]
    v_pk_mul_f32 v[52:53], v[52:53], v[116:117]
    v_pk_mul_f32 v[54:55], v[54:55], v[116:117]
    v_pk_mul_f32 v[56:57], v[56:57], v[116:117]
    v_cvt_pk_bf16_f32 v82, v50, v51
    v_cvt_pk_bf16_f32 v83, v52, v53
    v_cvt_pk_bf16_f32 v84, v54, v55
    v_cvt_pk_bf16_f32 v85, v56, v57
    s_lshl_b32 s89, s77, 2
    s_add_u32 s89, s89, s76
    s_lshl_b32 s89, s89, 15
    s_lshl_b32 s92, s78, 11
    s_add_u32 s89, s89, s92
    s_add_u32 s89, s89, 0x800000
    s_cmp_eq_u32 s93, 0
    s_cbranch_scc1 Lfar_68
    buffer_store_dwordx4 v[82:85], v124, s[40:43], s89 offen offset:0
    s_branch Lstored_69
Lfar_68:
    buffer_store_dwordx4 v[82:85], v124, s[40:43], s89 offen offset:0 sc1
Lstored_69:
    v_lshlrev_b32 v125, 7, v0
    s_lshl_b32 s88, s76, 13
    s_add_u32 s88, s88, 0x1900000
    buffer_load_dword v119, v125, s[40:43], s88 offen offset:4 sc1
    v_mov_b32 v121, v123
    v_mov_b32 v116, 13824
    v_cmp_ne_u32 vcc, 0, v122
    v_mov_b32 v117, 0
    s_nop 0
    v_cndmask_b32 v116, v117, v116, vcc
    v_add_u32 v121, v121, v116
    s_cmp_lg_u32 s83, 0
    s_cbranch_scc1 La2s_70
    ds_read_b128 v[90:93], v120 offset:13824
    ds_read_b128 v[94:97], v120 offset:14976
    ds_read_b64_tr_b16 v[98:99], v121 offset:0
    ds_read_b64_tr_b16 v[100:101], v121 offset:128
    ds_read_b64_tr_b16 v[102:103], v121 offset:256
    ds_read_b64_tr_b16 v[104:105], v121 offset:384
    v_mul_f32 v66, -1.0, v141
    v_mul_f32 v67, -1.0, v141
    v_mul_f32 v68, -1.0, v141
    v_mul_f32 v69, -1.0, v141
    v_mul_f32 v70, -1.0, v141
    v_mul_f32 v71, -1.0, v141
    v_mul_f32 v72, -1.0, v141
    v_mul_f32 v73, -1.0, v141
    v_mul_f32 v74, -1.0, v141
    v_mul_f32 v75, -1.0, v141
    v_mul_f32 v76, -1.0, v141
    v_mul_f32 v77, -1.0, v141
    v_mul_f32 v78, -1.0, v141
    v_mul_f32 v79, -1.0, v141
    v_mul_f32 v80, -1.0, v141
    v_mul_f32 v81, -1.0, v141
    s_waitcnt lgkmcnt(5)
    s_nop 0
    v_mfma_f32_32x32x16_bf16 v[18:33], v[90:93], v[14:17], v[66:81]
    s_nop 7
    s_nop 3
La2b_79:
    v_exp_f32 v18, v18
    v_exp_f32 v19, v19
    v_exp_f32 v20, v20
    v_exp_f32 v21, v21
    s_waitcnt lgkmcnt(4)
    v_mfma_f32_32x32x16_bf16 v[34:49], v[94:97], v[14:17], v[66:81]
    v_exp_f32 v22, v22
    v_exp_f32 v23, v23
    v_exp_f32 v24, v24
    v_exp_f32 v25, v25
    ds_read_b128 v[90:93], v120 offset:16128
    v_cvt_pk_bf16_f32 v82, v18, v19
    v_cvt_pk_bf16_f32 v83, v20, v21
    v_cvt_pk_bf16_f32 v84, v22, v23
    v_cvt_pk_bf16_f32 v85, v24, v25
    v_bfi_b32 v82, v144, 0, v82
    v_bfi_b32 v83, v145, 0, v83
    v_bfi_b32 v84, v146, 0, v84
    v_bfi_b32 v85, v147, 0, v85
    v_exp_f32 v26, v26
    v_exp_f32 v27, v27
    s_waitcnt lgkmcnt(1)
    v_mfma_f32_32x32x16_bf16 v[50:65], v[98:101], v[82:85], 0
    buffer_load_dwordx4 a[112:115], v136, s[40:43], s97 offen offset:1024 sc1
    buffer_load_dwordx4 a[116:119], v136, s[40:43], s97 offen offset:2048 sc1
    s_add_u32 s97, s96, 0x7800
    buffer_load_dwordx4 a[120:123], v136, s[40:43], s97 offen offset:0 sc1
    v_exp_f32 v28, v28
    v_exp_f32 v29, v29
    v_exp_f32 v30, v30
    v_add_u32 v121, v121, v122
    ds_read_b64_tr_b16 v[106:107], v121 offset:0
    ds_read_b64_tr_b16 v[108:109], v121 offset:128
    v_exp_f32 v31, v31
    v_exp_f32 v32, v32
    v_exp_f32 v33, v33
    buffer_load_dwordx4 a[124:127], v136, s[40:43], s97 offen offset:1024 sc1
    buffer_load_dwordx4 a[128:131], v136, s[40:43], s97 offen offset:2048 sc1
    s_add_u32 s97, s96, 0x8400
    buffer_load_dwordx4 a[132:135], v136, s[40:43], s97 offen offset:0 sc1
    v_cvt_pk_bf16_f32 v86, v26, v27
    v_cvt_pk_bf16_f32 v87, v28, v29
    v_cvt_pk_bf16_f32 v88, v30, v31
    v_cvt_pk_bf16_f32 v89, v32, v33
    v_bfi_b32 v86, v148, 0, v86
    v_bfi_b32 v87, v149, 0, v87
    v_bfi_b32 v88, v150, 0, v88
    v_bfi_b32 v89, v151, 0, v89
    ds_read_b64_tr_b16 v[110:111], v121 offset:256
    ds_read_b64_tr_b16 v[112:113], v121 offset:384
    v_mfma_f32_32x32x16_bf16 v[50:65], v[102:105], v[86:89], v[50:65]
La2b_80:
    v_exp_f32 v34, v34
    v_exp_f32 v35, v35
    v_exp_f32 v36, v36
    v_exp_f32 v37, v37
    s_waitcnt lgkmcnt(4)
    v_mfma_f32_32x32x16_bf16 v[18:33], v[90:93], v[14:17], v[66:81]
    v_exp_f32 v38, v38
    v_exp_f32 v39, v39
    v_exp_f32 v40, v40
    v_exp_f32 v41, v41
    ds_read_b128 v[94:97], v120 offset:17280
    v_cvt_pk_bf16_f32 v82, v34, v35
    v_cvt_pk_bf16_f32 v83, v36, v37
    v_cvt_pk_bf16_f32 v84, v38, v39
    v_cvt_pk_bf16_f32 v85, v40, v41
    v_exp_f32 v42, v42
    v_exp_f32 v43, v43
    s_waitcnt lgkmcnt(1)
    v_mfma_f32_32x32x16_bf16 v[50:65], v[106:109], v[82:85], v[50:65]
    buffer_load_dwordx4 a[136:139], v136, s[40:43], s97 offen offset:1024 sc1
    buffer_load_dwordx4 a[140:143], v136, s[40:43], s97 offen offset:2048 sc1
    s_add_u32 s97, s96, 0x9000
    buffer_load_dwordx4 a[144:147], v136, s[40:43], s97 offen offset:0 sc1
    v_exp_f32 v44, v44
    v_exp_f32 v45, v45
    v_exp_f32 v46, v46
    v_add_u32 v121, v121, v122
    ds_read_b64_tr_b16 v[98:99], v121 offset:0
    ds_read_b64_tr_b16 v[100:101], v121 offset:128
    v_exp_f32 v47, v47
    v_exp_f32 v48, v48
    v_exp_f32 v49, v49
    buffer_load_dwordx4 a[148:151], v136, s[40:43], s97 offen offset:1024 sc1
    buffer_load_dwordx4 a[152:155], v136, s[40:43], s97 offen offset:2048 sc1
    s_add_u32 s97, s96, 0x9c00
    buffer_load_dwordx4 a[156:159], v136, s[40:43], s97 offen offset:0 sc1
    v_cvt_pk_bf16_f32 v86, v42, v43
    v_cvt_pk_bf16_f32 v87, v44, v45
    v_cvt_pk_bf16_f32 v88, v46, v47
    v_cvt_pk_bf16_f32 v89, v48, v49
    ds_read_b64_tr_b16 v[102:103], v121 offset:256
    ds_read_b64_tr_b16 v[104:105], v121 offset:384
    v_mfma_f32_32x32x16_bf16 v[50:65], v[110:113], v[86:89], v[50:65]
La2b_81:
    v_exp_f32 v18, v18
    v_exp_f32 v19, v19
    v_exp_f32 v20, v20
    v_exp_f32 v21, v21
    s_waitcnt lgkmcnt(4)
    v_mfma_f32_32x32x16_bf16 v[34:49], v[94:97], v[14:17], v[66:81]
    v_exp_f32 v22, v22
    v_exp_f32 v23, v23
    v_exp_f32 v24, v24
    v_exp_f32 v25, v25
    ds_read_b128 v[90:93], v120 offset:18432
    v_cvt_pk_bf16_f32 v82, v18, v19
    v_cvt_pk_bf16_f32 v83, v20, v21
    v_cvt_pk_bf16_f32 v84, v22, v23
    v_cvt_pk_bf16_f32 v85, v24, v25
    v_exp_f32 v26, v26
    v_exp_f32 v27, v27
    s_waitcnt lgkmcnt(1)
    v_mfma_f32_32x32x16_bf16 v[50:65], v[98:101], v[82:85], v[50:65]
    buffer_load_dwordx4 a[160:163], v136, s[40:43], s97 offen offset:1024 sc1
    buffer_load_dwordx4 a[164:167], v136, s[40:43], s97 offen offset:2048 sc1
    s_add_u32 s97, s96, 0xa800
    buffer_load_dwordx4 a[168:171], v136, s[40:43], s97 offen offset:0 sc1
    v_exp_f32 v28, v28
    v_exp_f32 v29, v29
    v_exp_f32 v30, v30
    v_add_u32 v121, v121, v122
    ds_read_b64_tr_b16 v[106:107], v121 offset:0
    ds_read_b64_tr_b16 v[108:109], v121 offset:128
    v_exp_f32 v31, v31
    v_exp_f32 v32, v32
    v_exp_f32 v33, v33
    buffer_load_dwordx4 a[172:175], v136, s[40:43], s97 offen offset:1024 sc1
    buffer_load_dwordx4 a[176:179], v136, s[40:43], s97 offen offset:2048 sc1
    s_add_u32 s97, s96, 0xb400
    buffer_load_dwordx4 a[180:183], v136, s[40:43], s97 offen offset:0 sc1
    v_cvt_pk_bf16_f32 v86, v26, v27
    v_cvt_pk_bf16_f32 v87, v28, v29
    v_cvt_pk_bf16_f32 v88, v30, v31
    v_cvt_pk_bf16_f32 v89, v32, v33
    ds_read_b64_tr_b16 v[110:111], v121 offset:256
    ds_read_b64_tr_b16 v[112:113], v121 offset:384
    v_mfma_f32_32x32x16_bf16 v[50:65], v[102:105], v[86:89], v[50:65]
La2b_82:
    v_exp_f32 v34, v34
    v_exp_f32 v35, v35
    v_exp_f32 v36, v36
    v_exp_f32 v37, v37
    s_waitcnt lgkmcnt(4)
    v_mfma_f32_32x32x16_bf16 v[18:33], v[90:93], v[14:17], v[66:81]
    v_exp_f32 v38, v38
    v_exp_f32 v39, v39
    v_exp_f32 v40, v40
    v_exp_f32 v41, v41
    ds_read_b128 v[94:97], v120 offset:19584
    v_cvt_pk_bf16_f32 v82, v34, v35
    v_cvt_pk_bf16_f32 v83, v36, v37
    v_cvt_pk_bf16_f32 v84, v38, v39
    v_cvt_pk_bf16_f32 v85, v40, v41
    v_exp_f32 v42, v42
    v_exp_f32 v43, v43
    s_waitcnt lgkmcnt(1)
    v_mfma_f32_32x32x16_bf16 v[50:65], v[106:109], v[82:85], v[50:65]
    buffer_load_dwordx4 a[184:187], v136, s[40:43], s97 offen offset:1024 sc1
    buffer_load_dwordx4 a[188:191], v136, s[40:43], s97 offen offset:2048 sc1
    v_exp_f32 v44, v44
    v_exp_f32 v45, v45
    v_exp_f32 v46, v46
    v_add_u32 v121, v121, v122
    ds_read_b64_tr_b16 v[98:99], v121 offset:0
    ds_read_b64_tr_b16 v[100:101], v121 offset:128
    v_exp_f32 v47, v47
    v_exp_f32 v48, v48
    v_exp_f32 v49, v49
    v_cvt_pk_bf16_f32 v86, v42, v43
    v_cvt_pk_bf16_f32 v87, v44, v45
    v_cvt_pk_bf16_f32 v88, v46, v47
    v_cvt_pk_bf16_f32 v89, v48, v49
    ds_read_b64_tr_b16 v[102:103], v121 offset:256
    ds_read_b64_tr_b16 v[104:105], v121 offset:384
    v_mfma_f32_32x32x16_bf16 v[50:65], v[110:113], v[86:89], v[50:65]
La2b_83:
    v_exp_f32 v18, v18
    v_exp_f32 v19, v19
    v_exp_f32 v20, v20
    v_exp_f32 v21, v21
    s_waitcnt lgkmcnt(4)
    v_mfma_f32_32x32x16_bf16 v[34:49], v[94:97], v[14:17], v[66:81]
    v_exp_f32 v22, v22
    v_exp_f32 v23, v23
    v_exp_f32 v24, v24
    v_exp_f32 v25, v25
    ds_read_b128 v[90:93], v120 offset:20736
    v_cvt_pk_bf16_f32 v82, v18, v19
    v_cvt_pk_bf16_f32 v83, v20, v21
    v_cvt_pk_bf16_f32 v84, v22, v23
    v_cvt_pk_bf16_f32 v85, v24, v25
    v_exp_f32 v26, v26
    v_exp_f32 v27, v27
    s_waitcnt lgkmcnt(1)
    v_mfma_f32_32x32x16_bf16 v[50:65], v[98:101], v[82:85], v[50:65]
    v_exp_f32 v28, v28
    v_exp_f32 v29, v29
    v_exp_f32 v30, v30
    v_add_u32 v121, v121, v122
    ds_read_b64_tr_b16 v[106:107], v121 offset:0
    ds_read_b64_tr_b16 v[108:109], v121 offset:128
    v_exp_f32 v31, v31
    v_exp_f32 v32, v32
    v_exp_f32 v33, v33
    v_cvt_pk_bf16_f32 v86, v26, v27
    v_cvt_pk_bf16_f32 v87, v28, v29
    v_cvt_pk_bf16_f32 v88, v30, v31
    v_cvt_pk_bf16_f32 v89, v32, v33
    ds_read_b64_tr_b16 v[110:111], v121 offset:256
    ds_read_b64_tr_b16 v[112:113], v121 offset:384
    v_mfma_f32_32x32x16_bf16 v[50:65], v[102:105], v[86:89], v[50:65]
La2b_84:
    v_exp_f32 v34, v34
    v_exp_f32 v35, v35
    v_exp_f32 v36, v36
    v_exp_f32 v37, v37
    s_waitcnt lgkmcnt(4)
    v_mfma_f32_32x32x16_bf16 v[18:33], v[90:93], v[14:17], v[66:81]
    v_exp_f32 v38, v38
    v_exp_f32 v39, v39
    v_exp_f32 v40, v40
    v_exp_f32 v41, v41
    ds_read_b128 v[94:97], v120 offset:21888
    v_cvt_pk_bf16_f32 v82, v34, v35
    v_cvt_pk_bf16_f32 v83, v36, v37
    v_cvt_pk_bf16_f32 v84, v38, v39
    v_cvt_pk_bf16_f32 v85, v40, v41
    v_exp_f32 v42, v42
    v_exp_f32 v43, v43
    s_waitcnt lgkmcnt(1)
    v_mfma_f32_32x32x16_bf16 v[50:65], v[106:109], v[82:85], v[50:65]
    v_exp_f32 v44, v44
    v_exp_f32 v45, v45
    v_exp_f32 v46, v46
    v_add_u32 v121, v121, v122
    ds_read_b64_tr_b16 v[98:99], v121 offset:0
    ds_read_b64_tr_b16 v[100:101], v121 offset:128
    v_exp_f32 v47, v47
    v_exp_f32 v48, v48
    v_exp_f32 v49, v49
    v_cvt_pk_bf16_f32 v86, v42, v43
    v_cvt_pk_bf16_f32 v87, v44, v45
    v_cvt_pk_bf16_f32 v88, v46, v47
    v_cvt_pk_bf16_f32 v89, v48, v49
    ds_read_b64_tr_b16 v[102:103], v121 offset:256
    ds_read_b64_tr_b16 v[104:105], v121 offset:384
    v_mfma_f32_32x32x16_bf16 v[50:65], v[110:113], v[86:89], v[50:65]
La2b_85:
    v_exp_f32 v18, v18
    v_exp_f32 v19, v19
    v_exp_f32 v20, v20
    v_exp_f32 v21, v21
    s_waitcnt lgkmcnt(4)
    v_mfma_f32_32x32x16_bf16 v[34:49], v[94:97], v[14:17], v[66:81]
    v_exp_f32 v22, v22
    v_exp_f32 v23, v23
    v_exp_f32 v24, v24
    v_exp_f32 v25, v25
    ds_read_b128 v[90:93], v120 offset:23040
    v_cvt_pk_bf16_f32 v82, v18, v19
    v_cvt_pk_bf16_f32 v83, v20, v21
    v_cvt_pk_bf16_f32 v84, v22, v23
    v_cvt_pk_bf16_f32 v85, v24, v25
    v_exp_f32 v26, v26
    v_exp_f32 v27, v27
    s_waitcnt lgkmcnt(1)
    v_mfma_f32_32x32x16_bf16 v[50:65], v[98:101], v[82:85], v[50:65]
    v_exp_f32 v28, v28
    v_exp_f32 v29, v29
    v_exp_f32 v30, v30
    v_add_u32 v121, v121, v122
    ds_read_b64_tr_b16 v[106:107], v121 offset:0
    ds_read_b64_tr_b16 v[108:109], v121 offset:128
    v_exp_f32 v31, v31
    v_exp_f32 v32, v32
    v_exp_f32 v33, v33
    v_cvt_pk_bf16_f32 v86, v26, v27
    v_cvt_pk_bf16_f32 v87, v28, v29
    v_cvt_pk_bf16_f32 v88, v30, v31
    v_cvt_pk_bf16_f32 v89, v32, v33
    ds_read_b64_tr_b16 v[110:111], v121 offset:256
    ds_read_b64_tr_b16 v[112:113], v121 offset:384
    v_mfma_f32_32x32x16_bf16 v[50:65], v[102:105], v[86:89], v[50:65]
La2b_86:
    v_exp_f32 v34, v34
    v_exp_f32 v35, v35
    v_exp_f32 v36, v36
    v_exp_f32 v37, v37
    s_waitcnt lgkmcnt(4)
    v_mfma_f32_32x32x16_bf16 v[18:33], v[90:93], v[14:17], v[66:81]
    v_exp_f32 v38, v38
    v_exp_f32 v39, v39
    v_exp_f32 v40, v40
    v_exp_f32 v41, v41
    v_cvt_pk_bf16_f32 v82, v34, v35
    v_cvt_pk_bf16_f32 v83, v36, v37
    v_cvt_pk_bf16_f32 v84, v38, v39
    v_cvt_pk_bf16_f32 v85, v40, v41
    v_exp_f32 v42, v42
    v_exp_f32 v43, v43
    s_waitcnt lgkmcnt(0)
    v_mfma_f32_32x32x16_bf16 v[50:65], v[106:109], v[82:85], v[50:65]
    v_exp_f32 v44, v44
    v_exp_f32 v45, v45
    v_exp_f32 v46, v46
    v_add_u32 v121, v121, v122
    ds_read_b64_tr_b16 v[98:99], v121 offset:0
    ds_read_b64_tr_b16 v[100:101], v121 offset:128
    v_exp_f32 v47, v47
    v_exp_f32 v48, v48
    v_exp_f32 v49, v49
    v_cvt_pk_bf16_f32 v86, v42, v43
    v_cvt_pk_bf16_f32 v87, v44, v45
    v_cvt_pk_bf16_f32 v88, v46, v47
    v_cvt_pk_bf16_f32 v89, v48, v49
    ds_read_b64_tr_b16 v[102:103], v121 offset:256
    ds_read_b64_tr_b16 v[104:105], v121 offset:384
    v_mfma_f32_32x32x16_bf16 v[50:65], v[110:113], v[86:89], v[50:65]
La2b_87:
    v_exp_f32 v18, v18
    v_exp_f32 v19, v19
    v_exp_f32 v20, v20
    v_exp_f32 v21, v21
    v_exp_f32 v22, v22
    v_exp_f32 v23, v23
    v_exp_f32 v24, v24
    v_exp_f32 v25, v25
    v_cvt_pk_bf16_f32 v82, v18, v19
    v_cvt_pk_bf16_f32 v83, v20, v21
    v_cvt_pk_bf16_f32 v84, v22, v23
    v_cvt_pk_bf16_f32 v85, v24, v25
    v_and_b32 v82, v144, v82
    v_and_b32 v83, v145, v83
    v_and_b32 v84, v146, v84
    v_and_b32 v85, v147, v85
    v_exp_f32 v26, v26
    v_exp_f32 v27, v27
    s_waitcnt lgkmcnt(0)
    v_mfma_f32_32x32x16_bf16 v[50:65], v[98:101], v[82:85], v[50:65]
    v_exp_f32 v28, v28
    v_exp_f32 v29, v29
    v_exp_f32 v30, v30
    v_exp_f32 v31, v31
    v_exp_f32 v32, v32
    v_exp_f32 v33, v33
    v_cvt_pk_bf16_f32 v86, v26, v27
    v_cvt_pk_bf16_f32 v87, v28, v29
    v_cvt_pk_bf16_f32 v88, v30, v31
    v_cvt_pk_bf16_f32 v89, v32, v33
    v_and_b32 v86, v148, v86
    v_and_b32 v87, v149, v87
    v_and_b32 v88, v150, v88
    v_and_b32 v89, v151, v89
    s_nop 1
    v_mfma_f32_32x32x16_bf16 v[50:65], v[102:105], v[86:89], v[50:65]
    s_waitcnt lgkmcnt(0)
    s_nop 10
    v_cmp_ngt_f32 vcc, 0x4e800000, v58
    s_cbranch_vccnz Lredo_88
Lredone_89:
    v_rcp_f32 v116, v58
    s_nop 0
    v_mov_b32 v117, v116
    v_pk_mul_f32 v[50:51], v[50:51], v[116:117]
    v_pk_mul_f32 v[52:53], v[52:53], v[116:117]
    v_pk_mul_f32 v[54:55], v[54:55], v[116:117]
    v_pk_mul_f32 v[56:57], v[56:57], v[116:117]
    v_cvt_pk_bf16_f32 v82, v50, v51
    v_cvt_pk_bf16_f32 v83, v52, v53
    v_cvt_pk_bf16_f32 v84, v54, v55
    v_cvt_pk_bf16_f32 v85, v56, v57
    s_lshl_b32 s89, s77, 2
    s_add_u32 s89, s89, s76
    s_lshl_b32 s89, s89, 15
    s_lshl_b32 s92, s78, 11
    s_add_u32 s89, s89, s92
    s_add_u32 s89, s89, 0x800000
    s_waitcnt vmcnt(63)
    s_cmp_eq_u32 s93, 0
    s_cbranch_scc1 Lfar_126
    buffer_store_dwordx4 v[82:85], v124, s[40:43], s89 offen offset:1024
    s_branch Lstored_127
Lfar_126:
    buffer_store_dwordx4 v[82:85], v124, s[40:43], s89 offen offset:1024 sc1
Lstored_127:
    v_lshlrev_b32 v122, 4, v0
    s_lshl_b32 s86, s79, 1
    s_add_u32 s86, s86, s101
    s_lshl_b32 s86, s86, 15
    s_lshl_b32 s89, s100, 14
    s_add_u32 s86, s86, s89
    s_add_u32 s86, s86, 0x800000
    s_waitcnt vmcnt(21)
    v_lshlrev_b32 v126, 7, v0
    s_lshl_b32 s89, s76, 13
    s_add_u32 s89, s89, 0x1900000
    s_branch Lflchk_130
Lfl_128:
    buffer_load_dword v119, v126, s[40:43], s89 offen offset:4 sc1
    s_waitcnt vmcnt(0)
Lflchk_130:
    v_cmp_ne_u32 vcc, 1, v119
    s_cbranch_vccz Lfldone_129
    s_cmp_eq_u32 s84, 0
    s_cbranch_scc1 Lfldone_129
    s_sub_u32 s84, s84, 1
    s_sleep 2
    s_branch Lfl_128
Lfldone_129:
    s_barrier
    s_add_u32 s89, s86, 0x0
    buffer_load_dwordx4 v[42:45], v122, s[40:43], s89 offen offset:0 sc1
    buffer_load_dwordx4 v[46:49], v122, s[40:43], s89 offen offset:2048 sc1
    s_add_u32 s89, s86, 0x1000
    buffer_load_dwordx4 v[50:53], v122, s[40:43], s89 offen offset:0 sc1
    buffer_load_dwordx4 v[54:57], v122, s[40:43], s89 offen offset:2048 sc1
    s_add_u32 s89, s86, 0x2000
    buffer_load_dwordx4 v[58:61], v122, s[40:43], s89 offen offset:0 sc1
    buffer_load_dwordx4 v[62:65], v122, s[40:43], s89 offen offset:2048 sc1
    s_add_u32 s89, s86, 0x3000
    buffer_load_dwordx4 v[66:69], v122, s[40:43], s89 offen offset:0 sc1
    buffer_load_dwordx4 v[70:73], v122, s[40:43], s89 offen offset:2048 sc1
    s_add_u32 s89, s86, 0x0
    buffer_load_dwordx4 v[74:77], v122, s[40:43], s89 offen offset:1024 sc1
    buffer_load_dwordx4 v[78:81], v122, s[40:43], s89 offen offset:3072 sc1
    s_add_u32 s89, s86, 0x1000
    buffer_load_dwordx4 v[82:85], v122, s[40:43], s89 offen offset:1024 sc1
    buffer_load_dwordx4 v[86:89], v122, s[40:43], s89 offen offset:3072 sc1
    s_add_u32 s89, s86, 0x2000
    buffer_load_dwordx4 v[90:93], v122, s[40:43], s89 offen offset:1024 sc1
    buffer_load_dwordx4 v[94:97], v122, s[40:43], s89 offen offset:3072 sc1
    s_add_u32 s89, s86, 0x3000
    buffer_load_dwordx4 v[98:101], v122, s[40:43], s89 offen offset:1024 sc1
    buffer_load_dwordx4 v[102:105], v122, s[40:43], s89 offen offset:3072 sc1
    v_lshrrev_b32 v123, 5, v0
    v_lshlrev_b32 v123, 3, v123
    v_bfe_u32 v125, v0, 2, 2
    v_add_u32 v123, v123, v125
    v_lshlrev_b32 v123, 7, v123
    v_bfe_u32 v125, v0, 3, 1
    v_xor_b32 v125, s100, v125
    v_lshlrev_b32 v125, 6, v125
    v_add_u32 v123, v123, v125
    v_bfe_u32 v125, v0, 4, 1
    v_lshlrev_b32 v125, 5, v125
    v_add_u32 v123, v123, v125
    v_and_b32 v125, 3, v0
    v_lshlrev_b32 v125, 3, v125
    v_add_u32 v123, v123, v125
    s_lshl_b32 s89, s100, 15
    s_add_u32 s89, s89, 0xe000
    v_add_u32 v123, s89, v123
    v_xor_b32 v124, 64, v123
    v_mov_b32 v128, -1
    v_mov_b32 v129, -1
    v_mov_b32 v130, -1
    v_mov_b32 v131, -1
    v_lshlrev_b32 v132, 4, v0
    v_lshlrev_b32 v133, 3, v0
    v_and_b32 v134, 31, v0
    v_lshlrev_b32 v134, 3, v134
    s_lshl_b32 s88, s78, 18
    s_lshl_b32 s92, s77, 12
    s_add_u32 s88, s88, s92
    s_lshl_b32 s92, s76, 10
    s_add_u32 s88, s88, s92
    s_add_u32 s88, s88, 0x400000
    buffer_store_dwordx4 v[128:131], v132, s[40:43], s88 offen offset:0 sc1
    s_add_u32 s91, s88, 0x10000
    buffer_store_dwordx4 v[128:131], v132, s[40:43], s91 offen offset:0 sc1
    s_waitcnt lgkmcnt(0)
    s_barrier
    v_lshlrev_b32 v10, 16, v2
    v_and_b32 v11, 0xffff0000, v2
    v_lshlrev_b32 v12, 16, v3
    v_and_b32 v13, 0xffff0000, v3
    v_lshlrev_b32 v14, 16, v4
    v_and_b32 v15, 0xffff0000, v4
    v_lshlrev_b32 v16, 16, v5
    v_and_b32 v17, 0xffff0000, v5
    v_lshlrev_b32 v18, 16, v6
    v_and_b32 v19, 0xffff0000, v6
    v_lshlrev_b32 v20, 16, v7
    v_and_b32 v21, 0xffff0000, v7
    v_lshlrev_b32 v22, 16, v8
    v_and_b32 v23, 0xffff0000, v8
    v_lshlrev_b32 v24, 16, v9
    v_and_b32 v25, 0xffff0000, v9
    ds_read_b64_tr_b16 v[106:107], v123 offset:0
    ds_read_b64_tr_b16 v[108:109], v123 offset:512
    ds_read_b64_tr_b16 v[110:111], v124 offset:0
    ds_read_b64_tr_b16 v[112:113], v124 offset:512
    s_waitcnt vmcnt(14)
    v_max3_u32 v125, v45, v49, v53
    v_max_u32 v125, v125, v57
    v_cmp_eq_u32 vcc, -1, v125
    s_cbranch_vccnz Lrt_p3_131
Lbk_p3_132:
    s_waitcnt lgkmcnt(2)
    v_mfma_f32_32x32x16_bf16 v[10:25], v[106:109], v[42:45], v[10:25]
    ds_read_b64_tr_b16 v[114:115], v123 offset:4096
    ds_read_b64_tr_b16 v[116:117], v123 offset:4608
    s_waitcnt lgkmcnt(2)
    v_mfma_f32_32x32x16_bf16 v[26:41], v[110:113], v[42:45], 0
    ds_read_b64_tr_b16 v[118:119], v124 offset:4096
    ds_read_b64_tr_b16 v[120:121], v124 offset:4608
    s_waitcnt vmcnt(10)
    v_max3_u32 v125, v61, v65, v69
    v_max_u32 v125, v125, v73
    v_cmp_eq_u32 vcc, -1, v125
    s_cbranch_vccnz Lrt_p3_133
Lbk_p3_134:
    s_add_u32 s91, s88, 0x20000
    buffer_store_dwordx4 v[128:131], v132, s[40:43], s91 offen offset:0 sc1
    s_waitcnt lgkmcnt(2)
    v_mfma_f32_32x32x16_bf16 v[10:25], v[114:117], v[46:49], v[10:25]
    ds_read_b64_tr_b16 v[106:107], v123 offset:8192
    ds_read_b64_tr_b16 v[108:109], v123 offset:8704
    s_waitcnt lgkmcnt(2)
    v_mfma_f32_32x32x16_bf16 v[26:41], v[118:121], v[46:49], v[26:41]
    ds_read_b64_tr_b16 v[110:111], v124 offset:8192
    ds_read_b64_tr_b16 v[112:113], v124 offset:8704
    s_add_u32 s91, s88, 0x30000
    buffer_store_dwordx4 v[128:131], v132, s[40:43], s91 offen offset:0 sc1
    s_waitcnt lgkmcnt(2)
    v_mfma_f32_32x32x16_bf16 v[10:25], v[106:109], v[50:53], v[10:25]
    ds_read_b64_tr_b16 v[114:115], v123 offset:12288
    ds_read_b64_tr_b16 v[116:117], v123 offset:12800
    s_waitcnt lgkmcnt(2)
    v_mfma_f32_32x32x16_bf16 v[26:41], v[110:113], v[50:53], v[26:41]
    ds_read_b64_tr_b16 v[118:119], v124 offset:12288
    ds_read_b64_tr_b16 v[120:121], v124 offset:12800
    s_lshl_b32 s88, s77, 2
    s_add_u32 s88, s88, s76
    s_lshl_b32 s88, s88, 15
    s_lshl_b32 s92, s78, 11
    s_add_u32 s88, s88, s92
    s_add_u32 s88, s88, 0xa00000
    buffer_store_dwordx4 v[128:131], v132, s[40:43], s88 offen offset:0 sc1
    s_waitcnt lgkmcnt(2)
    v_mfma_f32_32x32x16_bf16 v[10:25], v[114:117], v[54:57], v[10:25]
    ds_read_b64_tr_b16 v[106:107], v123 offset:16384
    ds_read_b64_tr_b16 v[108:109], v123 offset:16896
    s_waitcnt lgkmcnt(2)
    v_mfma_f32_32x32x16_bf16 v[26:41], v[118:121], v[54:57], v[26:41]
    ds_read_b64_tr_b16 v[110:111], v124 offset:16384
    ds_read_b64_tr_b16 v[112:113], v124 offset:16896
    buffer_store_dwordx4 v[128:131], v132, s[40:43], s88 offen offset:1024 sc1
    s_waitcnt lgkmcnt(2)
    v_mfma_f32_32x32x16_bf16 v[10:25], v[106:109], v[58:61], v[10:25]
    ds_read_b64_tr_b16 v[114:115], v123 offset:20480
    ds_read_b64_tr_b16 v[116:117], v123 offset:20992
    s_waitcnt lgkmcnt(2)
    v_mfma_f32_32x32x16_bf16 v[26:41], v[110:113], v[58:61], v[26:41]
    ds_read_b64_tr_b16 v[118:119], v124 offset:20480
    ds_read_b64_tr_b16 v[120:121], v124 offset:20992
    s_waitcnt vmcnt(10)
    v_max3_u32 v125, v77, v81, v85
    v_max_u32 v125, v125, v89
    v_cmp_eq_u32 vcc, -1, v125
    s_cbranch_vccnz Lrt_p3_135
Lbk_p3_136:
    s_lshl_b32 s88, s79, 3
    s_add_u32 s88, s88, s80
    s_lshl_b32 s88, s88, 1
    s_add_u32 s88, s88, s100
    s_lshl_b32 s88, s88, 9
    s_lshl_b32 s92, s101, 8
    s_add_u32 s88, s88, s92
    s_add_u32 s88, s88, 0x1640000
    buffer_store_dwordx2 v[128:129], v134, s[40:43], s88 offen offset:0 sc1
    s_waitcnt lgkmcnt(2)
    v_mfma_f32_32x32x16_bf16 v[10:25], v[114:117], v[62:65], v[10:25]
    ds_read_b64_tr_b16 v[106:107], v123 offset:24576
    ds_read_b64_tr_b16 v[108:109], v123 offset:25088
    s_waitcnt lgkmcnt(2)
    v_mfma_f32_32x32x16_bf16 v[26:41], v[118:121], v[62:65], v[26:41]
    ds_read_b64_tr_b16 v[110:111], v124 offset:24576
    ds_read_b64_tr_b16 v[112:113], v124 offset:25088
    s_lshl_b32 s88, s80, 6
    s_lshl_b32 s92, s79, 1
    s_add_u32 s88, s88, s92
    s_add_u32 s88, s88, s100
    s_lshl_b32 s88, s88, 12
    s_lshl_b32 s92, s101, 11
    s_add_u32 s88, s88, s92
    s_add_u32 s88, s88, 0xe00000
    buffer_store_dwordx4 v[128:131], v132, s[40:43], s88 offen offset:0 sc1
    s_waitcnt lgkmcnt(2)
    v_mfma_f32_32x32x16_bf16 v[10:25], v[106:109], v[66:69], v[10:25]
    ds_read_b64_tr_b16 v[114:115], v123 offset:28672
    ds_read_b64_tr_b16 v[116:117], v123 offset:29184
    s_waitcnt lgkmcnt(2)
    v_mfma_f32_32x32x16_bf16 v[26:41], v[110:113], v[66:69], v[26:41]
    ds_read_b64_tr_b16 v[118:119], v124 offset:28672
    ds_read_b64_tr_b16 v[120:121], v124 offset:29184
    buffer_store_dwordx4 v[128:131], v132, s[40:43], s88 offen offset:1024 sc1
    s_waitcnt lgkmcnt(2)
    v_mfma_f32_32x32x16_bf16 v[10:25], v[114:117], v[70:73], v[10:25]
    ds_read_b64_tr_b16 v[106:107], v123 offset:2048
    ds_read_b64_tr_b16 v[108:109], v123 offset:2560
    s_waitcnt lgkmcnt(2)
    v_mfma_f32_32x32x16_bf16 v[26:41], v[118:121], v[70:73], v[26:41]
    ds_read_b64_tr_b16 v[110:111], v124 offset:2048
    ds_read_b64_tr_b16 v[112:113], v124 offset:2560
    s_lshl_b32 s88, s81, 1
    s_add_u32 s88, s88, s100
    s_mul_i32 s88, s88, 96
    s_mul_i32 s92, s82, 3
    s_add_u32 s88, s88, s92
    s_lshl_b32 s88, s88, 10
    s_add_u32 s88, s88, 0x1200000
    s_lshl_b32 s92, s101, 9
    s_add_u32 s88, s88, s92
    buffer_store_dwordx2 v[128:129], v133, s[40:43], s88 offen offset:0 sc1
    s_waitcnt lgkmcnt(2)
    v_mfma_f32_32x32x16_bf16 v[10:25], v[106:109], v[74:77], v[10:25]
    ds_read_b64_tr_b16 v[114:115], v123 offset:6144
    ds_read_b64_tr_b16 v[116:117], v123 offset:6656
    s_waitcnt lgkmcnt(2)
    v_mfma_f32_32x32x16_bf16 v[26:41], v[110:113], v[74:77], v[26:41]
    ds_read_b64_tr_b16 v[118:119], v124 offset:6144
    ds_read_b64_tr_b16 v[120:121], v124 offset:6656
    s_waitcnt vmcnt(10)
    v_max3_u32 v125, v93, v97, v101
    v_max_u32 v125, v125, v105
    v_cmp_eq_u32 vcc, -1, v125
    s_cbranch_vccnz Lrt_p3_137
Lbk_p3_138:
    buffer_store_dwordx2 v[128:129], v133, s[40:43], s88 offen offset:1024 sc1
    s_waitcnt lgkmcnt(2)
    v_mfma_f32_32x32x16_bf16 v[10:25], v[114:117], v[78:81], v[10:25]
    ds_read_b64_tr_b16 v[106:107], v123 offset:10240
    ds_read_b64_tr_b16 v[108:109], v123 offset:10752
    s_waitcnt lgkmcnt(2)
    v_mfma_f32_32x32x16_bf16 v[26:41], v[118:121], v[78:81], v[26:41]
    ds_read_b64_tr_b16 v[110:111], v124 offset:10240
    ds_read_b64_tr_b16 v[112:113], v124 offset:10752
    buffer_store_dwordx2 v[128:129], v133, s[40:43], s88 offen offset:2048 sc1
    s_waitcnt lgkmcnt(2)
    v_mfma_f32_32x32x16_bf16 v[10:25], v[106:109], v[82:85], v[10:25]
    ds_read_b64_tr_b16 v[114:115], v123 offset:14336
    ds_read_b64_tr_b16 v[116:117], v123 offset:14848
    s_waitcnt lgkmcnt(2)
    v_mfma_f32_32x32x16_bf16 v[26:41], v[110:113], v[82:85], v[26:41]
    ds_read_b64_tr_b16 v[118:119], v124 offset:14336
    ds_read_b64_tr_b16 v[120:121], v124 offset:14848
    s_waitcnt lgkmcnt(2)
    v_mfma_f32_32x32x16_bf16 v[10:25], v[114:117], v[86:89], v[10:25]
    ds_read_b64_tr_b16 v[106:107], v123 offset:18432
    ds_read_b64_tr_b16 v[108:109], v123 offset:18944
    s_waitcnt lgkmcnt(2)
    v_mfma_f32_32x32x16_bf16 v[26:41], v[118:121], v[86:89], v[26:41]
    ds_read_b64_tr_b16 v[110:111], v124 offset:18432
    ds_read_b64_tr_b16 v[112:113], v124 offset:18944
    v_lshlrev_b32 v139, 4, v0
    s_lshl_b32 s97, s101, 10
    v_xor_b32 v140, 0x400, v139
    v_add_u32 v139, s97, v139
    v_subrev_u32 v140, s97, v140
    s_mul_i32 s96, s79, 88
    s_mul_i32 s97, s76, 22
    s_add_u32 s96, s96, s97
    s_lshl_b32 s96, s96, 11
    s_add_u32 s96, s96, 0x2000000
    s_waitcnt lgkmcnt(2)
    v_mfma_f32_32x32x16_bf16 v[10:25], v[106:109], v[90:93], v[10:25]
    ds_read_b64_tr_b16 v[114:115], v123 offset:22528
    ds_read_b64_tr_b16 v[116:117], v123 offset:23040
    s_waitcnt lgkmcnt(2)
    v_mfma_f32_32x32x16_bf16 v[26:41], v[110:113], v[90:93], v[26:41]
    ds_read_b64_tr_b16 v[118:119], v124 offset:22528
    ds_read_b64_tr_b16 v[120:121], v124 offset:23040
    s_add_u32 s97, s96, 0x0
    buffer_load_dwordx4 a[192:195], v139, s[40:43], s97 offen offset:0 sc1
    s_waitcnt lgkmcnt(2)
    v_mfma_f32_32x32x16_bf16 v[10:25], v[114:117], v[94:97], v[10:25]
    ds_read_b64_tr_b16 v[106:107], v123 offset:26624
    ds_read_b64_tr_b16 v[108:109], v123 offset:27136
    s_waitcnt lgkmcnt(2)
    v_mfma_f32_32x32x16_bf16 v[26:41], v[118:121], v[94:97], v[26:41]
    ds_read_b64_tr_b16 v[110:111], v124 offset:26624
    ds_read_b64_tr_b16 v[112:113], v124 offset:27136
    buffer_load_dwordx4 a[196:199], v140, s[40:43], s97 offen offset:0 sc1
    s_waitcnt lgkmcnt(2)
    v_mfma_f32_32x32x16_bf16 v[10:25], v[106:109], v[98:101], v[10:25]
    ds_read_b64_tr_b16 v[114:115], v123 offset:30720
    ds_read_b64_tr_b16 v[116:117], v123 offset:31232
    s_waitcnt lgkmcnt(2)
    v_mfma_f32_32x32x16_bf16 v[26:41], v[110:113], v[98:101], v[26:41]
    ds_read_b64_tr_b16 v[118:119], v124 offset:30720
    ds_read_b64_tr_b16 v[120:121], v124 offset:31232
    s_add_u32 s97, s96, 0x800
    buffer_load_dwordx4 a[200:203], v139, s[40:43], s97 offen offset:0 sc1
    s_waitcnt lgkmcnt(2)
    v_mfma_f32_32x32x16_bf16 v[10:25], v[114:117], v[102:105], v[10:25]
    s_waitcnt lgkmcnt(0)
    v_mfma_f32_32x32x16_bf16 v[26:41], v[118:121], v[102:105], v[26:41]
    buffer_load_dwordx4 a[204:207], v140, s[40:43], s97 offen offset:0 sc1
    s_xor_b32 s89, s76, 2
    s_lshl_b32 s89, s89, 12
    s_add_u32 s89, s89, 0x0
    v_add_u32 v125, s89, v122
    s_nop 6
    ds_write_b128 v125, v[26:29] offset:0
    ds_write_b128 v125, v[30:33] offset:1024
    ds_write_b128 v125, v[34:37] offset:2048
    ds_write_b128 v125, v[38:41] offset:3072
    s_lshl_b32 s89, s76, 12
    s_add_u32 s89, s89, 0x0
    v_add_u32 v125, s89, v122
    s_add_u32 s97, s96, 0x1000
    buffer_load_dwordx4 a[208:211], v139, s[40:43], s97 offen offset:0 sc1
    buffer_load_dwordx4 a[212:215], v140, s[40:43], s97 offen offset:0 sc1
    s_add_u32 s97, s96, 0x1800
    buffer_load_dwordx4 a[216:219], v139, s[40:43], s97 offen offset:0 sc1
    s_waitcnt lgkmcnt(0)
    s_barrier
    ds_read_b128 v[26:29], v125 offset:0
    ds_read_b128 v[30:33], v125 offset:1024
    ds_read_b128 v[34:37], v125 offset:2048
    ds_read_b128 v[38:41], v125 offset:3072
    v_and_b32 v62, 31, v0
    v_lshlrev_b32 v62, 3, v62
    v_lshrrev_b32 v126, 5, v0
    v_lshlrev_b32 v126, 9, v126
    v_add_u32 v63, v62, v126
    s_lshl_b32 s90, s79, 3
    s_add_u32 s90, s90, s80
    s_lshl_b32 s90, s90, 1
    s_add_u32 s90, s90, s100
    s_lshl_b32 s90, s90, 9
    s_lshl_b32 s92, s101, 8
    s_add_u32 s90, s90, s92
    s_add_u32 s90, s90, 0x1600000
    s_lshl_b32 s86, s79, 13
    s_lshl_b32 s89, s101, 8
    s_add_u32 s86, s86, s89
    s_add_u32 s86, s86, 0x1600000
    s_waitcnt lgkmcnt(0)
    v_pk_add_f32 v[10:11], v[10:11], v[26:27]
    v_pk_add_f32 v[12:13], v[12:13], v[28:29]
    v_pk_add_f32 v[14:15], v[14:15], v[30:31]
    v_pk_add_f32 v[16:17], v[16:17], v[32:33]
    v_pk_add_f32 v[18:19], v[18:19], v[34:35]
    v_pk_add_f32 v[20:21], v[20:21], v[36:37]
    v_pk_add_f32 v[22:23], v[22:23], v[38:39]
    v_pk_add_f32 v[24:25], v[24:25], v[40:41]
    v_cvt_pk_bf16_f32 v2, v10, v11
    v_cvt_pk_bf16_f32 v3, v12, v13
    v_cvt_pk_bf16_f32 v4, v14, v15
    v_cvt_pk_bf16_f32 v5, v16, v17
    v_cvt_pk_bf16_f32 v6, v18, v19
    v_cvt_pk_bf16_f32 v7, v20, v21
    v_cvt_pk_bf16_f32 v8, v22, v23
    v_cvt_pk_bf16_f32 v9, v24, v25
    v_add_f32 v58, v10, v11
    v_mul_f32 v59, v10, v10
    v_fmac_f32 v59, v11, v11
    v_add_f32 v58, v58, v12
    v_fmac_f32 v59, v12, v12
    v_add_f32 v58, v58, v13
    v_fmac_f32 v59, v13, v13
    v_add_f32 v58, v58, v14
    v_fmac_f32 v59, v14, v14
    v_add_f32 v58, v58, v15
    v_fmac_f32 v59, v15, v15
    v_add_f32 v58, v58, v16
    v_fmac_f32 v59, v16, v16
    v_add_f32 v58, v58, v17
    v_fmac_f32 v59, v17, v17
    v_add_f32 v58, v58, v18
    v_fmac_f32 v59, v18, v18
    v_add_f32 v58, v58, v19
    v_fmac_f32 v59, v19, v19
    v_add_f32 v58, v58, v20
    v_fmac_f32 v59, v20, v20
    v_add_f32 v58, v58, v21
    v_fmac_f32 v59, v21, v21
    v_add_f32 v58, v58, v22
    v_fmac_f32 v59, v22, v22
    v_add_f32 v58, v58, v23
    v_fmac_f32 v59, v23, v23
    v_add_f32 v58, v58, v24
    v_fmac_f32 v59, v24, v24
    v_add_f32 v58, v58, v25
    v_fmac_f32 v59, v25, v25
    v_mov_b32 v125, v58
    s_nop 1
    v_permlane32_swap_b32 v58, v125
    v_add_f32 v58, v58, v125
    v_mov_b32 v125, v59
    s_nop 1
    v_permlane32_swap_b32 v59, v125
    v_add_f32 v59, v59, v125
    s_cmp_eq_u32 s93, 0
    s_cbranch_scc1 Lfar_139
    buffer_store_dwordx2 v[58:59], v62, s[40:43], s90 offen offset:0
    s_branch Lstored_140
Lfar_139:
    buffer_store_dwordx2 v[58:59], v62, s[40:43], s90 offen offset:0 sc1
Lstored_140:
    s_add_u32 s89, s86, 0x0
    buffer_load_dwordx2 v[66:67], v63, s[40:43], s89 offen offset:0 sc1
    s_add_u32 s89, s86, 0x400
    buffer_load_dwordx2 v[68:69], v63, s[40:43], s89 offen offset:0 sc1
    s_add_u32 s89, s86, 0x800
    buffer_load_dwordx2 v[70:71], v63, s[40:43], s89 offen offset:0 sc1
    s_add_u32 s89, s86, 0xc00
    buffer_load_dwordx2 v[72:73], v63, s[40:43], s89 offen offset:0 sc1
    s_add_u32 s89, s86, 0x1000
    buffer_load_dwordx2 v[74:75], v63, s[40:43], s89 offen offset:0 sc1
    s_add_u32 s89, s86, 0x1400
    buffer_load_dwordx2 v[76:77], v63, s[40:43], s89 offen offset:0 sc1
    s_add_u32 s89, s86, 0x1800
    buffer_load_dwordx2 v[78:79], v63, s[40:43], s89 offen offset:0 sc1
    s_add_u32 s89, s86, 0x1c00
    buffer_load_dwordx2 v[80:81], v63, s[40:43], s89 offen offset:0 sc1
    v_and_b32 v84, 31, v0
    s_lshl_b32 s89, s101, 5
    v_add_u32 v84, s89, v84
    v_mul_u32_u24 v84, 136, v84
    v_lshrrev_b32 v126, 5, v0
    v_lshlrev_b32 v126, 3, v126
    v_add_u32 v84, v84, v126
    s_lshl_b32 s89, s100, 6
    s_add_u32 s89, s89, 0x4000
    v_add_u32 v84, s89, v84
    v_lshrrev_b32 v85, 4, v0
    v_lshlrev_b32 v85, 3, v85
    v_bfe_u32 v126, v0, 2, 2
    v_add_u32 v85, v85, v126
    s_lshl_b32 s89, s100, 5
    v_add_u32 v85, s89, v85
    v_mul_u32_u24 v85, 136, v85
    v_and_b32 v126, 3, v0
    v_lshlrev_b32 v126, 3, v126
    v_add_u32 v85, v85, v126
    s_lshl_b32 s89, s101, 6
    s_add_u32 s89, s89, 0x4000
    v_add_u32 v85, s89, v85
    s_lshl_b32 s87, s80, 6
    s_lshl_b32 s92, s79, 1
    s_add_u32 s87, s87, s92
    s_add_u32 s87, s87, s100
    s_lshl_b32 s87, s87, 12
    s_lshl_b32 s92, s101, 11
    s_add_u32 s87, s87, s92
    s_add_u32 s87, s87, 0xc00000
    buffer_load_dwordx4 a[220:223], v140, s[40:43], s97 offen offset:0 sc1
    s_add_u32 s97, s96, 0x2000
    buffer_load_dwordx4 a[224:227], v139, s[40:43], s97 offen offset:0 sc1
    buffer_load_dwordx4 a[228:231], v140, s[40:43], s97 offen offset:0 sc1
    s_add_u32 s97, s96, 0x2800
    buffer_load_dwordx4 a[232:235], v139, s[40:43], s97 offen offset:0 sc1
    buffer_load_dwordx4 a[236:239], v140, s[40:43], s97 offen offset:0 sc1
    s_add_u32 s97, s96, 0x3000
    buffer_load_dwordx4 a[240:243], v139, s[40:43], s97 offen offset:0 sc1
    s_waitcnt vmcnt(6)
    v_max3_u32 v125, v67, v69, v71
    v_max3_u32 v125, v125, v73, v75
    v_max3_u32 v125, v125, v77, v79
    v_max_u32 v125, v125, v81
    v_cmp_eq_u32 vcc, -1, v125
    s_cbranch_vccnz Lrt_st_141
Lbk_st_142:
    v_add_f32 v66, v66, v68
    v_add_f32 v67, v67, v69
    v_add_f32 v66, v66, v70
    v_add_f32 v67, v67, v71
    v_add_f32 v66, v66, v72
    v_add_f32 v67, v67, v73
    v_add_f32 v66, v66, v74
    v_add_f32 v67, v67, v75
    v_add_f32 v66, v66, v76
    v_add_f32 v67, v67, v77
    v_add_f32 v66, v66, v78
    v_add_f32 v67, v67, v79
    v_add_f32 v66, v66, v80
    v_add_f32 v67, v67, v81
    v_mov_b32 v125, v66
    s_nop 1
    v_permlane32_swap_b32 v66, v125
    v_add_f32 v66, v66, v125
    v_mov_b32 v125, v67
    s_nop 1
    v_permlane32_swap_b32 v67, v125
    v_add_f32 v67, v67, v125
    v_mul_f32 v68, 0x3b000000, v66
    v_mul_f32 v69, 0x3b000000, v67
    v_fma_f32 v69, -v68, v68, v69
    v_max_f32 v69, 0, v69
    v_add_f32 v70, 0x3727c5ac, v69
    v_rsq_f32 v70, v70
    s_nop 0
    v_mul_f32 v71, v70, v70
    v_mul_f32 v71, v71, v69
    v_add_f32 v71, 0x3727c5ac, v71
    v_rsq_f32 v71, v71
    s_nop 0
    v_mul_f32 v70, v70, v71
    v_mul_f32 v68, v68, v70
    v_fma_f32 v10, v10, v70, -v68
    v_fma_f32 v11, v11, v70, -v68
    v_fma_f32 v12, v12, v70, -v68
    v_fma_f32 v13, v13, v70, -v68
    v_fma_f32 v14, v14, v70, -v68
    v_fma_f32 v15, v15, v70, -v68
    v_fma_f32 v16, v16, v70, -v68
    v_fma_f32 v17, v17, v70, -v68
    v_fma_f32 v18, v18, v70, -v68
    v_fma_f32 v19, v19, v70, -v68
    v_fma_f32 v20, v20, v70, -v68
    v_fma_f32 v21, v21, v70, -v68
    v_fma_f32 v22, v22, v70, -v68
    v_fma_f32 v23, v23, v70, -v68
    v_fma_f32 v24, v24, v70, -v68
    v_fma_f32 v25, v25, v70, -v68
    v_cvt_pk_bf16_f32 v26, v10, v11
    v_cvt_pk_bf16_f32 v27, v12, v13
    v_cvt_pk_bf16_f32 v28, v14, v15
    v_cvt_pk_bf16_f32 v29, v16, v17
    v_cvt_pk_bf16_f32 v30, v18, v19
    v_cvt_pk_bf16_f32 v31, v20, v21
    v_cvt_pk_bf16_f32 v32, v22, v23
    v_cvt_pk_bf16_f32 v33, v24, v25
    ds_write_b64 v84, v[26:27] offset:0
    ds_write_b64 v84, v[28:29] offset:16
    ds_write_b64 v84, v[30:31] offset:32
    ds_write_b64 v84, v[32:33] offset:48
    s_waitcnt lgkmcnt(0)
    s_barrier
    ds_read_b64_tr_b16 v[42:43], v85 offset:0
    ds_read_b64_tr_b16 v[44:45], v85 offset:544
    ds_read_b64_tr_b16 v[46:47], v85 offset:32
    ds_read_b64_tr_b16 v[48:49], v85 offset:576
    s_waitcnt lgkmcnt(0)
    buffer_store_dwordx4 v[42:45], v122, s[40:43], s87 offen offset:0 sc1
    buffer_store_dwordx4 v[46:49], v122, s[40:43], s87 offen offset:1024 sc1
    s_xor_b32 s89, s76, 0
    s_lshl_b32 s89, s89, 10
    v_lshlrev_b32 v122, 4, v0
    v_add_u32 v122, s89, v122
    s_xor_b32 s89, s76, 1
    s_lshl_b32 s89, s89, 10
    v_lshlrev_b32 v123, 4, v0
    v_add_u32 v123, s89, v123
    s_xor_b32 s89, s76, 2
    s_lshl_b32 s89, s89, 10
    v_lshlrev_b32 v124, 4, v0
    v_add_u32 v124, s89, v124
    s_xor_b32 s89, s76, 3
    s_lshl_b32 s89, s89, 10
    v_lshlrev_b32 v125, 4, v0
    v_add_u32 v125, s89, v125
    s_lshl_b32 s86, s81, 6
    s_lshl_b32 s89, s76, 4
    s_add_u32 s86, s86, s89
    s_lshl_b32 s86, s86, 12
    s_add_u32 s86, s86, 0xc00000
    buffer_load_dwordx4 a[244:247], v140, s[40:43], s97 offen offset:0 sc1
    s_add_u32 s97, s96, 0x3800
    buffer_load_dwordx4 a[248:251], v139, s[40:43], s97 offen offset:0 sc1
    buffer_load_dwordx4 a[252:255], v140, s[40:43], s97 offen offset:0 sc1
    s_add_u32 s97, s96, 0x4000
    buffer_load_dwordx4 v[144:147], v139, s[40:43], s97 offen offset:0 sc1
    buffer_load_dwordx4 v[148:151], v140, s[40:43], s97 offen offset:0 sc1
    s_add_u32 s97, s96, 0x4800
    buffer_load_dwordx4 v[152:155], v139, s[40:43], s97 offen offset:0 sc1
    buffer_load_dwordx4 v[156:159], v140, s[40:43], s97 offen offset:0 sc1
    s_add_u32 s97, s96, 0x5000
    buffer_load_dwordx4 v[160:163], v139, s[40:43], s97 offen offset:0 sc1
    buffer_load_dwordx4 v[164:167], v140, s[40:43], s97 offen offset:0 sc1
    s_add_u32 s97, s96, 0x5800
    buffer_load_dwordx4 v[168:171], v139, s[40:43], s97 offen offset:0 sc1
    buffer_load_dwordx4 v[172:175], v140, s[40:43], s97 offen offset:0 sc1
    s_add_u32 s97, s96, 0x6000
    buffer_load_dwordx4 v[176:179], v139, s[40:43], s97 offen offset:0 sc1
    buffer_load_dwordx4 v[180:183], v140, s[40:43], s97 offen offset:0 sc1
    s_add_u32 s97, s96, 0x6800
    buffer_load_dwordx4 v[184:187], v139, s[40:43], s97 offen offset:0 sc1
    s_add_u32 s89, s86, 0x0
    buffer_load_dwordx4 v[58:61], v122, s[40:43], s89 offen offset:0 sc1
    buffer_load_dwordx4 v[62:65], v123, s[40:43], s89 offen offset:0 sc1
    buffer_load_dwordx4 v[66:69], v124, s[40:43], s89 offen offset:0 sc1
    buffer_load_dwordx4 v[70:73], v125, s[40:43], s89 offen offset:0 sc1
    s_add_u32 s89, s86, 0x1000
    buffer_load_dwordx4 v[74:77], v122, s[40:43], s89 offen offset:0 sc1
    buffer_load_dwordx4 v[78:81], v123, s[40:43], s89 offen offset:0 sc1
    buffer_load_dwordx4 v[82:85], v124, s[40:43], s89 offen offset:0 sc1
    buffer_load_dwordx4 v[86:89], v125, s[40:43], s89 offen offset:0 sc1
    s_add_u32 s89, s86, 0x2000
    buffer_load_dwordx4 v[90:93], v122, s[40:43], s89 offen offset:0 sc1
    buffer_load_dwordx4 v[94:97], v123, s[40:43], s89 offen offset:0 sc1
    buffer_load_dwordx4 v[98:101], v124, s[40:43], s89 offen offset:0 sc1
    buffer_load_dwordx4 v[102:105], v125, s[40:43], s89 offen offset:0 sc1
    s_add_u32 s89, s86, 0x3000
    buffer_load_dwordx4 v[106:109], v122, s[40:43], s89 offen offset:0 sc1
    buffer_load_dwordx4 v[110:113], v123, s[40:43], s89 offen offset:0 sc1
    buffer_load_dwordx4 v[114:117], v124, s[40:43], s89 offen offset:0 sc1
    buffer_load_dwordx4 v[118:121], v125, s[40:43], s89 offen offset:0 sc1
    v_lshrrev_b32 v126, 4, v0
    v_lshlrev_b32 v126, 3, v126
    s_mul_i32 s89, s82, 96
    buffer_load_dwordx2 v[128:129], v126, s[20:23], s89 offen offset:0
    buffer_load_dwordx2 v[130:131], v126, s[20:23], s89 offen offset:32
    buffer_load_dwordx2 v[132:133], v126, s[20:23], s89 offen offset:64
    buffer_load_dwordx4 v[188:191], v140, s[40:43], s97 offen offset:0 sc1
    s_add_u32 s97, s96, 0x7000
    buffer_load_dwordx4 v[192:195], v139, s[40:43], s97 offen offset:0 sc1
    buffer_load_dwordx4 v[196:199], v140, s[40:43], s97 offen offset:0 sc1
    s_add_u32 s97, s96, 0x7800
    buffer_load_dwordx4 v[200:203], v139, s[40:43], s97 offen offset:0 sc1
    buffer_load_dwordx4 v[204:207], v140, s[40:43], s97 offen offset:0 sc1
    s_add_u32 s97, s96, 0x8000
    buffer_load_dwordx4 v[208:211], v139, s[40:43], s97 offen offset:0 sc1
    buffer_load_dwordx4 v[212:215], v140, s[40:43], s97 offen offset:0 sc1
    s_add_u32 s97, s96, 0x8800
    buffer_load_dwordx4 v[216:219], v139, s[40:43], s97 offen offset:0 sc1
    buffer_load_dwordx4 v[220:223], v140, s[40:43], s97 offen offset:0 sc1
    s_add_u32 s97, s96, 0x9000
    buffer_load_dwordx4 v[224:227], v139, s[40:43], s97 offen offset:0 sc1
    buffer_load_dwordx4 v[228:231], v140, s[40:43], s97 offen offset:0 sc1
    s_add_u32 s97, s96, 0x9800
    buffer_load_dwordx4 v[232:235], v139, s[40:43], s97 offen offset:0 sc1
    buffer_load_dwordx4 v[236:239], v140, s[40:43], s97 offen offset:0 sc1
    s_add_u32 s97, s96, 0xa000
    buffer_load_dwordx4 v[240:243], v139, s[40:43], s97 offen offset:0 sc1
    buffer_load_dwordx4 v[244:247], v140, s[40:43], s97 offen offset:0 sc1
    s_add_u32 s97, s96, 0xa800
    buffer_load_dwordx4 v[248:251], v139, s[40:43], s97 offen offset:0 sc1
    buffer_load_dwordx4 v[252:255], v140, s[40:43], s97 offen offset:0 sc1
    v_lshlrev_b32 v127, 4, v0
    s_xor_b32 s89, s76, 1
    s_mul_i32 s89, s89, 3
    s_add_u32 s89, s89, 0
    s_mul_i32 s89, s89, 3072
    s_add_u32 s89, s89, 0xf000
    v_add_u32 v134, s89, v127
    s_xor_b32 s89, s76, 2
    s_mul_i32 s89, s89, 3
    s_add_u32 s89, s89, 1
    s_mul_i32 s89, s89, 3072
    s_add_u32 s89, s89, 0xf000
    v_add_u32 v135, s89, v127
    s_xor_b32 s89, s76, 3
    s_mul_i32 s89, s89, 3
    s_add_u32 s89, s89, 2
    s_mul_i32 s89, s89, 3072
    s_add_u32 s89, s89, 0xf000
    v_add_u32 v136, s89, v127
    s_mul_i32 s89, s76, 9216
    s_add_u32 s89, s89, 0xf000
    v_add_u32 v137, s89, v127
    v_lshrrev_b32 v141, 5, v0
    v_lshlrev_b32 v141, 9, v141
    v_and_b32 v127, 15, v0
    v_lshlrev_b32 v127, 4, v127
    v_add_u32 v141, v141, v127
    v_bfe_u32 v127, v0, 4, 1
    v_lshlrev_b32 v127, 3, v127
    v_add_u32 v141, v141, v127
    s_lshl_b32 s89, s101, 8
    v_add_u32 v141, s89, v141
    s_waitcnt vmcnt(17)
    v_lshlrev_b32 v10, 16, v128
    v_and_b32 v11, 0xffff0000, v128
    v_lshlrev_b32 v12, 16, v129
    v_and_b32 v13, 0xffff0000, v129
    v_lshlrev_b32 v26, 16, v130
    v_and_b32 v27, 0xffff0000, v130
    v_lshlrev_b32 v28, 16, v131
    v_and_b32 v29, 0xffff0000, v131
    v_lshlrev_b32 v42, 16, v132
    v_and_b32 v43, 0xffff0000, v132
    v_lshlrev_b32 v44, 16, v133
    v_and_b32 v45, 0xffff0000, v133
    s_waitcnt lgkmcnt(0)
    s_barrier
    v_max3_u32 v126, v61, v65, v69
    v_max_u32 v126, v126, v73
    v_cmp_eq_u32 vcc, -1, v126
    s_cbranch_vccnz Lrt_p4_143
Lbk_p4_144:
    v_mfma_f32_16x16x32_bf16 v[10:13], a[0:3], v[58:61], v[10:13]
    v_mfma_f32_16x16x32_bf16 v[14:17], a[0:3], v[62:65], 0
    v_max3_u32 v126, v77, v81, v85
    v_max_u32 v126, v126, v89
    v_cmp_eq_u32 vcc, -1, v126
    s_cbranch_vccnz Lrt_p4_145
Lbk_p4_146:
    v_mfma_f32_16x16x32_bf16 v[18:21], a[0:3], v[66:69], 0
    v_mfma_f32_16x16x32_bf16 v[22:25], a[0:3], v[70:73], 0
    v_mfma_f32_16x16x32_bf16 v[26:29], a[4:7], v[58:61], v[26:29]
    v_mfma_f32_16x16x32_bf16 v[30:33], a[4:7], v[62:65], 0
    v_mfma_f32_16x16x32_bf16 v[34:37], a[4:7], v[66:69], 0
    v_mfma_f32_16x16x32_bf16 v[38:41], a[4:7], v[70:73], 0
    v_mfma_f32_16x16x32_bf16 v[42:45], a[8:11], v[58:61], v[42:45]
    v_mfma_f32_16x16x32_bf16 v[46:49], a[8:11], v[62:65], 0
    v_mfma_f32_16x16x32_bf16 v[50:53], a[8:11], v[66:69], 0
    v_mfma_f32_16x16x32_bf16 v[54:57], a[8:11], v[70:73], 0
    s_add_u32 s89, s86, 0x4000
    buffer_load_dwordx4 v[58:61], v122, s[40:43], s89 offen offset:0 sc1
    buffer_load_dwordx4 v[62:65], v123, s[40:43], s89 offen offset:0 sc1
    buffer_load_dwordx4 v[66:69], v124, s[40:43], s89 offen offset:0 sc1
    buffer_load_dwordx4 v[70:73], v125, s[40:43], s89 offen offset:0 sc1
    v_mfma_f32_16x16x32_bf16 v[10:13], a[12:15], v[74:77], v[10:13]
    v_mfma_f32_16x16x32_bf16 v[14:17], a[12:15], v[78:81], v[14:17]
    v_max3_u32 v126, v93, v97, v101
    v_max_u32 v126, v126, v105
    v_cmp_eq_u32 vcc, -1, v126
    s_cbranch_vccnz Lrt_p4_147
Lbk_p4_148:
    v_mfma_f32_16x16x32_bf16 v[18:21], a[12:15], v[82:85], v[18:21]
    v_mfma_f32_16x16x32_bf16 v[22:25], a[12:15], v[86:89], v[22:25]
    v_mfma_f32_16x16x32_bf16 v[26:29], a[16:19], v[74:77], v[26:29]
    v_mfma_f32_16x16x32_bf16 v[30:33], a[16:19], v[78:81], v[30:33]
    v_mfma_f32_16x16x32_bf16 v[34:37], a[16:19], v[82:85], v[34:37]
    v_mfma_f32_16x16x32_bf16 v[38:41], a[16:19], v[86:89], v[38:41]
    v_mfma_f32_16x16x32_bf16 v[42:45], a[20:23], v[74:77], v[42:45]
    v_mfma_f32_16x16x32_bf16 v[46:49], a[20:23], v[78:81], v[46:49]
    v_mfma_f32_16x16x32_bf16 v[50:53], a[20:23], v[82:85], v[50:53]
    v_mfma_f32_16x16x32_bf16 v[54:57], a[20:23], v[86:89], v[54:57]
    s_add_u32 s89, s86, 0x5000
    buffer_load_dwordx4 v[74:77], v122, s[40:43], s89 offen offset:0 sc1
    buffer_load_dwordx4 v[78:81], v123, s[40:43], s89 offen offset:0 sc1
    buffer_load_dwordx4 v[82:85], v124, s[40:43], s89 offen offset:0 sc1
    buffer_load_dwordx4 v[86:89], v125, s[40:43], s89 offen offset:0 sc1
    v_mfma_f32_16x16x32_bf16 v[10:13], a[24:27], v[90:93], v[10:13]
    v_mfma_f32_16x16x32_bf16 v[14:17], a[24:27], v[94:97], v[14:17]
    v_max3_u32 v126, v109, v113, v117
    v_max_u32 v126, v126, v121
    v_cmp_eq_u32 vcc, -1, v126
    s_cbranch_vccnz Lrt_p4_149
Lbk_p4_150:
    v_mfma_f32_16x16x32_bf16 v[18:21], a[24:27], v[98:101], v[18:21]
    v_mfma_f32_16x16x32_bf16 v[22:25], a[24:27], v[102:105], v[22:25]
    v_mfma_f32_16x16x32_bf16 v[26:29], a[28:31], v[90:93], v[26:29]
    v_mfma_f32_16x16x32_bf16 v[30:33], a[28:31], v[94:97], v[30:33]
    v_mfma_f32_16x16x32_bf16 v[34:37], a[28:31], v[98:101], v[34:37]
    v_mfma_f32_16x16x32_bf16 v[38:41], a[28:31], v[102:105], v[38:41]
    v_mfma_f32_16x16x32_bf16 v[42:45], a[32:35], v[90:93], v[42:45]
    v_mfma_f32_16x16x32_bf16 v[46:49], a[32:35], v[94:97], v[46:49]
    v_mfma_f32_16x16x32_bf16 v[50:53], a[32:35], v[98:101], v[50:53]
    v_mfma_f32_16x16x32_bf16 v[54:57], a[32:35], v[102:105], v[54:57]
    s_add_u32 s89, s86, 0x6000
    buffer_load_dwordx4 v[90:93], v122, s[40:43], s89 offen offset:0 sc1
    buffer_load_dwordx4 v[94:97], v123, s[40:43], s89 offen offset:0 sc1
    buffer_load_dwordx4 v[98:101], v124, s[40:43], s89 offen offset:0 sc1
    buffer_load_dwordx4 v[102:105], v125, s[40:43], s89 offen offset:0 sc1
    v_mfma_f32_16x16x32_bf16 v[10:13], a[36:39], v[106:109], v[10:13]
    v_mfma_f32_16x16x32_bf16 v[14:17], a[36:39], v[110:113], v[14:17]
    s_waitcnt vmcnt(8)
    v_max3_u32 v126, v61, v65, v69
    v_max_u32 v126, v126, v73
    v_cmp_eq_u32 vcc, -1, v126
    s_cbranch_vccnz Lrt_p4_151
Lbk_p4_152:
    v_mfma_f32_16x16x32_bf16 v[18:21], a[36:39], v[114:117], v[18:21]
    v_mfma_f32_16x16x32_bf16 v[22:25], a[36:39], v[118:121], v[22:25]
    v_mfma_f32_16x16x32_bf16 v[26:29], a[40:43], v[106:109], v[26:29]
    v_mfma_f32_16x16x32_bf16 v[30:33], a[40:43], v[110:113], v[30:33]
    v_mfma_f32_16x16x32_bf16 v[34:37], a[40:43], v[114:117], v[34:37]
    v_mfma_f32_16x16x32_bf16 v[38:41], a[40:43], v[118:121], v[38:41]
    v_mfma_f32_16x16x32_bf16 v[42:45], a[44:47], v[106:109], v[42:45]
    v_mfma_f32_16x16x32_bf16 v[46:49], a[44:47], v[110:113], v[46:49]
    v_mfma_f32_16x16x32_bf16 v[50:53], a[44:47], v[114:117], v[50:53]
    v_mfma_f32_16x16x32_bf16 v[54:57], a[44:47], v[118:121], v[54:57]
    s_add_u32 s89, s86, 0x7000
    buffer_load_dwordx4 v[106:109], v122, s[40:43], s89 offen offset:0 sc1
    buffer_load_dwordx4 v[110:113], v123, s[40:43], s89 offen offset:0 sc1
    buffer_load_dwordx4 v[114:117], v124, s[40:43], s89 offen offset:0 sc1
    buffer_load_dwordx4 v[118:121], v125, s[40:43], s89 offen offset:0 sc1
    v_mfma_f32_16x16x32_bf16 v[10:13], a[48:51], v[58:61], v[10:13]
    v_mfma_f32_16x16x32_bf16 v[14:17], a[48:51], v[62:65], v[14:17]
    s_waitcnt vmcnt(8)
    v_max3_u32 v126, v77, v81, v85
    v_max_u32 v126, v126, v89
    v_cmp_eq_u32 vcc, -1, v126
    s_cbranch_vccnz Lrt_p4_153
Lbk_p4_154:
    v_mfma_f32_16x16x32_bf16 v[18:21], a[48:51], v[66:69], v[18:21]
    v_mfma_f32_16x16x32_bf16 v[22:25], a[48:51], v[70:73], v[22:25]
    v_mfma_f32_16x16x32_bf16 v[26:29], a[52:55], v[58:61], v[26:29]
    v_mfma_f32_16x16x32_bf16 v[30:33], a[52:55], v[62:65], v[30:33]
    v_mfma_f32_16x16x32_bf16 v[34:37], a[52:55], v[66:69], v[34:37]
    v_mfma_f32_16x16x32_bf16 v[38:41], a[52:55], v[70:73], v[38:41]
    v_mfma_f32_16x16x32_bf16 v[42:45], a[56:59], v[58:61], v[42:45]
    v_mfma_f32_16x16x32_bf16 v[46:49], a[56:59], v[62:65], v[46:49]
    v_mfma_f32_16x16x32_bf16 v[50:53], a[56:59], v[66:69], v[50:53]
    v_mfma_f32_16x16x32_bf16 v[54:57], a[56:59], v[70:73], v[54:57]
    s_add_u32 s89, s86, 0x8000
    buffer_load_dwordx4 v[58:61], v122, s[40:43], s89 offen offset:0 sc1
    buffer_load_dwordx4 v[62:65], v123, s[40:43], s89 offen offset:0 sc1
    buffer_load_dwordx4 v[66:69], v124, s[40:43], s89 offen offset:0 sc1
    buffer_load_dwordx4 v[70:73], v125, s[40:43], s89 offen offset:0 sc1
    v_mfma_f32_16x16x32_bf16 v[10:13], a[60:63], v[74:77], v[10:13]
    v_mfma_f32_16x16x32_bf16 v[14:17], a[60:63], v[78:81], v[14:17]
    s_waitcnt vmcnt(8)
    v_max3_u32 v126, v93, v97, v101
    v_max_u32 v126, v126, v105
    v_cmp_eq_u32 vcc, -1, v126
    s_cbranch_vccnz Lrt_p4_155
Lbk_p4_156:
    v_mfma_f32_16x16x32_bf16 v[18:21], a[60:63], v[82:85], v[18:21]
    v_mfma_f32_16x16x32_bf16 v[22:25], a[60:63], v[86:89], v[22:25]
    v_mfma_f32_16x16x32_bf16 v[26:29], a[64:67], v[74:77], v[26:29]
    v_mfma_f32_16x16x32_bf16 v[30:33], a[64:67], v[78:81], v[30:33]
    v_mfma_f32_16x16x32_bf16 v[34:37], a[64:67], v[82:85], v[34:37]
    v_mfma_f32_16x16x32_bf16 v[38:41], a[64:67], v[86:89], v[38:41]
    v_mfma_f32_16x16x32_bf16 v[42:45], a[68:71], v[74:77], v[42:45]
    v_mfma_f32_16x16x32_bf16 v[46:49], a[68:71], v[78:81], v[46:49]
    v_mfma_f32_16x16x32_bf16 v[50:53], a[68:71], v[82:85], v[50:53]
    v_mfma_f32_16x16x32_bf16 v[54:57], a[68:71], v[86:89], v[54:57]
    s_add_u32 s89, s86, 0x9000
    buffer_load_dwordx4 v[74:77], v122, s[40:43], s89 offen offset:0 sc1
    buffer_load_dwordx4 v[78:81], v123, s[40:43], s89 offen offset:0 sc1
    buffer_load_dwordx4 v[82:85], v124, s[40:43], s89 offen offset:0 sc1
    buffer_load_dwordx4 v[86:89], v125, s[40:43], s89 offen offset:0 sc1
    v_mfma_f32_16x16x32_bf16 v[10:13], a[72:75], v[90:93], v[10:13]
    v_mfma_f32_16x16x32_bf16 v[14:17], a[72:75], v[94:97], v[14:17]
    s_waitcnt vmcnt(8)
    v_max3_u32 v126, v109, v113, v117
    v_max_u32 v126, v126, v121
    v_cmp_eq_u32 vcc, -1, v126
    s_cbranch_vccnz Lrt_p4_157
Lbk_p4_158:
    v_mfma_f32_16x16x32_bf16 v[18:21], a[72:75], v[98:101], v[18:21]
    v_mfma_f32_16x16x32_bf16 v[22:25], a[72:75], v[102:105], v[22:25]
    v_mfma_f32_16x16x32_bf16 v[26:29], a[76:79], v[90:93], v[26:29]
    v_mfma_f32_16x16x32_bf16 v[30:33], a[76:79], v[94:97], v[30:33]
    v_mfma_f32_16x16x32_bf16 v[34:37], a[76:79], v[98:101], v[34:37]
    v_mfma_f32_16x16x32_bf16 v[38:41], a[76:79], v[102:105], v[38:41]
    v_mfma_f32_16x16x32_bf16 v[42:45], a[80:83], v[90:93], v[42:45]
    v_mfma_f32_16x16x32_bf16 v[46:49], a[80:83], v[94:97], v[46:49]
    v_mfma_f32_16x16x32_bf16 v[50:53], a[80:83], v[98:101], v[50:53]
    v_mfma_f32_16x16x32_bf16 v[54:57], a[80:83], v[102:105], v[54:57]
    s_add_u32 s89, s86, 0xa000
    buffer_load_dwordx4 v[90:93], v122, s[40:43], s89 offen offset:0 sc1
    buffer_load_dwordx4 v[94:97], v123, s[40:43], s89 offen offset:0 sc1
    buffer_load_dwordx4 v[98:101], v124, s[40:43], s89 offen offset:0 sc1
    buffer_load_dwordx4 v[102:105], v125, s[40:43], s89 offen offset:0 sc1
    v_mfma_f32_16x16x32_bf16 v[10:13], a[84:87], v[106:109], v[10:13]
    v_mfma_f32_16x16x32_bf16 v[14:17], a[84:87], v[110:113], v[14:17]
    s_waitcnt vmcnt(8)
    v_max3_u32 v126, v61, v65, v69
    v_max_u32 v126, v126, v73
    v_cmp_eq_u32 vcc, -1, v126
    s_cbranch_vccnz Lrt_p4_159
Lbk_p4_160:
    v_mfma_f32_16x16x32_bf16 v[18:21], a[84:87], v[114:117], v[18:21]
    v_mfma_f32_16x16x32_bf16 v[22:25], a[84:87], v[118:121], v[22:25]
    v_mfma_f32_16x16x32_bf16 v[26:29], a[88:91], v[106:109], v[26:29]
    v_mfma_f32_16x16x32_bf16 v[30:33], a[88:91], v[110:113], v[30:33]
    v_mfma_f32_16x16x32_bf16 v[34:37], a[88:91], v[114:117], v[34:37]
    v_mfma_f32_16x16x32_bf16 v[38:41], a[88:91], v[118:121], v[38:41]
    v_mfma_f32_16x16x32_bf16 v[42:45], a[92:95], v[106:109], v[42:45]
    v_mfma_f32_16x16x32_bf16 v[46:49], a[92:95], v[110:113], v[46:49]
    v_mfma_f32_16x16x32_bf16 v[50:53], a[92:95], v[114:117], v[50:53]
    v_mfma_f32_16x16x32_bf16 v[54:57], a[92:95], v[118:121], v[54:57]
    s_add_u32 s89, s86, 0xb000
    buffer_load_dwordx4 v[106:109], v122, s[40:43], s89 offen offset:0 sc1
    buffer_load_dwordx4 v[110:113], v123, s[40:43], s89 offen offset:0 sc1
    buffer_load_dwordx4 v[114:117], v124, s[40:43], s89 offen offset:0 sc1
    buffer_load_dwordx4 v[118:121], v125, s[40:43], s89 offen offset:0 sc1
    v_mfma_f32_16x16x32_bf16 v[10:13], a[96:99], v[58:61], v[10:13]
    v_mfma_f32_16x16x32_bf16 v[14:17], a[96:99], v[62:65], v[14:17]
    s_waitcnt vmcnt(8)
    v_max3_u32 v126, v77, v81, v85
    v_max_u32 v126, v126, v89
    v_cmp_eq_u32 vcc, -1, v126
    s_cbranch_vccnz Lrt_p4_161
Lbk_p4_162:
    v_mfma_f32_16x16x32_bf16 v[18:21], a[96:99], v[66:69], v[18:21]
    v_mfma_f32_16x16x32_bf16 v[22:25], a[96:99], v[70:73], v[22:25]
    v_mfma_f32_16x16x32_bf16 v[26:29], a[100:103], v[58:61], v[26:29]
    v_mfma_f32_16x16x32_bf16 v[30:33], a[100:103], v[62:65], v[30:33]
    v_mfma_f32_16x16x32_bf16 v[34:37], a[100:103], v[66:69], v[34:37]
    v_mfma_f32_16x16x32_bf16 v[38:41], a[100:103], v[70:73], v[38:41]
    v_mfma_f32_16x16x32_bf16 v[42:45], a[104:107], v[58:61], v[42:45]
    v_mfma_f32_16x16x32_bf16 v[46:49], a[104:107], v[62:65], v[46:49]
    v_mfma_f32_16x16x32_bf16 v[50:53], a[104:107], v[66:69], v[50:53]
    v_mfma_f32_16x16x32_bf16 v[54:57], a[104:107], v[70:73], v[54:57]
    s_add_u32 s89, s86, 0xc000
    buffer_load_dwordx4 v[58:61], v122, s[40:43], s89 offen offset:0 sc1
    buffer_load_dwordx4 v[62:65], v123, s[40:43], s89 offen offset:0 sc1
    buffer_load_dwordx4 v[66:69], v124, s[40:43], s89 offen offset:0 sc1
    buffer_load_dwordx4 v[70:73], v125, s[40:43], s89 offen offset:0 sc1
    v_mfma_f32_16x16x32_bf16 v[10:13], a[108:111], v[74:77], v[10:13]
    v_mfma_f32_16x16x32_bf16 v[14:17], a[108:111], v[78:81], v[14:17]
    s_waitcnt vmcnt(8)
    v_max3_u32 v126, v93, v97, v101
    v_max_u32 v126, v126, v105
    v_cmp_eq_u32 vcc, -1, v126
    s_cbranch_vccnz Lrt_p4_163
Lbk_p4_164:
    v_mfma_f32_16x16x32_bf16 v[18:21], a[108:111], v[82:85], v[18:21]
    v_mfma_f32_16x16x32_bf16 v[22:25], a[108:111], v[86:89], v[22:25]
    v_mfma_f32_16x16x32_bf16 v[26:29], a[112:115], v[74:77], v[26:29]
    v_mfma_f32_16x16x32_bf16 v[30:33], a[112:115], v[78:81], v[30:33]
    v_mfma_f32_16x16x32_bf16 v[34:37], a[112:115], v[82:85], v[34:37]
    v_mfma_f32_16x16x32_bf16 v[38:41], a[112:115], v[86:89], v[38:41]
    v_mfma_f32_16x16x32_bf16 v[42:45], a[116:119], v[74:77], v[42:45]
    v_mfma_f32_16x16x32_bf16 v[46:49], a[116:119], v[78:81], v[46:49]
    v_mfma_f32_16x16x32_bf16 v[50:53], a[116:119], v[82:85], v[50:53]
    v_mfma_f32_16x16x32_bf16 v[54:57], a[116:119], v[86:89], v[54:57]
    s_add_u32 s89, s86, 0xd000
    buffer_load_dwordx4 v[74:77], v122, s[40:43], s89 offen offset:0 sc1
    buffer_load_dwordx4 v[78:81], v123, s[40:43], s89 offen offset:0 sc1
    buffer_load_dwordx4 v[82:85], v124, s[40:43], s89 offen offset:0 sc1
    buffer_load_dwordx4 v[86:89], v125, s[40:43], s89 offen offset:0 sc1
    v_mfma_f32_16x16x32_bf16 v[10:13], a[120:123], v[90:93], v[10:13]
    v_mfma_f32_16x16x32_bf16 v[14:17], a[120:123], v[94:97], v[14:17]
    s_waitcnt vmcnt(8)
    v_max3_u32 v126, v109, v113, v117
    v_max_u32 v126, v126, v121
    v_cmp_eq_u32 vcc, -1, v126
    s_cbranch_vccnz Lrt_p4_165
Lbk_p4_166:
    v_mfma_f32_16x16x32_bf16 v[18:21], a[120:123], v[98:101], v[18:21]
    v_mfma_f32_16x16x32_bf16 v[22:25], a[120:123], v[102:105], v[22:25]
    v_mfma_f32_16x16x32_bf16 v[26:29], a[124:127], v[90:93], v[26:29]
    v_mfma_f32_16x16x32_bf16 v[30:33], a[124:127], v[94:97], v[30:33]
    v_mfma_f32_16x16x32_bf16 v[34:37], a[124:127], v[98:101], v[34:37]
    v_mfma_f32_16x16x32_bf16 v[38:41], a[124:127], v[102:105], v[38:41]
    v_mfma_f32_16x16x32_bf16 v[42:45], a[128:131], v[90:93], v[42:45]
    v_mfma_f32_16x16x32_bf16 v[46:49], a[128:131], v[94:97], v[46:49]
    v_mfma_f32_16x16x32_bf16 v[50:53], a[128:131], v[98:101], v[50:53]
    v_mfma_f32_16x16x32_bf16 v[54:57], a[128:131], v[102:105], v[54:57]
    s_add_u32 s89, s86, 0xe000
    buffer_load_dwordx4 v[90:93], v122, s[40:43], s89 offen offset:0 sc1
    buffer_load_dwordx4 v[94:97], v123, s[40:43], s89 offen offset:0 sc1
    buffer_load_dwordx4 v[98:101], v124, s[40:43], s89 offen offset:0 sc1
    buffer_load_dwordx4 v[102:105], v125, s[40:43], s89 offen offset:0 sc1
    v_mfma_f32_16x16x32_bf16 v[10:13], a[132:135], v[106:109], v[10:13]
    v_mfma_f32_16x16x32_bf16 v[14:17], a[132:135], v[110:113], v[14:17]
    s_waitcnt vmcnt(8)
    v_max3_u32 v126, v61, v65, v69
    v_max_u32 v126, v126, v73
    v_cmp_eq_u32 vcc, -1, v126
    s_cbranch_vccnz Lrt_p4_167
Lbk_p4_168:
    v_mfma_f32_16x16x32_bf16 v[18:21], a[132:135], v[114:117], v[18:21]
    v_mfma_f32_16x16x32_bf16 v[22:25], a[132:135], v[118:121], v[22:25]
    v_mfma_f32_16x16x32_bf16 v[26:29], a[136:139], v[106:109], v[26:29]
    v_mfma_f32_16x16x32_bf16 v[30:33], a[136:139], v[110:113], v[30:33]
    v_mfma_f32_16x16x32_bf16 v[34:37], a[136:139], v[114:117], v[34:37]
    v_mfma_f32_16x16x32_bf16 v[38:41], a[136:139], v[118:121], v[38:41]
    v_mfma_f32_16x16x32_bf16 v[42:45], a[140:143], v[106:109], v[42:45]
    v_mfma_f32_16x16x32_bf16 v[46:49], a[140:143], v[110:113], v[46:49]
    v_mfma_f32_16x16x32_bf16 v[50:53], a[140:143], v[114:117], v[50:53]
    v_mfma_f32_16x16x32_bf16 v[54:57], a[140:143], v[118:121], v[54:57]
    s_add_u32 s89, s86, 0xf000
    buffer_load_dwordx4 v[106:109], v122, s[40:43], s89 offen offset:0 sc1
    buffer_load_dwordx4 v[110:113], v123, s[40:43], s89 offen offset:0 sc1
    buffer_load_dwordx4 v[114:117], v124, s[40:43], s89 offen offset:0 sc1
    buffer_load_dwordx4 v[118:121], v125, s[40:43], s89 offen offset:0 sc1
    v_mfma_f32_16x16x32_bf16 v[10:13], a[144:147], v[58:61], v[10:13]
    v_mfma_f32_16x16x32_bf16 v[14:17], a[144:147], v[62:65], v[14:17]
    s_waitcnt vmcnt(8)
    v_max3_u32 v126, v77, v81, v85
    v_max_u32 v126, v126, v89
    v_cmp_eq_u32 vcc, -1, v126
    s_cbranch_vccnz Lrt_p4_169
Lbk_p4_170:
    v_mfma_f32_16x16x32_bf16 v[18:21], a[144:147], v[66:69], v[18:21]
    v_mfma_f32_16x16x32_bf16 v[22:25], a[144:147], v[70:73], v[22:25]
    v_mfma_f32_16x16x32_bf16 v[26:29], a[148:151], v[58:61], v[26:29]
    v_mfma_f32_16x16x32_bf16 v[30:33], a[148:151], v[62:65], v[30:33]
    v_mfma_f32_16x16x32_bf16 v[34:37], a[148:151], v[66:69], v[34:37]
    v_mfma_f32_16x16x32_bf16 v[38:41], a[148:151], v[70:73], v[38:41]
    v_mfma_f32_16x16x32_bf16 v[42:45], a[152:155], v[58:61], v[42:45]
    v_mfma_f32_16x16x32_bf16 v[46:49], a[152:155], v[62:65], v[46:49]
    v_mfma_f32_16x16x32_bf16 v[50:53], a[152:155], v[66:69], v[50:53]
    v_mfma_f32_16x16x32_bf16 v[54:57], a[152:155], v[70:73], v[54:57]
    v_mfma_f32_16x16x32_bf16 v[10:13], a[156:159], v[74:77], v[10:13]
    v_mfma_f32_16x16x32_bf16 v[14:17], a[156:159], v[78:81], v[14:17]
    s_waitcnt vmcnt(4)
    v_max3_u32 v126, v93, v97, v101
    v_max_u32 v126, v126, v105
    v_cmp_eq_u32 vcc, -1, v126
    s_cbranch_vccnz Lrt_p4_171
Lbk_p4_172:
    v_mfma_f32_16x16x32_bf16 v[18:21], a[156:159], v[82:85], v[18:21]
    v_mfma_f32_16x16x32_bf16 v[22:25], a[156:159], v[86:89], v[22:25]
    v_mfma_f32_16x16x32_bf16 v[26:29], a[160:163], v[74:77], v[26:29]
    v_mfma_f32_16x16x32_bf16 v[30:33], a[160:163], v[78:81], v[30:33]
    v_mfma_f32_16x16x32_bf16 v[34:37], a[160:163], v[82:85], v[34:37]
    v_mfma_f32_16x16x32_bf16 v[38:41], a[160:163], v[86:89], v[38:41]
    v_mfma_f32_16x16x32_bf16 v[42:45], a[164:167], v[74:77], v[42:45]
    v_mfma_f32_16x16x32_bf16 v[46:49], a[164:167], v[78:81], v[46:49]
    v_mfma_f32_16x16x32_bf16 v[50:53], a[164:167], v[82:85], v[50:53]
    v_mfma_f32_16x16x32_bf16 v[54:57], a[164:167], v[86:89], v[54:57]
    v_mfma_f32_16x16x32_bf16 v[10:13], a[168:171], v[90:93], v[10:13]
    v_mfma_f32_16x16x32_bf16 v[14:17], a[168:171], v[94:97], v[14:17]
    s_waitcnt vmcnt(0)
    v_max3_u32 v126, v109, v113, v117
    v_max_u32 v126, v126, v121
    v_cmp_eq_u32 vcc, -1, v126
    s_cbranch_vccnz Lrt_p4_173
Lbk_p4_174:
    v_mfma_f32_16x16x32_bf16 v[18:21], a[168:171], v[98:101], v[18:21]
    v_mfma_f32_16x16x32_bf16 v[22:25], a[168:171], v[102:105], v[22:25]
    v_mfma_f32_16x16x32_bf16 v[26:29], a[172:175], v[90:93], v[26:29]
    v_mfma_f32_16x16x32_bf16 v[30:33], a[172:175], v[94:97], v[30:33]
    v_mfma_f32_16x16x32_bf16 v[34:37], a[172:175], v[98:101], v[34:37]
    v_mfma_f32_16x16x32_bf16 v[38:41], a[172:175], v[102:105], v[38:41]
    v_mfma_f32_16x16x32_bf16 v[42:45], a[176:179], v[90:93], v[42:45]
    v_mfma_f32_16x16x32_bf16 v[46:49], a[176:179], v[94:97], v[46:49]
    v_mfma_f32_16x16x32_bf16 v[50:53], a[176:179], v[98:101], v[50:53]
    v_mfma_f32_16x16x32_bf16 v[54:57], a[176:179], v[102:105], v[54:57]
    v_mfma_f32_16x16x32_bf16 v[10:13], a[180:183], v[106:109], v[10:13]
    v_mfma_f32_16x16x32_bf16 v[14:17], a[180:183], v[110:113], v[14:17]
    v_mfma_f32_16x16x32_bf16 v[18:21], a[180:183], v[114:117], v[18:21]
    v_mfma_f32_16x16x32_bf16 v[22:25], a[180:183], v[118:121], v[22:25]
    v_mfma_f32_16x16x32_bf16 v[26:29], a[184:187], v[106:109], v[26:29]
    v_mfma_f32_16x16x32_bf16 v[30:33], a[184:187], v[110:113], v[30:33]
    v_mfma_f32_16x16x32_bf16 v[34:37], a[184:187], v[114:117], v[34:37]
    v_mfma_f32_16x16x32_bf16 v[38:41], a[184:187], v[118:121], v[38:41]
    v_mfma_f32_16x16x32_bf16 v[42:45], a[188:191], v[106:109], v[42:45]
    v_mfma_f32_16x16x32_bf16 v[46:49], a[188:191], v[110:113], v[46:49]
    v_mfma_f32_16x16x32_bf16 v[50:53], a[188:191], v[114:117], v[50:53]
    v_mfma_f32_16x16x32_bf16 v[54:57], a[188:191], v[118:121], v[54:57]
    ds_write_b128 v134, v[14:17] offset:0
    s_nop 0
    ds_write_b128 v134, v[30:33] offset:1024
    s_nop 2
    ds_write_b128 v134, v[46:49] offset:2048
    ds_write_b128 v135, v[18:21] offset:0
    ds_write_b128 v135, v[34:37] offset:1024
    ds_write_b128 v135, v[50:53] offset:2048
    ds_write_b128 v136, v[22:25] offset:0
    ds_write_b128 v136, v[38:41] offset:1024
    ds_write_b128 v136, v[54:57] offset:2048
    s_lshl_b32 s86, s81, 1
    s_add_u32 s86, s86, s100
    s_mul_i32 s86, s86, 96
    s_mul_i32 s92, s82, 3
    s_add_u32 s86, s86, s92
    s_lshl_b32 s86, s86, 10
    s_add_u32 s86, s86, 0x1000000
    v_mov_b32 v106, 0xc0135761
    v_mov_b32 v108, 0xbdd2d3e8
    v_mov_b32 v107, 0xc0135761
    v_mov_b32 v109, 0xbdd2d3e8
    s_waitcnt lgkmcnt(0)
    s_barrier
    v_lshlrev_b32 v138, 4, v0
    s_mul_i32 s97, s76, 15360
    s_mul_i32 s96, s78, 98304
    s_add_u32 s96, s96, s97
    s_add_u32 s96, s96, 0x2609000
    ds_read_b128 v[58:61], v137 offset:0
    ds_read_b128 v[70:73], v137 offset:3072
    ds_read_b128 v[82:85], v137 offset:6144
    ds_read_b128 v[62:65], v137 offset:1024
    ds_read_b128 v[74:77], v137 offset:4096
    ds_read_b128 v[86:89], v137 offset:7168
    ds_read_b128 v[66:69], v137 offset:2048
    ds_read_b128 v[78:81], v137 offset:5120
    ds_read_b128 v[90:93], v137 offset:8192
    s_waitcnt lgkmcnt(6)
    v_pk_add_f32 v[58:59], v[58:59], v[70:71]
    v_pk_add_f32 v[10:11], v[10:11], v[82:83]
    v_pk_add_f32 v[60:61], v[60:61], v[72:73]
    v_pk_add_f32 v[12:13], v[12:13], v[84:85]
    v_pk_add_f32 v[10:11], v[10:11], v[58:59]
    v_pk_add_f32 v[12:13], v[12:13], v[60:61]
    v_pk_mul_f32 v[110:111], v[10:11], v[10:11]
    v_pk_mul_f32 v[112:113], v[12:13], v[12:13]
    v_pk_fma_f32 v[110:111], v[110:111], v[108:109], v[106:107]
    v_pk_fma_f32 v[112:113], v[112:113], v[108:109], v[106:107]
    v_pk_mul_f32 v[110:111], v[110:111], v[10:11]
    v_pk_mul_f32 v[112:113], v[112:113], v[12:13]
    v_exp_f32 v110, v110
    v_exp_f32 v111, v111
    v_exp_f32 v112, v112
    v_exp_f32 v113, v113
    v_add_f32 v110, 1.0, v110
    v_add_f32 v111, 1.0, v111
    v_add_f32 v112, 1.0, v112
    v_add_f32 v113, 1.0, v113
    v_rcp_f32 v110, v110
    v_rcp_f32 v111, v111
    v_rcp_f32 v112, v112
    v_rcp_f32 v113, v113
    v_pk_mul_f32 v[10:11], v[10:11], v[110:111]
    v_pk_mul_f32 v[12:13], v[12:13], v[112:113]
    v_cvt_pk_bf16_f32 v118, v10, v11
    v_cvt_pk_bf16_f32 v119, v12, v13
    buffer_store_dwordx2 v[118:119], v141, s[40:43], s86 offen offset:0 sc1
    s_add_u32 m0, s97, 0
    s_add_u32 s1, s96, 0x0
    buffer_load_dwordx4 v138, s[40:43], s1 offen lds
    s_add_u32 m0, s97, 1024
    s_add_u32 s1, s96, 0x400
    buffer_load_dwordx4 v138, s[40:43], s1 offen lds
    s_add_u32 m0, s97, 2048
    s_add_u32 s1, s96, 0x800
    buffer_load_dwordx4 v138, s[40:43], s1 offen lds
    s_add_u32 m0, s97, 3072
    s_add_u32 s1, s96, 0xc00
    buffer_load_dwordx4 v138, s[40:43], s1 offen lds
    s_waitcnt lgkmcnt(3)
    v_pk_add_f32 v[62:63], v[62:63], v[74:75]
    v_pk_add_f32 v[26:27], v[26:27], v[86:87]
    v_pk_add_f32 v[64:65], v[64:65], v[76:77]
    v_pk_add_f32 v[28:29], v[28:29], v[88:89]
    v_pk_add_f32 v[26:27], v[26:27], v[62:63]
    v_pk_add_f32 v[28:29], v[28:29], v[64:65]
    v_pk_mul_f32 v[110:111], v[26:27], v[26:27]
    v_pk_mul_f32 v[112:113], v[28:29], v[28:29]
    v_pk_fma_f32 v[110:111], v[110:111], v[108:109], v[106:107]
    v_pk_fma_f32 v[112:113], v[112:113], v[108:109], v[106:107]
    v_pk_mul_f32 v[110:111], v[110:111], v[26:27]
    v_pk_mul_f32 v[112:113], v[112:113], v[28:29]
    v_exp_f32 v110, v110
    v_exp_f32 v111, v111
    v_exp_f32 v112, v112
    v_exp_f32 v113, v113
    v_add_f32 v110, 1.0, v110
    v_add_f32 v111, 1.0, v111
    v_add_f32 v112, 1.0, v112
    v_add_f32 v113, 1.0, v113
    v_rcp_f32 v110, v110
    v_rcp_f32 v111, v111
    v_rcp_f32 v112, v112
    v_rcp_f32 v113, v113
    v_pk_mul_f32 v[26:27], v[26:27], v[110:111]
    v_pk_mul_f32 v[28:29], v[28:29], v[112:113]
    v_cvt_pk_bf16_f32 v120, v26, v27
    v_cvt_pk_bf16_f32 v121, v28, v29
    buffer_store_dwordx2 v[120:121], v141, s[40:43], s86 offen offset:1024 sc1
    s_add_u32 m0, s97, 4096
    s_add_u32 s1, s96, 0x1000
    buffer_load_dwordx4 v138, s[40:43], s1 offen lds
    s_add_u32 m0, s97, 5120
    s_add_u32 s1, s96, 0x1400
    buffer_load_dwordx4 v138, s[40:43], s1 offen lds
    s_add_u32 m0, s97, 6144
    s_add_u32 s1, s96, 0x1800
    buffer_load_dwordx4 v138, s[40:43], s1 offen lds
    s_add_u32 m0, s97, 7168
    s_add_u32 s1, s96, 0x1c00
    buffer_load_dwordx4 v138, s[40:43], s1 offen lds
    s_waitcnt lgkmcnt(0)
    v_pk_add_f32 v[66:67], v[66:67], v[78:79]
    v_pk_add_f32 v[42:43], v[42:43], v[90:91]
    v_pk_add_f32 v[68:69], v[68:69], v[80:81]
    v_pk_add_f32 v[44:45], v[44:45], v[92:93]
    v_pk_add_f32 v[42:43], v[42:43], v[66:67]
    v_pk_add_f32 v[44:45], v[44:45], v[68:69]
    v_pk_mul_f32 v[110:111], v[42:43], v[42:43]
    v_pk_mul_f32 v[112:113], v[44:45], v[44:45]
    v_pk_fma_f32 v[110:111], v[110:111], v[108:109], v[106:107]
    v_pk_fma_f32 v[112:113], v[112:113], v[108:109], v[106:107]
    v_pk_mul_f32 v[110:111], v[110:111], v[42:43]
    v_pk_mul_f32 v[112:113], v[112:113], v[44:45]
    v_exp_f32 v110, v110
    v_exp_f32 v111, v111
    v_exp_f32 v112, v112
    v_exp_f32 v113, v113
    v_add_f32 v110, 1.0, v110
    v_add_f32 v111, 1.0, v111
    v_add_f32 v112, 1.0, v112
    v_add_f32 v113, 1.0, v113
    v_rcp_f32 v110, v110
    v_rcp_f32 v111, v111
    v_rcp_f32 v112, v112
    v_rcp_f32 v113, v113
    v_pk_mul_f32 v[42:43], v[42:43], v[110:111]
    v_pk_mul_f32 v[44:45], v[44:45], v[112:113]
    v_cvt_pk_bf16_f32 v118, v42, v43
    v_cvt_pk_bf16_f32 v119, v44, v45
    buffer_store_dwordx2 v[118:119], v141, s[40:43], s86 offen offset:2048 sc1
    s_add_u32 m0, s97, 8192
    s_add_u32 s1, s96, 0x2000
    buffer_load_dwordx4 v138, s[40:43], s1 offen lds
    s_add_u32 m0, s97, 9216
    s_add_u32 s1, s96, 0x2400
    buffer_load_dwordx4 v138, s[40:43], s1 offen lds
    s_add_u32 m0, s97, 10240
    s_add_u32 s1, s96, 0x2800
    buffer_load_dwordx4 v138, s[40:43], s1 offen lds
    s_add_u32 m0, s97, 11264
    s_add_u32 s1, s96, 0x2c00
    buffer_load_dwordx4 v138, s[40:43], s1 offen lds
    v_lshlrev_b32 v130, 4, v0
    s_mul_i32 s86, s80, 196608
    s_add_u32 s86, s86, 0x1000000
    s_mul_i32 s89, s100, 98304
    v_add_u32 v134, s89, v130
    s_sub_u32 s89, 98304, s89
    v_add_u32 v133, s89, v130
    s_mul_i32 s88, s76, 22
    s_lshl_b32 s87, s88, 10
    s_add_u32 s87, s87, s86
    s_add_u32 m0, s97, 12288
    s_add_u32 s1, s96, 0x3000
    buffer_load_dwordx4 v138, s[40:43], s1 offen lds
    s_add_u32 m0, s97, 13312
    s_add_u32 s1, s96, 0x3400
    buffer_load_dwordx4 v138, s[40:43], s1 offen lds
    s_add_u32 s89, s87, 0x0
    buffer_load_dwordx4 v[74:77], v134, s[40:43], s89 offen offset:0 sc1
    buffer_load_dwordx4 v[78:81], v133, s[40:43], s89 offen offset:0 sc1
    s_add_u32 s89, s87, 0x0
    buffer_load_dwordx4 v[82:85], v134, s[40:43], s89 offen offset:1024 sc1
    buffer_load_dwordx4 v[86:89], v133, s[40:43], s89 offen offset:1024 sc1
    s_add_u32 s89, s87, 0x0
    buffer_load_dwordx4 v[90:93], v134, s[40:43], s89 offen offset:2048 sc1
    buffer_load_dwordx4 v[94:97], v133, s[40:43], s89 offen offset:2048 sc1
    s_add_u32 s89, s87, 0x0
    buffer_load_dwordx4 v[98:101], v134, s[40:43], s89 offen offset:3072 sc1
    buffer_load_dwordx4 v[102:105], v133, s[40:43], s89 offen offset:3072 sc1
    s_add_u32 s89, s87, 0x1000
    buffer_load_dwordx4 v[106:109], v134, s[40:43], s89 offen offset:0 sc1
    buffer_load_dwordx4 v[110:113], v133, s[40:43], s89 offen offset:0 sc1
    s_add_u32 s89, s87, 0x1000
    buffer_load_dwordx4 v[114:117], v134, s[40:43], s89 offen offset:1024 sc1
    buffer_load_dwordx4 v[118:121], v133, s[40:43], s89 offen offset:1024 sc1
    s_add_u32 s89, s87, 0x1000
    buffer_load_dwordx4 v[122:125], v134, s[40:43], s89 offen offset:2048 sc1
    buffer_load_dwordx4 v[126:129], v133, s[40:43], s89 offen offset:2048 sc1
    s_add_u32 m0, s97, 14336
    s_add_u32 s1, s96, 0x3800
    buffer_load_dwordx4 v138, s[40:43], s1 offen lds
    s_xor_b32 s89, s76, 1
    s_mul_i32 s89, s89, 3
    s_add_u32 s89, s89, 0
    s_lshl_b32 s89, s89, 12
    s_add_u32 s89, s89, 0xf000
    v_add_u32 v135, s89, v130
    s_xor_b32 s89, s76, 2
    s_mul_i32 s89, s89, 3
    s_add_u32 s89, s89, 1
    s_lshl_b32 s89, s89, 12
    s_add_u32 s89, s89, 0xf000
    v_add_u32 v136, s89, v130
    s_xor_b32 s89, s76, 3
    s_mul_i32 s89, s89, 3
    s_add_u32 s89, s89, 2
    s_lshl_b32 s89, s89, 12
    s_add_u32 s89, s89, 0xf000
    v_add_u32 v137, s89, v130
    s_mul_i32 s89, s76, 12288
    s_add_u32 s89, s89, 0xf000
    v_add_u32 v139, s89, v130
    v_lshlrev_b32 v10, 16, v2
    v_and_b32 v11, 0xffff0000, v2
    v_lshlrev_b32 v12, 16, v3
    v_and_b32 v13, 0xffff0000, v3
    v_lshlrev_b32 v14, 16, v4
    v_and_b32 v15, 0xffff0000, v4
    v_lshlrev_b32 v16, 16, v5
    v_and_b32 v17, 0xffff0000, v5
    v_lshlrev_b32 v18, 16, v6
    v_and_b32 v19, 0xffff0000, v6
    v_lshlrev_b32 v20, 16, v7
    v_and_b32 v21, 0xffff0000, v7
    v_lshlrev_b32 v22, 16, v8
    v_and_b32 v23, 0xffff0000, v8
    v_lshlrev_b32 v24, 16, v9
    v_and_b32 v25, 0xffff0000, v9
    v_add_f32 v10, v10, v1
    v_add_f32 v11, v11, v1
    v_add_f32 v12, v12, v1
    v_add_f32 v13, v13, v1
    v_add_f32 v14, v14, v1
    v_add_f32 v15, v15, v1
    v_add_f32 v16, v16, v1
    v_add_f32 v17, v17, v1
    v_add_f32 v18, v18, v1
    v_add_f32 v19, v19, v1
    v_add_f32 v20, v20, v1
    v_add_f32 v21, v21, v1
    v_add_f32 v22, v22, v1
    v_add_f32 v23, v23, v1
    v_add_f32 v24, v24, v1
    v_add_f32 v25, v25, v1
    s_waitcnt lgkmcnt(0)
    s_barrier
    s_waitcnt vmcnt(13)
    v_max3_u32 v131, v75, v77, v79
    v_max_u32 v131, v131, v81
    v_cmp_eq_u32 vcc, -1, v131
    s_cbranch_vccnz Lrt_p5_175
Lbk_p5_176:
    v_mfma_f32_32x32x16_bf16 v[10:25], v[74:77], a[192:195], v[10:25]
    s_waitcnt vmcnt(11)
    v_max3_u32 v131, v83, v85, v87
    v_max_u32 v131, v131, v89
    v_cmp_eq_u32 vcc, -1, v131
    s_cbranch_vccnz Lrt_p5_177
Lbk_p5_178:
    v_mfma_f32_32x32x16_bf16 v[26:41], v[74:77], a[196:199], 0
    v_mfma_f32_32x32x16_bf16 v[42:57], v[78:81], a[192:195], 0
    v_mfma_f32_32x32x16_bf16 v[58:73], v[78:81], a[196:199], 0
    s_add_u32 s89, s87, 0x1000
    buffer_load_dwordx4 v[74:77], v134, s[40:43], s89 offen offset:3072 sc1
    buffer_load_dwordx4 v[78:81], v133, s[40:43], s89 offen offset:3072 sc1
    v_mfma_f32_32x32x16_bf16 v[10:25], v[82:85], a[200:203], v[10:25]
    s_waitcnt vmcnt(11)
    v_max3_u32 v131, v91, v93, v95
    v_max_u32 v131, v131, v97
    v_cmp_eq_u32 vcc, -1, v131
    s_cbranch_vccnz Lrt_p5_179
Lbk_p5_180:
    v_mfma_f32_32x32x16_bf16 v[26:41], v[82:85], a[204:207], v[26:41]
    v_mfma_f32_32x32x16_bf16 v[42:57], v[86:89], a[200:203], v[42:57]
    v_mfma_f32_32x32x16_bf16 v[58:73], v[86:89], a[204:207], v[58:73]
    s_add_u32 s89, s87, 0x2000
    buffer_load_dwordx4 v[82:85], v134, s[40:43], s89 offen offset:0 sc1
    buffer_load_dwordx4 v[86:89], v133, s[40:43], s89 offen offset:0 sc1
    v_mfma_f32_32x32x16_bf16 v[10:25], v[90:93], a[208:211], v[10:25]
    s_waitcnt vmcnt(11)
    v_max3_u32 v131, v99, v101, v103
    v_max_u32 v131, v131, v105
    v_cmp_eq_u32 vcc, -1, v131
    s_cbranch_vccnz Lrt_p5_181
Lbk_p5_182:
    v_mfma_f32_32x32x16_bf16 v[26:41], v[90:93], a[212:215], v[26:41]
    v_mfma_f32_32x32x16_bf16 v[42:57], v[94:97], a[208:211], v[42:57]
    v_mfma_f32_32x32x16_bf16 v[58:73], v[94:97], a[212:215], v[58:73]
    s_add_u32 s89, s87, 0x2000
    buffer_load_dwordx4 v[90:93], v134, s[40:43], s89 offen offset:1024 sc1
    buffer_load_dwordx4 v[94:97], v133, s[40:43], s89 offen offset:1024 sc1
    v_mfma_f32_32x32x16_bf16 v[10:25], v[98:101], a[216:219], v[10:25]
    s_waitcnt vmcnt(11)
    v_max3_u32 v131, v107, v109, v111
    v_max_u32 v131, v131, v113
    v_cmp_eq_u32 vcc, -1, v131
    s_cbranch_vccnz Lrt_p5_183
Lbk_p5_184:
    v_mfma_f32_32x32x16_bf16 v[26:41], v[98:101], a[220:223], v[26:41]
    v_mfma_f32_32x32x16_bf16 v[42:57], v[102:105], a[216:219], v[42:57]
    v_mfma_f32_32x32x16_bf16 v[58:73], v[102:105], a[220:223], v[58:73]
    s_add_u32 s89, s87, 0x2000
    buffer_load_dwordx4 v[98:101], v134, s[40:43], s89 offen offset:2048 sc1
    buffer_load_dwordx4 v[102:105], v133, s[40:43], s89 offen offset:2048 sc1
    v_mfma_f32_32x32x16_bf16 v[10:25], v[106:109], a[224:227], v[10:25]
    s_waitcnt vmcnt(11)
    v_max3_u32 v131, v115, v117, v119
    v_max_u32 v131, v131, v121
    v_cmp_eq_u32 vcc, -1, v131
    s_cbranch_vccnz Lrt_p5_185
Lbk_p5_186:
    v_mfma_f32_32x32x16_bf16 v[26:41], v[106:109], a[228:231], v[26:41]
    v_mfma_f32_32x32x16_bf16 v[42:57], v[110:113], a[224:227], v[42:57]
    v_mfma_f32_32x32x16_bf16 v[58:73], v[110:113], a[228:231], v[58:73]
    s_add_u32 s89, s87, 0x2000
    buffer_load_dwordx4 v[106:109], v134, s[40:43], s89 offen offset:3072 sc1
    buffer_load_dwordx4 v[110:113], v133, s[40:43], s89 offen offset:3072 sc1
    v_mfma_f32_32x32x16_bf16 v[10:25], v[114:117], a[232:235], v[10:25]
    s_waitcnt vmcnt(11)
    v_max3_u32 v131, v123, v125, v127
    v_max_u32 v131, v131, v129
    v_cmp_eq_u32 vcc, -1, v131
    s_cbranch_vccnz Lrt_p5_187
Lbk_p5_188:
    v_mfma_f32_32x32x16_bf16 v[26:41], v[114:117], a[236:239], v[26:41]
    v_mfma_f32_32x32x16_bf16 v[42:57], v[118:121], a[232:235], v[42:57]
    v_mfma_f32_32x32x16_bf16 v[58:73], v[118:121], a[236:239], v[58:73]
    s_add_u32 s89, s87, 0x3000
    buffer_load_dwordx4 v[114:117], v134, s[40:43], s89 offen offset:0 sc1
    buffer_load_dwordx4 v[118:121], v133, s[40:43], s89 offen offset:0 sc1
    v_mfma_f32_32x32x16_bf16 v[10:25], v[122:125], a[240:243], v[10:25]
    s_waitcnt vmcnt(10)
    v_max3_u32 v131, v75, v77, v79
    v_max_u32 v131, v131, v81
    v_cmp_eq_u32 vcc, -1, v131
    s_cbranch_vccnz Lrt_p5_189
Lbk_p5_190:
    v_mfma_f32_32x32x16_bf16 v[26:41], v[122:125], a[244:247], v[26:41]
    v_mfma_f32_32x32x16_bf16 v[42:57], v[126:129], a[240:243], v[42:57]
    v_mfma_f32_32x32x16_bf16 v[58:73], v[126:129], a[244:247], v[58:73]
    s_add_u32 s89, s87, 0x3000
    buffer_load_dwordx4 v[122:125], v134, s[40:43], s89 offen offset:1024 sc1
    buffer_load_dwordx4 v[126:129], v133, s[40:43], s89 offen offset:1024 sc1
    v_mfma_f32_32x32x16_bf16 v[10:25], v[74:77], a[248:251], v[10:25]
    s_waitcnt vmcnt(10)
    v_max3_u32 v131, v83, v85, v87
    v_max_u32 v131, v131, v89
    v_cmp_eq_u32 vcc, -1, v131
    s_cbranch_vccnz Lrt_p5_191
Lbk_p5_192:
    v_mfma_f32_32x32x16_bf16 v[26:41], v[74:77], a[252:255], v[26:41]
    v_mfma_f32_32x32x16_bf16 v[42:57], v[78:81], a[248:251], v[42:57]
    v_mfma_f32_32x32x16_bf16 v[58:73], v[78:81], a[252:255], v[58:73]
    s_add_u32 s89, s87, 0x3000
    buffer_load_dwordx4 v[74:77], v134, s[40:43], s89 offen offset:2048 sc1
    buffer_load_dwordx4 v[78:81], v133, s[40:43], s89 offen offset:2048 sc1
    v_mfma_f32_32x32x16_bf16 v[10:25], v[82:85], v[144:147], v[10:25]
    s_waitcnt vmcnt(10)
    v_max3_u32 v131, v91, v93, v95
    v_max_u32 v131, v131, v97
    v_cmp_eq_u32 vcc, -1, v131
    s_cbranch_vccnz Lrt_p5_193
Lbk_p5_194:
    v_mfma_f32_32x32x16_bf16 v[26:41], v[82:85], v[148:151], v[26:41]
    v_mfma_f32_32x32x16_bf16 v[42:57], v[86:89], v[144:147], v[42:57]
    v_mfma_f32_32x32x16_bf16 v[58:73], v[86:89], v[148:151], v[58:73]
    s_add_u32 s89, s87, 0x3000
    buffer_load_dwordx4 v[82:85], v134, s[40:43], s89 offen offset:3072 sc1
    buffer_load_dwordx4 v[86:89], v133, s[40:43], s89 offen offset:3072 sc1
    v_mfma_f32_32x32x16_bf16 v[10:25], v[90:93], v[152:155], v[10:25]
    s_waitcnt vmcnt(10)
    v_max3_u32 v131, v99, v101, v103
    v_max_u32 v131, v131, v105
    v_cmp_eq_u32 vcc, -1, v131
    s_cbranch_vccnz Lrt_p5_195
Lbk_p5_196:
    v_mfma_f32_32x32x16_bf16 v[26:41], v[90:93], v[156:159], v[26:41]
    v_mfma_f32_32x32x16_bf16 v[42:57], v[94:97], v[152:155], v[42:57]
    v_mfma_f32_32x32x16_bf16 v[58:73], v[94:97], v[156:159], v[58:73]
    s_add_u32 s89, s87, 0x4000
    buffer_load_dwordx4 v[90:93], v134, s[40:43], s89 offen offset:0 sc1
    buffer_load_dwordx4 v[94:97], v133, s[40:43], s89 offen offset:0 sc1
    v_mfma_f32_32x32x16_bf16 v[10:25], v[98:101], v[160:163], v[10:25]
    s_waitcnt vmcnt(10)
    v_max3_u32 v131, v107, v109, v111
    v_max_u32 v131, v131, v113
    v_cmp_eq_u32 vcc, -1, v131
    s_cbranch_vccnz Lrt_p5_197
Lbk_p5_198:
    v_mfma_f32_32x32x16_bf16 v[26:41], v[98:101], v[164:167], v[26:41]
    v_mfma_f32_32x32x16_bf16 v[42:57], v[102:105], v[160:163], v[42:57]
    v_mfma_f32_32x32x16_bf16 v[58:73], v[102:105], v[164:167], v[58:73]
    s_add_u32 s89, s87, 0x4000
    buffer_load_dwordx4 v[98:101], v134, s[40:43], s89 offen offset:1024 sc1
    buffer_load_dwordx4 v[102:105], v133, s[40:43], s89 offen offset:1024 sc1
    v_mfma_f32_32x32x16_bf16 v[10:25], v[106:109], v[168:171], v[10:25]
    s_waitcnt vmcnt(10)
    v_max3_u32 v131, v115, v117, v119
    v_max_u32 v131, v131, v121
    v_cmp_eq_u32 vcc, -1, v131
    s_cbranch_vccnz Lrt_p5_199
Lbk_p5_200:
    v_mfma_f32_32x32x16_bf16 v[26:41], v[106:109], v[172:175], v[26:41]
    v_mfma_f32_32x32x16_bf16 v[42:57], v[110:113], v[168:171], v[42:57]
    v_mfma_f32_32x32x16_bf16 v[58:73], v[110:113], v[172:175], v[58:73]
    s_add_u32 s89, s87, 0x4000
    buffer_load_dwordx4 v[106:109], v134, s[40:43], s89 offen offset:2048 sc1
    buffer_load_dwordx4 v[110:113], v133, s[40:43], s89 offen offset:2048 sc1
    v_mfma_f32_32x32x16_bf16 v[10:25], v[114:117], v[176:179], v[10:25]
    s_waitcnt vmcnt(10)
    v_max3_u32 v131, v123, v125, v127
    v_max_u32 v131, v131, v129
    v_cmp_eq_u32 vcc, -1, v131
    s_cbranch_vccnz Lrt_p5_201
Lbk_p5_202:
    v_mfma_f32_32x32x16_bf16 v[26:41], v[114:117], v[180:183], v[26:41]
    v_mfma_f32_32x32x16_bf16 v[42:57], v[118:121], v[176:179], v[42:57]
    v_mfma_f32_32x32x16_bf16 v[58:73], v[118:121], v[180:183], v[58:73]
    s_add_u32 s89, s87, 0x4000
    buffer_load_dwordx4 v[114:117], v134, s[40:43], s89 offen offset:3072 sc1
    buffer_load_dwordx4 v[118:121], v133, s[40:43], s89 offen offset:3072 sc1
    v_mfma_f32_32x32x16_bf16 v[10:25], v[122:125], v[184:187], v[10:25]
    s_waitcnt vmcnt(10)
    v_max3_u32 v131, v75, v77, v79
    v_max_u32 v131, v131, v81
    v_cmp_eq_u32 vcc, -1, v131
    s_cbranch_vccnz Lrt_p5_203
Lbk_p5_204:
    v_mfma_f32_32x32x16_bf16 v[26:41], v[122:125], v[188:191], v[26:41]
    v_mfma_f32_32x32x16_bf16 v[42:57], v[126:129], v[184:187], v[42:57]
    v_mfma_f32_32x32x16_bf16 v[58:73], v[126:129], v[188:191], v[58:73]
    s_add_u32 s89, s88, 20
    s_min_u32 s89, s89, 85
    s_lshl_b32 s89, s89, 10
    s_add_u32 s89, s89, s86
    buffer_load_dwordx4 v[122:125], v134, s[40:43], s89 offen offset:0 sc1
    buffer_load_dwordx4 v[126:129], v133, s[40:43], s89 offen offset:0 sc1
    v_mfma_f32_32x32x16_bf16 v[10:25], v[74:77], v[192:195], v[10:25]
    s_waitcnt vmcnt(10)
    v_max3_u32 v131, v83, v85, v87
    v_max_u32 v131, v131, v89
    v_cmp_eq_u32 vcc, -1, v131
    s_cbranch_vccnz Lrt_p5_205
Lbk_p5_206:
    v_mfma_f32_32x32x16_bf16 v[26:41], v[74:77], v[196:199], v[26:41]
    v_mfma_f32_32x32x16_bf16 v[42:57], v[78:81], v[192:195], v[42:57]
    v_mfma_f32_32x32x16_bf16 v[58:73], v[78:81], v[196:199], v[58:73]
    s_add_u32 s89, s88, 21
    s_min_u32 s89, s89, 85
    s_lshl_b32 s89, s89, 10
    s_add_u32 s89, s89, s86
    buffer_load_dwordx4 v[74:77], v134, s[40:43], s89 offen offset:0 sc1
    buffer_load_dwordx4 v[78:81], v133, s[40:43], s89 offen offset:0 sc1
    v_mfma_f32_32x32x16_bf16 v[10:25], v[82:85], v[200:203], v[10:25]
    s_waitcnt vmcnt(10)
    v_max3_u32 v131, v91, v93, v95
    v_max_u32 v131, v131, v97
    v_cmp_eq_u32 vcc, -1, v131
    s_cbranch_vccnz Lrt_p5_207
Lbk_p5_208:
    v_mfma_f32_32x32x16_bf16 v[26:41], v[82:85], v[204:207], v[26:41]
    v_mfma_f32_32x32x16_bf16 v[42:57], v[86:89], v[200:203], v[42:57]
    v_mfma_f32_32x32x16_bf16 v[58:73], v[86:89], v[204:207], v[58:73]
    v_mfma_f32_32x32x16_bf16 v[10:25], v[90:93], v[208:211], v[10:25]
    s_waitcnt vmcnt(8)
    v_max3_u32 v131, v99, v101, v103
    v_max_u32 v131, v131, v105
    v_cmp_eq_u32 vcc, -1, v131
    s_cbranch_vccnz Lrt_p5_209
Lbk_p5_210:
    v_mfma_f32_32x32x16_bf16 v[26:41], v[90:93], v[212:215], v[26:41]
    v_mfma_f32_32x32x16_bf16 v[42:57], v[94:97], v[208:211], v[42:57]
    v_mfma_f32_32x32x16_bf16 v[58:73], v[94:97], v[212:215], v[58:73]
    v_mfma_f32_32x32x16_bf16 v[10:25], v[98:101], v[216:219], v[10:25]
    s_waitcnt vmcnt(6)
    v_max3_u32 v131, v107, v109, v111
    v_max_u32 v131, v131, v113
    v_cmp_eq_u32 vcc, -1, v131
    s_cbranch_vccnz Lrt_p5_211
Lbk_p5_212:
    v_mfma_f32_32x32x16_bf16 v[26:41], v[98:101], v[220:223], v[26:41]
    v_mfma_f32_32x32x16_bf16 v[42:57], v[102:105], v[216:219], v[42:57]
    v_mfma_f32_32x32x16_bf16 v[58:73], v[102:105], v[220:223], v[58:73]
    v_mfma_f32_32x32x16_bf16 v[10:25], v[106:109], v[224:227], v[10:25]
    s_waitcnt vmcnt(4)
    v_max3_u32 v131, v115, v117, v119
    v_max_u32 v131, v131, v121
    v_cmp_eq_u32 vcc, -1, v131
    s_cbranch_vccnz Lrt_p5_213
Lbk_p5_214:
    v_mfma_f32_32x32x16_bf16 v[26:41], v[106:109], v[228:231], v[26:41]
    v_mfma_f32_32x32x16_bf16 v[42:57], v[110:113], v[224:227], v[42:57]
    v_mfma_f32_32x32x16_bf16 v[58:73], v[110:113], v[228:231], v[58:73]
    v_mfma_f32_32x32x16_bf16 v[10:25], v[114:117], v[232:235], v[10:25]
    s_waitcnt vmcnt(2)
    v_max3_u32 v131, v123, v125, v127
    v_max_u32 v131, v131, v129
    v_cmp_eq_u32 vcc, -1, v131
    s_cbranch_vccnz Lrt_p5_215
Lbk_p5_216:
    v_mfma_f32_32x32x16_bf16 v[26:41], v[114:117], v[236:239], v[26:41]
    v_mfma_f32_32x32x16_bf16 v[42:57], v[118:121], v[232:235], v[42:57]
    v_mfma_f32_32x32x16_bf16 v[58:73], v[118:121], v[236:239], v[58:73]
    v_mfma_f32_32x32x16_bf16 v[10:25], v[122:125], v[240:243], v[10:25]
    s_waitcnt vmcnt(0)
    v_max3_u32 v131, v75, v77, v79
    v_max_u32 v131, v131, v81
    v_cmp_eq_u32 vcc, -1, v131
    s_cbranch_vccnz Lrt_p5_217
Lbk_p5_218:
    v_mfma_f32_32x32x16_bf16 v[26:41], v[122:125], v[244:247], v[26:41]
    v_mfma_f32_32x32x16_bf16 v[42:57], v[126:129], v[240:243], v[42:57]
    v_mfma_f32_32x32x16_bf16 v[58:73], v[126:129], v[244:247], v[58:73]
    v_mfma_f32_32x32x16_bf16 v[10:25], v[74:77], v[248:251], v[10:25]
    v_mfma_f32_32x32x16_bf16 v[26:41], v[74:77], v[252:255], v[26:41]
    v_mfma_f32_32x32x16_bf16 v[42:57], v[78:81], v[248:251], v[42:57]
    v_mfma_f32_32x32x16_bf16 v[58:73], v[78:81], v[252:255], v[58:73]
    s_nop 9
    ds_write_b128 v135, v[26:29] offset:0
    ds_write_b128 v135, v[30:33] offset:1024
    ds_write_b128 v135, v[34:37] offset:2048
    ds_write_b128 v135, v[38:41] offset:3072
    s_waitcnt lgkmcnt(3)
    ds_write_b128 v136, v[42:45] offset:0
    ds_write_b128 v136, v[46:49] offset:1024
    ds_write_b128 v136, v[50:53] offset:2048
    ds_write_b128 v136, v[54:57] offset:3072
    s_waitcnt lgkmcnt(3)
    ds_write_b128 v137, v[58:61] offset:0
    ds_write_b128 v137, v[62:65] offset:1024
    ds_write_b128 v137, v[66:69] offset:2048
    ds_write_b128 v137, v[70:73] offset:3072
    s_waitcnt lgkmcnt(3)
    v_mov_b32 v131, v139
    s_waitcnt lgkmcnt(0)
    s_barrier
    ds_read_b128 v[26:29], v131 offset:0
    ds_read_b128 v[30:33], v131 offset:1024
    ds_read_b128 v[34:37], v131 offset:2048
    ds_read_b128 v[38:41], v131 offset:3072
    ds_read_b128 v[42:45], v131 offset:4096
    ds_read_b128 v[46:49], v131 offset:5120
    ds_read_b128 v[50:53], v131 offset:6144
    ds_read_b128 v[54:57], v131 offset:7168
    ds_read_b128 v[58:61], v131 offset:8192
    ds_read_b128 v[62:65], v131 offset:9216
    ds_read_b128 v[66:69], v131 offset:10240
    ds_read_b128 v[70:73], v131 offset:11264
    s_waitcnt lgkmcnt(4)
    v_pk_add_f32 v[26:27], v[26:27], v[42:43]
    v_pk_add_f32 v[28:29], v[28:29], v[44:45]
    v_pk_add_f32 v[30:31], v[30:31], v[46:47]
    v_pk_add_f32 v[32:33], v[32:33], v[48:49]
    v_pk_add_f32 v[34:35], v[34:35], v[50:51]
    v_pk_add_f32 v[36:37], v[36:37], v[52:53]
    v_pk_add_f32 v[38:39], v[38:39], v[54:55]
    v_pk_add_f32 v[40:41], v[40:41], v[56:57]
    s_waitcnt lgkmcnt(0)
    v_pk_add_f32 v[10:11], v[10:11], v[58:59]
    v_pk_add_f32 v[12:13], v[12:13], v[60:61]
    v_pk_add_f32 v[14:15], v[14:15], v[62:63]
    v_pk_add_f32 v[16:17], v[16:17], v[64:65]
    v_pk_add_f32 v[18:19], v[18:19], v[66:67]
    v_pk_add_f32 v[20:21], v[20:21], v[68:69]
    v_pk_add_f32 v[22:23], v[22:23], v[70:71]
    v_pk_add_f32 v[24:25], v[24:25], v[72:73]
    v_pk_add_f32 v[10:11], v[10:11], v[26:27]
    v_pk_add_f32 v[12:13], v[12:13], v[28:29]
    v_pk_add_f32 v[14:15], v[14:15], v[30:31]
    v_pk_add_f32 v[16:17], v[16:17], v[32:33]
    v_pk_add_f32 v[18:19], v[18:19], v[34:35]
    v_pk_add_f32 v[20:21], v[20:21], v[36:37]
    v_pk_add_f32 v[22:23], v[22:23], v[38:39]
    v_pk_add_f32 v[24:25], v[24:25], v[40:41]
    v_cvt_pk_bf16_f32 v2, v10, v11
    v_cvt_pk_bf16_f32 v3, v12, v13
    v_cvt_pk_bf16_f32 v4, v14, v15
    v_cvt_pk_bf16_f32 v5, v16, v17
    v_cvt_pk_bf16_f32 v6, v18, v19
    v_cvt_pk_bf16_f32 v7, v20, v21
    v_cvt_pk_bf16_f32 v8, v22, v23
    v_cvt_pk_bf16_f32 v9, v24, v25
    s_lshl_b32 s89, s79, 1
    s_add_u32 s89, s89, s101
    s_lshl_b32 s89, s89, 5
    s_lshl_b32 s92, s80, 2
    s_add_u32 s89, s89, s92
    s_lshl_b32 s92, s100, 1
    s_add_u32 s89, s89, s92
    s_lshl_b32 s89, s89, 10
    s_add_u32 s89, s89, 0x1400000
    s_cmp_eq_u32 s93, 0
    s_cbranch_scc1 Lfar_219
    buffer_store_dwordx4 v[2:5], v130, s[40:43], s89 offen offset:0
    buffer_store_dwordx4 v[6:9], v130, s[40:43], s89 offen offset:1024
    s_branch Lstored_220
Lfar_219:
    buffer_store_dwordx4 v[2:5], v130, s[40:43], s89 offen offset:0 sc1
    buffer_store_dwordx4 v[6:9], v130, s[40:43], s89 offen offset:1024 sc1
Lstored_220:
    v_lshlrev_b32 v10, 16, v2
    v_and_b32 v11, 0xffff0000, v2
    v_lshlrev_b32 v12, 16, v3
    v_and_b32 v13, 0xffff0000, v3
    v_lshlrev_b32 v14, 16, v4
    v_and_b32 v15, 0xffff0000, v4
    v_lshlrev_b32 v16, 16, v5
    v_and_b32 v17, 0xffff0000, v5
    v_lshlrev_b32 v18, 16, v6
    v_and_b32 v19, 0xffff0000, v6
    v_lshlrev_b32 v20, 16, v7
    v_and_b32 v21, 0xffff0000, v7
    v_lshlrev_b32 v22, 16, v8
    v_and_b32 v23, 0xffff0000, v8
    v_lshlrev_b32 v24, 16, v9
    v_and_b32 v25, 0xffff0000, v9
    v_add_f32 v26, v10, v11
    v_mul_f32 v27, v10, v10
    v_fmac_f32 v27, v11, v11
    v_add_f32 v26, v26, v12
    v_fmac_f32 v27, v12, v12
    v_add_f32 v26, v26, v13
    v_fmac_f32 v27, v13, v13
    v_add_f32 v26, v26, v14
    v_fmac_f32 v27, v14, v14
    v_add_f32 v26, v26, v15
    v_fmac_f32 v27, v15, v15
    v_add_f32 v26, v26, v16
    v_fmac_f32 v27, v16, v16
    v_add_f32 v26, v26, v17
    v_fmac_f32 v27, v17, v17
    v_add_f32 v26, v26, v18
    v_fmac_f32 v27, v18, v18
    v_add_f32 v26, v26, v19
    v_fmac_f32 v27, v19, v19
    v_add_f32 v26, v26, v20
    v_fmac_f32 v27, v20, v20
    v_add_f32 v26, v26, v21
    v_fmac_f32 v27, v21, v21
    v_add_f32 v26, v26, v22
    v_fmac_f32 v27, v22, v22
    v_add_f32 v26, v26, v23
    v_fmac_f32 v27, v23, v23
    v_add_f32 v26, v26, v24
    v_fmac_f32 v27, v24, v24
    v_add_f32 v26, v26, v25
    v_fmac_f32 v27, v25, v25
    v_mov_b32 v131, v26
    s_nop 1
    v_permlane32_swap_b32 v26, v131
    v_add_f32 v26, v26, v131
    v_mov_b32 v131, v27
    s_nop 1
    v_permlane32_swap_b32 v27, v131
    v_add_f32 v27, v27, v131
    v_and_b32 v132, 31, v0
    v_lshlrev_b32 v132, 3, v132
    s_lshl_b32 s89, s79, 3
    s_add_u32 s89, s89, s80
    s_lshl_b32 s89, s89, 1
    s_add_u32 s89, s89, s100
    s_lshl_b32 s89, s89, 9
    s_lshl_b32 s92, s101, 8
    s_add_u32 s89, s89, s92
    s_add_u32 s89, s89, 0x1680000
    s_cmp_eq_u32 s93, 0
    s_cbranch_scc1 Lfar_221
    buffer_store_dwordx2 v[26:27], v132, s[40:43], s89 offen offset:0
    s_branch Lstored_222
Lfar_221:
    buffer_store_dwordx2 v[26:27], v132, s[40:43], s89 offen offset:0 sc1
Lstored_222:
    v_lshlrev_b32 v130, 4, v0
    s_lshl_b32 s86, s77, 2
    s_add_u32 s86, s86, s76
    s_lshl_b32 s86, s86, 15
    s_add_u32 s86, s86, 0x1400000
    s_add_u32 s89, s86, 0x0
    buffer_load_dwordx4 v[58:61], v130, s[40:43], s89 offen offset:0 sc1
    s_add_u32 s89, s86, 0x0
    buffer_load_dwordx4 v[62:65], v130, s[40:43], s89 offen offset:1024 sc1
    s_add_u32 s89, s86, 0x0
    buffer_load_dwordx4 v[66:69], v130, s[40:43], s89 offen offset:2048 sc1
    s_add_u32 s89, s86, 0x0
    buffer_load_dwordx4 v[70:73], v130, s[40:43], s89 offen offset:3072 sc1
    s_add_u32 s89, s86, 0x1000
    buffer_load_dwordx4 v[74:77], v130, s[40:43], s89 offen offset:0 sc1
    s_add_u32 s89, s86, 0x1000
    buffer_load_dwordx4 v[78:81], v130, s[40:43], s89 offen offset:1024 sc1
    s_add_u32 s89, s86, 0x1000
    buffer_load_dwordx4 v[82:85], v130, s[40:43], s89 offen offset:2048 sc1
    s_add_u32 s89, s86, 0x1000
    buffer_load_dwordx4 v[86:89], v130, s[40:43], s89 offen offset:3072 sc1
    s_add_u32 s89, s86, 0x2000
    buffer_load_dwordx4 v[90:93], v130, s[40:43], s89 offen offset:0 sc1
    s_add_u32 s89, s86, 0x2000
    buffer_load_dwordx4 v[94:97], v130, s[40:43], s89 offen offset:1024 sc1
    s_add_u32 s89, s86, 0x2000
    buffer_load_dwordx4 v[98:101], v130, s[40:43], s89 offen offset:2048 sc1
    s_add_u32 s89, s86, 0x2000
    buffer_load_dwordx4 v[102:105], v130, s[40:43], s89 offen offset:3072 sc1
    v_lshrrev_b32 v131, 5, v0
    v_mul_u32_u24 v131, 4, v131
    v_bfe_u32 v133, v0, 2, 2
    v_add_u32 v131, v131, v133
    v_mul_u32_u24 v131, 192, v131
    v_bfe_u32 v133, v0, 4, 1
    v_lshlrev_b32 v133, 5, v133
    v_add_u32 v131, v131, v133
    v_and_b32 v133, 3, v0
    v_lshlrev_b32 v133, 3, v133
    v_add_u32 v131, v131, v133
    v_mov_b32 v132, v131
    v_add_u32 v131, 0x1f000, v131
    v_and_b32 v134, 31, v0
    v_lshlrev_b32 v134, 3, v134
    v_lshrrev_b32 v133, 5, v0
    v_lshlrev_b32 v133, 9, v133
    v_add_u32 v134, v134, v133
    s_lshl_b32 s87, s77, 1
    s_add_u32 s87, s87, s100
    s_lshl_b32 s87, s87, 13
    s_lshl_b32 s89, s101, 8
    s_add_u32 s87, s87, s89
    s_add_u32 s87, s87, 0x1680000
    s_waitcnt vmcnt(8)
    v_max3_u32 v133, v61, v65, v69
    v_max_u32 v133, v133, v73
    v_cmp_eq_u32 vcc, -1, v133
    s_cbranch_vccnz Lrt_p1_223
Lbk_p1_224:
    ds_read_b64_tr_b16 v[106:107], v131 offset:0
    ds_read_b64_tr_b16 v[108:109], v131 offset:1536
    ds_read_b64_tr_b16 v[110:111], v131 offset:64
    ds_read_b64_tr_b16 v[112:113], v131 offset:1600
    ds_read_b64_tr_b16 v[114:115], v131 offset:128
    ds_read_b64_tr_b16 v[116:117], v131 offset:1664
    s_waitcnt lgkmcnt(4)
    v_mfma_f32_32x32x16_bf16 v[10:25], v[106:109], v[58:61], 0
    ds_read_b64_tr_b16 v[118:119], v131 offset:3072
    ds_read_b64_tr_b16 v[120:121], v131 offset:4608
    s_waitcnt vmcnt(4)
    v_max3_u32 v133, v77, v81, v85
    v_max_u32 v133, v133, v89
    v_cmp_eq_u32 vcc, -1, v133
    s_cbranch_vccnz Lrt_p1_225
Lbk_p1_226:
    s_waitcnt lgkmcnt(4)
    v_mfma_f32_32x32x16_bf16 v[26:41], v[110:113], v[58:61], 0
    ds_read_b64_tr_b16 v[122:123], v131 offset:3136
    ds_read_b64_tr_b16 v[124:125], v131 offset:4672
    s_waitcnt lgkmcnt(4)
    v_mfma_f32_32x32x16_bf16 v[42:57], v[114:117], v[58:61], 0
    ds_read_b64_tr_b16 v[126:127], v131 offset:3200
    ds_read_b64_tr_b16 v[128:129], v131 offset:4736
    s_add_u32 s89, s86, 0x3000
    buffer_load_dwordx4 v[58:61], v130, s[40:43], s89 offen offset:0 sc1
    s_waitcnt lgkmcnt(4)
    v_mfma_f32_32x32x16_bf16 v[10:25], v[118:121], v[62:65], v[10:25]
    ds_read_b64_tr_b16 v[106:107], v131 offset:6144
    ds_read_b64_tr_b16 v[108:109], v131 offset:7680
    s_waitcnt lgkmcnt(4)
    v_mfma_f32_32x32x16_bf16 v[26:41], v[122:125], v[62:65], v[26:41]
    ds_read_b64_tr_b16 v[110:111], v131 offset:6208
    ds_read_b64_tr_b16 v[112:113], v131 offset:7744
    s_waitcnt lgkmcnt(4)
    v_mfma_f32_32x32x16_bf16 v[42:57], v[126:129], v[62:65], v[42:57]
    ds_read_b64_tr_b16 v[114:115], v131 offset:6272
    ds_read_b64_tr_b16 v[116:117], v131 offset:7808
    s_add_u32 s89, s86, 0x3000
    buffer_load_dwordx4 v[62:65], v130, s[40:43], s89 offen offset:1024 sc1
    s_waitcnt lgkmcnt(4)
    v_mfma_f32_32x32x16_bf16 v[10:25], v[106:109], v[66:69], v[10:25]
    ds_read_b64_tr_b16 v[118:119], v131 offset:9216
    ds_read_b64_tr_b16 v[120:121], v131 offset:10752
    s_waitcnt lgkmcnt(4)
    v_mfma_f32_32x32x16_bf16 v[26:41], v[110:113], v[66:69], v[26:41]
    ds_read_b64_tr_b16 v[122:123], v131 offset:9280
    ds_read_b64_tr_b16 v[124:125], v131 offset:10816
    s_waitcnt lgkmcnt(4)
    v_mfma_f32_32x32x16_bf16 v[42:57], v[114:117], v[66:69], v[42:57]
    ds_read_b64_tr_b16 v[126:127], v131 offset:9344
    ds_read_b64_tr_b16 v[128:129], v131 offset:10880
    s_add_u32 s89, s86, 0x3000
    buffer_load_dwordx4 v[66:69], v130, s[40:43], s89 offen offset:2048 sc1
    s_waitcnt lgkmcnt(4)
    v_mfma_f32_32x32x16_bf16 v[10:25], v[118:121], v[70:73], v[10:25]
    ds_read_b64_tr_b16 v[106:107], v131 offset:12288
    ds_read_b64_tr_b16 v[108:109], v131 offset:13824
    s_waitcnt lgkmcnt(4)
    v_mfma_f32_32x32x16_bf16 v[26:41], v[122:125], v[70:73], v[26:41]
    ds_read_b64_tr_b16 v[110:111], v131 offset:12352
    ds_read_b64_tr_b16 v[112:113], v131 offset:13888
    s_waitcnt lgkmcnt(4)
    v_mfma_f32_32x32x16_bf16 v[42:57], v[126:129], v[70:73], v[42:57]
    ds_read_b64_tr_b16 v[114:115], v131 offset:12416
    ds_read_b64_tr_b16 v[116:117], v131 offset:13952
    s_add_u32 s89, s86, 0x3000
    buffer_load_dwordx4 v[70:73], v130, s[40:43], s89 offen offset:3072 sc1
    s_waitcnt lgkmcnt(4)
    v_mfma_f32_32x32x16_bf16 v[10:25], v[106:109], v[74:77], v[10:25]
    ds_read_b64_tr_b16 v[118:119], v131 offset:15360
    ds_read_b64_tr_b16 v[120:121], v131 offset:16896
    s_waitcnt vmcnt(4)
    v_max3_u32 v133, v93, v97, v101
    v_max_u32 v133, v133, v105
    v_cmp_eq_u32 vcc, -1, v133
    s_cbranch_vccnz Lrt_p1_227
Lbk_p1_228:
    s_waitcnt lgkmcnt(4)
    v_mfma_f32_32x32x16_bf16 v[26:41], v[110:113], v[74:77], v[26:41]
    ds_read_b64_tr_b16 v[122:123], v131 offset:15424
    ds_read_b64_tr_b16 v[124:125], v131 offset:16960
    s_waitcnt lgkmcnt(4)
    v_mfma_f32_32x32x16_bf16 v[42:57], v[114:117], v[74:77], v[42:57]
    ds_read_b64_tr_b16 v[126:127], v131 offset:15488
    ds_read_b64_tr_b16 v[128:129], v131 offset:17024
    s_add_u32 s89, s86, 0x4000
    buffer_load_dwordx4 v[74:77], v130, s[40:43], s89 offen offset:0 sc1
    s_waitcnt lgkmcnt(4)
    v_mfma_f32_32x32x16_bf16 v[10:25], v[118:121], v[78:81], v[10:25]
    ds_read_b64_tr_b16 v[106:107], v131 offset:18432
    ds_read_b64_tr_b16 v[108:109], v131 offset:19968
    s_waitcnt lgkmcnt(4)
    v_mfma_f32_32x32x16_bf16 v[26:41], v[122:125], v[78:81], v[26:41]
    ds_read_b64_tr_b16 v[110:111], v131 offset:18496
    ds_read_b64_tr_b16 v[112:113], v131 offset:20032
    s_waitcnt lgkmcnt(4)
    v_mfma_f32_32x32x16_bf16 v[42:57], v[126:129], v[78:81], v[42:57]
    ds_read_b64_tr_b16 v[114:115], v131 offset:18560
    ds_read_b64_tr_b16 v[116:117], v131 offset:20096
    s_add_u32 s89, s86, 0x4000
    buffer_load_dwordx4 v[78:81], v130, s[40:43], s89 offen offset:1024 sc1
    s_waitcnt lgkmcnt(4)
    v_mfma_f32_32x32x16_bf16 v[10:25], v[106:109], v[82:85], v[10:25]
    ds_read_b64_tr_b16 v[118:119], v131 offset:21504
    ds_read_b64_tr_b16 v[120:121], v131 offset:23040
    s_waitcnt lgkmcnt(4)
    v_mfma_f32_32x32x16_bf16 v[26:41], v[110:113], v[82:85], v[26:41]
    ds_read_b64_tr_b16 v[122:123], v131 offset:21568
    ds_read_b64_tr_b16 v[124:125], v131 offset:23104
    s_waitcnt lgkmcnt(4)
    v_mfma_f32_32x32x16_bf16 v[42:57], v[114:117], v[82:85], v[42:57]
    ds_read_b64_tr_b16 v[126:127], v131 offset:21632
    ds_read_b64_tr_b16 v[128:129], v131 offset:23168
    s_add_u32 s89, s86, 0x4000
    buffer_load_dwordx4 v[82:85], v130, s[40:43], s89 offen offset:2048 sc1
    s_waitcnt lgkmcnt(4)
    v_mfma_f32_32x32x16_bf16 v[10:25], v[118:121], v[86:89], v[10:25]
    ds_read_b64_tr_b16 v[106:107], v131 offset:24576
    ds_read_b64_tr_b16 v[108:109], v131 offset:26112
    s_waitcnt lgkmcnt(4)
    v_mfma_f32_32x32x16_bf16 v[26:41], v[122:125], v[86:89], v[26:41]
    ds_read_b64_tr_b16 v[110:111], v131 offset:24640
    ds_read_b64_tr_b16 v[112:113], v131 offset:26176
    s_waitcnt lgkmcnt(4)
    v_mfma_f32_32x32x16_bf16 v[42:57], v[126:129], v[86:89], v[42:57]
    ds_read_b64_tr_b16 v[114:115], v131 offset:24704
    ds_read_b64_tr_b16 v[116:117], v131 offset:26240
    s_add_u32 s89, s86, 0x4000
    buffer_load_dwordx4 v[86:89], v130, s[40:43], s89 offen offset:3072 sc1
    s_waitcnt lgkmcnt(4)
    v_mfma_f32_32x32x16_bf16 v[10:25], v[106:109], v[90:93], v[10:25]
    ds_read_b64_tr_b16 v[118:119], v131 offset:27648
    ds_read_b64_tr_b16 v[120:121], v131 offset:29184
    s_waitcnt vmcnt(4)
    v_max3_u32 v133, v61, v65, v69
    v_max_u32 v133, v133, v73
    v_cmp_eq_u32 vcc, -1, v133
    s_cbranch_vccnz Lrt_p1_229
Lbk_p1_230:
    s_waitcnt lgkmcnt(4)
    v_mfma_f32_32x32x16_bf16 v[26:41], v[110:113], v[90:93], v[26:41]
    ds_read_b64_tr_b16 v[122:123], v131 offset:27712
    ds_read_b64_tr_b16 v[124:125], v131 offset:29248
    s_waitcnt lgkmcnt(4)
    v_mfma_f32_32x32x16_bf16 v[42:57], v[114:117], v[90:93], v[42:57]
    ds_read_b64_tr_b16 v[126:127], v131 offset:27776
    ds_read_b64_tr_b16 v[128:129], v131 offset:29312
    s_add_u32 s89, s86, 0x5000
    buffer_load_dwordx4 v[90:93], v130, s[40:43], s89 offen offset:0 sc1
    s_waitcnt lgkmcnt(4)
    v_mfma_f32_32x32x16_bf16 v[10:25], v[118:121], v[94:97], v[10:25]
    ds_read_b64_tr_b16 v[106:107], v131 offset:30720
    ds_read_b64_tr_b16 v[108:109], v131 offset:32256
    s_waitcnt lgkmcnt(4)
    v_mfma_f32_32x32x16_bf16 v[26:41], v[122:125], v[94:97], v[26:41]
    ds_read_b64_tr_b16 v[110:111], v131 offset:30784
    ds_read_b64_tr_b16 v[112:113], v131 offset:32320
    s_waitcnt lgkmcnt(4)
    v_mfma_f32_32x32x16_bf16 v[42:57], v[126:129], v[94:97], v[42:57]
    ds_read_b64_tr_b16 v[114:115], v131 offset:30848
    ds_read_b64_tr_b16 v[116:117], v131 offset:32384
    s_add_u32 s89, s86, 0x5000
    buffer_load_dwordx4 v[94:97], v130, s[40:43], s89 offen offset:1024 sc1
    s_waitcnt lgkmcnt(4)
    v_mfma_f32_32x32x16_bf16 v[10:25], v[106:109], v[98:101], v[10:25]
    ds_read_b64_tr_b16 v[118:119], v131 offset:33792
    ds_read_b64_tr_b16 v[120:121], v131 offset:35328
    s_waitcnt lgkmcnt(4)
    v_mfma_f32_32x32x16_bf16 v[26:41], v[110:113], v[98:101], v[26:41]
    ds_read_b64_tr_b16 v[122:123], v131 offset:33856
    ds_read_b64_tr_b16 v[124:125], v131 offset:35392
    s_waitcnt lgkmcnt(4)
    v_mfma_f32_32x32x16_bf16 v[42:57], v[114:117], v[98:101], v[42:57]
    ds_read_b64_tr_b16 v[126:127], v131 offset:33920
    ds_read_b64_tr_b16 v[128:129], v131 offset:35456
    s_add_u32 s89, s86, 0x5000
    buffer_load_dwordx4 v[98:101], v130, s[40:43], s89 offen offset:2048 sc1
    s_waitcnt lgkmcnt(4)
    v_mfma_f32_32x32x16_bf16 v[10:25], v[118:121], v[102:105], v[10:25]
    ds_read_b64_tr_b16 v[106:107], v132 offset:0
    ds_read_b64_tr_b16 v[108:109], v132 offset:1536
    s_waitcnt lgkmcnt(4)
    v_mfma_f32_32x32x16_bf16 v[26:41], v[122:125], v[102:105], v[26:41]
    ds_read_b64_tr_b16 v[110:111], v132 offset:64
    ds_read_b64_tr_b16 v[112:113], v132 offset:1600
    s_waitcnt lgkmcnt(4)
    v_mfma_f32_32x32x16_bf16 v[42:57], v[126:129], v[102:105], v[42:57]
    ds_read_b64_tr_b16 v[114:115], v132 offset:128
    ds_read_b64_tr_b16 v[116:117], v132 offset:1664
    s_add_u32 s89, s86, 0x5000
    buffer_load_dwordx4 v[102:105], v130, s[40:43], s89 offen offset:3072 sc1
    s_waitcnt lgkmcnt(4)
    v_mfma_f32_32x32x16_bf16 v[10:25], v[106:109], v[58:61], v[10:25]
    ds_read_b64_tr_b16 v[118:119], v132 offset:3072
    ds_read_b64_tr_b16 v[120:121], v132 offset:4608
    s_waitcnt vmcnt(4)
    v_max3_u32 v133, v77, v81, v85
    v_max_u32 v133, v133, v89
    v_cmp_eq_u32 vcc, -1, v133
    s_cbranch_vccnz Lrt_p1_231
Lbk_p1_232:
    s_waitcnt lgkmcnt(4)
    v_mfma_f32_32x32x16_bf16 v[26:41], v[110:113], v[58:61], v[26:41]
    ds_read_b64_tr_b16 v[122:123], v132 offset:3136
    ds_read_b64_tr_b16 v[124:125], v132 offset:4672
    s_waitcnt lgkmcnt(4)
    v_mfma_f32_32x32x16_bf16 v[42:57], v[114:117], v[58:61], v[42:57]
    ds_read_b64_tr_b16 v[126:127], v132 offset:3200
    ds_read_b64_tr_b16 v[128:129], v132 offset:4736
    s_add_u32 s89, s86, 0x6000
    buffer_load_dwordx4 v[58:61], v130, s[40:43], s89 offen offset:0 sc1
    s_waitcnt lgkmcnt(4)
    v_mfma_f32_32x32x16_bf16 v[10:25], v[118:121], v[62:65], v[10:25]
    ds_read_b64_tr_b16 v[106:107], v132 offset:6144
    ds_read_b64_tr_b16 v[108:109], v132 offset:7680
    s_waitcnt lgkmcnt(4)
    v_mfma_f32_32x32x16_bf16 v[26:41], v[122:125], v[62:65], v[26:41]
    ds_read_b64_tr_b16 v[110:111], v132 offset:6208
    ds_read_b64_tr_b16 v[112:113], v132 offset:7744
    s_waitcnt lgkmcnt(4)
    v_mfma_f32_32x32x16_bf16 v[42:57], v[126:129], v[62:65], v[42:57]
    ds_read_b64_tr_b16 v[114:115], v132 offset:6272
    ds_read_b64_tr_b16 v[116:117], v132 offset:7808
    s_add_u32 s89, s86, 0x6000
    buffer_load_dwordx4 v[62:65], v130, s[40:43], s89 offen offset:1024 sc1
    s_waitcnt lgkmcnt(4)
    v_mfma_f32_32x32x16_bf16 v[10:25], v[106:109], v[66:69], v[10:25]
    ds_read_b64_tr_b16 v[118:119], v132 offset:9216
    ds_read_b64_tr_b16 v[120:121], v132 offset:10752
    s_waitcnt lgkmcnt(4)
    v_mfma_f32_32x32x16_bf16 v[26:41], v[110:113], v[66:69], v[26:41]
    ds_read_b64_tr_b16 v[122:123], v132 offset:9280
    ds_read_b64_tr_b16 v[124:125], v132 offset:10816
    s_waitcnt lgkmcnt(4)
    v_mfma_f32_32x32x16_bf16 v[42:57], v[114:117], v[66:69], v[42:57]
    ds_read_b64_tr_b16 v[126:127], v132 offset:9344
    ds_read_b64_tr_b16 v[128:129], v132 offset:10880
    s_add_u32 s89, s86, 0x6000
    buffer_load_dwordx4 v[66:69], v130, s[40:43], s89 offen offset:2048 sc1
    s_waitcnt lgkmcnt(4)
    v_mfma_f32_32x32x16_bf16 v[10:25], v[118:121], v[70:73], v[10:25]
    ds_read_b64_tr_b16 v[106:107], v132 offset:12288
    ds_read_b64_tr_b16 v[108:109], v132 offset:13824
    s_waitcnt lgkmcnt(4)
    v_mfma_f32_32x32x16_bf16 v[26:41], v[122:125], v[70:73], v[26:41]
    ds_read_b64_tr_b16 v[110:111], v132 offset:12352
    ds_read_b64_tr_b16 v[112:113], v132 offset:13888
    s_waitcnt lgkmcnt(4)
    v_mfma_f32_32x32x16_bf16 v[42:57], v[126:129], v[70:73], v[42:57]
    ds_read_b64_tr_b16 v[114:115], v132 offset:12416
    ds_read_b64_tr_b16 v[116:117], v132 offset:13952
    s_add_u32 s89, s86, 0x6000
    buffer_load_dwordx4 v[70:73], v130, s[40:43], s89 offen offset:3072 sc1
    s_waitcnt lgkmcnt(4)
    v_mfma_f32_32x32x16_bf16 v[10:25], v[106:109], v[74:77], v[10:25]
    ds_read_b64_tr_b16 v[118:119], v132 offset:15360
    ds_read_b64_tr_b16 v[120:121], v132 offset:16896
    s_waitcnt vmcnt(4)
    v_max3_u32 v133, v93, v97, v101
    v_max_u32 v133, v133, v105
    v_cmp_eq_u32 vcc, -1, v133
    s_cbranch_vccnz Lrt_p1_233
Lbk_p1_234:
    s_waitcnt lgkmcnt(4)
    v_mfma_f32_32x32x16_bf16 v[26:41], v[110:113], v[74:77], v[26:41]
    ds_read_b64_tr_b16 v[122:123], v132 offset:15424
    ds_read_b64_tr_b16 v[124:125], v132 offset:16960
    s_waitcnt lgkmcnt(4)
    v_mfma_f32_32x32x16_bf16 v[42:57], v[114:117], v[74:77], v[42:57]
    ds_read_b64_tr_b16 v[126:127], v132 offset:15488
    ds_read_b64_tr_b16 v[128:129], v132 offset:17024
    s_add_u32 s89, s86, 0x7000
    buffer_load_dwordx4 v[74:77], v130, s[40:43], s89 offen offset:0 sc1
    s_waitcnt lgkmcnt(4)
    v_mfma_f32_32x32x16_bf16 v[10:25], v[118:121], v[78:81], v[10:25]
    ds_read_b64_tr_b16 v[106:107], v132 offset:18432
    ds_read_b64_tr_b16 v[108:109], v132 offset:19968
    s_waitcnt lgkmcnt(4)
    v_mfma_f32_32x32x16_bf16 v[26:41], v[122:125], v[78:81], v[26:41]
    ds_read_b64_tr_b16 v[110:111], v132 offset:18496
    ds_read_b64_tr_b16 v[112:113], v132 offset:20032
    s_waitcnt lgkmcnt(4)
    v_mfma_f32_32x32x16_bf16 v[42:57], v[126:129], v[78:81], v[42:57]
    ds_read_b64_tr_b16 v[114:115], v132 offset:18560
    ds_read_b64_tr_b16 v[116:117], v132 offset:20096
    s_add_u32 s89, s86, 0x7000
    buffer_load_dwordx4 v[78:81], v130, s[40:43], s89 offen offset:1024 sc1
    s_waitcnt lgkmcnt(4)
    v_mfma_f32_32x32x16_bf16 v[10:25], v[106:109], v[82:85], v[10:25]
    ds_read_b64_tr_b16 v[118:119], v132 offset:21504
    ds_read_b64_tr_b16 v[120:121], v132 offset:23040
    s_waitcnt lgkmcnt(4)
    v_mfma_f32_32x32x16_bf16 v[26:41], v[110:113], v[82:85], v[26:41]
    ds_read_b64_tr_b16 v[122:123], v132 offset:21568
    ds_read_b64_tr_b16 v[124:125], v132 offset:23104
    s_waitcnt lgkmcnt(4)
    v_mfma_f32_32x32x16_bf16 v[42:57], v[114:117], v[82:85], v[42:57]
    ds_read_b64_tr_b16 v[126:127], v132 offset:21632
    ds_read_b64_tr_b16 v[128:129], v132 offset:23168
    s_add_u32 s89, s86, 0x7000
    buffer_load_dwordx4 v[82:85], v130, s[40:43], s89 offen offset:2048 sc1
    s_waitcnt lgkmcnt(4)
    v_mfma_f32_32x32x16_bf16 v[10:25], v[118:121], v[86:89], v[10:25]
    ds_read_b64_tr_b16 v[106:107], v132 offset:24576
    ds_read_b64_tr_b16 v[108:109], v132 offset:26112
    s_waitcnt lgkmcnt(4)
    v_mfma_f32_32x32x16_bf16 v[26:41], v[122:125], v[86:89], v[26:41]
    ds_read_b64_tr_b16 v[110:111], v132 offset:24640
    ds_read_b64_tr_b16 v[112:113], v132 offset:26176
    s_waitcnt lgkmcnt(4)
    v_mfma_f32_32x32x16_bf16 v[42:57], v[126:129], v[86:89], v[42:57]
    ds_read_b64_tr_b16 v[114:115], v132 offset:24704
    ds_read_b64_tr_b16 v[116:117], v132 offset:26240
    s_add_u32 s89, s86, 0x7000
    buffer_load_dwordx4 v[86:89], v130, s[40:43], s89 offen offset:3072 sc1
    s_waitcnt lgkmcnt(4)
    v_mfma_f32_32x32x16_bf16 v[10:25], v[106:109], v[90:93], v[10:25]
    ds_read_b64_tr_b16 v[118:119], v132 offset:27648
    ds_read_b64_tr_b16 v[120:121], v132 offset:29184
    s_waitcnt vmcnt(4)
    v_max3_u32 v133, v61, v65, v69
    v_max_u32 v133, v133, v73
    v_cmp_eq_u32 vcc, -1, v133
    s_cbranch_vccnz Lrt_p1_235
Lbk_p1_236:
    s_waitcnt lgkmcnt(4)
    v_mfma_f32_32x32x16_bf16 v[26:41], v[110:113], v[90:93], v[26:41]
    ds_read_b64_tr_b16 v[122:123], v132 offset:27712
    ds_read_b64_tr_b16 v[124:125], v132 offset:29248
    s_waitcnt lgkmcnt(4)
    v_mfma_f32_32x32x16_bf16 v[42:57], v[114:117], v[90:93], v[42:57]
    ds_read_b64_tr_b16 v[126:127], v132 offset:27776
    ds_read_b64_tr_b16 v[128:129], v132 offset:29312
    s_waitcnt lgkmcnt(4)
    v_mfma_f32_32x32x16_bf16 v[10:25], v[118:121], v[94:97], v[10:25]
    ds_read_b64_tr_b16 v[106:107], v132 offset:30720
    ds_read_b64_tr_b16 v[108:109], v132 offset:32256
    s_waitcnt lgkmcnt(4)
    v_mfma_f32_32x32x16_bf16 v[26:41], v[122:125], v[94:97], v[26:41]
    ds_read_b64_tr_b16 v[110:111], v132 offset:30784
    ds_read_b64_tr_b16 v[112:113], v132 offset:32320
    s_waitcnt lgkmcnt(4)
    v_mfma_f32_32x32x16_bf16 v[42:57], v[126:129], v[94:97], v[42:57]
    ds_read_b64_tr_b16 v[114:115], v132 offset:30848
    ds_read_b64_tr_b16 v[116:117], v132 offset:32384
    s_waitcnt lgkmcnt(4)
    v_mfma_f32_32x32x16_bf16 v[10:25], v[106:109], v[98:101], v[10:25]
    ds_read_b64_tr_b16 v[118:119], v132 offset:33792
    ds_read_b64_tr_b16 v[120:121], v132 offset:35328
    s_waitcnt lgkmcnt(4)
    v_mfma_f32_32x32x16_bf16 v[26:41], v[110:113], v[98:101], v[26:41]
    ds_read_b64_tr_b16 v[122:123], v132 offset:33856
    ds_read_b64_tr_b16 v[124:125], v132 offset:35392
    s_waitcnt lgkmcnt(4)
    v_mfma_f32_32x32x16_bf16 v[42:57], v[114:117], v[98:101], v[42:57]
    ds_read_b64_tr_b16 v[126:127], v132 offset:33920
    ds_read_b64_tr_b16 v[128:129], v132 offset:35456
    s_waitcnt lgkmcnt(4)
    v_mfma_f32_32x32x16_bf16 v[10:25], v[118:121], v[102:105], v[10:25]
    ds_read_b64_tr_b16 v[106:107], v132 offset:36864
    ds_read_b64_tr_b16 v[108:109], v132 offset:38400
    s_waitcnt lgkmcnt(4)
    v_mfma_f32_32x32x16_bf16 v[26:41], v[122:125], v[102:105], v[26:41]
    ds_read_b64_tr_b16 v[110:111], v132 offset:36928
    ds_read_b64_tr_b16 v[112:113], v132 offset:38464
    s_waitcnt lgkmcnt(4)
    v_mfma_f32_32x32x16_bf16 v[42:57], v[126:129], v[102:105], v[42:57]
    ds_read_b64_tr_b16 v[114:115], v132 offset:36992
    ds_read_b64_tr_b16 v[116:117], v132 offset:38528
    s_add_u32 s89, s87, 0x0
    buffer_load_dwordx2 v[90:91], v134, s[40:43], s89 offen offset:0 sc1
    s_add_u32 s89, s87, 0x400
    buffer_load_dwordx2 v[92:93], v134, s[40:43], s89 offen offset:0 sc1
    s_add_u32 s89, s87, 0x800
    buffer_load_dwordx2 v[94:95], v134, s[40:43], s89 offen offset:0 sc1
    s_add_u32 s89, s87, 0xc00
    buffer_load_dwordx2 v[96:97], v134, s[40:43], s89 offen offset:0 sc1
    s_add_u32 s89, s87, 0x1000
    buffer_load_dwordx2 v[98:99], v134, s[40:43], s89 offen offset:0 sc1
    s_add_u32 s89, s87, 0x1400
    buffer_load_dwordx2 v[100:101], v134, s[40:43], s89 offen offset:0 sc1
    s_add_u32 s89, s87, 0x1800
    buffer_load_dwordx2 v[102:103], v134, s[40:43], s89 offen offset:0 sc1
    s_add_u32 s89, s87, 0x1c00
    buffer_load_dwordx2 v[104:105], v134, s[40:43], s89 offen offset:0 sc1
    s_waitcnt lgkmcnt(4)
    v_mfma_f32_32x32x16_bf16 v[10:25], v[106:109], v[58:61], v[10:25]
    ds_read_b64_tr_b16 v[118:119], v132 offset:39936
    ds_read_b64_tr_b16 v[120:121], v132 offset:41472
    s_waitcnt vmcnt(8)
    v_max3_u32 v133, v77, v81, v85
    v_max_u32 v133, v133, v89
    v_cmp_eq_u32 vcc, -1, v133
    s_cbranch_vccnz Lrt_p1_237
Lbk_p1_238:
    s_waitcnt lgkmcnt(4)
    v_mfma_f32_32x32x16_bf16 v[26:41], v[110:113], v[58:61], v[26:41]
    ds_read_b64_tr_b16 v[122:123], v132 offset:40000
    ds_read_b64_tr_b16 v[124:125], v132 offset:41536
    s_waitcnt lgkmcnt(4)
    v_mfma_f32_32x32x16_bf16 v[42:57], v[114:117], v[58:61], v[42:57]
    ds_read_b64_tr_b16 v[126:127], v132 offset:40064
    ds_read_b64_tr_b16 v[128:129], v132 offset:41600
    s_waitcnt lgkmcnt(4)
    v_mfma_f32_32x32x16_bf16 v[10:25], v[118:121], v[62:65], v[10:25]
    ds_read_b64_tr_b16 v[106:107], v132 offset:43008
    ds_read_b64_tr_b16 v[108:109], v132 offset:44544
    s_waitcnt lgkmcnt(4)
    v_mfma_f32_32x32x16_bf16 v[26:41], v[122:125], v[62:65], v[26:41]
    ds_read_b64_tr_b16 v[110:111], v132 offset:43072
    ds_read_b64_tr_b16 v[112:113], v132 offset:44608
    s_waitcnt lgkmcnt(4)
    v_mfma_f32_32x32x16_bf16 v[42:57], v[126:129], v[62:65], v[42:57]
    ds_read_b64_tr_b16 v[114:115], v132 offset:43136
    ds_read_b64_tr_b16 v[116:117], v132 offset:44672
    s_waitcnt lgkmcnt(4)
    v_mfma_f32_32x32x16_bf16 v[10:25], v[106:109], v[66:69], v[10:25]
    ds_read_b64_tr_b16 v[118:119], v132 offset:46080
    ds_read_b64_tr_b16 v[120:121], v132 offset:47616
    s_waitcnt lgkmcnt(4)
    v_mfma_f32_32x32x16_bf16 v[26:41], v[110:113], v[66:69], v[26:41]
    ds_read_b64_tr_b16 v[122:123], v132 offset:46144
    ds_read_b64_tr_b16 v[124:125], v132 offset:47680
    s_waitcnt lgkmcnt(4)
    v_mfma_f32_32x32x16_bf16 v[42:57], v[114:117], v[66:69], v[42:57]
    ds_read_b64_tr_b16 v[126:127], v132 offset:46208
    ds_read_b64_tr_b16 v[128:129], v132 offset:47744
    s_waitcnt lgkmcnt(4)
    v_mfma_f32_32x32x16_bf16 v[10:25], v[118:121], v[70:73], v[10:25]
    ds_read_b64_tr_b16 v[106:107], v132 offset:49152
    ds_read_b64_tr_b16 v[108:109], v132 offset:50688
    s_waitcnt lgkmcnt(4)
    v_mfma_f32_32x32x16_bf16 v[26:41], v[122:125], v[70:73], v[26:41]
    ds_read_b64_tr_b16 v[110:111], v132 offset:49216
    ds_read_b64_tr_b16 v[112:113], v132 offset:50752
    s_waitcnt lgkmcnt(4)
    v_mfma_f32_32x32x16_bf16 v[42:57], v[126:129], v[70:73], v[42:57]
    ds_read_b64_tr_b16 v[114:115], v132 offset:49280
    ds_read_b64_tr_b16 v[116:117], v132 offset:50816
    s_waitcnt lgkmcnt(4)
    v_mfma_f32_32x32x16_bf16 v[10:25], v[106:109], v[74:77], v[10:25]
    ds_read_b64_tr_b16 v[118:119], v132 offset:52224
    ds_read_b64_tr_b16 v[120:121], v132 offset:53760
    s_waitcnt lgkmcnt(4)
    v_mfma_f32_32x32x16_bf16 v[26:41], v[110:113], v[74:77], v[26:41]
    ds_read_b64_tr_b16 v[122:123], v132 offset:52288
    ds_read_b64_tr_b16 v[124:125], v132 offset:53824
    s_waitcnt lgkmcnt(4)
    v_mfma_f32_32x32x16_bf16 v[42:57], v[114:117], v[74:77], v[42:57]
    ds_read_b64_tr_b16 v[126:127], v132 offset:52352
    ds_read_b64_tr_b16 v[128:129], v132 offset:53888
    s_waitcnt lgkmcnt(4)
    v_mfma_f32_32x32x16_bf16 v[10:25], v[118:121], v[78:81], v[10:25]
    ds_read_b64_tr_b16 v[106:107], v132 offset:55296
    ds_read_b64_tr_b16 v[108:109], v132 offset:56832
    s_waitcnt lgkmcnt(4)
    v_mfma_f32_32x32x16_bf16 v[26:41], v[122:125], v[78:81], v[26:41]
    ds_read_b64_tr_b16 v[110:111], v132 offset:55360
    ds_read_b64_tr_b16 v[112:113], v132 offset:56896
    s_waitcnt lgkmcnt(4)
    v_mfma_f32_32x32x16_bf16 v[42:57], v[126:129], v[78:81], v[42:57]
    ds_read_b64_tr_b16 v[114:115], v132 offset:55424
    ds_read_b64_tr_b16 v[116:117], v132 offset:56960
    s_waitcnt lgkmcnt(4)
    v_mfma_f32_32x32x16_bf16 v[10:25], v[106:109], v[82:85], v[10:25]
    ds_read_b64_tr_b16 v[118:119], v132 offset:58368
    ds_read_b64_tr_b16 v[120:121], v132 offset:59904
    s_waitcnt lgkmcnt(4)
    v_mfma_f32_32x32x16_bf16 v[26:41], v[110:113], v[82:85], v[26:41]
    ds_read_b64_tr_b16 v[122:123], v132 offset:58432
    ds_read_b64_tr_b16 v[124:125], v132 offset:59968
    s_waitcnt lgkmcnt(4)
    v_mfma_f32_32x32x16_bf16 v[42:57], v[114:117], v[82:85], v[42:57]
    ds_read_b64_tr_b16 v[126:127], v132 offset:58496
    ds_read_b64_tr_b16 v[128:129], v132 offset:60032
    s_waitcnt lgkmcnt(4)
    v_mfma_f32_32x32x16_bf16 v[10:25], v[118:121], v[86:89], v[10:25]
    s_waitcnt lgkmcnt(2)
    v_mfma_f32_32x32x16_bf16 v[26:41], v[122:125], v[86:89], v[26:41]
    s_waitcnt lgkmcnt(0)
    v_mfma_f32_32x32x16_bf16 v[42:57], v[126:129], v[86:89], v[42:57]
    s_waitcnt vmcnt(0)
    v_max3_u32 v133, v91, v93, v95
    v_max3_u32 v133, v133, v97, v99
    v_max3_u32 v133, v133, v101, v103
    v_max_u32 v133, v133, v105
    v_cmp_eq_u32 vcc, -1, v133
    s_cbranch_vccnz Lrt_st2_239
Lbk_st2_240:
    v_add_f32 v90, v90, v92
    v_add_f32 v91, v91, v93
    v_add_f32 v90, v90, v94
    v_add_f32 v91, v91, v95
    v_add_f32 v90, v90, v96
    v_add_f32 v91, v91, v97
    v_add_f32 v90, v90, v98
    v_add_f32 v91, v91, v99
    v_add_f32 v90, v90, v100
    v_add_f32 v91, v91, v101
    v_add_f32 v90, v90, v102
    v_add_f32 v91, v91, v103
    v_add_f32 v90, v90, v104
    v_add_f32 v91, v91, v105
    v_mov_b32 v133, v90
    s_nop 1
    v_permlane32_swap_b32 v90, v133
    v_add_f32 v90, v90, v133
    v_mov_b32 v133, v91
    s_nop 1
    v_permlane32_swap_b32 v91, v133
    v_add_f32 v91, v91, v133
    s_waitcnt lgkmcnt(0)
    s_barrier
    v_lshrrev_b32 v107, 5, v0
    v_lshlrev_b32 v107, 4, v107
    v_add_u32 v107, 0x1e600, v107
    ds_read_b128 v[58:61], v107 offset:128
    ds_read_b128 v[62:65], v107 offset:160
    ds_read_b128 v[66:69], v107 offset:192
    ds_read_b128 v[70:73], v107 offset:224
    v_mul_f32 v108, 0x3b000000, v90
    v_mul_f32 v106, 0x3b000000, v91
    v_fma_f32 v106, -v108, v108, v106
    v_max_f32 v106, 0, v106
    v_add_f32 v106, 0x3727c5ac, v106
    v_rsq_f32 v109, v106
    s_nop 0
    v_mul_f32 v110, 0x3eb8aa3b, v109
    v_lshlrev_b32 v111, 4, v0
    v_mul_f32 v114, -1.0, v108
    v_mul_f32 v115, -1.0, v108
    v_mov_b32 v116, v109
    v_mov_b32 v118, v110
    v_mov_b32 v117, v109
    v_mov_b32 v119, v110
    s_lshl_b32 s89, s78, 18
    s_lshl_b32 s92, s77, 12
    s_add_u32 s89, s89, s92
    s_lshl_b32 s92, s76, 10
    s_add_u32 s89, s89, s92
    s_add_u32 s89, s89, 0x400000
    s_waitcnt lgkmcnt(0)
    v_pk_fma_f32 v[26:27], v[114:115], v[58:59], v[26:27]
    v_pk_fma_f32 v[28:29], v[114:115], v[60:61], v[28:29]
    v_pk_fma_f32 v[30:31], v[114:115], v[62:63], v[30:31]
    v_pk_fma_f32 v[32:33], v[114:115], v[64:65], v[32:33]
    v_pk_fma_f32 v[34:35], v[114:115], v[66:67], v[34:35]
    v_pk_fma_f32 v[36:37], v[114:115], v[68:69], v[36:37]
    v_pk_fma_f32 v[38:39], v[114:115], v[70:71], v[38:39]
    v_pk_fma_f32 v[40:41], v[114:115], v[72:73], v[40:41]
    ds_read_b128 v[58:61], v107 offset:256
    ds_read_b128 v[62:65], v107 offset:288
    ds_read_b128 v[66:69], v107 offset:320
    ds_read_b128 v[70:73], v107 offset:352
    v_pk_mul_f32 v[26:27], v[26:27], v[116:117]
    v_pk_mul_f32 v[28:29], v[28:29], v[116:117]
    v_pk_mul_f32 v[30:31], v[30:31], v[116:117]
    v_pk_mul_f32 v[32:33], v[32:33], v[116:117]
    v_pk_mul_f32 v[34:35], v[34:35], v[116:117]
    v_pk_mul_f32 v[36:37], v[36:37], v[116:117]
    v_pk_mul_f32 v[38:39], v[38:39], v[116:117]
    v_pk_mul_f32 v[40:41], v[40:41], v[116:117]
    v_cvt_pk_bf16_f32 v74, v26, v27
    v_cvt_pk_bf16_f32 v75, v28, v29
    v_cvt_pk_bf16_f32 v76, v30, v31
    v_cvt_pk_bf16_f32 v77, v32, v33
    v_cvt_pk_bf16_f32 v78, v34, v35
    v_cvt_pk_bf16_f32 v79, v36, v37
    v_cvt_pk_bf16_f32 v80, v38, v39
    v_cvt_pk_bf16_f32 v81, v40, v41
    s_add_u32 s90, s89, 0x0
    buffer_store_dwordx4 v[74:77], v111, s[40:43], s90 offen offset:0 sc1
    s_add_u32 s90, s89, 0x10000
    buffer_store_dwordx4 v[78:81], v111, s[40:43], s90 offen offset:0 sc1
    s_waitcnt lgkmcnt(0)
    v_pk_fma_f32 v[42:43], v[114:115], v[58:59], v[42:43]
    v_pk_fma_f32 v[44:45], v[114:115], v[60:61], v[44:45]
    v_pk_fma_f32 v[46:47], v[114:115], v[62:63], v[46:47]
    v_pk_fma_f32 v[48:49], v[114:115], v[64:65], v[48:49]
    v_pk_fma_f32 v[50:51], v[114:115], v[66:67], v[50:51]
    v_pk_fma_f32 v[52:53], v[114:115], v[68:69], v[52:53]
    v_pk_fma_f32 v[54:55], v[114:115], v[70:71], v[54:55]
    v_pk_fma_f32 v[56:57], v[114:115], v[72:73], v[56:57]
    ds_read_b128 v[58:61], v107 offset:0
    ds_read_b128 v[62:65], v107 offset:32
    ds_read_b128 v[66:69], v107 offset:64
    ds_read_b128 v[70:73], v107 offset:96
    v_pk_mul_f32 v[42:43], v[42:43], v[116:117]
    v_pk_mul_f32 v[44:45], v[44:45], v[116:117]
    v_pk_mul_f32 v[46:47], v[46:47], v[116:117]
    v_pk_mul_f32 v[48:49], v[48:49], v[116:117]
    v_pk_mul_f32 v[50:51], v[50:51], v[116:117]
    v_pk_mul_f32 v[52:53], v[52:53], v[116:117]
    v_pk_mul_f32 v[54:55], v[54:55], v[116:117]
    v_pk_mul_f32 v[56:57], v[56:57], v[116:117]
    v_cvt_pk_bf16_f32 v82, v42, v43
    v_cvt_pk_bf16_f32 v83, v44, v45
    v_cvt_pk_bf16_f32 v84, v46, v47
    v_cvt_pk_bf16_f32 v85, v48, v49
    v_cvt_pk_bf16_f32 v86, v50, v51
    v_cvt_pk_bf16_f32 v87, v52, v53
    v_cvt_pk_bf16_f32 v88, v54, v55
    v_cvt_pk_bf16_f32 v89, v56, v57
    s_add_u32 s90, s89, 0x20000
    buffer_store_dwordx4 v[82:85], v111, s[40:43], s90 offen offset:0 sc1
    s_add_u32 s90, s89, 0x30000
    buffer_store_dwordx4 v[86:89], v111, s[40:43], s90 offen offset:0 sc1
    s_add_u32 s89, s76, 8
    s_mul_i32 s89, s89, 1152
    v_add_u32 v112, s89, v111
    v_lshrrev_b32 v113, 5, v0
    v_mul_u32_u24 v113, 576, v113
    v_and_b32 v106, 31, v0
    v_lshlrev_b32 v106, 4, v106
    v_add_u32 v113, v113, v106
    v_add_u32 v113, s89, v113
    s_waitcnt lgkmcnt(0)
    ds_write_b128 v112, v[74:77] offset:0
    ds_write_b128 v112, v[78:81] offset:13824
    ds_write_b128 v113, v[82:85] offset:27648
    ds_write_b128 v113, v[86:89] offset:41472
    v_pk_fma_f32 v[10:11], v[114:115], v[58:59], v[10:11]
    v_pk_fma_f32 v[12:13], v[114:115], v[60:61], v[12:13]
    v_pk_fma_f32 v[14:15], v[114:115], v[62:63], v[14:15]
    v_pk_fma_f32 v[16:17], v[114:115], v[64:65], v[16:17]
    v_pk_fma_f32 v[18:19], v[114:115], v[66:67], v[18:19]
    v_pk_fma_f32 v[20:21], v[114:115], v[68:69], v[20:21]
    v_pk_fma_f32 v[22:23], v[114:115], v[70:71], v[22:23]
    v_pk_fma_f32 v[24:25], v[114:115], v[72:73], v[24:25]
    v_pk_mul_f32 v[10:11], v[10:11], v[118:119]
    v_pk_mul_f32 v[12:13], v[12:13], v[118:119]
    v_pk_mul_f32 v[14:15], v[14:15], v[118:119]
    v_pk_mul_f32 v[16:17], v[16:17], v[118:119]
    v_pk_mul_f32 v[18:19], v[18:19], v[118:119]
    v_pk_mul_f32 v[20:21], v[20:21], v[118:119]
    v_pk_mul_f32 v[22:23], v[22:23], v[118:119]
    v_pk_mul_f32 v[24:25], v[24:25], v[118:119]
    v_cvt_pk_bf16_f32 v10, v10, v11
    v_cvt_pk_bf16_f32 v11, v12, v13
    v_cvt_pk_bf16_f32 v12, v14, v15
    v_cvt_pk_bf16_f32 v13, v16, v17
    v_cvt_pk_bf16_f32 v14, v18, v19
    v_cvt_pk_bf16_f32 v15, v20, v21
    v_cvt_pk_bf16_f32 v16, v22, v23
    v_cvt_pk_bf16_f32 v17, v24, v25
    v_mov_b32 v58, s85
    v_mov_b32 v59, s85
    v_mov_b32 v60, s85
    v_mov_b32 v61, s85
    ds_write_b128 v111, v[58:61] offset:55296
    v_lshlrev_b32 v124, 4, v0
    s_lshl_b32 s86, s78, 2
    s_add_u32 s86, s86, s76
    s_lshl_b32 s86, s86, 16
    s_add_u32 s86, s86, 0x400000
    s_lshl_b32 s87, s77, 2
    s_add_u32 s89, s87, 0
    s_max_u32 s89, s89, 8
    s_sub_u32 s89, s89, 8
    s_lshl_b32 s89, s89, 10
    s_add_u32 s89, s89, s86
    buffer_load_dwordx4 v[18:21], v124, s[40:43], s89 offen offset:0 sc1
    s_add_u32 s89, s87, 1
    s_max_u32 s89, s89, 8
    s_sub_u32 s89, s89, 8
    s_lshl_b32 s89, s89, 10
    s_add_u32 s89, s89, s86
    buffer_load_dwordx4 v[22:25], v124, s[40:43], s89 offen offset:0 sc1
    s_add_u32 s89, s87, 2
    s_max_u32 s89, s89, 8
    s_sub_u32 s89, s89, 8
    s_lshl_b32 s89, s89, 10
    s_add_u32 s89, s89, s86
    buffer_load_dwordx4 v[26:29], v124, s[40:43], s89 offen offset:0 sc1
    s_add_u32 s89, s87, 3
    s_max_u32 s89, s89, 8
    s_sub_u32 s89, s89, 8
    s_lshl_b32 s89, s89, 10
    s_add_u32 s89, s89, s86
    buffer_load_dwordx4 v[30:33], v124, s[40:43], s89 offen offset:0 sc1
    s_add_u32 s89, s87, 4
    s_max_u32 s89, s89, 8
    s_sub_u32 s89, s89, 8
    s_lshl_b32 s89, s89, 10
    s_add_u32 s89, s89, s86
    buffer_load_dwordx4 v[34:37], v124, s[40:43], s89 offen offset:0 sc1
    s_add_u32 s89, s87, 5
    s_max_u32 s89, s89, 8
    s_sub_u32 s89, s89, 8
    s_lshl_b32 s89, s89, 10
    s_add_u32 s89, s89, s86
    buffer_load_dwordx4 v[38:41], v124, s[40:43], s89 offen offset:0 sc1
    s_add_u32 s89, s87, 6
    s_max_u32 s89, s89, 8
    s_sub_u32 s89, s89, 8
    s_lshl_b32 s89, s89, 10
    s_add_u32 s89, s89, s86
    buffer_load_dwordx4 v[42:45], v124, s[40:43], s89 offen offset:0 sc1
    s_add_u32 s89, s87, 7
    s_max_u32 s89, s89, 8
    s_sub_u32 s89, s89, 8
    s_lshl_b32 s89, s89, 10
    s_add_u32 s89, s89, s86
    buffer_load_dwordx4 v[46:49], v124, s[40:43], s89 offen offset:0 sc1
    v_lshrrev_b32 v121, 5, v0
    v_mul_u32_u24 v121, 576, v121
    v_and_b32 v116, 31, v0
    v_lshlrev_b32 v116, 4, v116
    v_add_u32 v121, v121, v116
    s_cmp_lt_u32 s76, 2
    s_cselect_b64 vcc, -1, 0
    v_cndmask_b32 v115, v121, v124, vcc
    s_mul_i32 s89, s76, 13824
    v_add_u32 v115, s89, v115
    s_mul_i32 s88, s76, 1152
    v_add_u32 v120, s88, v124
    v_bfe_u32 v123, v0, 1, 1
    v_mul_u32_u24 v123, 576, v123
    v_lshrrev_b32 v116, 5, v0
    v_lshlrev_b32 v116, 2, v116
    v_bfe_u32 v117, v0, 2, 2
    v_add_u32 v116, v116, v117
    v_lshlrev_b32 v116, 4, v116
    v_add_u32 v123, v123, v116
    v_and_b32 v116, 1, v0
    v_lshlrev_b32 v116, 3, v116
    v_add_u32 v123, v123, v116
    s_mul_i32 s89, s83, 1152
    s_add_u32 s89, s89, s88
    s_add_u32 s89, s89, 27648
    v_add_u32 v123, s89, v123
    v_bfe_u32 v116, v0, 4, 1
    v_cmp_eq_u32 vcc, 1, v116
    v_mov_b32 v117, 55296
    s_nop 0
    v_cndmask_b32 v123, v123, v117, vcc
    v_mov_b32 v116, 1152
    v_mov_b32 v117, 0
    v_cndmask_b32 v122, v116, v117, vcc
    v_mov_b32 v118, 0xff800000
    v_mov_b32 v116, 0
    v_mov_b32 v117, 0xffff
    v_mov_b32 v82, 0xffff0000
    v_cndmask_b32 v126, v116, v117, s[44:45]
    v_cndmask_b32 v83, v116, v82, s[46:47]
    v_or_b32 v126, v126, v83
    v_cndmask_b32 v127, v116, v117, s[48:49]
    v_cndmask_b32 v83, v116, v82, s[50:51]
    v_or_b32 v127, v127, v83
    v_cndmask_b32 v128, v116, v117, s[52:53]
    v_cndmask_b32 v83, v116, v82, s[54:55]
    v_or_b32 v128, v128, v83
    v_cndmask_b32 v129, v116, v117, s[56:57]
    v_cndmask_b32 v83, v116, v82, s[58:59]
    v_or_b32 v129, v129, v83
    v_cndmask_b32 v130, v116, v117, s[60:61]
    v_cndmask_b32 v83, v116, v82, s[62:63]
    v_or_b32 v130, v130, v83
    v_cndmask_b32 v131, v116, v117, s[64:65]
    v_cndmask_b32 v83, v116, v82, s[66:67]
    v_or_b32 v131, v131, v83
    v_cndmask_b32 v132, v116, v117, s[68:69]
    v_cndmask_b32 v83, v116, v82, s[70:71]
    v_or_b32 v132, v132, v83
    v_cndmask_b32 v133, v116, v117, s[72:73]
    v_cndmask_b32 v83, v116, v82, s[74:75]
    v_or_b32 v133, v133, v83
    ds_read_b128 v[90:93], v120 offset:9216
    ds_read_b128 v[94:97], v120 offset:23040
    s_waitcnt lgkmcnt(0)
    v_mfma_f32_32x32x16_bf16 v[50:65], v[90:93], v[10:13], 0
    v_mfma_f32_32x32x16_bf16 v[66:81], v[94:97], v[14:17], 0
    s_nop 10
    v_cndmask_b32 v50, v118, v50, s[44:45]
    v_cndmask_b32 v51, v118, v51, s[46:47]
    v_cndmask_b32 v52, v118, v52, s[48:49]
    v_cndmask_b32 v53, v118, v53, s[50:51]
    v_cndmask_b32 v54, v118, v54, s[52:53]
    v_cndmask_b32 v55, v118, v55, s[54:55]
    v_cndmask_b32 v56, v118, v56, s[56:57]
    v_cndmask_b32 v57, v118, v57, s[58:59]
    v_cndmask_b32 v58, v118, v58, s[60:61]
    v_cndmask_b32 v59, v118, v59, s[62:63]
    v_cndmask_b32 v60, v118, v60, s[64:65]
    v_cndmask_b32 v61, v118, v61, s[66:67]
    v_cndmask_b32 v62, v118, v62, s[68:69]
    v_cndmask_b32 v63, v118, v63, s[70:71]
    v_cndmask_b32 v64, v118, v64, s[72:73]
    v_cndmask_b32 v65, v118, v65, s[74:75]
    v_max3_f32 v82, v50, v51, v52
    v_max3_f32 v83, v53, v54, v55
    v_max3_f32 v82, v82, v56, v57
    v_max3_f32 v83, v83, v58, v59
    v_max3_f32 v82, v82, v60, v61
    v_max3_f32 v83, v83, v62, v63
    v_max3_f32 v82, v82, v64, v65
    v_max_f32 v82, v82, v83
    v_mov_b32 v83, v82
    s_nop 1
    v_permlane32_swap_b32 v82, v83
    v_max_f32 v114, v82, v83
    v_cndmask_b32 v66, v118, v66, s[44:45]
    v_cndmask_b32 v67, v118, v67, s[46:47]
    v_cndmask_b32 v68, v118, v68, s[48:49]
    v_cndmask_b32 v69, v118, v69, s[50:51]
    v_cndmask_b32 v70, v118, v70, s[52:53]
    v_cndmask_b32 v71, v118, v71, s[54:55]
    v_cndmask_b32 v72, v118, v72, s[56:57]
    v_cndmask_b32 v73, v118, v73, s[58:59]
    v_cndmask_b32 v74, v118, v74, s[60:61]
    v_cndmask_b32 v75, v118, v75, s[62:63]
    v_cndmask_b32 v76, v118, v76, s[64:65]
    v_cndmask_b32 v77, v118, v77, s[66:67]
    v_cndmask_b32 v78, v118, v78, s[68:69]
    v_cndmask_b32 v79, v118, v79, s[70:71]
    v_cndmask_b32 v80, v118, v80, s[72:73]
    v_cndmask_b32 v81, v118, v81, s[74:75]
    v_max3_f32 v82, v66, v67, v68
    v_max3_f32 v83, v69, v70, v71
    v_max3_f32 v82, v82, v72, v73
    v_max3_f32 v83, v83, v74, v75
    v_max3_f32 v82, v82, v76, v77
    v_max3_f32 v83, v83, v78, v79
    v_max3_f32 v82, v82, v80, v81
    v_max_f32 v82, v82, v83
    v_mov_b32 v83, v82
    s_nop 1
    v_permlane32_swap_b32 v82, v83
    v_max_f32 v141, v82, v83
    s_waitcnt vmcnt(0)
    v_max3_u32 v116, v21, v25, v29
    v_max3_u32 v116, v116, v33, v37
    v_max3_u32 v116, v116, v41, v45
    v_max_u32 v116, v116, v49
    v_cmp_eq_u32 vcc, -1, v116
    s_cbranch_vccnz Lrt_halo_241
Lbk_halo_242:
    ds_write_b128 v115, v[18:21] offset:0
    ds_write_b128 v115, v[22:25] offset:1152
    ds_write_b128 v115, v[26:29] offset:2304
    ds_write_b128 v115, v[30:33] offset:3456
    ds_write_b128 v115, v[34:37] offset:4608
    ds_write_b128 v115, v[38:41] offset:5760
    ds_write_b128 v115, v[42:45] offset:6912
    ds_write_b128 v115, v[46:49] offset:8064
    s_waitcnt lgkmcnt(0)
    s_barrier
    v_mov_b32 v121, v123
    s_cmp_lg_u32 s83, 0
    s_cbranch_scc1 La2s_243
    ds_read_b128 v[90:93], v120 offset:0
    ds_read_b128 v[94:97], v120 offset:1152
    ds_read_b64_tr_b16 v[98:99], v121 offset:0
    ds_read_b64_tr_b16 v[100:101], v121 offset:128
    ds_read_b64_tr_b16 v[102:103], v121 offset:256
    ds_read_b64_tr_b16 v[104:105], v121 offset:384
    v_mul_f32 v66, -1.0, v114
    v_mul_f32 v67, -1.0, v114
    v_mul_f32 v68, -1.0, v114
    v_mul_f32 v69, -1.0, v114
    v_mul_f32 v70, -1.0, v114
    v_mul_f32 v71, -1.0, v114
    v_mul_f32 v72, -1.0, v114
    v_mul_f32 v73, -1.0, v114
    v_mul_f32 v74, -1.0, v114
    v_mul_f32 v75, -1.0, v114
    v_mul_f32 v76, -1.0, v114
    v_mul_f32 v77, -1.0, v114
    v_mul_f32 v78, -1.0, v114
    v_mul_f32 v79, -1.0, v114
    v_mul_f32 v80, -1.0, v114
    v_mul_f32 v81, -1.0, v114
    s_waitcnt lgkmcnt(5)
    s_nop 0
    v_mfma_f32_32x32x16_bf16 v[18:33], v[90:93], v[10:13], v[66:81]
    s_nop 7
    s_nop 3
La2b_252:
    v_exp_f32 v18, v18
    v_exp_f32 v19, v19
    v_exp_f32 v20, v20
    v_exp_f32 v21, v21
    s_waitcnt lgkmcnt(4)
    v_mfma_f32_32x32x16_bf16 v[34:49], v[94:97], v[10:13], v[66:81]
    v_exp_f32 v22, v22
    v_exp_f32 v23, v23
    v_exp_f32 v24, v24
    v_exp_f32 v25, v25
    ds_read_b128 v[90:93], v120 offset:2304
    v_cvt_pk_bf16_f32 v82, v18, v19
    v_cvt_pk_bf16_f32 v83, v20, v21
    v_cvt_pk_bf16_f32 v84, v22, v23
    v_cvt_pk_bf16_f32 v85, v24, v25
    v_bfi_b32 v82, v126, 0, v82
    v_bfi_b32 v83, v127, 0, v83
    v_bfi_b32 v84, v128, 0, v84
    v_bfi_b32 v85, v129, 0, v85
    v_exp_f32 v26, v26
    v_exp_f32 v27, v27
    s_waitcnt lgkmcnt(1)
    v_mfma_f32_32x32x16_bf16 v[50:65], v[98:101], v[82:85], 0
    v_lshrrev_b32 v138, 3, v0
    v_lshlrev_b32 v138, 10, v138
    v_and_b32 v139, 7, v0
    v_lshrrev_b32 v140, 4, v0
    v_and_b32 v140, 1, v140
    v_lshlrev_b32 v140, 2, v140
    v_xor_b32 v139, v139, v140
    v_lshlrev_b32 v139, 4, v139
    v_add_u32 v138, v138, v139
    s_lshl_b32 s96, s76, 17
    s_lshl_b32 s97, s80, 7
    s_add_u32 s96, s96, s97
    s_lshl_b32 s97, s76, 14
    v_exp_f32 v28, v28
    v_exp_f32 v29, v29
    v_exp_f32 v30, v30
    v_add_u32 v121, v121, v122
    ds_read_b64_tr_b16 v[106:107], v121 offset:0
    ds_read_b64_tr_b16 v[108:109], v121 offset:128
    v_exp_f32 v31, v31
    v_exp_f32 v32, v32
    v_exp_f32 v33, v33
    s_add_u32 s92, s96, 0x0
    s_add_u32 m0, s97, 57344
    s_nop 0
    buffer_load_dwordx4 v138, s[12:15], s92 offen lds
    v_cvt_pk_bf16_f32 v86, v26, v27
    v_cvt_pk_bf16_f32 v87, v28, v29
    v_cvt_pk_bf16_f32 v88, v30, v31
    v_cvt_pk_bf16_f32 v89, v32, v33
    v_bfi_b32 v86, v130, 0, v86
    v_bfi_b32 v87, v131, 0, v87
    v_bfi_b32 v88, v132, 0, v88
    v_bfi_b32 v89, v133, 0, v89
    ds_read_b64_tr_b16 v[110:111], v121 offset:256
    ds_read_b64_tr_b16 v[112:113], v121 offset:384
    v_mfma_f32_32x32x16_bf16 v[50:65], v[102:105], v[86:89], v[50:65]
La2b_253:
    v_exp_f32 v34, v34
    v_exp_f32 v35, v35
    v_exp_f32 v36, v36
    v_exp_f32 v37, v37
    s_waitcnt lgkmcnt(4)
    v_mfma_f32_32x32x16_bf16 v[18:33], v[90:93], v[10:13], v[66:81]
    v_exp_f32 v38, v38
    v_exp_f32 v39, v39
    v_exp_f32 v40, v40
    v_exp_f32 v41, v41
    ds_read_b128 v[94:97], v120 offset:3456
    v_cvt_pk_bf16_f32 v82, v34, v35
    v_cvt_pk_bf16_f32 v83, v36, v37
    v_cvt_pk_bf16_f32 v84, v38, v39
    v_cvt_pk_bf16_f32 v85, v40, v41
    v_exp_f32 v42, v42
    v_exp_f32 v43, v43
    s_waitcnt lgkmcnt(1)
    v_mfma_f32_32x32x16_bf16 v[50:65], v[106:109], v[82:85], v[50:65]
    s_add_u32 s92, s96, 0x2000
    s_add_u32 m0, s97, 58368
    s_nop 0
    buffer_load_dwordx4 v138, s[12:15], s92 offen lds
    v_exp_f32 v44, v44
    v_exp_f32 v45, v45
    v_exp_f32 v46, v46
    v_add_u32 v121, v121, v122
    ds_read_b64_tr_b16 v[98:99], v121 offset:0
    ds_read_b64_tr_b16 v[100:101], v121 offset:128
    v_exp_f32 v47, v47
    v_exp_f32 v48, v48
    v_exp_f32 v49, v49
    s_add_u32 s92, s96, 0x4000
    s_add_u32 m0, s97, 59392
    s_nop 0
    buffer_load_dwordx4 v138, s[12:15], s92 offen lds
    v_cvt_pk_bf16_f32 v86, v42, v43
    v_cvt_pk_bf16_f32 v87, v44, v45
    v_cvt_pk_bf16_f32 v88, v46, v47
    v_cvt_pk_bf16_f32 v89, v48, v49
    ds_read_b64_tr_b16 v[102:103], v121 offset:256
    ds_read_b64_tr_b16 v[104:105], v121 offset:384
    v_mfma_f32_32x32x16_bf16 v[50:65], v[110:113], v[86:89], v[50:65]
La2b_254:
    v_exp_f32 v18, v18
    v_exp_f32 v19, v19
    v_exp_f32 v20, v20
    v_exp_f32 v21, v21
    s_waitcnt lgkmcnt(4)
    v_mfma_f32_32x32x16_bf16 v[34:49], v[94:97], v[10:13], v[66:81]
    v_exp_f32 v22, v22
    v_exp_f32 v23, v23
    v_exp_f32 v24, v24
    v_exp_f32 v25, v25
    ds_read_b128 v[90:93], v120 offset:4608
    v_cvt_pk_bf16_f32 v82, v18, v19
    v_cvt_pk_bf16_f32 v83, v20, v21
    v_cvt_pk_bf16_f32 v84, v22, v23
    v_cvt_pk_bf16_f32 v85, v24, v25
    v_exp_f32 v26, v26
    v_exp_f32 v27, v27
    s_waitcnt lgkmcnt(1)
    v_mfma_f32_32x32x16_bf16 v[50:65], v[98:101], v[82:85], v[50:65]
    s_add_u32 s92, s96, 0x6000
    s_add_u32 m0, s97, 60416
    s_nop 0
    buffer_load_dwordx4 v138, s[12:15], s92 offen lds
    v_exp_f32 v28, v28
    v_exp_f32 v29, v29
    v_exp_f32 v30, v30
    v_add_u32 v121, v121, v122
    ds_read_b64_tr_b16 v[106:107], v121 offset:0
    ds_read_b64_tr_b16 v[108:109], v121 offset:128
    v_exp_f32 v31, v31
    v_exp_f32 v32, v32
    v_exp_f32 v33, v33
    s_add_u32 s92, s96, 0x8000
    s_add_u32 m0, s97, 61440
    s_nop 0
    buffer_load_dwordx4 v138, s[12:15], s92 offen lds
    v_cvt_pk_bf16_f32 v86, v26, v27
    v_cvt_pk_bf16_f32 v87, v28, v29
    v_cvt_pk_bf16_f32 v88, v30, v31
    v_cvt_pk_bf16_f32 v89, v32, v33
    ds_read_b64_tr_b16 v[110:111], v121 offset:256
    ds_read_b64_tr_b16 v[112:113], v121 offset:384
    v_mfma_f32_32x32x16_bf16 v[50:65], v[102:105], v[86:89], v[50:65]
La2b_255:
    v_exp_f32 v34, v34
    v_exp_f32 v35, v35
    v_exp_f32 v36, v36
    v_exp_f32 v37, v37
    s_waitcnt lgkmcnt(4)
    v_mfma_f32_32x32x16_bf16 v[18:33], v[90:93], v[10:13], v[66:81]
    v_exp_f32 v38, v38
    v_exp_f32 v39, v39
    v_exp_f32 v40, v40
    v_exp_f32 v41, v41
    ds_read_b128 v[94:97], v120 offset:5760
    v_cvt_pk_bf16_f32 v82, v34, v35
    v_cvt_pk_bf16_f32 v83, v36, v37
    v_cvt_pk_bf16_f32 v84, v38, v39
    v_cvt_pk_bf16_f32 v85, v40, v41
    v_exp_f32 v42, v42
    v_exp_f32 v43, v43
    s_waitcnt lgkmcnt(1)
    v_mfma_f32_32x32x16_bf16 v[50:65], v[106:109], v[82:85], v[50:65]
    s_add_u32 s92, s96, 0xa000
    s_add_u32 m0, s97, 62464
    s_nop 0
    buffer_load_dwordx4 v138, s[12:15], s92 offen lds
    v_exp_f32 v44, v44
    v_exp_f32 v45, v45
    v_exp_f32 v46, v46
    v_add_u32 v121, v121, v122
    ds_read_b64_tr_b16 v[98:99], v121 offset:0
    ds_read_b64_tr_b16 v[100:101], v121 offset:128
    v_exp_f32 v47, v47
    v_exp_f32 v48, v48
    v_exp_f32 v49, v49
    s_add_u32 s92, s96, 0xc000
    s_add_u32 m0, s97, 63488
    s_nop 0
    buffer_load_dwordx4 v138, s[12:15], s92 offen lds
    v_cvt_pk_bf16_f32 v86, v42, v43
    v_cvt_pk_bf16_f32 v87, v44, v45
    v_cvt_pk_bf16_f32 v88, v46, v47
    v_cvt_pk_bf16_f32 v89, v48, v49
    ds_read_b64_tr_b16 v[102:103], v121 offset:256
    ds_read_b64_tr_b16 v[104:105], v121 offset:384
    v_mfma_f32_32x32x16_bf16 v[50:65], v[110:113], v[86:89], v[50:65]
La2b_256:
    v_exp_f32 v18, v18
    v_exp_f32 v19, v19
    v_exp_f32 v20, v20
    v_exp_f32 v21, v21
    s_waitcnt lgkmcnt(4)
    v_mfma_f32_32x32x16_bf16 v[34:49], v[94:97], v[10:13], v[66:81]
    v_exp_f32 v22, v22
    v_exp_f32 v23, v23
    v_exp_f32 v24, v24
    v_exp_f32 v25, v25
    ds_read_b128 v[90:93], v120 offset:6912
    v_cvt_pk_bf16_f32 v82, v18, v19
    v_cvt_pk_bf16_f32 v83, v20, v21
    v_cvt_pk_bf16_f32 v84, v22, v23
    v_cvt_pk_bf16_f32 v85, v24, v25
    v_exp_f32 v26, v26
    v_exp_f32 v27, v27
    s_waitcnt lgkmcnt(1)
    v_mfma_f32_32x32x16_bf16 v[50:65], v[98:101], v[82:85], v[50:65]
    s_add_u32 s92, s96, 0xe000
    s_add_u32 m0, s97, 64512
    s_nop 0
    buffer_load_dwordx4 v138, s[12:15], s92 offen lds
    v_exp_f32 v28, v28
    v_exp_f32 v29, v29
    v_exp_f32 v30, v30
    v_add_u32 v121, v121, v122
    ds_read_b64_tr_b16 v[106:107], v121 offset:0
    ds_read_b64_tr_b16 v[108:109], v121 offset:128
    v_exp_f32 v31, v31
    v_exp_f32 v32, v32
    v_exp_f32 v33, v33
    s_add_u32 s92, s96, 0x10000
    s_add_u32 m0, s97, 65536
    s_nop 0
    buffer_load_dwordx4 v138, s[12:15], s92 offen lds
    v_cvt_pk_bf16_f32 v86, v26, v27
    v_cvt_pk_bf16_f32 v87, v28, v29
    v_cvt_pk_bf16_f32 v88, v30, v31
    v_cvt_pk_bf16_f32 v89, v32, v33
    ds_read_b64_tr_b16 v[110:111], v121 offset:256
    ds_read_b64_tr_b16 v[112:113], v121 offset:384
    v_mfma_f32_32x32x16_bf16 v[50:65], v[102:105], v[86:89], v[50:65]
La2b_257:
    v_exp_f32 v34, v34
    v_exp_f32 v35, v35
    v_exp_f32 v36, v36
    v_exp_f32 v37, v37
    s_waitcnt lgkmcnt(4)
    v_mfma_f32_32x32x16_bf16 v[18:33], v[90:93], v[10:13], v[66:81]
    v_exp_f32 v38, v38
    v_exp_f32 v39, v39
    v_exp_f32 v40, v40
    v_exp_f32 v41, v41
    ds_read_b128 v[94:97], v120 offset:8064
    v_cvt_pk_bf16_f32 v82, v34, v35
    v_cvt_pk_bf16_f32 v83, v36, v37
    v_cvt_pk_bf16_f32 v84, v38, v39
    v_cvt_pk_bf16_f32 v85, v40, v41
    v_exp_f32 v42, v42
    v_exp_f32 v43, v43
    s_waitcnt lgkmcnt(1)
    v_mfma_f32_32x32x16_bf16 v[50:65], v[106:109], v[82:85], v[50:65]
    s_add_u32 s92, s96, 0x12000
    s_add_u32 m0, s97, 66560
    s_nop 0
    buffer_load_dwordx4 v138, s[12:15], s92 offen lds
    v_exp_f32 v44, v44
    v_exp_f32 v45, v45
    v_exp_f32 v46, v46
    v_add_u32 v121, v121, v122
    ds_read_b64_tr_b16 v[98:99], v121 offset:0
    ds_read_b64_tr_b16 v[100:101], v121 offset:128
    v_exp_f32 v47, v47
    v_exp_f32 v48, v48
    v_exp_f32 v49, v49
    s_add_u32 s92, s96, 0x14000
    s_add_u32 m0, s97, 67584
    s_nop 0
    buffer_load_dwordx4 v138, s[12:15], s92 offen lds
    v_cvt_pk_bf16_f32 v86, v42, v43
    v_cvt_pk_bf16_f32 v87, v44, v45
    v_cvt_pk_bf16_f32 v88, v46, v47
    v_cvt_pk_bf16_f32 v89, v48, v49
    ds_read_b64_tr_b16 v[102:103], v121 offset:256
    ds_read_b64_tr_b16 v[104:105], v121 offset:384
    v_mfma_f32_32x32x16_bf16 v[50:65], v[110:113], v[86:89], v[50:65]
La2b_258:
    v_exp_f32 v18, v18
    v_exp_f32 v19, v19
    v_exp_f32 v20, v20
    v_exp_f32 v21, v21
    s_waitcnt lgkmcnt(4)
    v_mfma_f32_32x32x16_bf16 v[34:49], v[94:97], v[10:13], v[66:81]
    v_exp_f32 v22, v22
    v_exp_f32 v23, v23
    v_exp_f32 v24, v24
    v_exp_f32 v25, v25
    ds_read_b128 v[90:93], v120 offset:9216
    v_cvt_pk_bf16_f32 v82, v18, v19
    v_cvt_pk_bf16_f32 v83, v20, v21
    v_cvt_pk_bf16_f32 v84, v22, v23
    v_cvt_pk_bf16_f32 v85, v24, v25
    v_exp_f32 v26, v26
    v_exp_f32 v27, v27
    s_waitcnt lgkmcnt(1)
    v_mfma_f32_32x32x16_bf16 v[50:65], v[98:101], v[82:85], v[50:65]
    s_add_u32 s92, s96, 0x16000
    s_add_u32 m0, s97, 68608
    s_nop 0
    buffer_load_dwordx4 v138, s[12:15], s92 offen lds
    v_exp_f32 v28, v28
    v_exp_f32 v29, v29
    v_exp_f32 v30, v30
    v_add_u32 v121, v121, v122
    ds_read_b64_tr_b16 v[106:107], v121 offset:0
    ds_read_b64_tr_b16 v[108:109], v121 offset:128
    v_exp_f32 v31, v31
    v_exp_f32 v32, v32
    v_exp_f32 v33, v33
    s_add_u32 s92, s96, 0x18000
    s_add_u32 m0, s97, 69632
    s_nop 0
    buffer_load_dwordx4 v138, s[12:15], s92 offen lds
    v_cvt_pk_bf16_f32 v86, v26, v27
    v_cvt_pk_bf16_f32 v87, v28, v29
    v_cvt_pk_bf16_f32 v88, v30, v31
    v_cvt_pk_bf16_f32 v89, v32, v33
    ds_read_b64_tr_b16 v[110:111], v121 offset:256
    ds_read_b64_tr_b16 v[112:113], v121 offset:384
    v_mfma_f32_32x32x16_bf16 v[50:65], v[102:105], v[86:89], v[50:65]
La2b_259:
    v_exp_f32 v34, v34
    v_exp_f32 v35, v35
    v_exp_f32 v36, v36
    v_exp_f32 v37, v37
    s_waitcnt lgkmcnt(4)
    v_mfma_f32_32x32x16_bf16 v[18:33], v[90:93], v[10:13], v[66:81]
    v_exp_f32 v38, v38
    v_exp_f32 v39, v39
    v_exp_f32 v40, v40
    v_exp_f32 v41, v41
    v_cvt_pk_bf16_f32 v82, v34, v35
    v_cvt_pk_bf16_f32 v83, v36, v37
    v_cvt_pk_bf16_f32 v84, v38, v39
    v_cvt_pk_bf16_f32 v85, v40, v41
    v_exp_f32 v42, v42
    v_exp_f32 v43, v43
    s_waitcnt lgkmcnt(0)
    v_mfma_f32_32x32x16_bf16 v[50:65], v[106:109], v[82:85], v[50:65]
    s_add_u32 s92, s96, 0x1a000
    s_add_u32 m0, s97, 70656
    s_nop 0
    buffer_load_dwordx4 v138, s[12:15], s92 offen lds
    v_exp_f32 v44, v44
    v_exp_f32 v45, v45
    v_exp_f32 v46, v46
    v_add_u32 v121, v121, v122
    ds_read_b64_tr_b16 v[98:99], v121 offset:0
    ds_read_b64_tr_b16 v[100:101], v121 offset:128
    v_exp_f32 v47, v47
    v_exp_f32 v48, v48
    v_exp_f32 v49, v49
    s_add_u32 s92, s96, 0x1c000
    s_add_u32 m0, s97, 71680
    s_nop 0
    buffer_load_dwordx4 v138, s[12:15], s92 offen lds
    v_cvt_pk_bf16_f32 v86, v42, v43
    v_cvt_pk_bf16_f32 v87, v44, v45
    v_cvt_pk_bf16_f32 v88, v46, v47
    v_cvt_pk_bf16_f32 v89, v48, v49
    ds_read_b64_tr_b16 v[102:103], v121 offset:256
    ds_read_b64_tr_b16 v[104:105], v121 offset:384
    v_mfma_f32_32x32x16_bf16 v[50:65], v[110:113], v[86:89], v[50:65]
La2b_260:
    v_exp_f32 v18, v18
    v_exp_f32 v19, v19
    v_exp_f32 v20, v20
    v_exp_f32 v21, v21
    v_exp_f32 v22, v22
    v_exp_f32 v23, v23
    v_exp_f32 v24, v24
    v_exp_f32 v25, v25
    v_cvt_pk_bf16_f32 v82, v18, v19
    v_cvt_pk_bf16_f32 v83, v20, v21
    v_cvt_pk_bf16_f32 v84, v22, v23
    v_cvt_pk_bf16_f32 v85, v24, v25
    v_and_b32 v82, v126, v82
    v_and_b32 v83, v127, v83
    v_and_b32 v84, v128, v84
    v_and_b32 v85, v129, v85
    v_exp_f32 v26, v26
    v_exp_f32 v27, v27
    s_waitcnt lgkmcnt(0)
    v_mfma_f32_32x32x16_bf16 v[50:65], v[98:101], v[82:85], v[50:65]
    s_add_u32 s92, s96, 0x1e000
    s_add_u32 m0, s97, 72704
    s_nop 0
    buffer_load_dwordx4 v138, s[12:15], s92 offen lds
    v_exp_f32 v28, v28
    v_exp_f32 v29, v29
    v_exp_f32 v30, v30
    v_exp_f32 v31, v31
    v_exp_f32 v32, v32
    v_exp_f32 v33, v33
    v_cvt_pk_bf16_f32 v86, v26, v27
    v_cvt_pk_bf16_f32 v87, v28, v29
    v_cvt_pk_bf16_f32 v88, v30, v31
    v_cvt_pk_bf16_f32 v89, v32, v33
    v_and_b32 v86, v130, v86
    v_and_b32 v87, v131, v87
    v_and_b32 v88, v132, v88
    v_and_b32 v89, v133, v89
    s_nop 1
    v_mfma_f32_32x32x16_bf16 v[50:65], v[102:105], v[86:89], v[50:65]
    s_waitcnt lgkmcnt(0)
    s_nop 10
    v_cmp_ngt_f32 vcc, 0x4e800000, v58
    s_cbranch_vccnz Lredo_261
Lredone_262:
    v_rcp_f32 v116, v58
    s_nop 0
    v_mov_b32 v117, v116
    v_pk_mul_f32 v[50:51], v[50:51], v[116:117]
    v_pk_mul_f32 v[52:53], v[52:53], v[116:117]
    v_pk_mul_f32 v[54:55], v[54:55], v[116:117]
    v_pk_mul_f32 v[56:57], v[56:57], v[116:117]
    v_cvt_pk_bf16_f32 v82, v50, v51
    v_cvt_pk_bf16_f32 v83, v52, v53
    v_cvt_pk_bf16_f32 v84, v54, v55
    v_cvt_pk_bf16_f32 v85, v56, v57
    s_lshl_b32 s89, s77, 2
    s_add_u32 s89, s89, s76
    s_lshl_b32 s89, s89, 15
    s_lshl_b32 s92, s78, 11
    s_add_u32 s89, s89, s92
    s_add_u32 s89, s89, 0xa00000
    s_cmp_eq_u32 s93, 0
    s_cbranch_scc1 Lfar_299
    buffer_store_dwordx4 v[82:85], v124, s[40:43], s89 offen offset:0
    s_branch Lstored_300
Lfar_299:
    buffer_store_dwordx4 v[82:85], v124, s[40:43], s89 offen offset:0 sc1
Lstored_300:
    v_mov_b32 v121, v123
    v_mov_b32 v116, 13824
    v_cmp_ne_u32 vcc, 0, v122
    v_mov_b32 v117, 0
    s_nop 0
    v_cndmask_b32 v116, v117, v116, vcc
    v_add_u32 v121, v121, v116
    s_cmp_lg_u32 s83, 0
    s_cbranch_scc1 La2s_301
    ds_read_b128 v[90:93], v120 offset:13824
    ds_read_b128 v[94:97], v120 offset:14976
    ds_read_b64_tr_b16 v[98:99], v121 offset:0
    ds_read_b64_tr_b16 v[100:101], v121 offset:128
    ds_read_b64_tr_b16 v[102:103], v121 offset:256
    ds_read_b64_tr_b16 v[104:105], v121 offset:384
    v_mul_f32 v66, -1.0, v141
    v_mul_f32 v67, -1.0, v141
    v_mul_f32 v68, -1.0, v141
    v_mul_f32 v69, -1.0, v141
    v_mul_f32 v70, -1.0, v141
    v_mul_f32 v71, -1.0, v141
    v_mul_f32 v72, -1.0, v141
    v_mul_f32 v73, -1.0, v141
    v_mul_f32 v74, -1.0, v141
    v_mul_f32 v75, -1.0, v141
    v_mul_f32 v76, -1.0, v141
    v_mul_f32 v77, -1.0, v141
    v_mul_f32 v78, -1.0, v141
    v_mul_f32 v79, -1.0, v141
    v_mul_f32 v80, -1.0, v141
    v_mul_f32 v81, -1.0, v141
    s_waitcnt lgkmcnt(5)
    s_nop 0
    v_mfma_f32_32x32x16_bf16 v[18:33], v[90:93], v[14:17], v[66:81]
    s_nop 7
    s_nop 3
La2b_310:
    v_exp_f32 v18, v18
    v_exp_f32 v19, v19
    v_exp_f32 v20, v20
    v_exp_f32 v21, v21
    s_waitcnt lgkmcnt(4)
    v_mfma_f32_32x32x16_bf16 v[34:49], v[94:97], v[14:17], v[66:81]
    v_exp_f32 v22, v22
    v_exp_f32 v23, v23
    v_exp_f32 v24, v24
    v_exp_f32 v25, v25
    ds_read_b128 v[90:93], v120 offset:16128
    v_cvt_pk_bf16_f32 v82, v18, v19
    v_cvt_pk_bf16_f32 v83, v20, v21
    v_cvt_pk_bf16_f32 v84, v22, v23
    v_cvt_pk_bf16_f32 v85, v24, v25
    v_bfi_b32 v82, v126, 0, v82
    v_bfi_b32 v83, v127, 0, v83
    v_bfi_b32 v84, v128, 0, v84
    v_bfi_b32 v85, v129, 0, v85
    v_exp_f32 v26, v26
    v_exp_f32 v27, v27
    s_waitcnt lgkmcnt(1)
    v_mfma_f32_32x32x16_bf16 v[50:65], v[98:101], v[82:85], 0
    v_exp_f32 v28, v28
    v_exp_f32 v29, v29
    v_exp_f32 v30, v30
    v_add_u32 v121, v121, v122
    ds_read_b64_tr_b16 v[106:107], v121 offset:0
    ds_read_b64_tr_b16 v[108:109], v121 offset:128
    v_exp_f32 v31, v31
    v_exp_f32 v32, v32
    v_exp_f32 v33, v33
    v_cvt_pk_bf16_f32 v86, v26, v27
    v_cvt_pk_bf16_f32 v87, v28, v29
    v_cvt_pk_bf16_f32 v88, v30, v31
    v_cvt_pk_bf16_f32 v89, v32, v33
    v_bfi_b32 v86, v130, 0, v86
    v_bfi_b32 v87, v131, 0, v87
    v_bfi_b32 v88, v132, 0, v88
    v_bfi_b32 v89, v133, 0, v89
    ds_read_b64_tr_b16 v[110:111], v121 offset:256
    ds_read_b64_tr_b16 v[112:113], v121 offset:384
    v_mfma_f32_32x32x16_bf16 v[50:65], v[102:105], v[86:89], v[50:65]
La2b_311:
    v_exp_f32 v34, v34
    v_exp_f32 v35, v35
    v_exp_f32 v36, v36
    v_exp_f32 v37, v37
    s_waitcnt lgkmcnt(4)
    v_mfma_f32_32x32x16_bf16 v[18:33], v[90:93], v[14:17], v[66:81]
    v_exp_f32 v38, v38
    v_exp_f32 v39, v39
    v_exp_f32 v40, v40
    v_exp_f32 v41, v41
    ds_read_b128 v[94:97], v120 offset:17280
    v_cvt_pk_bf16_f32 v82, v34, v35
    v_cvt_pk_bf16_f32 v83, v36, v37
    v_cvt_pk_bf16_f32 v84, v38, v39
    v_cvt_pk_bf16_f32 v85, v40, v41
    v_exp_f32 v42, v42
    v_exp_f32 v43, v43
    s_waitcnt lgkmcnt(1)
    v_mfma_f32_32x32x16_bf16 v[50:65], v[106:109], v[82:85], v[50:65]
    v_exp_f32 v44, v44
    v_exp_f32 v45, v45
    v_exp_f32 v46, v46
    v_add_u32 v121, v121, v122
    ds_read_b64_tr_b16 v[98:99], v121 offset:0
    ds_read_b64_tr_b16 v[100:101], v121 offset:128
    v_exp_f32 v47, v47
    v_exp_f32 v48, v48
    v_exp_f32 v49, v49
    v_cvt_pk_bf16_f32 v86, v42, v43
    v_cvt_pk_bf16_f32 v87, v44, v45
    v_cvt_pk_bf16_f32 v88, v46, v47
    v_cvt_pk_bf16_f32 v89, v48, v49
    ds_read_b64_tr_b16 v[102:103], v121 offset:256
    ds_read_b64_tr_b16 v[104:105], v121 offset:384
    v_mfma_f32_32x32x16_bf16 v[50:65], v[110:113], v[86:89], v[50:65]
La2b_312:
    v_exp_f32 v18, v18
    v_exp_f32 v19, v19
    v_exp_f32 v20, v20
    v_exp_f32 v21, v21
    s_waitcnt lgkmcnt(4)
    v_mfma_f32_32x32x16_bf16 v[34:49], v[94:97], v[14:17], v[66:81]
    v_exp_f32 v22, v22
    v_exp_f32 v23, v23
    v_exp_f32 v24, v24
    v_exp_f32 v25, v25
    ds_read_b128 v[90:93], v120 offset:18432
    v_cvt_pk_bf16_f32 v82, v18, v19
    v_cvt_pk_bf16_f32 v83, v20, v21
    v_cvt_pk_bf16_f32 v84, v22, v23
    v_cvt_pk_bf16_f32 v85, v24, v25
    v_exp_f32 v26, v26
    v_exp_f32 v27, v27
    s_waitcnt lgkmcnt(1)
    v_mfma_f32_32x32x16_bf16 v[50:65], v[98:101], v[82:85], v[50:65]
    v_exp_f32 v28, v28
    v_exp_f32 v29, v29
    v_exp_f32 v30, v30
    v_add_u32 v121, v121, v122
    ds_read_b64_tr_b16 v[106:107], v121 offset:0
    ds_read_b64_tr_b16 v[108:109], v121 offset:128
    v_exp_f32 v31, v31
    v_exp_f32 v32, v32
    v_exp_f32 v33, v33
    v_cvt_pk_bf16_f32 v86, v26, v27
    v_cvt_pk_bf16_f32 v87, v28, v29
    v_cvt_pk_bf16_f32 v88, v30, v31
    v_cvt_pk_bf16_f32 v89, v32, v33
    ds_read_b64_tr_b16 v[110:111], v121 offset:256
    ds_read_b64_tr_b16 v[112:113], v121 offset:384
    v_mfma_f32_32x32x16_bf16 v[50:65], v[102:105], v[86:89], v[50:65]
La2b_313:
    v_exp_f32 v34, v34
    v_exp_f32 v35, v35
    v_exp_f32 v36, v36
    v_exp_f32 v37, v37
    s_waitcnt lgkmcnt(4)
    v_mfma_f32_32x32x16_bf16 v[18:33], v[90:93], v[14:17], v[66:81]
    v_exp_f32 v38, v38
    v_exp_f32 v39, v39
    v_exp_f32 v40, v40
    v_exp_f32 v41, v41
    ds_read_b128 v[94:97], v120 offset:19584
    v_cvt_pk_bf16_f32 v82, v34, v35
    v_cvt_pk_bf16_f32 v83, v36, v37
    v_cvt_pk_bf16_f32 v84, v38, v39
    v_cvt_pk_bf16_f32 v85, v40, v41
    v_exp_f32 v42, v42
    v_exp_f32 v43, v43
    s_waitcnt lgkmcnt(1)
    v_mfma_f32_32x32x16_bf16 v[50:65], v[106:109], v[82:85], v[50:65]
    v_exp_f32 v44, v44
    v_exp_f32 v45, v45
    v_exp_f32 v46, v46
    v_add_u32 v121, v121, v122
    ds_read_b64_tr_b16 v[98:99], v121 offset:0
    ds_read_b64_tr_b16 v[100:101], v121 offset:128
    v_exp_f32 v47, v47
    v_exp_f32 v48, v48
    v_exp_f32 v49, v49
    v_cvt_pk_bf16_f32 v86, v42, v43
    v_cvt_pk_bf16_f32 v87, v44, v45
    v_cvt_pk_bf16_f32 v88, v46, v47
    v_cvt_pk_bf16_f32 v89, v48, v49
    ds_read_b64_tr_b16 v[102:103], v121 offset:256
    ds_read_b64_tr_b16 v[104:105], v121 offset:384
    v_mfma_f32_32x32x16_bf16 v[50:65], v[110:113], v[86:89], v[50:65]
La2b_314:
    v_exp_f32 v18, v18
    v_exp_f32 v19, v19
    v_exp_f32 v20, v20
    v_exp_f32 v21, v21
    s_waitcnt lgkmcnt(4)
    v_mfma_f32_32x32x16_bf16 v[34:49], v[94:97], v[14:17], v[66:81]
    v_exp_f32 v22, v22
    v_exp_f32 v23, v23
    v_exp_f32 v24, v24
    v_exp_f32 v25, v25
    ds_read_b128 v[90:93], v120 offset:20736
    v_cvt_pk_bf16_f32 v82, v18, v19
    v_cvt_pk_bf16_f32 v83, v20, v21
    v_cvt_pk_bf16_f32 v84, v22, v23
    v_cvt_pk_bf16_f32 v85, v24, v25
    v_exp_f32 v26, v26
    v_exp_f32 v27, v27
    s_waitcnt lgkmcnt(1)
    v_mfma_f32_32x32x16_bf16 v[50:65], v[98:101], v[82:85], v[50:65]
    v_exp_f32 v28, v28
    v_exp_f32 v29, v29
    v_exp_f32 v30, v30
    v_add_u32 v121, v121, v122
    ds_read_b64_tr_b16 v[106:107], v121 offset:0
    ds_read_b64_tr_b16 v[108:109], v121 offset:128
    v_exp_f32 v31, v31
    v_exp_f32 v32, v32
    v_exp_f32 v33, v33
    v_cvt_pk_bf16_f32 v86, v26, v27
    v_cvt_pk_bf16_f32 v87, v28, v29
    v_cvt_pk_bf16_f32 v88, v30, v31
    v_cvt_pk_bf16_f32 v89, v32, v33
    ds_read_b64_tr_b16 v[110:111], v121 offset:256
    ds_read_b64_tr_b16 v[112:113], v121 offset:384
    v_mfma_f32_32x32x16_bf16 v[50:65], v[102:105], v[86:89], v[50:65]
La2b_315:
    v_exp_f32 v34, v34
    v_exp_f32 v35, v35
    v_exp_f32 v36, v36
    v_exp_f32 v37, v37
    s_waitcnt lgkmcnt(4)
    v_mfma_f32_32x32x16_bf16 v[18:33], v[90:93], v[14:17], v[66:81]
    v_exp_f32 v38, v38
    v_exp_f32 v39, v39
    v_exp_f32 v40, v40
    v_exp_f32 v41, v41
    ds_read_b128 v[94:97], v120 offset:21888
    v_cvt_pk_bf16_f32 v82, v34, v35
    v_cvt_pk_bf16_f32 v83, v36, v37
    v_cvt_pk_bf16_f32 v84, v38, v39
    v_cvt_pk_bf16_f32 v85, v40, v41
    v_exp_f32 v42, v42
    v_exp_f32 v43, v43
    s_waitcnt lgkmcnt(1)
    v_mfma_f32_32x32x16_bf16 v[50:65], v[106:109], v[82:85], v[50:65]
    v_exp_f32 v44, v44
    v_exp_f32 v45, v45
    v_exp_f32 v46, v46
    v_add_u32 v121, v121, v122
    ds_read_b64_tr_b16 v[98:99], v121 offset:0
    ds_read_b64_tr_b16 v[100:101], v121 offset:128
    v_exp_f32 v47, v47
    v_exp_f32 v48, v48
    v_exp_f32 v49, v49
    v_cvt_pk_bf16_f32 v86, v42, v43
    v_cvt_pk_bf16_f32 v87, v44, v45
    v_cvt_pk_bf16_f32 v88, v46, v47
    v_cvt_pk_bf16_f32 v89, v48, v49
    ds_read_b64_tr_b16 v[102:103], v121 offset:256
    ds_read_b64_tr_b16 v[104:105], v121 offset:384
    v_mfma_f32_32x32x16_bf16 v[50:65], v[110:113], v[86:89], v[50:65]
La2b_316:
    v_exp_f32 v18, v18
    v_exp_f32 v19, v19
    v_exp_f32 v20, v20
    v_exp_f32 v21, v21
    s_waitcnt lgkmcnt(4)
    v_mfma_f32_32x32x16_bf16 v[34:49], v[94:97], v[14:17], v[66:81]
    v_exp_f32 v22, v22
    v_exp_f32 v23, v23
    v_exp_f32 v24, v24
    v_exp_f32 v25, v25
    ds_read_b128 v[90:93], v120 offset:23040
    v_cvt_pk_bf16_f32 v82, v18, v19
    v_cvt_pk_bf16_f32 v83, v20, v21
    v_cvt_pk_bf16_f32 v84, v22, v23
    v_cvt_pk_bf16_f32 v85, v24, v25
    v_exp_f32 v26, v26
    v_exp_f32 v27, v27
    s_waitcnt lgkmcnt(1)
    v_mfma_f32_32x32x16_bf16 v[50:65], v[98:101], v[82:85], v[50:65]
    v_exp_f32 v28, v28
    v_exp_f32 v29, v29
    v_exp_f32 v30, v30
    v_add_u32 v121, v121, v122
    ds_read_b64_tr_b16 v[106:107], v121 offset:0
    ds_read_b64_tr_b16 v[108:109], v121 offset:128
    v_exp_f32 v31, v31
    v_exp_f32 v32, v32
    v_exp_f32 v33, v33
    v_cvt_pk_bf16_f32 v86, v26, v27
    v_cvt_pk_bf16_f32 v87, v28, v29
    v_cvt_pk_bf16_f32 v88, v30, v31
    v_cvt_pk_bf16_f32 v89, v32, v33
    ds_read_b64_tr_b16 v[110:111], v121 offset:256
    ds_read_b64_tr_b16 v[112:113], v121 offset:384
    v_mfma_f32_32x32x16_bf16 v[50:65], v[102:105], v[86:89], v[50:65]
La2b_317:
    v_exp_f32 v34, v34
    v_exp_f32 v35, v35
    v_exp_f32 v36, v36
    v_exp_f32 v37, v37
    s_waitcnt lgkmcnt(4)
    v_mfma_f32_32x32x16_bf16 v[18:33], v[90:93], v[14:17], v[66:81]
    v_exp_f32 v38, v38
    v_exp_f32 v39, v39
    v_exp_f32 v40, v40
    v_exp_f32 v41, v41
    v_cvt_pk_bf16_f32 v82, v34, v35
    v_cvt_pk_bf16_f32 v83, v36, v37
    v_cvt_pk_bf16_f32 v84, v38, v39
    v_cvt_pk_bf16_f32 v85, v40, v41
    v_exp_f32 v42, v42
    v_exp_f32 v43, v43
    s_waitcnt lgkmcnt(0)
    v_mfma_f32_32x32x16_bf16 v[50:65], v[106:109], v[82:85], v[50:65]
    v_exp_f32 v44, v44
    v_exp_f32 v45, v45
    v_exp_f32 v46, v46
    v_add_u32 v121, v121, v122
    ds_read_b64_tr_b16 v[98:99], v121 offset:0
    ds_read_b64_tr_b16 v[100:101], v121 offset:128
    v_exp_f32 v47, v47
    v_exp_f32 v48, v48
    v_exp_f32 v49, v49
    v_cvt_pk_bf16_f32 v86, v42, v43
    v_cvt_pk_bf16_f32 v87, v44, v45
    v_cvt_pk_bf16_f32 v88, v46, v47
    v_cvt_pk_bf16_f32 v89, v48, v49
    ds_read_b64_tr_b16 v[102:103], v121 offset:256
    ds_read_b64_tr_b16 v[104:105], v121 offset:384
    v_mfma_f32_32x32x16_bf16 v[50:65], v[110:113], v[86:89], v[50:65]
La2b_318:
    v_exp_f32 v18, v18
    v_exp_f32 v19, v19
    v_exp_f32 v20, v20
    v_exp_f32 v21, v21
    v_exp_f32 v22, v22
    v_exp_f32 v23, v23
    v_exp_f32 v24, v24
    v_exp_f32 v25, v25
    v_cvt_pk_bf16_f32 v82, v18, v19
    v_cvt_pk_bf16_f32 v83, v20, v21
    v_cvt_pk_bf16_f32 v84, v22, v23
    v_cvt_pk_bf16_f32 v85, v24, v25
    v_and_b32 v82, v126, v82
    v_and_b32 v83, v127, v83
    v_and_b32 v84, v128, v84
    v_and_b32 v85, v129, v85
    v_exp_f32 v26, v26
    v_exp_f32 v27, v27
    s_waitcnt lgkmcnt(0)
    v_mfma_f32_32x32x16_bf16 v[50:65], v[98:101], v[82:85], v[50:65]
    v_exp_f32 v28, v28
    v_exp_f32 v29, v29
    v_exp_f32 v30, v30
    v_exp_f32 v31, v31
    v_exp_f32 v32, v32
    v_exp_f32 v33, v33
    v_cvt_pk_bf16_f32 v86, v26, v27
    v_cvt_pk_bf16_f32 v87, v28, v29
    v_cvt_pk_bf16_f32 v88, v30, v31
    v_cvt_pk_bf16_f32 v89, v32, v33
    v_and_b32 v86, v130, v86
    v_and_b32 v87, v131, v87
    v_and_b32 v88, v132, v88
    v_and_b32 v89, v133, v89
    s_nop 1
    v_mfma_f32_32x32x16_bf16 v[50:65], v[102:105], v[86:89], v[50:65]
    s_waitcnt lgkmcnt(0)
    s_nop 10
    v_cmp_ngt_f32 vcc, 0x4e800000, v58
    s_cbranch_vccnz Lredo_319
Lredone_320:
    v_rcp_f32 v116, v58
    s_nop 0
    v_mov_b32 v117, v116
    v_pk_mul_f32 v[50:51], v[50:51], v[116:117]
    v_pk_mul_f32 v[52:53], v[52:53], v[116:117]
    v_pk_mul_f32 v[54:55], v[54:55], v[116:117]
    v_pk_mul_f32 v[56:57], v[56:57], v[116:117]
    v_cvt_pk_bf16_f32 v82, v50, v51
    v_cvt_pk_bf16_f32 v83, v52, v53
    v_cvt_pk_bf16_f32 v84, v54, v55
    v_cvt_pk_bf16_f32 v85, v56, v57
    s_lshl_b32 s89, s77, 2
    s_add_u32 s89, s89, s76
    s_lshl_b32 s89, s89, 15
    s_lshl_b32 s92, s78, 11
    s_add_u32 s89, s89, s92
    s_add_u32 s89, s89, 0xa00000
    s_cmp_eq_u32 s93, 0
    s_cbranch_scc1 Lfar_357
    buffer_store_dwordx4 v[82:85], v124, s[40:43], s89 offen offset:1024
    s_branch Lstored_358
Lfar_357:
    buffer_store_dwordx4 v[82:85], v124, s[40:43], s89 offen offset:1024 sc1
Lstored_358:
    v_lshlrev_b32 v122, 4, v0
    s_lshl_b32 s86, s79, 1
    s_add_u32 s86, s86, s101
    s_lshl_b32 s86, s86, 15
    s_lshl_b32 s89, s100, 14
    s_add_u32 s86, s86, s89
    s_add_u32 s86, s86, 0xa00000
    s_add_u32 s89, s86, 0x0
    buffer_load_dwordx4 v[42:45], v122, s[40:43], s89 offen offset:0 sc1
    buffer_load_dwordx4 v[46:49], v122, s[40:43], s89 offen offset:2048 sc1
    s_add_u32 s89, s86, 0x1000
    buffer_load_dwordx4 v[50:53], v122, s[40:43], s89 offen offset:0 sc1
    buffer_load_dwordx4 v[54:57], v122, s[40:43], s89 offen offset:2048 sc1
    s_add_u32 s89, s86, 0x2000
    buffer_load_dwordx4 v[58:61], v122, s[40:43], s89 offen offset:0 sc1
    buffer_load_dwordx4 v[62:65], v122, s[40:43], s89 offen offset:2048 sc1
    s_add_u32 s89, s86, 0x3000
    buffer_load_dwordx4 v[66:69], v122, s[40:43], s89 offen offset:0 sc1
    buffer_load_dwordx4 v[70:73], v122, s[40:43], s89 offen offset:2048 sc1
    s_add_u32 s89, s86, 0x0
    buffer_load_dwordx4 v[74:77], v122, s[40:43], s89 offen offset:1024 sc1
    buffer_load_dwordx4 v[78:81], v122, s[40:43], s89 offen offset:3072 sc1
    s_add_u32 s89, s86, 0x1000
    buffer_load_dwordx4 v[82:85], v122, s[40:43], s89 offen offset:1024 sc1
    buffer_load_dwordx4 v[86:89], v122, s[40:43], s89 offen offset:3072 sc1
    s_add_u32 s89, s86, 0x2000
    buffer_load_dwordx4 v[90:93], v122, s[40:43], s89 offen offset:1024 sc1
    buffer_load_dwordx4 v[94:97], v122, s[40:43], s89 offen offset:3072 sc1
    s_add_u32 s89, s86, 0x3000
    buffer_load_dwordx4 v[98:101], v122, s[40:43], s89 offen offset:1024 sc1
    buffer_load_dwordx4 v[102:105], v122, s[40:43], s89 offen offset:3072 sc1
    v_lshrrev_b32 v123, 5, v0
    v_lshlrev_b32 v123, 3, v123
    v_bfe_u32 v125, v0, 2, 2
    v_add_u32 v123, v123, v125
    v_lshlrev_b32 v123, 7, v123
    v_bfe_u32 v125, v0, 3, 1
    v_xor_b32 v125, s100, v125
    v_lshlrev_b32 v125, 6, v125
    v_add_u32 v123, v123, v125
    v_bfe_u32 v125, v0, 4, 1
    v_lshlrev_b32 v125, 5, v125
    v_add_u32 v123, v123, v125
    v_and_b32 v125, 3, v0
    v_lshlrev_b32 v125, 3, v125
    v_add_u32 v123, v123, v125
    s_lshl_b32 s89, s100, 15
    s_add_u32 s89, s89, 0xe000
    v_add_u32 v123, s89, v123
    v_xor_b32 v124, 64, v123
    s_waitcnt vmcnt(18)
    s_waitcnt lgkmcnt(0)
    s_barrier
    v_lshlrev_b32 v10, 16, v2
    v_and_b32 v11, 0xffff0000, v2
    v_lshlrev_b32 v12, 16, v3
    v_and_b32 v13, 0xffff0000, v3
    v_lshlrev_b32 v14, 16, v4
    v_and_b32 v15, 0xffff0000, v4
    v_lshlrev_b32 v16, 16, v5
    v_and_b32 v17, 0xffff0000, v5
    v_lshlrev_b32 v18, 16, v6
    v_and_b32 v19, 0xffff0000, v6
    v_lshlrev_b32 v20, 16, v7
    v_and_b32 v21, 0xffff0000, v7
    v_lshlrev_b32 v22, 16, v8
    v_and_b32 v23, 0xffff0000, v8
    v_lshlrev_b32 v24, 16, v9
    v_and_b32 v25, 0xffff0000, v9
    ds_read_b64_tr_b16 v[106:107], v123 offset:0
    ds_read_b64_tr_b16 v[108:109], v123 offset:512
    ds_read_b64_tr_b16 v[110:111], v124 offset:0
    ds_read_b64_tr_b16 v[112:113], v124 offset:512
    s_waitcnt vmcnt(12)
    v_max3_u32 v125, v45, v49, v53
    v_max_u32 v125, v125, v57
    v_cmp_eq_u32 vcc, -1, v125
    s_cbranch_vccnz Lrt_p3_359
Lbk_p3_360:
    s_waitcnt lgkmcnt(2)
    v_mfma_f32_32x32x16_bf16 v[10:25], v[106:109], v[42:45], v[10:25]
    ds_read_b64_tr_b16 v[114:115], v123 offset:4096
    ds_read_b64_tr_b16 v[116:117], v123 offset:4608
    s_waitcnt lgkmcnt(2)
    v_mfma_f32_32x32x16_bf16 v[26:41], v[110:113], v[42:45], 0
    ds_read_b64_tr_b16 v[118:119], v124 offset:4096
    ds_read_b64_tr_b16 v[120:121], v124 offset:4608
    s_waitcnt vmcnt(8)
    v_max3_u32 v125, v61, v65, v69
    v_max_u32 v125, v125, v73
    v_cmp_eq_u32 vcc, -1, v125
    s_cbranch_vccnz Lrt_p3_361
Lbk_p3_362:
    s_waitcnt lgkmcnt(2)
    v_mfma_f32_32x32x16_bf16 v[10:25], v[114:117], v[46:49], v[10:25]
    ds_read_b64_tr_b16 v[106:107], v123 offset:8192
    ds_read_b64_tr_b16 v[108:109], v123 offset:8704
    s_waitcnt lgkmcnt(2)
    v_mfma_f32_32x32x16_bf16 v[26:41], v[118:121], v[46:49], v[26:41]
    ds_read_b64_tr_b16 v[110:111], v124 offset:8192
    ds_read_b64_tr_b16 v[112:113], v124 offset:8704
    s_waitcnt lgkmcnt(2)
    v_mfma_f32_32x32x16_bf16 v[10:25], v[106:109], v[50:53], v[10:25]
    ds_read_b64_tr_b16 v[114:115], v123 offset:12288
    ds_read_b64_tr_b16 v[116:117], v123 offset:12800
    s_waitcnt lgkmcnt(2)
    v_mfma_f32_32x32x16_bf16 v[26:41], v[110:113], v[50:53], v[26:41]
    ds_read_b64_tr_b16 v[118:119], v124 offset:12288
    ds_read_b64_tr_b16 v[120:121], v124 offset:12800
    s_waitcnt lgkmcnt(2)
    v_mfma_f32_32x32x16_bf16 v[10:25], v[114:117], v[54:57], v[10:25]
    ds_read_b64_tr_b16 v[106:107], v123 offset:16384
    ds_read_b64_tr_b16 v[108:109], v123 offset:16896
    s_waitcnt lgkmcnt(2)
    v_mfma_f32_32x32x16_bf16 v[26:41], v[118:121], v[54:57], v[26:41]
    ds_read_b64_tr_b16 v[110:111], v124 offset:16384
    ds_read_b64_tr_b16 v[112:113], v124 offset:16896
    s_waitcnt lgkmcnt(2)
    v_mfma_f32_32x32x16_bf16 v[10:25], v[106:109], v[58:61], v[10:25]
    ds_read_b64_tr_b16 v[114:115], v123 offset:20480
    ds_read_b64_tr_b16 v[116:117], v123 offset:20992
    s_waitcnt lgkmcnt(2)
    v_mfma_f32_32x32x16_bf16 v[26:41], v[110:113], v[58:61], v[26:41]
    ds_read_b64_tr_b16 v[118:119], v124 offset:20480
    ds_read_b64_tr_b16 v[120:121], v124 offset:20992
    s_waitcnt vmcnt(4)
    v_max3_u32 v125, v77, v81, v85
    v_max_u32 v125, v125, v89
    v_cmp_eq_u32 vcc, -1, v125
    s_cbranch_vccnz Lrt_p3_363
Lbk_p3_364:
    s_waitcnt lgkmcnt(2)
    v_mfma_f32_32x32x16_bf16 v[10:25], v[114:117], v[62:65], v[10:25]
    ds_read_b64_tr_b16 v[106:107], v123 offset:24576
    ds_read_b64_tr_b16 v[108:109], v123 offset:25088
    s_waitcnt lgkmcnt(2)
    v_mfma_f32_32x32x16_bf16 v[26:41], v[118:121], v[62:65], v[26:41]
    ds_read_b64_tr_b16 v[110:111], v124 offset:24576
    ds_read_b64_tr_b16 v[112:113], v124 offset:25088
    s_waitcnt lgkmcnt(2)
    v_mfma_f32_32x32x16_bf16 v[10:25], v[106:109], v[66:69], v[10:25]
    ds_read_b64_tr_b16 v[114:115], v123 offset:28672
    ds_read_b64_tr_b16 v[116:117], v123 offset:29184
    s_waitcnt lgkmcnt(2)
    v_mfma_f32_32x32x16_bf16 v[26:41], v[110:113], v[66:69], v[26:41]
    ds_read_b64_tr_b16 v[118:119], v124 offset:28672
    ds_read_b64_tr_b16 v[120:121], v124 offset:29184
    s_waitcnt lgkmcnt(2)
    v_mfma_f32_32x32x16_bf16 v[10:25], v[114:117], v[70:73], v[10:25]
    ds_read_b64_tr_b16 v[106:107], v123 offset:2048
    ds_read_b64_tr_b16 v[108:109], v123 offset:2560
    s_waitcnt lgkmcnt(2)
    v_mfma_f32_32x32x16_bf16 v[26:41], v[118:121], v[70:73], v[26:41]
    ds_read_b64_tr_b16 v[110:111], v124 offset:2048
    ds_read_b64_tr_b16 v[112:113], v124 offset:2560
    s_waitcnt lgkmcnt(2)
    v_mfma_f32_32x32x16_bf16 v[10:25], v[106:109], v[74:77], v[10:25]
    ds_read_b64_tr_b16 v[114:115], v123 offset:6144
    ds_read_b64_tr_b16 v[116:117], v123 offset:6656
    s_waitcnt lgkmcnt(2)
    v_mfma_f32_32x32x16_bf16 v[26:41], v[110:113], v[74:77], v[26:41]
    ds_read_b64_tr_b16 v[118:119], v124 offset:6144
    ds_read_b64_tr_b16 v[120:121], v124 offset:6656
    s_waitcnt vmcnt(0)
    v_max3_u32 v125, v93, v97, v101
    v_max_u32 v125, v125, v105
    v_cmp_eq_u32 vcc, -1, v125
    s_cbranch_vccnz Lrt_p3_365
Lbk_p3_366:
    s_waitcnt lgkmcnt(2)
    v_mfma_f32_32x32x16_bf16 v[10:25], v[114:117], v[78:81], v[10:25]
    ds_read_b64_tr_b16 v[106:107], v123 offset:10240
    ds_read_b64_tr_b16 v[108:109], v123 offset:10752
    s_waitcnt lgkmcnt(2)
    v_mfma_f32_32x32x16_bf16 v[26:41], v[118:121], v[78:81], v[26:41]
    ds_read_b64_tr_b16 v[110:111], v124 offset:10240
    ds_read_b64_tr_b16 v[112:113], v124 offset:10752
    s_waitcnt lgkmcnt(2)
    v_mfma_f32_32x32x16_bf16 v[10:25], v[106:109], v[82:85], v[10:25]
    ds_read_b64_tr_b16 v[114:115], v123 offset:14336
    ds_read_b64_tr_b16 v[116:117], v123 offset:14848
    s_waitcnt lgkmcnt(2)
    v_mfma_f32_32x32x16_bf16 v[26:41], v[110:113], v[82:85], v[26:41]
    ds_read_b64_tr_b16 v[118:119], v124 offset:14336
    ds_read_b64_tr_b16 v[120:121], v124 offset:14848
    s_waitcnt lgkmcnt(2)
    v_mfma_f32_32x32x16_bf16 v[10:25], v[114:117], v[86:89], v[10:25]
    ds_read_b64_tr_b16 v[106:107], v123 offset:18432
    ds_read_b64_tr_b16 v[108:109], v123 offset:18944
    s_waitcnt lgkmcnt(2)
    v_mfma_f32_32x32x16_bf16 v[26:41], v[118:121], v[86:89], v[26:41]
    ds_read_b64_tr_b16 v[110:111], v124 offset:18432
    ds_read_b64_tr_b16 v[112:113], v124 offset:18944
    s_waitcnt lgkmcnt(2)
    v_mfma_f32_32x32x16_bf16 v[10:25], v[106:109], v[90:93], v[10:25]
    ds_read_b64_tr_b16 v[114:115], v123 offset:22528
    ds_read_b64_tr_b16 v[116:117], v123 offset:23040
    s_waitcnt lgkmcnt(2)
    v_mfma_f32_32x32x16_bf16 v[26:41], v[110:113], v[90:93], v[26:41]
    ds_read_b64_tr_b16 v[118:119], v124 offset:22528
    ds_read_b64_tr_b16 v[120:121], v124 offset:23040
    s_waitcnt lgkmcnt(2)
    v_mfma_f32_32x32x16_bf16 v[10:25], v[114:117], v[94:97], v[10:25]
    ds_read_b64_tr_b16 v[106:107], v123 offset:26624
    ds_read_b64_tr_b16 v[108:109], v123 offset:27136
    s_waitcnt lgkmcnt(2)
    v_mfma_f32_32x32x16_bf16 v[26:41], v[118:121], v[94:97], v[26:41]
    ds_read_b64_tr_b16 v[110:111], v124 offset:26624
    ds_read_b64_tr_b16 v[112:113], v124 offset:27136
    s_waitcnt lgkmcnt(2)
    v_mfma_f32_32x32x16_bf16 v[10:25], v[106:109], v[98:101], v[10:25]
    ds_read_b64_tr_b16 v[114:115], v123 offset:30720
    ds_read_b64_tr_b16 v[116:117], v123 offset:31232
    s_waitcnt lgkmcnt(2)
    v_mfma_f32_32x32x16_bf16 v[26:41], v[110:113], v[98:101], v[26:41]
    ds_read_b64_tr_b16 v[118:119], v124 offset:30720
    ds_read_b64_tr_b16 v[120:121], v124 offset:31232
    s_waitcnt lgkmcnt(2)
    v_mfma_f32_32x32x16_bf16 v[10:25], v[114:117], v[102:105], v[10:25]
    s_waitcnt lgkmcnt(0)
    v_mfma_f32_32x32x16_bf16 v[26:41], v[118:121], v[102:105], v[26:41]
    s_xor_b32 s89, s76, 2
    s_lshl_b32 s89, s89, 12
    s_add_u32 s89, s89, 0x0
    v_add_u32 v125, s89, v122
    s_nop 7
    ds_write_b128 v125, v[26:29] offset:0
    ds_write_b128 v125, v[30:33] offset:1024
    ds_write_b128 v125, v[34:37] offset:2048
    ds_write_b128 v125, v[38:41] offset:3072
    s_lshl_b32 s89, s76, 12
    s_add_u32 s89, s89, 0x0
    v_add_u32 v125, s89, v122
    s_waitcnt lgkmcnt(0)
    s_barrier
    ds_read_b128 v[26:29], v125 offset:0
    ds_read_b128 v[30:33], v125 offset:1024
    ds_read_b128 v[34:37], v125 offset:2048
    ds_read_b128 v[38:41], v125 offset:3072
    v_and_b32 v62, 31, v0
    v_lshlrev_b32 v62, 3, v62
    v_lshrrev_b32 v126, 5, v0
    v_lshlrev_b32 v126, 9, v126
    v_add_u32 v63, v62, v126
    s_lshl_b32 s90, s79, 3
    s_add_u32 s90, s90, s80
    s_lshl_b32 s90, s90, 1
    s_add_u32 s90, s90, s100
    s_lshl_b32 s90, s90, 9
    s_lshl_b32 s92, s101, 8
    s_add_u32 s90, s90, s92
    s_add_u32 s90, s90, 0x1640000
    s_lshl_b32 s86, s79, 13
    s_lshl_b32 s89, s101, 8
    s_add_u32 s86, s86, s89
    s_add_u32 s86, s86, 0x1640000
    s_waitcnt lgkmcnt(0)
    v_pk_add_f32 v[10:11], v[10:11], v[26:27]
    v_pk_add_f32 v[12:13], v[12:13], v[28:29]
    v_pk_add_f32 v[14:15], v[14:15], v[30:31]
    v_pk_add_f32 v[16:17], v[16:17], v[32:33]
    v_pk_add_f32 v[18:19], v[18:19], v[34:35]
    v_pk_add_f32 v[20:21], v[20:21], v[36:37]
    v_pk_add_f32 v[22:23], v[22:23], v[38:39]
    v_pk_add_f32 v[24:25], v[24:25], v[40:41]
    v_cvt_pk_bf16_f32 v2, v10, v11
    v_cvt_pk_bf16_f32 v3, v12, v13
    v_cvt_pk_bf16_f32 v4, v14, v15
    v_cvt_pk_bf16_f32 v5, v16, v17
    v_cvt_pk_bf16_f32 v6, v18, v19
    v_cvt_pk_bf16_f32 v7, v20, v21
    v_cvt_pk_bf16_f32 v8, v22, v23
    v_cvt_pk_bf16_f32 v9, v24, v25
    v_add_f32 v58, v10, v11
    v_mul_f32 v59, v10, v10
    v_fmac_f32 v59, v11, v11
    v_add_f32 v58, v58, v12
    v_fmac_f32 v59, v12, v12
    v_add_f32 v58, v58, v13
    v_fmac_f32 v59, v13, v13
    v_add_f32 v58, v58, v14
    v_fmac_f32 v59, v14, v14
    v_add_f32 v58, v58, v15
    v_fmac_f32 v59, v15, v15
    v_add_f32 v58, v58, v16
    v_fmac_f32 v59, v16, v16
    v_add_f32 v58, v58, v17
    v_fmac_f32 v59, v17, v17
    v_add_f32 v58, v58, v18
    v_fmac_f32 v59, v18, v18
    v_add_f32 v58, v58, v19
    v_fmac_f32 v59, v19, v19
    v_add_f32 v58, v58, v20
    v_fmac_f32 v59, v20, v20
    v_add_f32 v58, v58, v21
    v_fmac_f32 v59, v21, v21
    v_add_f32 v58, v58, v22
    v_fmac_f32 v59, v22, v22
    v_add_f32 v58, v58, v23
    v_fmac_f32 v59, v23, v23
    v_add_f32 v58, v58, v24
    v_fmac_f32 v59, v24, v24
    v_add_f32 v58, v58, v25
    v_fmac_f32 v59, v25, v25
    v_mov_b32 v125, v58
    s_nop 1
    v_permlane32_swap_b32 v58, v125
    v_add_f32 v58, v58, v125
    v_mov_b32 v125, v59
    s_nop 1
    v_permlane32_swap_b32 v59, v125
    v_add_f32 v59, v59, v125
    s_cmp_eq_u32 s93, 0
    s_cbranch_scc1 Lfar_367
    buffer_store_dwordx2 v[58:59], v62, s[40:43], s90 offen offset:0
    s_branch Lstored_368
Lfar_367:
    buffer_store_dwordx2 v[58:59], v62, s[40:43], s90 offen offset:0 sc1
Lstored_368:
    s_add_u32 s89, s86, 0x0
    buffer_load_dwordx2 v[66:67], v63, s[40:43], s89 offen offset:0 sc1
    s_add_u32 s89, s86, 0x400
    buffer_load_dwordx2 v[68:69], v63, s[40:43], s89 offen offset:0 sc1
    s_add_u32 s89, s86, 0x800
    buffer_load_dwordx2 v[70:71], v63, s[40:43], s89 offen offset:0 sc1
    s_add_u32 s89, s86, 0xc00
    buffer_load_dwordx2 v[72:73], v63, s[40:43], s89 offen offset:0 sc1
    s_add_u32 s89, s86, 0x1000
    buffer_load_dwordx2 v[74:75], v63, s[40:43], s89 offen offset:0 sc1
    s_add_u32 s89, s86, 0x1400
    buffer_load_dwordx2 v[76:77], v63, s[40:43], s89 offen offset:0 sc1
    s_add_u32 s89, s86, 0x1800
    buffer_load_dwordx2 v[78:79], v63, s[40:43], s89 offen offset:0 sc1
    s_add_u32 s89, s86, 0x1c00
    buffer_load_dwordx2 v[80:81], v63, s[40:43], s89 offen offset:0 sc1
    v_and_b32 v84, 31, v0
    s_lshl_b32 s89, s101, 5
    v_add_u32 v84, s89, v84
    v_mul_u32_u24 v84, 136, v84
    v_lshrrev_b32 v126, 5, v0
    v_lshlrev_b32 v126, 3, v126
    v_add_u32 v84, v84, v126
    s_lshl_b32 s89, s100, 6
    s_add_u32 s89, s89, 0x4000
    v_add_u32 v84, s89, v84
    v_lshrrev_b32 v85, 4, v0
    v_lshlrev_b32 v85, 3, v85
    v_bfe_u32 v126, v0, 2, 2
    v_add_u32 v85, v85, v126
    s_lshl_b32 s89, s100, 5
    v_add_u32 v85, s89, v85
    v_mul_u32_u24 v85, 136, v85
    v_and_b32 v126, 3, v0
    v_lshlrev_b32 v126, 3, v126
    v_add_u32 v85, v85, v126
    s_lshl_b32 s89, s101, 6
    s_add_u32 s89, s89, 0x4000
    v_add_u32 v85, s89, v85
    s_lshl_b32 s87, s80, 6
    s_lshl_b32 s92, s79, 1
    s_add_u32 s87, s87, s92
    s_add_u32 s87, s87, s100
    s_lshl_b32 s87, s87, 12
    s_lshl_b32 s92, s101, 11
    s_add_u32 s87, s87, s92
    s_add_u32 s87, s87, 0xe00000
    s_waitcnt vmcnt(0)
    v_max3_u32 v125, v67, v69, v71
    v_max3_u32 v125, v125, v73, v75
    v_max3_u32 v125, v125, v77, v79
    v_max_u32 v125, v125, v81
    v_cmp_eq_u32 vcc, -1, v125
    s_cbranch_vccnz Lrt_st_369
Lbk_st_370:
    v_add_f32 v66, v66, v68
    v_add_f32 v67, v67, v69
    v_add_f32 v66, v66, v70
    v_add_f32 v67, v67, v71
    v_add_f32 v66, v66, v72
    v_add_f32 v67, v67, v73
    v_add_f32 v66, v66, v74
    v_add_f32 v67, v67, v75
    v_add_f32 v66, v66, v76
    v_add_f32 v67, v67, v77
    v_add_f32 v66, v66, v78
    v_add_f32 v67, v67, v79
    v_add_f32 v66, v66, v80
    v_add_f32 v67, v67, v81
    v_mov_b32 v125, v66
    s_nop 1
    v_permlane32_swap_b32 v66, v125
    v_add_f32 v66, v66, v125
    v_mov_b32 v125, v67
    s_nop 1
    v_permlane32_swap_b32 v67, v125
    v_add_f32 v67, v67, v125
    v_mul_f32 v68, 0x3b000000, v66
    v_mul_f32 v69, 0x3b000000, v67
    v_fma_f32 v69, -v68, v68, v69
    v_max_f32 v69, 0, v69
    v_add_f32 v70, 0x3727c5ac, v69
    v_rsq_f32 v70, v70
    s_nop 0
    v_mul_f32 v71, v70, v70
    v_mul_f32 v71, v71, v69
    v_add_f32 v71, 0x3727c5ac, v71
    v_rsq_f32 v71, v71
    s_nop 0
    v_mul_f32 v70, v70, v71
    v_mul_f32 v68, v68, v70
    v_fma_f32 v10, v10, v70, -v68
    v_fma_f32 v11, v11, v70, -v68
    v_fma_f32 v12, v12, v70, -v68
    v_fma_f32 v13, v13, v70, -v68
    v_fma_f32 v14, v14, v70, -v68
    v_fma_f32 v15, v15, v70, -v68
    v_fma_f32 v16, v16, v70, -v68
    v_fma_f32 v17, v17, v70, -v68
    v_fma_f32 v18, v18, v70, -v68
    v_fma_f32 v19, v19, v70, -v68
    v_fma_f32 v20, v20, v70, -v68
    v_fma_f32 v21, v21, v70, -v68
    v_fma_f32 v22, v22, v70, -v68
    v_fma_f32 v23, v23, v70, -v68
    v_fma_f32 v24, v24, v70, -v68
    v_fma_f32 v25, v25, v70, -v68
    v_cvt_pk_bf16_f32 v26, v10, v11
    v_cvt_pk_bf16_f32 v27, v12, v13
    v_cvt_pk_bf16_f32 v28, v14, v15
    v_cvt_pk_bf16_f32 v29, v16, v17
    v_cvt_pk_bf16_f32 v30, v18, v19
    v_cvt_pk_bf16_f32 v31, v20, v21
    v_cvt_pk_bf16_f32 v32, v22, v23
    v_cvt_pk_bf16_f32 v33, v24, v25
    ds_write_b64 v84, v[26:27] offset:0
    ds_write_b64 v84, v[28:29] offset:16
    ds_write_b64 v84, v[30:31] offset:32
    ds_write_b64 v84, v[32:33] offset:48
    s_waitcnt lgkmcnt(0)
    s_barrier
    ds_read_b64_tr_b16 v[42:43], v85 offset:0
    ds_read_b64_tr_b16 v[44:45], v85 offset:544
    ds_read_b64_tr_b16 v[46:47], v85 offset:32
    ds_read_b64_tr_b16 v[48:49], v85 offset:576
    s_waitcnt lgkmcnt(0)
    buffer_store_dwordx4 v[42:45], v122, s[40:43], s87 offen offset:0 sc1
    buffer_store_dwordx4 v[46:49], v122, s[40:43], s87 offen offset:1024 sc1
    s_xor_b32 s89, s76, 0
    s_lshl_b32 s89, s89, 10
    v_lshlrev_b32 v122, 4, v0
    v_add_u32 v122, s89, v122
    s_xor_b32 s89, s76, 1
    s_lshl_b32 s89, s89, 10
    v_lshlrev_b32 v123, 4, v0
    v_add_u32 v123, s89, v123
    s_xor_b32 s89, s76, 2
    s_lshl_b32 s89, s89, 10
    v_lshlrev_b32 v124, 4, v0
    v_add_u32 v124, s89, v124
    s_xor_b32 s89, s76, 3
    s_lshl_b32 s89, s89, 10
    v_lshlrev_b32 v125, 4, v0
    v_add_u32 v125, s89, v125
    s_lshl_b32 s86, s81, 6
    s_lshl_b32 s89, s76, 4
    s_add_u32 s86, s86, s89
    s_lshl_b32 s86, s86, 12
    s_add_u32 s86, s86, 0xe00000
    v_lshrrev_b32 v126, 4, v0
    v_lshlrev_b32 v126, 3, v126
    s_mul_i32 s89, s82, 96
    buffer_load_dwordx2 v[128:129], v126, s[20:23], s89 offen offset:0
    buffer_load_dwordx2 v[130:131], v126, s[20:23], s89 offen offset:32
    buffer_load_dwordx2 v[132:133], v126, s[20:23], s89 offen offset:64
    v_lshlrev_b32 v127, 4, v0
    s_xor_b32 s89, s76, 1
    s_mul_i32 s89, s89, 3
    s_add_u32 s89, s89, 0
    s_mul_i32 s89, s89, 3072
    s_add_u32 s89, s89, 0xf000
    v_add_u32 v134, s89, v127
    s_xor_b32 s89, s76, 2
    s_mul_i32 s89, s89, 3
    s_add_u32 s89, s89, 1
    s_mul_i32 s89, s89, 3072
    s_add_u32 s89, s89, 0xf000
    v_add_u32 v135, s89, v127
    s_xor_b32 s89, s76, 3
    s_mul_i32 s89, s89, 3
    s_add_u32 s89, s89, 2
    s_mul_i32 s89, s89, 3072
    s_add_u32 s89, s89, 0xf000
    v_add_u32 v136, s89, v127
    s_mul_i32 s89, s76, 9216
    s_add_u32 s89, s89, 0xf000
    v_add_u32 v137, s89, v127
    v_lshrrev_b32 v141, 5, v0
    v_lshlrev_b32 v141, 9, v141
    v_and_b32 v127, 15, v0
    v_lshlrev_b32 v127, 4, v127
    v_add_u32 v141, v141, v127
    v_bfe_u32 v127, v0, 4, 1
    v_lshlrev_b32 v127, 3, v127
    v_add_u32 v141, v141, v127
    s_lshl_b32 s89, s101, 8
    v_add_u32 v141, s89, v141
    s_waitcnt vmcnt(0)
    v_lshlrev_b32 v10, 16, v128
    v_and_b32 v11, 0xffff0000, v128
    v_lshlrev_b32 v12, 16, v129
    v_and_b32 v13, 0xffff0000, v129
    v_lshlrev_b32 v26, 16, v130
    v_and_b32 v27, 0xffff0000, v130
    v_lshlrev_b32 v28, 16, v131
    v_and_b32 v29, 0xffff0000, v131
    v_lshlrev_b32 v42, 16, v132
    v_and_b32 v43, 0xffff0000, v132
    v_lshlrev_b32 v44, 16, v133
    v_and_b32 v45, 0xffff0000, v133
    s_waitcnt lgkmcnt(0)
    s_barrier
    s_add_u32 s89, s86, 0x0
    buffer_load_dwordx4 v[58:61], v122, s[40:43], s89 offen offset:0 sc1
    buffer_load_dwordx4 v[62:65], v123, s[40:43], s89 offen offset:0 sc1
    buffer_load_dwordx4 v[66:69], v124, s[40:43], s89 offen offset:0 sc1
    buffer_load_dwordx4 v[70:73], v125, s[40:43], s89 offen offset:0 sc1
    s_add_u32 s89, s86, 0x1000
    buffer_load_dwordx4 v[74:77], v122, s[40:43], s89 offen offset:0 sc1
    buffer_load_dwordx4 v[78:81], v123, s[40:43], s89 offen offset:0 sc1
    buffer_load_dwordx4 v[82:85], v124, s[40:43], s89 offen offset:0 sc1
    buffer_load_dwordx4 v[86:89], v125, s[40:43], s89 offen offset:0 sc1
    s_add_u32 s89, s86, 0x2000
    buffer_load_dwordx4 v[90:93], v122, s[40:43], s89 offen offset:0 sc1
    buffer_load_dwordx4 v[94:97], v123, s[40:43], s89 offen offset:0 sc1
    buffer_load_dwordx4 v[98:101], v124, s[40:43], s89 offen offset:0 sc1
    buffer_load_dwordx4 v[102:105], v125, s[40:43], s89 offen offset:0 sc1
    s_add_u32 s89, s86, 0x3000
    buffer_load_dwordx4 v[106:109], v122, s[40:43], s89 offen offset:0 sc1
    buffer_load_dwordx4 v[110:113], v123, s[40:43], s89 offen offset:0 sc1
    buffer_load_dwordx4 v[114:117], v124, s[40:43], s89 offen offset:0 sc1
    buffer_load_dwordx4 v[118:121], v125, s[40:43], s89 offen offset:0 sc1
    s_waitcnt vmcnt(12)
    v_max3_u32 v126, v61, v65, v69
    v_max_u32 v126, v126, v73
    v_cmp_eq_u32 vcc, -1, v126
    s_cbranch_vccnz Lrt_p4_371
Lbk_p4_372:
    v_mfma_f32_16x16x32_bf16 v[10:13], a[0:3], v[58:61], v[10:13]
    v_mfma_f32_16x16x32_bf16 v[14:17], a[0:3], v[62:65], 0
    s_waitcnt vmcnt(8)
    v_max3_u32 v126, v77, v81, v85
    v_max_u32 v126, v126, v89
    v_cmp_eq_u32 vcc, -1, v126
    s_cbranch_vccnz Lrt_p4_373
Lbk_p4_374:
    v_mfma_f32_16x16x32_bf16 v[18:21], a[0:3], v[66:69], 0
    v_mfma_f32_16x16x32_bf16 v[22:25], a[0:3], v[70:73], 0
    v_mfma_f32_16x16x32_bf16 v[26:29], a[4:7], v[58:61], v[26:29]
    v_mfma_f32_16x16x32_bf16 v[30:33], a[4:7], v[62:65], 0
    v_mfma_f32_16x16x32_bf16 v[34:37], a[4:7], v[66:69], 0
    v_mfma_f32_16x16x32_bf16 v[38:41], a[4:7], v[70:73], 0
    v_mfma_f32_16x16x32_bf16 v[42:45], a[8:11], v[58:61], v[42:45]
    v_mfma_f32_16x16x32_bf16 v[46:49], a[8:11], v[62:65], 0
    v_mfma_f32_16x16x32_bf16 v[50:53], a[8:11], v[66:69], 0
    v_mfma_f32_16x16x32_bf16 v[54:57], a[8:11], v[70:73], 0
    s_add_u32 s89, s86, 0x4000
    buffer_load_dwordx4 v[58:61], v122, s[40:43], s89 offen offset:0 sc1
    buffer_load_dwordx4 v[62:65], v123, s[40:43], s89 offen offset:0 sc1
    buffer_load_dwordx4 v[66:69], v124, s[40:43], s89 offen offset:0 sc1
    buffer_load_dwordx4 v[70:73], v125, s[40:43], s89 offen offset:0 sc1
    v_mfma_f32_16x16x32_bf16 v[10:13], a[12:15], v[74:77], v[10:13]
    v_mfma_f32_16x16x32_bf16 v[14:17], a[12:15], v[78:81], v[14:17]
    s_waitcnt vmcnt(8)
    v_max3_u32 v126, v93, v97, v101
    v_max_u32 v126, v126, v105
    v_cmp_eq_u32 vcc, -1, v126
    s_cbranch_vccnz Lrt_p4_375
Lbk_p4_376:
    v_mfma_f32_16x16x32_bf16 v[18:21], a[12:15], v[82:85], v[18:21]
    v_mfma_f32_16x16x32_bf16 v[22:25], a[12:15], v[86:89], v[22:25]
    v_mfma_f32_16x16x32_bf16 v[26:29], a[16:19], v[74:77], v[26:29]
    v_mfma_f32_16x16x32_bf16 v[30:33], a[16:19], v[78:81], v[30:33]
    v_mfma_f32_16x16x32_bf16 v[34:37], a[16:19], v[82:85], v[34:37]
    v_mfma_f32_16x16x32_bf16 v[38:41], a[16:19], v[86:89], v[38:41]
    v_mfma_f32_16x16x32_bf16 v[42:45], a[20:23], v[74:77], v[42:45]
    v_mfma_f32_16x16x32_bf16 v[46:49], a[20:23], v[78:81], v[46:49]
    v_mfma_f32_16x16x32_bf16 v[50:53], a[20:23], v[82:85], v[50:53]
    v_mfma_f32_16x16x32_bf16 v[54:57], a[20:23], v[86:89], v[54:57]
    s_add_u32 s89, s86, 0x5000
    buffer_load_dwordx4 v[74:77], v122, s[40:43], s89 offen offset:0 sc1
    buffer_load_dwordx4 v[78:81], v123, s[40:43], s89 offen offset:0 sc1
    buffer_load_dwordx4 v[82:85], v124, s[40:43], s89 offen offset:0 sc1
    buffer_load_dwordx4 v[86:89], v125, s[40:43], s89 offen offset:0 sc1
    v_mfma_f32_16x16x32_bf16 v[10:13], a[24:27], v[90:93], v[10:13]
    v_mfma_f32_16x16x32_bf16 v[14:17], a[24:27], v[94:97], v[14:17]
    s_waitcnt vmcnt(8)
    v_max3_u32 v126, v109, v113, v117
    v_max_u32 v126, v126, v121
    v_cmp_eq_u32 vcc, -1, v126
    s_cbranch_vccnz Lrt_p4_377
Lbk_p4_378:
    v_mfma_f32_16x16x32_bf16 v[18:21], a[24:27], v[98:101], v[18:21]
    v_mfma_f32_16x16x32_bf16 v[22:25], a[24:27], v[102:105], v[22:25]
    v_mfma_f32_16x16x32_bf16 v[26:29], a[28:31], v[90:93], v[26:29]
    v_mfma_f32_16x16x32_bf16 v[30:33], a[28:31], v[94:97], v[30:33]
    v_mfma_f32_16x16x32_bf16 v[34:37], a[28:31], v[98:101], v[34:37]
    v_mfma_f32_16x16x32_bf16 v[38:41], a[28:31], v[102:105], v[38:41]
    v_mfma_f32_16x16x32_bf16 v[42:45], a[32:35], v[90:93], v[42:45]
    v_mfma_f32_16x16x32_bf16 v[46:49], a[32:35], v[94:97], v[46:49]
    v_mfma_f32_16x16x32_bf16 v[50:53], a[32:35], v[98:101], v[50:53]
    v_mfma_f32_16x16x32_bf16 v[54:57], a[32:35], v[102:105], v[54:57]
    s_add_u32 s89, s86, 0x6000
    buffer_load_dwordx4 v[90:93], v122, s[40:43], s89 offen offset:0 sc1
    buffer_load_dwordx4 v[94:97], v123, s[40:43], s89 offen offset:0 sc1
    buffer_load_dwordx4 v[98:101], v124, s[40:43], s89 offen offset:0 sc1
    buffer_load_dwordx4 v[102:105], v125, s[40:43], s89 offen offset:0 sc1
    v_mfma_f32_16x16x32_bf16 v[10:13], a[36:39], v[106:109], v[10:13]
    v_mfma_f32_16x16x32_bf16 v[14:17], a[36:39], v[110:113], v[14:17]
    s_waitcnt vmcnt(8)
    v_max3_u32 v126, v61, v65, v69
    v_max_u32 v126, v126, v73
    v_cmp_eq_u32 vcc, -1, v126
    s_cbranch_vccnz Lrt_p4_379
Lbk_p4_380:
    v_mfma_f32_16x16x32_bf16 v[18:21], a[36:39], v[114:117], v[18:21]
    v_mfma_f32_16x16x32_bf16 v[22:25], a[36:39], v[118:121], v[22:25]
    v_mfma_f32_16x16x32_bf16 v[26:29], a[40:43], v[106:109], v[26:29]
    v_mfma_f32_16x16x32_bf16 v[30:33], a[40:43], v[110:113], v[30:33]
    v_mfma_f32_16x16x32_bf16 v[34:37], a[40:43], v[114:117], v[34:37]
    v_mfma_f32_16x16x32_bf16 v[38:41], a[40:43], v[118:121], v[38:41]
    v_mfma_f32_16x16x32_bf16 v[42:45], a[44:47], v[106:109], v[42:45]
    v_mfma_f32_16x16x32_bf16 v[46:49], a[44:47], v[110:113], v[46:49]
    v_mfma_f32_16x16x32_bf16 v[50:53], a[44:47], v[114:117], v[50:53]
    v_mfma_f32_16x16x32_bf16 v[54:57], a[44:47], v[118:121], v[54:57]
    s_add_u32 s89, s86, 0x7000
    buffer_load_dwordx4 v[106:109], v122, s[40:43], s89 offen offset:0 sc1
    buffer_load_dwordx4 v[110:113], v123, s[40:43], s89 offen offset:0 sc1
    buffer_load_dwordx4 v[114:117], v124, s[40:43], s89 offen offset:0 sc1
    buffer_load_dwordx4 v[118:121], v125, s[40:43], s89 offen offset:0 sc1
    v_mfma_f32_16x16x32_bf16 v[10:13], a[48:51], v[58:61], v[10:13]
    v_mfma_f32_16x16x32_bf16 v[14:17], a[48:51], v[62:65], v[14:17]
    s_waitcnt vmcnt(8)
    v_max3_u32 v126, v77, v81, v85
    v_max_u32 v126, v126, v89
    v_cmp_eq_u32 vcc, -1, v126
    s_cbranch_vccnz Lrt_p4_381
Lbk_p4_382:
    v_mfma_f32_16x16x32_bf16 v[18:21], a[48:51], v[66:69], v[18:21]
    v_mfma_f32_16x16x32_bf16 v[22:25], a[48:51], v[70:73], v[22:25]
    v_mfma_f32_16x16x32_bf16 v[26:29], a[52:55], v[58:61], v[26:29]
    v_mfma_f32_16x16x32_bf16 v[30:33], a[52:55], v[62:65], v[30:33]
    v_mfma_f32_16x16x32_bf16 v[34:37], a[52:55], v[66:69], v[34:37]
    v_mfma_f32_16x16x32_bf16 v[38:41], a[52:55], v[70:73], v[38:41]
    v_mfma_f32_16x16x32_bf16 v[42:45], a[56:59], v[58:61], v[42:45]
    v_mfma_f32_16x16x32_bf16 v[46:49], a[56:59], v[62:65], v[46:49]
    v_mfma_f32_16x16x32_bf16 v[50:53], a[56:59], v[66:69], v[50:53]
    v_mfma_f32_16x16x32_bf16 v[54:57], a[56:59], v[70:73], v[54:57]
    s_add_u32 s89, s86, 0x8000
    buffer_load_dwordx4 v[58:61], v122, s[40:43], s89 offen offset:0 sc1
    buffer_load_dwordx4 v[62:65], v123, s[40:43], s89 offen offset:0 sc1
    buffer_load_dwordx4 v[66:69], v124, s[40:43], s89 offen offset:0 sc1
    buffer_load_dwordx4 v[70:73], v125, s[40:43], s89 offen offset:0 sc1
    v_mfma_f32_16x16x32_bf16 v[10:13], a[60:63], v[74:77], v[10:13]
    v_mfma_f32_16x16x32_bf16 v[14:17], a[60:63], v[78:81], v[14:17]
    s_waitcnt vmcnt(8)
    v_max3_u32 v126, v93, v97, v101
    v_max_u32 v126, v126, v105
    v_cmp_eq_u32 vcc, -1, v126
    s_cbranch_vccnz Lrt_p4_383
Lbk_p4_384:
    v_mfma_f32_16x16x32_bf16 v[18:21], a[60:63], v[82:85], v[18:21]
    v_mfma_f32_16x16x32_bf16 v[22:25], a[60:63], v[86:89], v[22:25]
    v_mfma_f32_16x16x32_bf16 v[26:29], a[64:67], v[74:77], v[26:29]
    v_mfma_f32_16x16x32_bf16 v[30:33], a[64:67], v[78:81], v[30:33]
    v_mfma_f32_16x16x32_bf16 v[34:37], a[64:67], v[82:85], v[34:37]
    v_mfma_f32_16x16x32_bf16 v[38:41], a[64:67], v[86:89], v[38:41]
    v_mfma_f32_16x16x32_bf16 v[42:45], a[68:71], v[74:77], v[42:45]
    v_mfma_f32_16x16x32_bf16 v[46:49], a[68:71], v[78:81], v[46:49]
    v_mfma_f32_16x16x32_bf16 v[50:53], a[68:71], v[82:85], v[50:53]
    v_mfma_f32_16x16x32_bf16 v[54:57], a[68:71], v[86:89], v[54:57]
    s_add_u32 s89, s86, 0x9000
    buffer_load_dwordx4 v[74:77], v122, s[40:43], s89 offen offset:0 sc1
    buffer_load_dwordx4 v[78:81], v123, s[40:43], s89 offen offset:0 sc1
    buffer_load_dwordx4 v[82:85], v124, s[40:43], s89 offen offset:0 sc1
    buffer_load_dwordx4 v[86:89], v125, s[40:43], s89 offen offset:0 sc1
    v_mfma_f32_16x16x32_bf16 v[10:13], a[72:75], v[90:93], v[10:13]
    v_mfma_f32_16x16x32_bf16 v[14:17], a[72:75], v[94:97], v[14:17]
    s_waitcnt vmcnt(8)
    v_max3_u32 v126, v109, v113, v117
    v_max_u32 v126, v126, v121
    v_cmp_eq_u32 vcc, -1, v126
    s_cbranch_vccnz Lrt_p4_385
Lbk_p4_386:
    v_mfma_f32_16x16x32_bf16 v[18:21], a[72:75], v[98:101], v[18:21]
    v_mfma_f32_16x16x32_bf16 v[22:25], a[72:75], v[102:105], v[22:25]
    v_mfma_f32_16x16x32_bf16 v[26:29], a[76:79], v[90:93], v[26:29]
    v_mfma_f32_16x16x32_bf16 v[30:33], a[76:79], v[94:97], v[30:33]
    v_mfma_f32_16x16x32_bf16 v[34:37], a[76:79], v[98:101], v[34:37]
    v_mfma_f32_16x16x32_bf16 v[38:41], a[76:79], v[102:105], v[38:41]
    v_mfma_f32_16x16x32_bf16 v[42:45], a[80:83], v[90:93], v[42:45]
    v_mfma_f32_16x16x32_bf16 v[46:49], a[80:83], v[94:97], v[46:49]
    v_mfma_f32_16x16x32_bf16 v[50:53], a[80:83], v[98:101], v[50:53]
    v_mfma_f32_16x16x32_bf16 v[54:57], a[80:83], v[102:105], v[54:57]
    s_add_u32 s89, s86, 0xa000
    buffer_load_dwordx4 v[90:93], v122, s[40:43], s89 offen offset:0 sc1
    buffer_load_dwordx4 v[94:97], v123, s[40:43], s89 offen offset:0 sc1
    buffer_load_dwordx4 v[98:101], v124, s[40:43], s89 offen offset:0 sc1
    buffer_load_dwordx4 v[102:105], v125, s[40:43], s89 offen offset:0 sc1
    v_mfma_f32_16x16x32_bf16 v[10:13], a[84:87], v[106:109], v[10:13]
    v_mfma_f32_16x16x32_bf16 v[14:17], a[84:87], v[110:113], v[14:17]
    s_waitcnt vmcnt(8)
    v_max3_u32 v126, v61, v65, v69
    v_max_u32 v126, v126, v73
    v_cmp_eq_u32 vcc, -1, v126
    s_cbranch_vccnz Lrt_p4_387
Lbk_p4_388:
    v_mfma_f32_16x16x32_bf16 v[18:21], a[84:87], v[114:117], v[18:21]
    v_mfma_f32_16x16x32_bf16 v[22:25], a[84:87], v[118:121], v[22:25]
    v_mfma_f32_16x16x32_bf16 v[26:29], a[88:91], v[106:109], v[26:29]
    v_mfma_f32_16x16x32_bf16 v[30:33], a[88:91], v[110:113], v[30:33]
    v_mfma_f32_16x16x32_bf16 v[34:37], a[88:91], v[114:117], v[34:37]
    v_mfma_f32_16x16x32_bf16 v[38:41], a[88:91], v[118:121], v[38:41]
    v_mfma_f32_16x16x32_bf16 v[42:45], a[92:95], v[106:109], v[42:45]
    v_mfma_f32_16x16x32_bf16 v[46:49], a[92:95], v[110:113], v[46:49]
    v_mfma_f32_16x16x32_bf16 v[50:53], a[92:95], v[114:117], v[50:53]
    v_mfma_f32_16x16x32_bf16 v[54:57], a[92:95], v[118:121], v[54:57]
    s_add_u32 s89, s86, 0xb000
    buffer_load_dwordx4 v[106:109], v122, s[40:43], s89 offen offset:0 sc1
    buffer_load_dwordx4 v[110:113], v123, s[40:43], s89 offen offset:0 sc1
    buffer_load_dwordx4 v[114:117], v124, s[40:43], s89 offen offset:0 sc1
    buffer_load_dwordx4 v[118:121], v125, s[40:43], s89 offen offset:0 sc1
    v_mfma_f32_16x16x32_bf16 v[10:13], a[96:99], v[58:61], v[10:13]
    v_mfma_f32_16x16x32_bf16 v[14:17], a[96:99], v[62:65], v[14:17]
    s_waitcnt vmcnt(8)
    v_max3_u32 v126, v77, v81, v85
    v_max_u32 v126, v126, v89
    v_cmp_eq_u32 vcc, -1, v126
    s_cbranch_vccnz Lrt_p4_389
Lbk_p4_390:
    v_mfma_f32_16x16x32_bf16 v[18:21], a[96:99], v[66:69], v[18:21]
    v_mfma_f32_16x16x32_bf16 v[22:25], a[96:99], v[70:73], v[22:25]
    v_mfma_f32_16x16x32_bf16 v[26:29], a[100:103], v[58:61], v[26:29]
    v_mfma_f32_16x16x32_bf16 v[30:33], a[100:103], v[62:65], v[30:33]
    v_mfma_f32_16x16x32_bf16 v[34:37], a[100:103], v[66:69], v[34:37]
    v_mfma_f32_16x16x32_bf16 v[38:41], a[100:103], v[70:73], v[38:41]
    v_mfma_f32_16x16x32_bf16 v[42:45], a[104:107], v[58:61], v[42:45]
    v_mfma_f32_16x16x32_bf16 v[46:49], a[104:107], v[62:65], v[46:49]
    v_mfma_f32_16x16x32_bf16 v[50:53], a[104:107], v[66:69], v[50:53]
    v_mfma_f32_16x16x32_bf16 v[54:57], a[104:107], v[70:73], v[54:57]
    s_add_u32 s89, s86, 0xc000
    buffer_load_dwordx4 v[58:61], v122, s[40:43], s89 offen offset:0 sc1
    buffer_load_dwordx4 v[62:65], v123, s[40:43], s89 offen offset:0 sc1
    buffer_load_dwordx4 v[66:69], v124, s[40:43], s89 offen offset:0 sc1
    buffer_load_dwordx4 v[70:73], v125, s[40:43], s89 offen offset:0 sc1
    v_mfma_f32_16x16x32_bf16 v[10:13], a[108:111], v[74:77], v[10:13]
    v_mfma_f32_16x16x32_bf16 v[14:17], a[108:111], v[78:81], v[14:17]
    s_waitcnt vmcnt(8)
    v_max3_u32 v126, v93, v97, v101
    v_max_u32 v126, v126, v105
    v_cmp_eq_u32 vcc, -1, v126
    s_cbranch_vccnz Lrt_p4_391
Lbk_p4_392:
    v_mfma_f32_16x16x32_bf16 v[18:21], a[108:111], v[82:85], v[18:21]
    v_mfma_f32_16x16x32_bf16 v[22:25], a[108:111], v[86:89], v[22:25]
    v_mfma_f32_16x16x32_bf16 v[26:29], a[112:115], v[74:77], v[26:29]
    v_mfma_f32_16x16x32_bf16 v[30:33], a[112:115], v[78:81], v[30:33]
    v_mfma_f32_16x16x32_bf16 v[34:37], a[112:115], v[82:85], v[34:37]
    v_mfma_f32_16x16x32_bf16 v[38:41], a[112:115], v[86:89], v[38:41]
    v_mfma_f32_16x16x32_bf16 v[42:45], a[116:119], v[74:77], v[42:45]
    v_mfma_f32_16x16x32_bf16 v[46:49], a[116:119], v[78:81], v[46:49]
    v_mfma_f32_16x16x32_bf16 v[50:53], a[116:119], v[82:85], v[50:53]
    v_mfma_f32_16x16x32_bf16 v[54:57], a[116:119], v[86:89], v[54:57]
    s_add_u32 s89, s86, 0xd000
    buffer_load_dwordx4 v[74:77], v122, s[40:43], s89 offen offset:0 sc1
    buffer_load_dwordx4 v[78:81], v123, s[40:43], s89 offen offset:0 sc1
    buffer_load_dwordx4 v[82:85], v124, s[40:43], s89 offen offset:0 sc1
    buffer_load_dwordx4 v[86:89], v125, s[40:43], s89 offen offset:0 sc1
    v_mfma_f32_16x16x32_bf16 v[10:13], a[120:123], v[90:93], v[10:13]
    v_mfma_f32_16x16x32_bf16 v[14:17], a[120:123], v[94:97], v[14:17]
    s_waitcnt vmcnt(8)
    v_max3_u32 v126, v109, v113, v117
    v_max_u32 v126, v126, v121
    v_cmp_eq_u32 vcc, -1, v126
    s_cbranch_vccnz Lrt_p4_393
Lbk_p4_394:
    v_mfma_f32_16x16x32_bf16 v[18:21], a[120:123], v[98:101], v[18:21]
    v_mfma_f32_16x16x32_bf16 v[22:25], a[120:123], v[102:105], v[22:25]
    v_mfma_f32_16x16x32_bf16 v[26:29], a[124:127], v[90:93], v[26:29]
    v_mfma_f32_16x16x32_bf16 v[30:33], a[124:127], v[94:97], v[30:33]
    v_mfma_f32_16x16x32_bf16 v[34:37], a[124:127], v[98:101], v[34:37]
    v_mfma_f32_16x16x32_bf16 v[38:41], a[124:127], v[102:105], v[38:41]
    v_mfma_f32_16x16x32_bf16 v[42:45], a[128:131], v[90:93], v[42:45]
    v_mfma_f32_16x16x32_bf16 v[46:49], a[128:131], v[94:97], v[46:49]
    v_mfma_f32_16x16x32_bf16 v[50:53], a[128:131], v[98:101], v[50:53]
    v_mfma_f32_16x16x32_bf16 v[54:57], a[128:131], v[102:105], v[54:57]
    s_add_u32 s89, s86, 0xe000
    buffer_load_dwordx4 v[90:93], v122, s[40:43], s89 offen offset:0 sc1
    buffer_load_dwordx4 v[94:97], v123, s[40:43], s89 offen offset:0 sc1
    buffer_load_dwordx4 v[98:101], v124, s[40:43], s89 offen offset:0 sc1
    buffer_load_dwordx4 v[102:105], v125, s[40:43], s89 offen offset:0 sc1
    v_mfma_f32_16x16x32_bf16 v[10:13], a[132:135], v[106:109], v[10:13]
    v_mfma_f32_16x16x32_bf16 v[14:17], a[132:135], v[110:113], v[14:17]
    s_waitcnt vmcnt(8)
    v_max3_u32 v126, v61, v65, v69
    v_max_u32 v126, v126, v73
    v_cmp_eq_u32 vcc, -1, v126
    s_cbranch_vccnz Lrt_p4_395
Lbk_p4_396:
    v_mfma_f32_16x16x32_bf16 v[18:21], a[132:135], v[114:117], v[18:21]
    v_mfma_f32_16x16x32_bf16 v[22:25], a[132:135], v[118:121], v[22:25]
    v_mfma_f32_16x16x32_bf16 v[26:29], a[136:139], v[106:109], v[26:29]
    v_mfma_f32_16x16x32_bf16 v[30:33], a[136:139], v[110:113], v[30:33]
    v_mfma_f32_16x16x32_bf16 v[34:37], a[136:139], v[114:117], v[34:37]
    v_mfma_f32_16x16x32_bf16 v[38:41], a[136:139], v[118:121], v[38:41]
    v_mfma_f32_16x16x32_bf16 v[42:45], a[140:143], v[106:109], v[42:45]
    v_mfma_f32_16x16x32_bf16 v[46:49], a[140:143], v[110:113], v[46:49]
    v_mfma_f32_16x16x32_bf16 v[50:53], a[140:143], v[114:117], v[50:53]
    v_mfma_f32_16x16x32_bf16 v[54:57], a[140:143], v[118:121], v[54:57]
    s_add_u32 s89, s86, 0xf000
    buffer_load_dwordx4 v[106:109], v122, s[40:43], s89 offen offset:0 sc1
    buffer_load_dwordx4 v[110:113], v123, s[40:43], s89 offen offset:0 sc1
    buffer_load_dwordx4 v[114:117], v124, s[40:43], s89 offen offset:0 sc1
    buffer_load_dwordx4 v[118:121], v125, s[40:43], s89 offen offset:0 sc1
    v_mfma_f32_16x16x32_bf16 v[10:13], a[144:147], v[58:61], v[10:13]
    v_mfma_f32_16x16x32_bf16 v[14:17], a[144:147], v[62:65], v[14:17]
    s_waitcnt vmcnt(8)
    v_max3_u32 v126, v77, v81, v85
    v_max_u32 v126, v126, v89
    v_cmp_eq_u32 vcc, -1, v126
    s_cbranch_vccnz Lrt_p4_397
Lbk_p4_398:
    v_mfma_f32_16x16x32_bf16 v[18:21], a[144:147], v[66:69], v[18:21]
    v_mfma_f32_16x16x32_bf16 v[22:25], a[144:147], v[70:73], v[22:25]
    v_mfma_f32_16x16x32_bf16 v[26:29], a[148:151], v[58:61], v[26:29]
    v_mfma_f32_16x16x32_bf16 v[30:33], a[148:151], v[62:65], v[30:33]
    v_mfma_f32_16x16x32_bf16 v[34:37], a[148:151], v[66:69], v[34:37]
    v_mfma_f32_16x16x32_bf16 v[38:41], a[148:151], v[70:73], v[38:41]
    v_mfma_f32_16x16x32_bf16 v[42:45], a[152:155], v[58:61], v[42:45]
    v_mfma_f32_16x16x32_bf16 v[46:49], a[152:155], v[62:65], v[46:49]
    v_mfma_f32_16x16x32_bf16 v[50:53], a[152:155], v[66:69], v[50:53]
    v_mfma_f32_16x16x32_bf16 v[54:57], a[152:155], v[70:73], v[54:57]
    v_mfma_f32_16x16x32_bf16 v[10:13], a[156:159], v[74:77], v[10:13]
    v_mfma_f32_16x16x32_bf16 v[14:17], a[156:159], v[78:81], v[14:17]
    s_waitcnt vmcnt(4)
    v_max3_u32 v126, v93, v97, v101
    v_max_u32 v126, v126, v105
    v_cmp_eq_u32 vcc, -1, v126
    s_cbranch_vccnz Lrt_p4_399
Lbk_p4_400:
    v_mfma_f32_16x16x32_bf16 v[18:21], a[156:159], v[82:85], v[18:21]
    v_mfma_f32_16x16x32_bf16 v[22:25], a[156:159], v[86:89], v[22:25]
    v_mfma_f32_16x16x32_bf16 v[26:29], a[160:163], v[74:77], v[26:29]
    v_mfma_f32_16x16x32_bf16 v[30:33], a[160:163], v[78:81], v[30:33]
    v_mfma_f32_16x16x32_bf16 v[34:37], a[160:163], v[82:85], v[34:37]
    v_mfma_f32_16x16x32_bf16 v[38:41], a[160:163], v[86:89], v[38:41]
    v_mfma_f32_16x16x32_bf16 v[42:45], a[164:167], v[74:77], v[42:45]
    v_mfma_f32_16x16x32_bf16 v[46:49], a[164:167], v[78:81], v[46:49]
    v_mfma_f32_16x16x32_bf16 v[50:53], a[164:167], v[82:85], v[50:53]
    v_mfma_f32_16x16x32_bf16 v[54:57], a[164:167], v[86:89], v[54:57]
    v_mfma_f32_16x16x32_bf16 v[10:13], a[168:171], v[90:93], v[10:13]
    v_mfma_f32_16x16x32_bf16 v[14:17], a[168:171], v[94:97], v[14:17]
    s_waitcnt vmcnt(0)
    v_max3_u32 v126, v109, v113, v117
    v_max_u32 v126, v126, v121
    v_cmp_eq_u32 vcc, -1, v126
    s_cbranch_vccnz Lrt_p4_401
Lbk_p4_402:
    v_mfma_f32_16x16x32_bf16 v[18:21], a[168:171], v[98:101], v[18:21]
    v_mfma_f32_16x16x32_bf16 v[22:25], a[168:171], v[102:105], v[22:25]
    v_mfma_f32_16x16x32_bf16 v[26:29], a[172:175], v[90:93], v[26:29]
    v_mfma_f32_16x16x32_bf16 v[30:33], a[172:175], v[94:97], v[30:33]
    v_mfma_f32_16x16x32_bf16 v[34:37], a[172:175], v[98:101], v[34:37]
    v_mfma_f32_16x16x32_bf16 v[38:41], a[172:175], v[102:105], v[38:41]
    v_mfma_f32_16x16x32_bf16 v[42:45], a[176:179], v[90:93], v[42:45]
    v_mfma_f32_16x16x32_bf16 v[46:49], a[176:179], v[94:97], v[46:49]
    v_mfma_f32_16x16x32_bf16 v[50:53], a[176:179], v[98:101], v[50:53]
    v_mfma_f32_16x16x32_bf16 v[54:57], a[176:179], v[102:105], v[54:57]
    v_mfma_f32_16x16x32_bf16 v[10:13], a[180:183], v[106:109], v[10:13]
    v_mfma_f32_16x16x32_bf16 v[14:17], a[180:183], v[110:113], v[14:17]
    v_mfma_f32_16x16x32_bf16 v[18:21], a[180:183], v[114:117], v[18:21]
    v_mfma_f32_16x16x32_bf16 v[22:25], a[180:183], v[118:121], v[22:25]
    v_mfma_f32_16x16x32_bf16 v[26:29], a[184:187], v[106:109], v[26:29]
    v_mfma_f32_16x16x32_bf16 v[30:33], a[184:187], v[110:113], v[30:33]
    v_mfma_f32_16x16x32_bf16 v[34:37], a[184:187], v[114:117], v[34:37]
    v_mfma_f32_16x16x32_bf16 v[38:41], a[184:187], v[118:121], v[38:41]
    v_mfma_f32_16x16x32_bf16 v[42:45], a[188:191], v[106:109], v[42:45]
    v_mfma_f32_16x16x32_bf16 v[46:49], a[188:191], v[110:113], v[46:49]
    v_mfma_f32_16x16x32_bf16 v[50:53], a[188:191], v[114:117], v[50:53]
    v_mfma_f32_16x16x32_bf16 v[54:57], a[188:191], v[118:121], v[54:57]
    ds_write_b128 v134, v[14:17] offset:0
    s_nop 0
    ds_write_b128 v134, v[30:33] offset:1024
    s_nop 2
    ds_write_b128 v134, v[46:49] offset:2048
    ds_write_b128 v135, v[18:21] offset:0
    ds_write_b128 v135, v[34:37] offset:1024
    ds_write_b128 v135, v[50:53] offset:2048
    ds_write_b128 v136, v[22:25] offset:0
    ds_write_b128 v136, v[38:41] offset:1024
    ds_write_b128 v136, v[54:57] offset:2048
    s_lshl_b32 s86, s81, 1
    s_add_u32 s86, s86, s100
    s_mul_i32 s86, s86, 96
    s_mul_i32 s92, s82, 3
    s_add_u32 s86, s86, s92
    s_lshl_b32 s86, s86, 10
    s_add_u32 s86, s86, 0x1200000
    v_mov_b32 v106, 0xc0135761
    v_mov_b32 v108, 0xbdd2d3e8
    v_mov_b32 v107, 0xc0135761
    v_mov_b32 v109, 0xbdd2d3e8
    s_waitcnt lgkmcnt(0)
    s_barrier
    ds_read_b128 v[58:61], v137 offset:0
    ds_read_b128 v[70:73], v137 offset:3072
    ds_read_b128 v[82:85], v137 offset:6144
    ds_read_b128 v[62:65], v137 offset:1024
    ds_read_b128 v[74:77], v137 offset:4096
    ds_read_b128 v[86:89], v137 offset:7168
    ds_read_b128 v[66:69], v137 offset:2048
    ds_read_b128 v[78:81], v137 offset:5120
    ds_read_b128 v[90:93], v137 offset:8192
    s_waitcnt lgkmcnt(6)
    v_pk_add_f32 v[58:59], v[58:59], v[70:71]
    v_pk_add_f32 v[10:11], v[10:11], v[82:83]
    v_pk_add_f32 v[60:61], v[60:61], v[72:73]
    v_pk_add_f32 v[12:13], v[12:13], v[84:85]
    v_pk_add_f32 v[10:11], v[10:11], v[58:59]
    v_pk_add_f32 v[12:13], v[12:13], v[60:61]
    v_pk_mul_f32 v[110:111], v[10:11], v[10:11]
    v_pk_mul_f32 v[112:113], v[12:13], v[12:13]
    v_pk_fma_f32 v[110:111], v[110:111], v[108:109], v[106:107]
    v_pk_fma_f32 v[112:113], v[112:113], v[108:109], v[106:107]
    v_pk_mul_f32 v[110:111], v[110:111], v[10:11]
    v_pk_mul_f32 v[112:113], v[112:113], v[12:13]
    v_exp_f32 v110, v110
    v_exp_f32 v111, v111
    v_exp_f32 v112, v112
    v_exp_f32 v113, v113
    v_add_f32 v110, 1.0, v110
    v_add_f32 v111, 1.0, v111
    v_add_f32 v112, 1.0, v112
    v_add_f32 v113, 1.0, v113
    v_rcp_f32 v110, v110
    v_rcp_f32 v111, v111
    v_rcp_f32 v112, v112
    v_rcp_f32 v113, v113
    v_pk_mul_f32 v[10:11], v[10:11], v[110:111]
    v_pk_mul_f32 v[12:13], v[12:13], v[112:113]
    v_cvt_pk_bf16_f32 v118, v10, v11
    v_cvt_pk_bf16_f32 v119, v12, v13
    buffer_store_dwordx2 v[118:119], v141, s[40:43], s86 offen offset:0 sc1
    s_waitcnt lgkmcnt(3)
    v_pk_add_f32 v[62:63], v[62:63], v[74:75]
    v_pk_add_f32 v[26:27], v[26:27], v[86:87]
    v_pk_add_f32 v[64:65], v[64:65], v[76:77]
    v_pk_add_f32 v[28:29], v[28:29], v[88:89]
    v_pk_add_f32 v[26:27], v[26:27], v[62:63]
    v_pk_add_f32 v[28:29], v[28:29], v[64:65]
    v_pk_mul_f32 v[110:111], v[26:27], v[26:27]
    v_pk_mul_f32 v[112:113], v[28:29], v[28:29]
    v_pk_fma_f32 v[110:111], v[110:111], v[108:109], v[106:107]
    v_pk_fma_f32 v[112:113], v[112:113], v[108:109], v[106:107]
    v_pk_mul_f32 v[110:111], v[110:111], v[26:27]
    v_pk_mul_f32 v[112:113], v[112:113], v[28:29]
    v_exp_f32 v110, v110
    v_exp_f32 v111, v111
    v_exp_f32 v112, v112
    v_exp_f32 v113, v113
    v_add_f32 v110, 1.0, v110
    v_add_f32 v111, 1.0, v111
    v_add_f32 v112, 1.0, v112
    v_add_f32 v113, 1.0, v113
    v_rcp_f32 v110, v110
    v_rcp_f32 v111, v111
    v_rcp_f32 v112, v112
    v_rcp_f32 v113, v113
    v_pk_mul_f32 v[26:27], v[26:27], v[110:111]
    v_pk_mul_f32 v[28:29], v[28:29], v[112:113]
    v_cvt_pk_bf16_f32 v120, v26, v27
    v_cvt_pk_bf16_f32 v121, v28, v29
    buffer_store_dwordx2 v[120:121], v141, s[40:43], s86 offen offset:1024 sc1
    s_waitcnt lgkmcnt(0)
    v_pk_add_f32 v[66:67], v[66:67], v[78:79]
    v_pk_add_f32 v[42:43], v[42:43], v[90:91]
    v_pk_add_f32 v[68:69], v[68:69], v[80:81]
    v_pk_add_f32 v[44:45], v[44:45], v[92:93]
    v_pk_add_f32 v[42:43], v[42:43], v[66:67]
    v_pk_add_f32 v[44:45], v[44:45], v[68:69]
    v_pk_mul_f32 v[110:111], v[42:43], v[42:43]
    v_pk_mul_f32 v[112:113], v[44:45], v[44:45]
    v_pk_fma_f32 v[110:111], v[110:111], v[108:109], v[106:107]
    v_pk_fma_f32 v[112:113], v[112:113], v[108:109], v[106:107]
    v_pk_mul_f32 v[110:111], v[110:111], v[42:43]
    v_pk_mul_f32 v[112:113], v[112:113], v[44:45]
    v_exp_f32 v110, v110
    v_exp_f32 v111, v111
    v_exp_f32 v112, v112
    v_exp_f32 v113, v113
    v_add_f32 v110, 1.0, v110
    v_add_f32 v111, 1.0, v111
    v_add_f32 v112, 1.0, v112
    v_add_f32 v113, 1.0, v113
    v_rcp_f32 v110, v110
    v_rcp_f32 v111, v111
    v_rcp_f32 v112, v112
    v_rcp_f32 v113, v113
    v_pk_mul_f32 v[42:43], v[42:43], v[110:111]
    v_pk_mul_f32 v[44:45], v[44:45], v[112:113]
    v_cvt_pk_bf16_f32 v118, v42, v43
    v_cvt_pk_bf16_f32 v119, v44, v45
    buffer_store_dwordx2 v[118:119], v141, s[40:43], s86 offen offset:2048 sc1
    v_lshlrev_b32 v130, 4, v0
    s_mul_i32 s86, s80, 196608
    s_add_u32 s86, s86, 0x1200000
    s_mul_i32 s89, s100, 98304
    v_add_u32 v134, s89, v130
    s_sub_u32 s89, 98304, s89
    v_add_u32 v133, s89, v130
    s_mul_i32 s88, s76, 22
    s_lshl_b32 s87, s88, 10
    s_add_u32 s87, s87, s86
    s_xor_b32 s89, s76, 1
    s_mul_i32 s89, s89, 3
    s_add_u32 s89, s89, 0
    s_lshl_b32 s89, s89, 12
    s_add_u32 s89, s89, 0xf000
    v_add_u32 v135, s89, v130
    s_xor_b32 s89, s76, 2
    s_mul_i32 s89, s89, 3
    s_add_u32 s89, s89, 1
    s_lshl_b32 s89, s89, 12
    s_add_u32 s89, s89, 0xf000
    v_add_u32 v136, s89, v130
    s_xor_b32 s89, s76, 3
    s_mul_i32 s89, s89, 3
    s_add_u32 s89, s89, 2
    s_lshl_b32 s89, s89, 12
    s_add_u32 s89, s89, 0xf000
    v_add_u32 v137, s89, v130
    s_mul_i32 s89, s76, 12288
    s_add_u32 s89, s89, 0xf000
    v_add_u32 v139, s89, v130
    v_and_b32 v140, 31, v0
    s_lshl_b32 s89, s79, 6
    s_lshl_b32 s90, s101, 5
    s_add_u32 s89, s89, s90
    v_add_u32 v140, s89, v140
    v_lshlrev_b32 v140, 10, v140
    v_lshrrev_b32 v132, 5, v0
    v_lshlrev_b32 v132, 4, v132
    v_add_u32 v140, v140, v132
    s_lshl_b32 s89, s80, 7
    s_lshl_b32 s90, s100, 6
    s_add_u32 s89, s89, s90
    v_add_u32 v140, s89, v140
    v_lshlrev_b32 v10, 16, v2
    v_and_b32 v11, 0xffff0000, v2
    v_lshlrev_b32 v12, 16, v3
    v_and_b32 v13, 0xffff0000, v3
    v_lshlrev_b32 v14, 16, v4
    v_and_b32 v15, 0xffff0000, v4
    v_lshlrev_b32 v16, 16, v5
    v_and_b32 v17, 0xffff0000, v5
    v_lshlrev_b32 v18, 16, v6
    v_and_b32 v19, 0xffff0000, v6
    v_lshlrev_b32 v20, 16, v7
    v_and_b32 v21, 0xffff0000, v7
    v_lshlrev_b32 v22, 16, v8
    v_and_b32 v23, 0xffff0000, v8
    v_lshlrev_b32 v24, 16, v9
    v_and_b32 v25, 0xffff0000, v9
    v_add_f32 v10, v10, v1
    v_add_f32 v11, v11, v1
    v_add_f32 v12, v12, v1
    v_add_f32 v13, v13, v1
    v_add_f32 v14, v14, v1
    v_add_f32 v15, v15, v1
    v_add_f32 v16, v16, v1
    v_add_f32 v17, v17, v1
    v_add_f32 v18, v18, v1
    v_add_f32 v19, v19, v1
    v_add_f32 v20, v20, v1
    v_add_f32 v21, v21, v1
    v_add_f32 v22, v22, v1
    v_add_f32 v23, v23, v1
    v_add_f32 v24, v24, v1
    v_add_f32 v25, v25, v1
    s_waitcnt lgkmcnt(0)
    s_barrier
    s_add_u32 s89, s87, 0x0
    buffer_load_dwordx4 v[74:77], v134, s[40:43], s89 offen offset:0 sc1
    buffer_load_dwordx4 v[78:81], v133, s[40:43], s89 offen offset:0 sc1
    s_add_u32 s89, s87, 0x0
    buffer_load_dwordx4 v[82:85], v134, s[40:43], s89 offen offset:1024 sc1
    buffer_load_dwordx4 v[86:89], v133, s[40:43], s89 offen offset:1024 sc1
    s_add_u32 s89, s87, 0x0
    buffer_load_dwordx4 v[90:93], v134, s[40:43], s89 offen offset:2048 sc1
    buffer_load_dwordx4 v[94:97], v133, s[40:43], s89 offen offset:2048 sc1
    s_add_u32 s89, s87, 0x0
    buffer_load_dwordx4 v[98:101], v134, s[40:43], s89 offen offset:3072 sc1
    buffer_load_dwordx4 v[102:105], v133, s[40:43], s89 offen offset:3072 sc1
    s_add_u32 s89, s87, 0x1000
    buffer_load_dwordx4 v[106:109], v134, s[40:43], s89 offen offset:0 sc1
    buffer_load_dwordx4 v[110:113], v133, s[40:43], s89 offen offset:0 sc1
    s_add_u32 s89, s87, 0x1000
    buffer_load_dwordx4 v[114:117], v134, s[40:43], s89 offen offset:1024 sc1
    buffer_load_dwordx4 v[118:121], v133, s[40:43], s89 offen offset:1024 sc1
    s_add_u32 s89, s87, 0x1000
    buffer_load_dwordx4 v[122:125], v134, s[40:43], s89 offen offset:2048 sc1
    buffer_load_dwordx4 v[126:129], v133, s[40:43], s89 offen offset:2048 sc1
    s_waitcnt vmcnt(12)
    v_max3_u32 v131, v75, v77, v79
    v_max_u32 v131, v131, v81
    v_cmp_eq_u32 vcc, -1, v131
    s_cbranch_vccnz Lrt_p5_403
Lbk_p5_404:
    v_mfma_f32_32x32x16_bf16 v[10:25], v[74:77], a[192:195], v[10:25]
    s_waitcnt vmcnt(10)
    v_max3_u32 v131, v83, v85, v87
    v_max_u32 v131, v131, v89
    v_cmp_eq_u32 vcc, -1, v131
    s_cbranch_vccnz Lrt_p5_405
Lbk_p5_406:
    v_mfma_f32_32x32x16_bf16 v[26:41], v[74:77], a[196:199], 0
    v_mfma_f32_32x32x16_bf16 v[42:57], v[78:81], a[192:195], 0
    v_mfma_f32_32x32x16_bf16 v[58:73], v[78:81], a[196:199], 0
    s_add_u32 s89, s87, 0x1000
    buffer_load_dwordx4 v[74:77], v134, s[40:43], s89 offen offset:3072 sc1
    buffer_load_dwordx4 v[78:81], v133, s[40:43], s89 offen offset:3072 sc1
    v_mfma_f32_32x32x16_bf16 v[10:25], v[82:85], a[200:203], v[10:25]
    s_waitcnt vmcnt(10)
    v_max3_u32 v131, v91, v93, v95
    v_max_u32 v131, v131, v97
    v_cmp_eq_u32 vcc, -1, v131
    s_cbranch_vccnz Lrt_p5_407
Lbk_p5_408:
    v_mfma_f32_32x32x16_bf16 v[26:41], v[82:85], a[204:207], v[26:41]
    v_mfma_f32_32x32x16_bf16 v[42:57], v[86:89], a[200:203], v[42:57]
    v_mfma_f32_32x32x16_bf16 v[58:73], v[86:89], a[204:207], v[58:73]
    s_add_u32 s89, s87, 0x2000
    buffer_load_dwordx4 v[82:85], v134, s[40:43], s89 offen offset:0 sc1
    buffer_load_dwordx4 v[86:89], v133, s[40:43], s89 offen offset:0 sc1
    v_mfma_f32_32x32x16_bf16 v[10:25], v[90:93], a[208:211], v[10:25]
    s_waitcnt vmcnt(10)
    v_max3_u32 v131, v99, v101, v103
    v_max_u32 v131, v131, v105
    v_cmp_eq_u32 vcc, -1, v131
    s_cbranch_vccnz Lrt_p5_409
Lbk_p5_410:
    v_mfma_f32_32x32x16_bf16 v[26:41], v[90:93], a[212:215], v[26:41]
    v_mfma_f32_32x32x16_bf16 v[42:57], v[94:97], a[208:211], v[42:57]
    v_mfma_f32_32x32x16_bf16 v[58:73], v[94:97], a[212:215], v[58:73]
    s_add_u32 s89, s87, 0x2000
    buffer_load_dwordx4 v[90:93], v134, s[40:43], s89 offen offset:1024 sc1
    buffer_load_dwordx4 v[94:97], v133, s[40:43], s89 offen offset:1024 sc1
    v_mfma_f32_32x32x16_bf16 v[10:25], v[98:101], a[216:219], v[10:25]
    s_waitcnt vmcnt(10)
    v_max3_u32 v131, v107, v109, v111
    v_max_u32 v131, v131, v113
    v_cmp_eq_u32 vcc, -1, v131
    s_cbranch_vccnz Lrt_p5_411
Lbk_p5_412:
    v_mfma_f32_32x32x16_bf16 v[26:41], v[98:101], a[220:223], v[26:41]
    v_mfma_f32_32x32x16_bf16 v[42:57], v[102:105], a[216:219], v[42:57]
    v_mfma_f32_32x32x16_bf16 v[58:73], v[102:105], a[220:223], v[58:73]
    s_add_u32 s89, s87, 0x2000
    buffer_load_dwordx4 v[98:101], v134, s[40:43], s89 offen offset:2048 sc1
    buffer_load_dwordx4 v[102:105], v133, s[40:43], s89 offen offset:2048 sc1
    v_mfma_f32_32x32x16_bf16 v[10:25], v[106:109], a[224:227], v[10:25]
    s_waitcnt vmcnt(10)
    v_max3_u32 v131, v115, v117, v119
    v_max_u32 v131, v131, v121
    v_cmp_eq_u32 vcc, -1, v131
    s_cbranch_vccnz Lrt_p5_413
Lbk_p5_414:
    v_mfma_f32_32x32x16_bf16 v[26:41], v[106:109], a[228:231], v[26:41]
    v_mfma_f32_32x32x16_bf16 v[42:57], v[110:113], a[224:227], v[42:57]
    v_mfma_f32_32x32x16_bf16 v[58:73], v[110:113], a[228:231], v[58:73]
    s_add_u32 s89, s87, 0x2000
    buffer_load_dwordx4 v[106:109], v134, s[40:43], s89 offen offset:3072 sc1
    buffer_load_dwordx4 v[110:113], v133, s[40:43], s89 offen offset:3072 sc1
    v_mfma_f32_32x32x16_bf16 v[10:25], v[114:117], a[232:235], v[10:25]
    s_waitcnt vmcnt(10)
    v_max3_u32 v131, v123, v125, v127
    v_max_u32 v131, v131, v129
    v_cmp_eq_u32 vcc, -1, v131
    s_cbranch_vccnz Lrt_p5_415
Lbk_p5_416:
    v_mfma_f32_32x32x16_bf16 v[26:41], v[114:117], a[236:239], v[26:41]
    v_mfma_f32_32x32x16_bf16 v[42:57], v[118:121], a[232:235], v[42:57]
    v_mfma_f32_32x32x16_bf16 v[58:73], v[118:121], a[236:239], v[58:73]
    s_add_u32 s89, s87, 0x3000
    buffer_load_dwordx4 v[114:117], v134, s[40:43], s89 offen offset:0 sc1
    buffer_load_dwordx4 v[118:121], v133, s[40:43], s89 offen offset:0 sc1
    v_mfma_f32_32x32x16_bf16 v[10:25], v[122:125], a[240:243], v[10:25]
    s_waitcnt vmcnt(10)
    v_max3_u32 v131, v75, v77, v79
    v_max_u32 v131, v131, v81
    v_cmp_eq_u32 vcc, -1, v131
    s_cbranch_vccnz Lrt_p5_417
Lbk_p5_418:
    v_mfma_f32_32x32x16_bf16 v[26:41], v[122:125], a[244:247], v[26:41]
    v_mfma_f32_32x32x16_bf16 v[42:57], v[126:129], a[240:243], v[42:57]
    v_mfma_f32_32x32x16_bf16 v[58:73], v[126:129], a[244:247], v[58:73]
    s_add_u32 s89, s87, 0x3000
    buffer_load_dwordx4 v[122:125], v134, s[40:43], s89 offen offset:1024 sc1
    buffer_load_dwordx4 v[126:129], v133, s[40:43], s89 offen offset:1024 sc1
    v_mfma_f32_32x32x16_bf16 v[10:25], v[74:77], a[248:251], v[10:25]
    s_waitcnt vmcnt(10)
    v_max3_u32 v131, v83, v85, v87
    v_max_u32 v131, v131, v89
    v_cmp_eq_u32 vcc, -1, v131
    s_cbranch_vccnz Lrt_p5_419
Lbk_p5_420:
    v_mfma_f32_32x32x16_bf16 v[26:41], v[74:77], a[252:255], v[26:41]
    v_mfma_f32_32x32x16_bf16 v[42:57], v[78:81], a[248:251], v[42:57]
    v_mfma_f32_32x32x16_bf16 v[58:73], v[78:81], a[252:255], v[58:73]
    s_add_u32 s89, s87, 0x3000
    buffer_load_dwordx4 v[74:77], v134, s[40:43], s89 offen offset:2048 sc1
    buffer_load_dwordx4 v[78:81], v133, s[40:43], s89 offen offset:2048 sc1
    v_mfma_f32_32x32x16_bf16 v[10:25], v[82:85], v[144:147], v[10:25]
    s_waitcnt vmcnt(10)
    v_max3_u32 v131, v91, v93, v95
    v_max_u32 v131, v131, v97
    v_cmp_eq_u32 vcc, -1, v131
    s_cbranch_vccnz Lrt_p5_421
Lbk_p5_422:
    v_mfma_f32_32x32x16_bf16 v[26:41], v[82:85], v[148:151], v[26:41]
    v_mfma_f32_32x32x16_bf16 v[42:57], v[86:89], v[144:147], v[42:57]
    v_mfma_f32_32x32x16_bf16 v[58:73], v[86:89], v[148:151], v[58:73]
    s_add_u32 s89, s87, 0x3000
    buffer_load_dwordx4 v[82:85], v134, s[40:43], s89 offen offset:3072 sc1
    buffer_load_dwordx4 v[86:89], v133, s[40:43], s89 offen offset:3072 sc1
    v_mfma_f32_32x32x16_bf16 v[10:25], v[90:93], v[152:155], v[10:25]
    s_waitcnt vmcnt(10)
    v_max3_u32 v131, v99, v101, v103
    v_max_u32 v131, v131, v105
    v_cmp_eq_u32 vcc, -1, v131
    s_cbranch_vccnz Lrt_p5_423
Lbk_p5_424:
    v_mfma_f32_32x32x16_bf16 v[26:41], v[90:93], v[156:159], v[26:41]
    v_mfma_f32_32x32x16_bf16 v[42:57], v[94:97], v[152:155], v[42:57]
    v_mfma_f32_32x32x16_bf16 v[58:73], v[94:97], v[156:159], v[58:73]
    s_add_u32 s89, s87, 0x4000
    buffer_load_dwordx4 v[90:93], v134, s[40:43], s89 offen offset:0 sc1
    buffer_load_dwordx4 v[94:97], v133, s[40:43], s89 offen offset:0 sc1
    v_mfma_f32_32x32x16_bf16 v[10:25], v[98:101], v[160:163], v[10:25]
    s_waitcnt vmcnt(10)
    v_max3_u32 v131, v107, v109, v111
    v_max_u32 v131, v131, v113
    v_cmp_eq_u32 vcc, -1, v131
    s_cbranch_vccnz Lrt_p5_425
Lbk_p5_426:
    v_mfma_f32_32x32x16_bf16 v[26:41], v[98:101], v[164:167], v[26:41]
    v_mfma_f32_32x32x16_bf16 v[42:57], v[102:105], v[160:163], v[42:57]
    v_mfma_f32_32x32x16_bf16 v[58:73], v[102:105], v[164:167], v[58:73]
    s_add_u32 s89, s87, 0x4000
    buffer_load_dwordx4 v[98:101], v134, s[40:43], s89 offen offset:1024 sc1
    buffer_load_dwordx4 v[102:105], v133, s[40:43], s89 offen offset:1024 sc1
    v_mfma_f32_32x32x16_bf16 v[10:25], v[106:109], v[168:171], v[10:25]
    s_waitcnt vmcnt(10)
    v_max3_u32 v131, v115, v117, v119
    v_max_u32 v131, v131, v121
    v_cmp_eq_u32 vcc, -1, v131
    s_cbranch_vccnz Lrt_p5_427
Lbk_p5_428:
    v_mfma_f32_32x32x16_bf16 v[26:41], v[106:109], v[172:175], v[26:41]
    v_mfma_f32_32x32x16_bf16 v[42:57], v[110:113], v[168:171], v[42:57]
    v_mfma_f32_32x32x16_bf16 v[58:73], v[110:113], v[172:175], v[58:73]
    s_add_u32 s89, s87, 0x4000
    buffer_load_dwordx4 v[106:109], v134, s[40:43], s89 offen offset:2048 sc1
    buffer_load_dwordx4 v[110:113], v133, s[40:43], s89 offen offset:2048 sc1
    v_mfma_f32_32x32x16_bf16 v[10:25], v[114:117], v[176:179], v[10:25]
    s_waitcnt vmcnt(10)
    v_max3_u32 v131, v123, v125, v127
    v_max_u32 v131, v131, v129
    v_cmp_eq_u32 vcc, -1, v131
    s_cbranch_vccnz Lrt_p5_429
Lbk_p5_430:
    v_mfma_f32_32x32x16_bf16 v[26:41], v[114:117], v[180:183], v[26:41]
    v_mfma_f32_32x32x16_bf16 v[42:57], v[118:121], v[176:179], v[42:57]
    v_mfma_f32_32x32x16_bf16 v[58:73], v[118:121], v[180:183], v[58:73]
    s_add_u32 s89, s87, 0x4000
    buffer_load_dwordx4 v[114:117], v134, s[40:43], s89 offen offset:3072 sc1
    buffer_load_dwordx4 v[118:121], v133, s[40:43], s89 offen offset:3072 sc1
    v_mfma_f32_32x32x16_bf16 v[10:25], v[122:125], v[184:187], v[10:25]
    s_waitcnt vmcnt(10)
    v_max3_u32 v131, v75, v77, v79
    v_max_u32 v131, v131, v81
    v_cmp_eq_u32 vcc, -1, v131
    s_cbranch_vccnz Lrt_p5_431
Lbk_p5_432:
    v_mfma_f32_32x32x16_bf16 v[26:41], v[122:125], v[188:191], v[26:41]
    v_mfma_f32_32x32x16_bf16 v[42:57], v[126:129], v[184:187], v[42:57]
    v_mfma_f32_32x32x16_bf16 v[58:73], v[126:129], v[188:191], v[58:73]
    s_add_u32 s89, s88, 20
    s_min_u32 s89, s89, 85
    s_lshl_b32 s89, s89, 10
    s_add_u32 s89, s89, s86
    buffer_load_dwordx4 v[122:125], v134, s[40:43], s89 offen offset:0 sc1
    buffer_load_dwordx4 v[126:129], v133, s[40:43], s89 offen offset:0 sc1
    v_mfma_f32_32x32x16_bf16 v[10:25], v[74:77], v[192:195], v[10:25]
    s_waitcnt vmcnt(10)
    v_max3_u32 v131, v83, v85, v87
    v_max_u32 v131, v131, v89
    v_cmp_eq_u32 vcc, -1, v131
    s_cbranch_vccnz Lrt_p5_433
Lbk_p5_434:
    v_mfma_f32_32x32x16_bf16 v[26:41], v[74:77], v[196:199], v[26:41]
    v_mfma_f32_32x32x16_bf16 v[42:57], v[78:81], v[192:195], v[42:57]
    v_mfma_f32_32x32x16_bf16 v[58:73], v[78:81], v[196:199], v[58:73]
    s_add_u32 s89, s88, 21
    s_min_u32 s89, s89, 85
    s_lshl_b32 s89, s89, 10
    s_add_u32 s89, s89, s86
    buffer_load_dwordx4 v[74:77], v134, s[40:43], s89 offen offset:0 sc1
    buffer_load_dwordx4 v[78:81], v133, s[40:43], s89 offen offset:0 sc1
    v_mfma_f32_32x32x16_bf16 v[10:25], v[82:85], v[200:203], v[10:25]
    s_waitcnt vmcnt(10)
    v_max3_u32 v131, v91, v93, v95
    v_max_u32 v131, v131, v97
    v_cmp_eq_u32 vcc, -1, v131
    s_cbranch_vccnz Lrt_p5_435
Lbk_p5_436:
    v_mfma_f32_32x32x16_bf16 v[26:41], v[82:85], v[204:207], v[26:41]
    v_mfma_f32_32x32x16_bf16 v[42:57], v[86:89], v[200:203], v[42:57]
    v_mfma_f32_32x32x16_bf16 v[58:73], v[86:89], v[204:207], v[58:73]
    v_mfma_f32_32x32x16_bf16 v[10:25], v[90:93], v[208:211], v[10:25]
    s_waitcnt vmcnt(8)
    v_max3_u32 v131, v99, v101, v103
    v_max_u32 v131, v131, v105
    v_cmp_eq_u32 vcc, -1, v131
    s_cbranch_vccnz Lrt_p5_437
Lbk_p5_438:
    v_mfma_f32_32x32x16_bf16 v[26:41], v[90:93], v[212:215], v[26:41]
    v_mfma_f32_32x32x16_bf16 v[42:57], v[94:97], v[208:211], v[42:57]
    v_mfma_f32_32x32x16_bf16 v[58:73], v[94:97], v[212:215], v[58:73]
    v_mfma_f32_32x32x16_bf16 v[10:25], v[98:101], v[216:219], v[10:25]
    s_waitcnt vmcnt(6)
    v_max3_u32 v131, v107, v109, v111
    v_max_u32 v131, v131, v113
    v_cmp_eq_u32 vcc, -1, v131
    s_cbranch_vccnz Lrt_p5_439
Lbk_p5_440:
    v_mfma_f32_32x32x16_bf16 v[26:41], v[98:101], v[220:223], v[26:41]
    v_mfma_f32_32x32x16_bf16 v[42:57], v[102:105], v[216:219], v[42:57]
    v_mfma_f32_32x32x16_bf16 v[58:73], v[102:105], v[220:223], v[58:73]
    v_mfma_f32_32x32x16_bf16 v[10:25], v[106:109], v[224:227], v[10:25]
    s_waitcnt vmcnt(4)
    v_max3_u32 v131, v115, v117, v119
    v_max_u32 v131, v131, v121
    v_cmp_eq_u32 vcc, -1, v131
    s_cbranch_vccnz Lrt_p5_441
Lbk_p5_442:
    v_mfma_f32_32x32x16_bf16 v[26:41], v[106:109], v[228:231], v[26:41]
    v_mfma_f32_32x32x16_bf16 v[42:57], v[110:113], v[224:227], v[42:57]
    v_mfma_f32_32x32x16_bf16 v[58:73], v[110:113], v[228:231], v[58:73]
    v_mfma_f32_32x32x16_bf16 v[10:25], v[114:117], v[232:235], v[10:25]
    s_waitcnt vmcnt(2)
    v_max3_u32 v131, v123, v125, v127
    v_max_u32 v131, v131, v129
    v_cmp_eq_u32 vcc, -1, v131
    s_cbranch_vccnz Lrt_p5_443
Lbk_p5_444:
    v_mfma_f32_32x32x16_bf16 v[26:41], v[114:117], v[236:239], v[26:41]
    v_mfma_f32_32x32x16_bf16 v[42:57], v[118:121], v[232:235], v[42:57]
    v_mfma_f32_32x32x16_bf16 v[58:73], v[118:121], v[236:239], v[58:73]
    v_mfma_f32_32x32x16_bf16 v[10:25], v[122:125], v[240:243], v[10:25]
    s_waitcnt vmcnt(0)
    v_max3_u32 v131, v75, v77, v79
    v_max_u32 v131, v131, v81
    v_cmp_eq_u32 vcc, -1, v131
    s_cbranch_vccnz Lrt_p5_445
Lbk_p5_446:
    v_mfma_f32_32x32x16_bf16 v[26:41], v[122:125], v[244:247], v[26:41]
    v_mfma_f32_32x32x16_bf16 v[42:57], v[126:129], v[240:243], v[42:57]
    v_mfma_f32_32x32x16_bf16 v[58:73], v[126:129], v[244:247], v[58:73]
    v_mfma_f32_32x32x16_bf16 v[10:25], v[74:77], v[248:251], v[10:25]
    v_mfma_f32_32x32x16_bf16 v[26:41], v[74:77], v[252:255], v[26:41]
    v_mfma_f32_32x32x16_bf16 v[42:57], v[78:81], v[248:251], v[42:57]
    v_mfma_f32_32x32x16_bf16 v[58:73], v[78:81], v[252:255], v[58:73]
    s_nop 9
    ds_write_b128 v135, v[26:29] offset:0
    ds_write_b128 v135, v[30:33] offset:1024
    ds_write_b128 v135, v[34:37] offset:2048
    ds_write_b128 v135, v[38:41] offset:3072
    s_waitcnt lgkmcnt(3)
    ds_write_b128 v136, v[42:45] offset:0
    ds_write_b128 v136, v[46:49] offset:1024
    ds_write_b128 v136, v[50:53] offset:2048
    ds_write_b128 v136, v[54:57] offset:3072
    s_waitcnt lgkmcnt(3)
    ds_write_b128 v137, v[58:61] offset:0
    ds_write_b128 v137, v[62:65] offset:1024
    ds_write_b128 v137, v[66:69] offset:2048
    ds_write_b128 v137, v[70:73] offset:3072
    s_waitcnt lgkmcnt(3)
    v_mov_b32 v131, v139
    s_waitcnt lgkmcnt(0)
    s_barrier
    ds_read_b128 v[26:29], v131 offset:0
    ds_read_b128 v[30:33], v131 offset:1024
    ds_read_b128 v[34:37], v131 offset:2048
    ds_read_b128 v[38:41], v131 offset:3072
    ds_read_b128 v[42:45], v131 offset:4096
    ds_read_b128 v[46:49], v131 offset:5120
    ds_read_b128 v[50:53], v131 offset:6144
    ds_read_b128 v[54:57], v131 offset:7168
    ds_read_b128 v[58:61], v131 offset:8192
    ds_read_b128 v[62:65], v131 offset:9216
    ds_read_b128 v[66:69], v131 offset:10240
    ds_read_b128 v[70:73], v131 offset:11264
    s_waitcnt lgkmcnt(4)
    v_pk_add_f32 v[26:27], v[26:27], v[42:43]
    v_pk_add_f32 v[28:29], v[28:29], v[44:45]
    v_pk_add_f32 v[30:31], v[30:31], v[46:47]
    v_pk_add_f32 v[32:33], v[32:33], v[48:49]
    v_pk_add_f32 v[34:35], v[34:35], v[50:51]
    v_pk_add_f32 v[36:37], v[36:37], v[52:53]
    v_pk_add_f32 v[38:39], v[38:39], v[54:55]
    v_pk_add_f32 v[40:41], v[40:41], v[56:57]
    s_waitcnt lgkmcnt(0)
    v_pk_add_f32 v[10:11], v[10:11], v[58:59]
    v_pk_add_f32 v[12:13], v[12:13], v[60:61]
    v_pk_add_f32 v[14:15], v[14:15], v[62:63]
    v_pk_add_f32 v[16:17], v[16:17], v[64:65]
    v_pk_add_f32 v[18:19], v[18:19], v[66:67]
    v_pk_add_f32 v[20:21], v[20:21], v[68:69]
    v_pk_add_f32 v[22:23], v[22:23], v[70:71]
    v_pk_add_f32 v[24:25], v[24:25], v[72:73]
    v_pk_add_f32 v[10:11], v[10:11], v[26:27]
    v_pk_add_f32 v[12:13], v[12:13], v[28:29]
    v_pk_add_f32 v[14:15], v[14:15], v[30:31]
    v_pk_add_f32 v[16:17], v[16:17], v[32:33]
    v_pk_add_f32 v[18:19], v[18:19], v[34:35]
    v_pk_add_f32 v[20:21], v[20:21], v[36:37]
    v_pk_add_f32 v[22:23], v[22:23], v[38:39]
    v_pk_add_f32 v[24:25], v[24:25], v[40:41]
    v_cvt_pk_bf16_f32 v2, v10, v11
    v_cvt_pk_bf16_f32 v3, v12, v13
    v_cvt_pk_bf16_f32 v4, v14, v15
    v_cvt_pk_bf16_f32 v5, v16, v17
    v_cvt_pk_bf16_f32 v6, v18, v19
    v_cvt_pk_bf16_f32 v7, v20, v21
    v_cvt_pk_bf16_f32 v8, v22, v23
    v_cvt_pk_bf16_f32 v9, v24, v25
    v_mov_b32 v10, v2
    v_mov_b32 v11, v3
    v_mov_b32 v12, v4
    v_mov_b32 v13, v5
    v_mov_b32 v14, v6
    v_mov_b32 v15, v7
    v_mov_b32 v16, v8
    v_mov_b32 v17, v9
    v_permlane32_swap_b32 v10, v12
    v_permlane32_swap_b32 v11, v13
    v_permlane32_swap_b32 v14, v16
    v_permlane32_swap_b32 v15, v17
    s_mov_b32 s89, 0
    buffer_store_dwordx4 v[10:13], v140, s[32:35], s89 offen offset:0
    buffer_store_dwordx4 v[14:17], v140, s[32:35], s89 offen offset:32
    s_waitcnt vmcnt(0) lgkmcnt(0)
L_END:
    s_endpgm
Lrt_halo_6:
    s_cmp_eq_u32 s84, 0
    s_cbranch_scc1 Lbk_halo_7
    s_sub_u32 s84, s84, 1
    s_nop 4
    s_add_u32 s89, s87, 0
    s_max_u32 s89, s89, 8
    s_sub_u32 s89, s89, 8
    s_lshl_b32 s89, s89, 10
    s_add_u32 s89, s89, s86
    buffer_load_dwordx4 v[18:21], v124, s[40:43], s89 offen offset:0 sc1
    s_add_u32 s89, s87, 1
    s_max_u32 s89, s89, 8
    s_sub_u32 s89, s89, 8
    s_lshl_b32 s89, s89, 10
    s_add_u32 s89, s89, s86
    buffer_load_dwordx4 v[22:25], v124, s[40:43], s89 offen offset:0 sc1
    s_add_u32 s89, s87, 2
    s_max_u32 s89, s89, 8
    s_sub_u32 s89, s89, 8
    s_lshl_b32 s89, s89, 10
    s_add_u32 s89, s89, s86
    buffer_load_dwordx4 v[26:29], v124, s[40:43], s89 offen offset:0 sc1
    s_add_u32 s89, s87, 3
    s_max_u32 s89, s89, 8
    s_sub_u32 s89, s89, 8
    s_lshl_b32 s89, s89, 10
    s_add_u32 s89, s89, s86
    buffer_load_dwordx4 v[30:33], v124, s[40:43], s89 offen offset:0 sc1
    s_add_u32 s89, s87, 4
    s_max_u32 s89, s89, 8
    s_sub_u32 s89, s89, 8
    s_lshl_b32 s89, s89, 10
    s_add_u32 s89, s89, s86
    buffer_load_dwordx4 v[34:37], v124, s[40:43], s89 offen offset:0 sc1
    s_add_u32 s89, s87, 5
    s_max_u32 s89, s89, 8
    s_sub_u32 s89, s89, 8
    s_lshl_b32 s89, s89, 10
    s_add_u32 s89, s89, s86
    buffer_load_dwordx4 v[38:41], v124, s[40:43], s89 offen offset:0 sc1
    s_add_u32 s89, s87, 6
    s_max_u32 s89, s89, 8
    s_sub_u32 s89, s89, 8
    s_lshl_b32 s89, s89, 10
    s_add_u32 s89, s89, s86
    buffer_load_dwordx4 v[42:45], v124, s[40:43], s89 offen offset:0 sc1
    s_add_u32 s89, s87, 7
    s_max_u32 s89, s89, 8
    s_sub_u32 s89, s89, 8
    s_lshl_b32 s89, s89, 10
    s_add_u32 s89, s89, s86
    buffer_load_dwordx4 v[46:49], v124, s[40:43], s89 offen offset:0 sc1
    s_waitcnt vmcnt(0)
    v_max3_u32 v116, v21, v25, v29
    v_max3_u32 v116, v116, v33, v37
    v_max3_u32 v116, v116, v41, v45
    v_max_u32 v116, v116, v49
    v_cmp_eq_u32 vcc, -1, v116
    s_cbranch_vccnz Lrt_halo_6
    s_branch Lbk_halo_7
La2s_12:
    s_cmp_eq_u32 s83, 1
    s_cbranch_scc1 La2s_13
    s_cmp_eq_u32 s83, 2
    s_cbranch_scc1 La2s_14
    s_cmp_eq_u32 s83, 3
    s_cbranch_scc1 La2s_15
    s_cmp_eq_u32 s83, 4
    s_cbranch_scc1 La2s_16
    s_cmp_eq_u32 s83, 5
    s_cbranch_scc1 La2s_17
    s_cmp_eq_u32 s83, 6
    s_cbranch_scc1 La2s_18
    s_cmp_eq_u32 s83, 7
    s_cbranch_scc1 La2s_19
    s_cmp_eq_u32 s83, 8
    s_cbranch_scc1 La2s_20
    s_branch La2s_20
La2s_13:
    v_mov_b32 v126, -1
    v_mov_b32 v127, -1
    v_mov_b32 v128, -1
    v_mov_b32 v129, -1
    v_lshlrev_b32 v130, 4, v0
    v_lshlrev_b32 v131, 3, v0
    v_and_b32 v132, 31, v0
    v_lshlrev_b32 v132, 3, v132
    s_lshl_b32 s88, s81, 1
    s_add_u32 s88, s88, s100
    s_mul_i32 s88, s88, 96
    s_mul_i32 s92, s82, 3
    s_add_u32 s88, s88, s92
    s_lshl_b32 s88, s88, 10
    s_add_u32 s88, s88, 0x1000000
    s_lshl_b32 s92, s101, 9
    s_add_u32 s88, s88, s92
    buffer_store_dwordx2 v[126:127], v131, s[40:43], s88 offen offset:0 sc1
    buffer_store_dwordx2 v[126:127], v131, s[40:43], s88 offen offset:1024 sc1
    buffer_store_dwordx2 v[126:127], v131, s[40:43], s88 offen offset:2048 sc1
    s_lshl_b32 s88, s79, 1
    s_add_u32 s88, s88, s101
    s_lshl_b32 s88, s88, 5
    s_lshl_b32 s92, s80, 2
    s_add_u32 s88, s88, s92
    s_lshl_b32 s92, s100, 1
    s_add_u32 s88, s88, s92
    s_lshl_b32 s88, s88, 10
    s_add_u32 s88, s88, 0x1400000
    buffer_store_dwordx4 v[126:129], v130, s[40:43], s88 offen offset:0 sc1
    buffer_store_dwordx4 v[126:129], v130, s[40:43], s88 offen offset:1024 sc1
    v_mov_b32 v50, 0
    v_mov_b32 v51, 0
    v_mov_b32 v52, 0
    v_mov_b32 v53, 0
    v_mov_b32 v54, 0
    v_mov_b32 v55, 0
    v_mov_b32 v56, 0
    v_mov_b32 v57, 0
    v_mov_b32 v58, 0
    v_mov_b32 v59, 0
    v_mov_b32 v60, 0
    v_mov_b32 v61, 0
    v_mov_b32 v62, 0
    v_mov_b32 v63, 0
    v_mov_b32 v64, 0
    v_mov_b32 v65, 0
    ds_read_b128 v[94:97], v120 offset:1152
    ds_read_b128 v[90:93], v120 offset:2304
    ds_read_b64_tr_b16 v[106:107], v121 offset:0
    ds_read_b64_tr_b16 v[108:109], v121 offset:128
    ds_read_b64_tr_b16 v[110:111], v121 offset:256
    ds_read_b64_tr_b16 v[112:113], v121 offset:384
    v_mul_f32 v66, -1.0, v114
    v_mul_f32 v67, -1.0, v114
    v_mul_f32 v68, -1.0, v114
    v_mul_f32 v69, -1.0, v114
    v_mul_f32 v70, -1.0, v114
    v_mul_f32 v71, -1.0, v114
    v_mul_f32 v72, -1.0, v114
    v_mul_f32 v73, -1.0, v114
    v_mul_f32 v74, -1.0, v114
    v_mul_f32 v75, -1.0, v114
    v_mul_f32 v76, -1.0, v114
    v_mul_f32 v77, -1.0, v114
    v_mul_f32 v78, -1.0, v114
    v_mul_f32 v79, -1.0, v114
    v_mul_f32 v80, -1.0, v114
    v_mul_f32 v81, -1.0, v114
    s_waitcnt lgkmcnt(5)
    s_nop 0
    v_mfma_f32_32x32x16_bf16 v[34:49], v[94:97], v[10:13], v[66:81]
    s_nop 7
    s_nop 3
    s_branch La2b_22
La2s_14:
    v_mov_b32 v126, -1
    v_mov_b32 v127, -1
    v_mov_b32 v128, -1
    v_mov_b32 v129, -1
    v_lshlrev_b32 v130, 4, v0
    v_lshlrev_b32 v131, 3, v0
    v_and_b32 v132, 31, v0
    v_lshlrev_b32 v132, 3, v132
    s_lshl_b32 s88, s81, 1
    s_add_u32 s88, s88, s100
    s_mul_i32 s88, s88, 96
    s_mul_i32 s92, s82, 3
    s_add_u32 s88, s88, s92
    s_lshl_b32 s88, s88, 10
    s_add_u32 s88, s88, 0x1000000
    s_lshl_b32 s92, s101, 9
    s_add_u32 s88, s88, s92
    buffer_store_dwordx2 v[126:127], v131, s[40:43], s88 offen offset:0 sc1
    buffer_store_dwordx2 v[126:127], v131, s[40:43], s88 offen offset:1024 sc1
    buffer_store_dwordx2 v[126:127], v131, s[40:43], s88 offen offset:2048 sc1
    s_lshl_b32 s88, s79, 1
    s_add_u32 s88, s88, s101
    s_lshl_b32 s88, s88, 5
    s_lshl_b32 s92, s80, 2
    s_add_u32 s88, s88, s92
    s_lshl_b32 s92, s100, 1
    s_add_u32 s88, s88, s92
    s_lshl_b32 s88, s88, 10
    s_add_u32 s88, s88, 0x1400000
    buffer_store_dwordx4 v[126:129], v130, s[40:43], s88 offen offset:0 sc1
    buffer_store_dwordx4 v[126:129], v130, s[40:43], s88 offen offset:1024 sc1
    s_lshl_b32 s88, s79, 3
    s_add_u32 s88, s88, s80
    s_lshl_b32 s88, s88, 1
    s_add_u32 s88, s88, s100
    s_lshl_b32 s88, s88, 9
    s_lshl_b32 s92, s101, 8
    s_add_u32 s88, s88, s92
    s_add_u32 s88, s88, 0x1680000
    buffer_store_dwordx2 v[126:127], v132, s[40:43], s88 offen offset:0 sc1
    v_lshrrev_b32 v138, 3, v0
    v_lshlrev_b32 v138, 10, v138
    v_and_b32 v139, 7, v0
    v_lshrrev_b32 v140, 4, v0
    v_and_b32 v140, 1, v140
    v_lshlrev_b32 v140, 2, v140
    v_xor_b32 v139, v139, v140
    v_lshlrev_b32 v139, 4, v139
    v_add_u32 v138, v138, v139
    s_lshl_b32 s96, s76, 17
    s_lshl_b32 s97, s80, 7
    s_add_u32 s96, s96, s97
    s_lshl_b32 s97, s76, 14
    s_add_u32 s92, s96, 0x0
    s_add_u32 m0, s97, 57344
    s_nop 0
    buffer_load_dwordx4 v138, s[12:15], s92 offen lds
    s_add_u32 s92, s96, 0x2000
    s_add_u32 m0, s97, 58368
    s_nop 0
    buffer_load_dwordx4 v138, s[12:15], s92 offen lds
    s_add_u32 s92, s96, 0x4000
    s_add_u32 m0, s97, 59392
    s_nop 0
    buffer_load_dwordx4 v138, s[12:15], s92 offen lds
    v_mov_b32 v50, 0
    v_mov_b32 v51, 0
    v_mov_b32 v52, 0
    v_mov_b32 v53, 0
    v_mov_b32 v54, 0
    v_mov_b32 v55, 0
    v_mov_b32 v56, 0
    v_mov_b32 v57, 0
    v_mov_b32 v58, 0
    v_mov_b32 v59, 0
    v_mov_b32 v60, 0
    v_mov_b32 v61, 0
    v_mov_b32 v62, 0
    v_mov_b32 v63, 0
    v_mov_b32 v64, 0
    v_mov_b32 v65, 0
    ds_read_b128 v[90:93], v120 offset:2304
    ds_read_b128 v[94:97], v120 offset:3456
    ds_read_b64_tr_b16 v[98:99], v121 offset:0
    ds_read_b64_tr_b16 v[100:101], v121 offset:128
    ds_read_b64_tr_b16 v[102:103], v121 offset:256
    ds_read_b64_tr_b16 v[104:105], v121 offset:384
    v_mul_f32 v66, -1.0, v114
    v_mul_f32 v67, -1.0, v114
    v_mul_f32 v68, -1.0, v114
    v_mul_f32 v69, -1.0, v114
    v_mul_f32 v70, -1.0, v114
    v_mul_f32 v71, -1.0, v114
    v_mul_f32 v72, -1.0, v114
    v_mul_f32 v73, -1.0, v114
    v_mul_f32 v74, -1.0, v114
    v_mul_f32 v75, -1.0, v114
    v_mul_f32 v76, -1.0, v114
    v_mul_f32 v77, -1.0, v114
    v_mul_f32 v78, -1.0, v114
    v_mul_f32 v79, -1.0, v114
    v_mul_f32 v80, -1.0, v114
    v_mul_f32 v81, -1.0, v114
    s_waitcnt lgkmcnt(5)
    s_nop 0
    v_mfma_f32_32x32x16_bf16 v[18:33], v[90:93], v[10:13], v[66:81]
    s_nop 7
    s_nop 3
    s_branch La2b_23
La2s_15:
    v_mov_b32 v126, -1
    v_mov_b32 v127, -1
    v_mov_b32 v128, -1
    v_mov_b32 v129, -1
    v_lshlrev_b32 v130, 4, v0
    v_lshlrev_b32 v131, 3, v0
    v_and_b32 v132, 31, v0
    v_lshlrev_b32 v132, 3, v132
    s_lshl_b32 s88, s81, 1
    s_add_u32 s88, s88, s100
    s_mul_i32 s88, s88, 96
    s_mul_i32 s92, s82, 3
    s_add_u32 s88, s88, s92
    s_lshl_b32 s88, s88, 10
    s_add_u32 s88, s88, 0x1000000
    s_lshl_b32 s92, s101, 9
    s_add_u32 s88, s88, s92
    buffer_store_dwordx2 v[126:127], v131, s[40:43], s88 offen offset:0 sc1
    buffer_store_dwordx2 v[126:127], v131, s[40:43], s88 offen offset:1024 sc1
    buffer_store_dwordx2 v[126:127], v131, s[40:43], s88 offen offset:2048 sc1
    s_lshl_b32 s88, s79, 1
    s_add_u32 s88, s88, s101
    s_lshl_b32 s88, s88, 5
    s_lshl_b32 s92, s80, 2
    s_add_u32 s88, s88, s92
    s_lshl_b32 s92, s100, 1
    s_add_u32 s88, s88, s92
    s_lshl_b32 s88, s88, 10
    s_add_u32 s88, s88, 0x1400000
    buffer_store_dwordx4 v[126:129], v130, s[40:43], s88 offen offset:0 sc1
    buffer_store_dwordx4 v[126:129], v130, s[40:43], s88 offen offset:1024 sc1
    s_lshl_b32 s88, s79, 3
    s_add_u32 s88, s88, s80
    s_lshl_b32 s88, s88, 1
    s_add_u32 s88, s88, s100
    s_lshl_b32 s88, s88, 9
    s_lshl_b32 s92, s101, 8
    s_add_u32 s88, s88, s92
    s_add_u32 s88, s88, 0x1680000
    buffer_store_dwordx2 v[126:127], v132, s[40:43], s88 offen offset:0 sc1
    v_lshrrev_b32 v138, 3, v0
    v_lshlrev_b32 v138, 10, v138
    v_and_b32 v139, 7, v0
    v_lshrrev_b32 v140, 4, v0
    v_and_b32 v140, 1, v140
    v_lshlrev_b32 v140, 2, v140
    v_xor_b32 v139, v139, v140
    v_lshlrev_b32 v139, 4, v139
    v_add_u32 v138, v138, v139
    s_lshl_b32 s96, s76, 17
    s_lshl_b32 s97, s80, 7
    s_add_u32 s96, s96, s97
    s_lshl_b32 s97, s76, 14
    s_add_u32 s92, s96, 0x0
    s_add_u32 m0, s97, 57344
    s_nop 0
    buffer_load_dwordx4 v138, s[12:15], s92 offen lds
    s_add_u32 s92, s96, 0x2000
    s_add_u32 m0, s97, 58368
    s_nop 0
    buffer_load_dwordx4 v138, s[12:15], s92 offen lds
    s_add_u32 s92, s96, 0x4000
    s_add_u32 m0, s97, 59392
    s_nop 0
    buffer_load_dwordx4 v138, s[12:15], s92 offen lds
    s_add_u32 s92, s96, 0x6000
    s_add_u32 m0, s97, 60416
    s_nop 0
    buffer_load_dwordx4 v138, s[12:15], s92 offen lds
    s_add_u32 s92, s96, 0x8000
    s_add_u32 m0, s97, 61440
    s_nop 0
    buffer_load_dwordx4 v138, s[12:15], s92 offen lds
    s_add_u32 s92, s96, 0xa000
    s_add_u32 m0, s97, 62464
    s_nop 0
    buffer_load_dwordx4 v138, s[12:15], s92 offen lds
    s_add_u32 s92, s96, 0xc000
    s_add_u32 m0, s97, 63488
    s_nop 0
    buffer_load_dwordx4 v138, s[12:15], s92 offen lds
    s_add_u32 s92, s96, 0xe000
    s_add_u32 m0, s97, 64512
    s_nop 0
    buffer_load_dwordx4 v138, s[12:15], s92 offen lds
    s_add_u32 s92, s96, 0x10000
    s_add_u32 m0, s97, 65536
    s_nop 0
    buffer_load_dwordx4 v138, s[12:15], s92 offen lds
    v_mov_b32 v50, 0
    v_mov_b32 v51, 0
    v_mov_b32 v52, 0
    v_mov_b32 v53, 0
    v_mov_b32 v54, 0
    v_mov_b32 v55, 0
    v_mov_b32 v56, 0
    v_mov_b32 v57, 0
    v_mov_b32 v58, 0
    v_mov_b32 v59, 0
    v_mov_b32 v60, 0
    v_mov_b32 v61, 0
    v_mov_b32 v62, 0
    v_mov_b32 v63, 0
    v_mov_b32 v64, 0
    v_mov_b32 v65, 0
    ds_read_b128 v[94:97], v120 offset:3456
    ds_read_b128 v[90:93], v120 offset:4608
    ds_read_b64_tr_b16 v[106:107], v121 offset:0
    ds_read_b64_tr_b16 v[108:109], v121 offset:128
    ds_read_b64_tr_b16 v[110:111], v121 offset:256
    ds_read_b64_tr_b16 v[112:113], v121 offset:384
    v_mul_f32 v66, -1.0, v114
    v_mul_f32 v67, -1.0, v114
    v_mul_f32 v68, -1.0, v114
    v_mul_f32 v69, -1.0, v114
    v_mul_f32 v70, -1.0, v114
    v_mul_f32 v71, -1.0, v114
    v_mul_f32 v72, -1.0, v114
    v_mul_f32 v73, -1.0, v114
    v_mul_f32 v74, -1.0, v114
    v_mul_f32 v75, -1.0, v114
    v_mul_f32 v76, -1.0, v114
    v_mul_f32 v77, -1.0, v114
    v_mul_f32 v78, -1.0, v114
    v_mul_f32 v79, -1.0, v114
    v_mul_f32 v80, -1.0, v114
    v_mul_f32 v81, -1.0, v114
    s_waitcnt lgkmcnt(5)
    s_nop 0
    v_mfma_f32_32x32x16_bf16 v[34:49], v[94:97], v[10:13], v[66:81]
    s_nop 7
    s_nop 3
    s_branch La2b_24
La2s_16:
    v_mov_b32 v126, -1
    v_mov_b32 v127, -1
    v_mov_b32 v128, -1
    v_mov_b32 v129, -1
    v_lshlrev_b32 v130, 4, v0
    v_lshlrev_b32 v131, 3, v0
    v_and_b32 v132, 31, v0
    v_lshlrev_b32 v132, 3, v132
    s_lshl_b32 s88, s81, 1
    s_add_u32 s88, s88, s100
    s_mul_i32 s88, s88, 96
    s_mul_i32 s92, s82, 3
    s_add_u32 s88, s88, s92
    s_lshl_b32 s88, s88, 10
    s_add_u32 s88, s88, 0x1000000
    s_lshl_b32 s92, s101, 9
    s_add_u32 s88, s88, s92
    buffer_store_dwordx2 v[126:127], v131, s[40:43], s88 offen offset:0 sc1
    buffer_store_dwordx2 v[126:127], v131, s[40:43], s88 offen offset:1024 sc1
    buffer_store_dwordx2 v[126:127], v131, s[40:43], s88 offen offset:2048 sc1
    s_lshl_b32 s88, s79, 1
    s_add_u32 s88, s88, s101
    s_lshl_b32 s88, s88, 5
    s_lshl_b32 s92, s80, 2
    s_add_u32 s88, s88, s92
    s_lshl_b32 s92, s100, 1
    s_add_u32 s88, s88, s92
    s_lshl_b32 s88, s88, 10
    s_add_u32 s88, s88, 0x1400000
    buffer_store_dwordx4 v[126:129], v130, s[40:43], s88 offen offset:0 sc1
    buffer_store_dwordx4 v[126:129], v130, s[40:43], s88 offen offset:1024 sc1
    s_lshl_b32 s88, s79, 3
    s_add_u32 s88, s88, s80
    s_lshl_b32 s88, s88, 1
    s_add_u32 s88, s88, s100
    s_lshl_b32 s88, s88, 9
    s_lshl_b32 s92, s101, 8
    s_add_u32 s88, s88, s92
    s_add_u32 s88, s88, 0x1680000
    buffer_store_dwordx2 v[126:127], v132, s[40:43], s88 offen offset:0 sc1
    v_lshrrev_b32 v138, 3, v0
    v_lshlrev_b32 v138, 10, v138
    v_and_b32 v139, 7, v0
    v_lshrrev_b32 v140, 4, v0
    v_and_b32 v140, 1, v140
    v_lshlrev_b32 v140, 2, v140
    v_xor_b32 v139, v139, v140
    v_lshlrev_b32 v139, 4, v139
    v_add_u32 v138, v138, v139
    s_lshl_b32 s96, s76, 17
    s_lshl_b32 s97, s80, 7
    s_add_u32 s96, s96, s97
    s_lshl_b32 s97, s76, 14
    s_add_u32 s92, s96, 0x0
    s_add_u32 m0, s97, 57344
    s_nop 0
    buffer_load_dwordx4 v138, s[12:15], s92 offen lds
    s_add_u32 s92, s96, 0x2000
    s_add_u32 m0, s97, 58368
    s_nop 0
    buffer_load_dwordx4 v138, s[12:15], s92 offen lds
    s_add_u32 s92, s96, 0x4000
    s_add_u32 m0, s97, 59392
    s_nop 0
    buffer_load_dwordx4 v138, s[12:15], s92 offen lds
    s_add_u32 s92, s96, 0x6000
    s_add_u32 m0, s97, 60416
    s_nop 0
    buffer_load_dwordx4 v138, s[12:15], s92 offen lds
    s_add_u32 s92, s96, 0x8000
    s_add_u32 m0, s97, 61440
    s_nop 0
    buffer_load_dwordx4 v138, s[12:15], s92 offen lds
    s_add_u32 s92, s96, 0xa000
    s_add_u32 m0, s97, 62464
    s_nop 0
    buffer_load_dwordx4 v138, s[12:15], s92 offen lds
    s_add_u32 s92, s96, 0xc000
    s_add_u32 m0, s97, 63488
    s_nop 0
    buffer_load_dwordx4 v138, s[12:15], s92 offen lds
    s_add_u32 s92, s96, 0xe000
    s_add_u32 m0, s97, 64512
    s_nop 0
    buffer_load_dwordx4 v138, s[12:15], s92 offen lds
    s_add_u32 s92, s96, 0x10000
    s_add_u32 m0, s97, 65536
    s_nop 0
    buffer_load_dwordx4 v138, s[12:15], s92 offen lds
    s_add_u32 s92, s96, 0x12000
    s_add_u32 m0, s97, 66560
    s_nop 0
    buffer_load_dwordx4 v138, s[12:15], s92 offen lds
    s_add_u32 s92, s96, 0x14000
    s_add_u32 m0, s97, 67584
    s_nop 0
    buffer_load_dwordx4 v138, s[12:15], s92 offen lds
    s_add_u32 s92, s96, 0x16000
    s_add_u32 m0, s97, 68608
    s_nop 0
    buffer_load_dwordx4 v138, s[12:15], s92 offen lds
    s_add_u32 s92, s96, 0x18000
    s_add_u32 m0, s97, 69632
    s_nop 0
    buffer_load_dwordx4 v138, s[12:15], s92 offen lds
    s_add_u32 s92, s96, 0x1a000
    s_add_u32 m0, s97, 70656
    s_nop 0
    buffer_load_dwordx4 v138, s[12:15], s92 offen lds
    s_add_u32 s92, s96, 0x1c000
    s_add_u32 m0, s97, 71680
    s_nop 0
    buffer_load_dwordx4 v138, s[12:15], s92 offen lds
    v_mov_b32 v50, 0
    v_mov_b32 v51, 0
    v_mov_b32 v52, 0
    v_mov_b32 v53, 0
    v_mov_b32 v54, 0
    v_mov_b32 v55, 0
    v_mov_b32 v56, 0
    v_mov_b32 v57, 0
    v_mov_b32 v58, 0
    v_mov_b32 v59, 0
    v_mov_b32 v60, 0
    v_mov_b32 v61, 0
    v_mov_b32 v62, 0
    v_mov_b32 v63, 0
    v_mov_b32 v64, 0
    v_mov_b32 v65, 0
    ds_read_b128 v[90:93], v120 offset:4608
    ds_read_b128 v[94:97], v120 offset:5760
    ds_read_b64_tr_b16 v[98:99], v121 offset:0
    ds_read_b64_tr_b16 v[100:101], v121 offset:128
    ds_read_b64_tr_b16 v[102:103], v121 offset:256
    ds_read_b64_tr_b16 v[104:105], v121 offset:384
    v_mul_f32 v66, -1.0, v114
    v_mul_f32 v67, -1.0, v114
    v_mul_f32 v68, -1.0, v114
    v_mul_f32 v69, -1.0, v114
    v_mul_f32 v70, -1.0, v114
    v_mul_f32 v71, -1.0, v114
    v_mul_f32 v72, -1.0, v114
    v_mul_f32 v73, -1.0, v114
    v_mul_f32 v74, -1.0, v114
    v_mul_f32 v75, -1.0, v114
    v_mul_f32 v76, -1.0, v114
    v_mul_f32 v77, -1.0, v114
    v_mul_f32 v78, -1.0, v114
    v_mul_f32 v79, -1.0, v114
    v_mul_f32 v80, -1.0, v114
    v_mul_f32 v81, -1.0, v114
    s_waitcnt lgkmcnt(5)
    s_nop 0
    v_mfma_f32_32x32x16_bf16 v[18:33], v[90:93], v[10:13], v[66:81]
    s_nop 7
    s_nop 3
    s_branch La2b_25
La2s_17:
    v_mov_b32 v126, -1
    v_mov_b32 v127, -1
    v_mov_b32 v128, -1
    v_mov_b32 v129, -1
    v_lshlrev_b32 v130, 4, v0
    v_lshlrev_b32 v131, 3, v0
    v_and_b32 v132, 31, v0
    v_lshlrev_b32 v132, 3, v132
    s_lshl_b32 s88, s81, 1
    s_add_u32 s88, s88, s100
    s_mul_i32 s88, s88, 96
    s_mul_i32 s92, s82, 3
    s_add_u32 s88, s88, s92
    s_lshl_b32 s88, s88, 10
    s_add_u32 s88, s88, 0x1000000
    s_lshl_b32 s92, s101, 9
    s_add_u32 s88, s88, s92
    buffer_store_dwordx2 v[126:127], v131, s[40:43], s88 offen offset:0 sc1
    buffer_store_dwordx2 v[126:127], v131, s[40:43], s88 offen offset:1024 sc1
    buffer_store_dwordx2 v[126:127], v131, s[40:43], s88 offen offset:2048 sc1
    s_lshl_b32 s88, s79, 1
    s_add_u32 s88, s88, s101
    s_lshl_b32 s88, s88, 5
    s_lshl_b32 s92, s80, 2
    s_add_u32 s88, s88, s92
    s_lshl_b32 s92, s100, 1
    s_add_u32 s88, s88, s92
    s_lshl_b32 s88, s88, 10
    s_add_u32 s88, s88, 0x1400000
    buffer_store_dwordx4 v[126:129], v130, s[40:43], s88 offen offset:0 sc1
    buffer_store_dwordx4 v[126:129], v130, s[40:43], s88 offen offset:1024 sc1
    s_lshl_b32 s88, s79, 3
    s_add_u32 s88, s88, s80
    s_lshl_b32 s88, s88, 1
    s_add_u32 s88, s88, s100
    s_lshl_b32 s88, s88, 9
    s_lshl_b32 s92, s101, 8
    s_add_u32 s88, s88, s92
    s_add_u32 s88, s88, 0x1680000
    buffer_store_dwordx2 v[126:127], v132, s[40:43], s88 offen offset:0 sc1
    v_lshrrev_b32 v138, 3, v0
    v_lshlrev_b32 v138, 10, v138
    v_and_b32 v139, 7, v0
    v_lshrrev_b32 v140, 4, v0
    v_and_b32 v140, 1, v140
    v_lshlrev_b32 v140, 2, v140
    v_xor_b32 v139, v139, v140
    v_lshlrev_b32 v139, 4, v139
    v_add_u32 v138, v138, v139
    s_lshl_b32 s96, s76, 17
    s_lshl_b32 s97, s80, 7
    s_add_u32 s96, s96, s97
    s_lshl_b32 s97, s76, 14
    s_add_u32 s92, s96, 0x0
    s_add_u32 m0, s97, 57344
    s_nop 0
    buffer_load_dwordx4 v138, s[12:15], s92 offen lds
    s_add_u32 s92, s96, 0x2000
    s_add_u32 m0, s97, 58368
    s_nop 0
    buffer_load_dwordx4 v138, s[12:15], s92 offen lds
    s_add_u32 s92, s96, 0x4000
    s_add_u32 m0, s97, 59392
    s_nop 0
    buffer_load_dwordx4 v138, s[12:15], s92 offen lds
    s_add_u32 s92, s96, 0x6000
    s_add_u32 m0, s97, 60416
    s_nop 0
    buffer_load_dwordx4 v138, s[12:15], s92 offen lds
    s_add_u32 s92, s96, 0x8000
    s_add_u32 m0, s97, 61440
    s_nop 0
    buffer_load_dwordx4 v138, s[12:15], s92 offen lds
    s_add_u32 s92, s96, 0xa000
    s_add_u32 m0, s97, 62464
    s_nop 0
    buffer_load_dwordx4 v138, s[12:15], s92 offen lds
    s_add_u32 s92, s96, 0xc000
    s_add_u32 m0, s97, 63488
    s_nop 0
    buffer_load_dwordx4 v138, s[12:15], s92 offen lds
    s_add_u32 s92, s96, 0xe000
    s_add_u32 m0, s97, 64512
    s_nop 0
    buffer_load_dwordx4 v138, s[12:15], s92 offen lds
    s_add_u32 s92, s96, 0x10000
    s_add_u32 m0, s97, 65536
    s_nop 0
    buffer_load_dwordx4 v138, s[12:15], s92 offen lds
    s_add_u32 s92, s96, 0x12000
    s_add_u32 m0, s97, 66560
    s_nop 0
    buffer_load_dwordx4 v138, s[12:15], s92 offen lds
    s_add_u32 s92, s96, 0x14000
    s_add_u32 m0, s97, 67584
    s_nop 0
    buffer_load_dwordx4 v138, s[12:15], s92 offen lds
    s_add_u32 s92, s96, 0x16000
    s_add_u32 m0, s97, 68608
    s_nop 0
    buffer_load_dwordx4 v138, s[12:15], s92 offen lds
    s_add_u32 s92, s96, 0x18000
    s_add_u32 m0, s97, 69632
    s_nop 0
    buffer_load_dwordx4 v138, s[12:15], s92 offen lds
    s_add_u32 s92, s96, 0x1a000
    s_add_u32 m0, s97, 70656
    s_nop 0
    buffer_load_dwordx4 v138, s[12:15], s92 offen lds
    s_add_u32 s92, s96, 0x1c000
    s_add_u32 m0, s97, 71680
    s_nop 0
    buffer_load_dwordx4 v138, s[12:15], s92 offen lds
    s_add_u32 s92, s96, 0x1e000
    s_add_u32 m0, s97, 72704
    s_nop 0
    buffer_load_dwordx4 v138, s[12:15], s92 offen lds
    v_lshlrev_b32 v136, 4, v0
    s_lshl_b32 s96, s82, 6
    s_lshl_b32 s97, s76, 4
    s_add_u32 s96, s96, s97
    s_mul_i32 s96, s96, 3072
    s_add_u32 s96, s96, 0x1a00000
    s_add_u32 s97, s96, 0x0
    buffer_load_dwordx4 a[0:3], v136, s[40:43], s97 offen offset:0 sc1
    buffer_load_dwordx4 a[4:7], v136, s[40:43], s97 offen offset:1024 sc1
    buffer_load_dwordx4 a[8:11], v136, s[40:43], s97 offen offset:2048 sc1
    s_add_u32 s97, s96, 0xc00
    buffer_load_dwordx4 a[12:15], v136, s[40:43], s97 offen offset:0 sc1
    v_mov_b32 v50, 0
    v_mov_b32 v51, 0
    v_mov_b32 v52, 0
    v_mov_b32 v53, 0
    v_mov_b32 v54, 0
    v_mov_b32 v55, 0
    v_mov_b32 v56, 0
    v_mov_b32 v57, 0
    v_mov_b32 v58, 0
    v_mov_b32 v59, 0
    v_mov_b32 v60, 0
    v_mov_b32 v61, 0
    v_mov_b32 v62, 0
    v_mov_b32 v63, 0
    v_mov_b32 v64, 0
    v_mov_b32 v65, 0
    ds_read_b128 v[94:97], v120 offset:5760
    ds_read_b128 v[90:93], v120 offset:6912
    ds_read_b64_tr_b16 v[106:107], v121 offset:0
    ds_read_b64_tr_b16 v[108:109], v121 offset:128
    ds_read_b64_tr_b16 v[110:111], v121 offset:256
    ds_read_b64_tr_b16 v[112:113], v121 offset:384
    v_mul_f32 v66, -1.0, v114
    v_mul_f32 v67, -1.0, v114
    v_mul_f32 v68, -1.0, v114
    v_mul_f32 v69, -1.0, v114
    v_mul_f32 v70, -1.0, v114
    v_mul_f32 v71, -1.0, v114
    v_mul_f32 v72, -1.0, v114
    v_mul_f32 v73, -1.0, v114
    v_mul_f32 v74, -1.0, v114
    v_mul_f32 v75, -1.0, v114
    v_mul_f32 v76, -1.0, v114
    v_mul_f32 v77, -1.0, v114
    v_mul_f32 v78, -1.0, v114
    v_mul_f32 v79, -1.0, v114
    v_mul_f32 v80, -1.0, v114
    v_mul_f32 v81, -1.0, v114
    s_waitcnt lgkmcnt(5)
    s_nop 0
    v_mfma_f32_32x32x16_bf16 v[34:49], v[94:97], v[10:13], v[66:81]
    s_nop 7
    s_nop 3
    s_branch La2b_26
La2s_18:
    v_mov_b32 v126, -1
    v_mov_b32 v127, -1
    v_mov_b32 v128, -1
    v_mov_b32 v129, -1
    v_lshlrev_b32 v130, 4, v0
    v_lshlrev_b32 v131, 3, v0
    v_and_b32 v132, 31, v0
    v_lshlrev_b32 v132, 3, v132
    s_lshl_b32 s88, s81, 1
    s_add_u32 s88, s88, s100
    s_mul_i32 s88, s88, 96
    s_mul_i32 s92, s82, 3
    s_add_u32 s88, s88, s92
    s_lshl_b32 s88, s88, 10
    s_add_u32 s88, s88, 0x1000000
    s_lshl_b32 s92, s101, 9
    s_add_u32 s88, s88, s92
    buffer_store_dwordx2 v[126:127], v131, s[40:43], s88 offen offset:0 sc1
    buffer_store_dwordx2 v[126:127], v131, s[40:43], s88 offen offset:1024 sc1
    buffer_store_dwordx2 v[126:127], v131, s[40:43], s88 offen offset:2048 sc1
    s_lshl_b32 s88, s79, 1
    s_add_u32 s88, s88, s101
    s_lshl_b32 s88, s88, 5
    s_lshl_b32 s92, s80, 2
    s_add_u32 s88, s88, s92
    s_lshl_b32 s92, s100, 1
    s_add_u32 s88, s88, s92
    s_lshl_b32 s88, s88, 10
    s_add_u32 s88, s88, 0x1400000
    buffer_store_dwordx4 v[126:129], v130, s[40:43], s88 offen offset:0 sc1
    buffer_store_dwordx4 v[126:129], v130, s[40:43], s88 offen offset:1024 sc1
    s_lshl_b32 s88, s79, 3
    s_add_u32 s88, s88, s80
    s_lshl_b32 s88, s88, 1
    s_add_u32 s88, s88, s100
    s_lshl_b32 s88, s88, 9
    s_lshl_b32 s92, s101, 8
    s_add_u32 s88, s88, s92
    s_add_u32 s88, s88, 0x1680000
    buffer_store_dwordx2 v[126:127], v132, s[40:43], s88 offen offset:0 sc1
    v_lshrrev_b32 v138, 3, v0
    v_lshlrev_b32 v138, 10, v138
    v_and_b32 v139, 7, v0
    v_lshrrev_b32 v140, 4, v0
    v_and_b32 v140, 1, v140
    v_lshlrev_b32 v140, 2, v140
    v_xor_b32 v139, v139, v140
    v_lshlrev_b32 v139, 4, v139
    v_add_u32 v138, v138, v139
    s_lshl_b32 s96, s76, 17
    s_lshl_b32 s97, s80, 7
    s_add_u32 s96, s96, s97
    s_lshl_b32 s97, s76, 14
    s_add_u32 s92, s96, 0x0
    s_add_u32 m0, s97, 57344
    s_nop 0
    buffer_load_dwordx4 v138, s[12:15], s92 offen lds
    s_add_u32 s92, s96, 0x2000
    s_add_u32 m0, s97, 58368
    s_nop 0
    buffer_load_dwordx4 v138, s[12:15], s92 offen lds
    s_add_u32 s92, s96, 0x4000
    s_add_u32 m0, s97, 59392
    s_nop 0
    buffer_load_dwordx4 v138, s[12:15], s92 offen lds
    s_add_u32 s92, s96, 0x6000
    s_add_u32 m0, s97, 60416
    s_nop 0
    buffer_load_dwordx4 v138, s[12:15], s92 offen lds
    s_add_u32 s92, s96, 0x8000
    s_add_u32 m0, s97, 61440
    s_nop 0
    buffer_load_dwordx4 v138, s[12:15], s92 offen lds
    s_add_u32 s92, s96, 0xa000
    s_add_u32 m0, s97, 62464
    s_nop 0
    buffer_load_dwordx4 v138, s[12:15], s92 offen lds
    s_add_u32 s92, s96, 0xc000
    s_add_u32 m0, s97, 63488
    s_nop 0
    buffer_load_dwordx4 v138, s[12:15], s92 offen lds
    s_add_u32 s92, s96, 0xe000
    s_add_u32 m0, s97, 64512
    s_nop 0
    buffer_load_dwordx4 v138, s[12:15], s92 offen lds
    s_add_u32 s92, s96, 0x10000
    s_add_u32 m0, s97, 65536
    s_nop 0
    buffer_load_dwordx4 v138, s[12:15], s92 offen lds
    s_add_u32 s92, s96, 0x12000
    s_add_u32 m0, s97, 66560
    s_nop 0
    buffer_load_dwordx4 v138, s[12:15], s92 offen lds
    s_add_u32 s92, s96, 0x14000
    s_add_u32 m0, s97, 67584
    s_nop 0
    buffer_load_dwordx4 v138, s[12:15], s92 offen lds
    s_add_u32 s92, s96, 0x16000
    s_add_u32 m0, s97, 68608
    s_nop 0
    buffer_load_dwordx4 v138, s[12:15], s92 offen lds
    s_add_u32 s92, s96, 0x18000
    s_add_u32 m0, s97, 69632
    s_nop 0
    buffer_load_dwordx4 v138, s[12:15], s92 offen lds
    s_add_u32 s92, s96, 0x1a000
    s_add_u32 m0, s97, 70656
    s_nop 0
    buffer_load_dwordx4 v138, s[12:15], s92 offen lds
    s_add_u32 s92, s96, 0x1c000
    s_add_u32 m0, s97, 71680
    s_nop 0
    buffer_load_dwordx4 v138, s[12:15], s92 offen lds
    s_add_u32 s92, s96, 0x1e000
    s_add_u32 m0, s97, 72704
    s_nop 0
    buffer_load_dwordx4 v138, s[12:15], s92 offen lds
    v_lshlrev_b32 v136, 4, v0
    s_lshl_b32 s96, s82, 6
    s_lshl_b32 s97, s76, 4
    s_add_u32 s96, s96, s97
    s_mul_i32 s96, s96, 3072
    s_add_u32 s96, s96, 0x1a00000
    s_add_u32 s97, s96, 0x0
    buffer_load_dwordx4 a[0:3], v136, s[40:43], s97 offen offset:0 sc1
    buffer_load_dwordx4 a[4:7], v136, s[40:43], s97 offen offset:1024 sc1
    buffer_load_dwordx4 a[8:11], v136, s[40:43], s97 offen offset:2048 sc1
    s_add_u32 s97, s96, 0xc00
    buffer_load_dwordx4 a[12:15], v136, s[40:43], s97 offen offset:0 sc1
    buffer_load_dwordx4 a[16:19], v136, s[40:43], s97 offen offset:1024 sc1
    buffer_load_dwordx4 a[20:23], v136, s[40:43], s97 offen offset:2048 sc1
    s_add_u32 s97, s96, 0x1800
    buffer_load_dwordx4 a[24:27], v136, s[40:43], s97 offen offset:0 sc1
    buffer_load_dwordx4 a[28:31], v136, s[40:43], s97 offen offset:1024 sc1
    buffer_load_dwordx4 a[32:35], v136, s[40:43], s97 offen offset:2048 sc1
    s_add_u32 s97, s96, 0x2400
    buffer_load_dwordx4 a[36:39], v136, s[40:43], s97 offen offset:0 sc1
    v_mov_b32 v50, 0
    v_mov_b32 v51, 0
    v_mov_b32 v52, 0
    v_mov_b32 v53, 0
    v_mov_b32 v54, 0
    v_mov_b32 v55, 0
    v_mov_b32 v56, 0
    v_mov_b32 v57, 0
    v_mov_b32 v58, 0
    v_mov_b32 v59, 0
    v_mov_b32 v60, 0
    v_mov_b32 v61, 0
    v_mov_b32 v62, 0
    v_mov_b32 v63, 0
    v_mov_b32 v64, 0
    v_mov_b32 v65, 0
    ds_read_b128 v[90:93], v120 offset:6912
    ds_read_b128 v[94:97], v120 offset:8064
    ds_read_b64_tr_b16 v[98:99], v121 offset:0
    ds_read_b64_tr_b16 v[100:101], v121 offset:128
    ds_read_b64_tr_b16 v[102:103], v121 offset:256
    ds_read_b64_tr_b16 v[104:105], v121 offset:384
    v_mul_f32 v66, -1.0, v114
    v_mul_f32 v67, -1.0, v114
    v_mul_f32 v68, -1.0, v114
    v_mul_f32 v69, -1.0, v114
    v_mul_f32 v70, -1.0, v114
    v_mul_f32 v71, -1.0, v114
    v_mul_f32 v72, -1.0, v114
    v_mul_f32 v73, -1.0, v114
    v_mul_f32 v74, -1.0, v114
    v_mul_f32 v75, -1.0, v114
    v_mul_f32 v76, -1.0, v114
    v_mul_f32 v77, -1.0, v114
    v_mul_f32 v78, -1.0, v114
    v_mul_f32 v79, -1.0, v114
    v_mul_f32 v80, -1.0, v114
    v_mul_f32 v81, -1.0, v114
    s_waitcnt lgkmcnt(5)
    s_nop 0
    v_mfma_f32_32x32x16_bf16 v[18:33], v[90:93], v[10:13], v[66:81]
    s_nop 7
    s_nop 3
    s_branch La2b_27
La2s_19:
    v_mov_b32 v126, -1
    v_mov_b32 v127, -1
    v_mov_b32 v128, -1
    v_mov_b32 v129, -1
    v_lshlrev_b32 v130, 4, v0
    v_lshlrev_b32 v131, 3, v0
    v_and_b32 v132, 31, v0
    v_lshlrev_b32 v132, 3, v132
    s_lshl_b32 s88, s81, 1
    s_add_u32 s88, s88, s100
    s_mul_i32 s88, s88, 96
    s_mul_i32 s92, s82, 3
    s_add_u32 s88, s88, s92
    s_lshl_b32 s88, s88, 10
    s_add_u32 s88, s88, 0x1000000
    s_lshl_b32 s92, s101, 9
    s_add_u32 s88, s88, s92
    buffer_store_dwordx2 v[126:127], v131, s[40:43], s88 offen offset:0 sc1
    buffer_store_dwordx2 v[126:127], v131, s[40:43], s88 offen offset:1024 sc1
    buffer_store_dwordx2 v[126:127], v131, s[40:43], s88 offen offset:2048 sc1
    s_lshl_b32 s88, s79, 1
    s_add_u32 s88, s88, s101
    s_lshl_b32 s88, s88, 5
    s_lshl_b32 s92, s80, 2
    s_add_u32 s88, s88, s92
    s_lshl_b32 s92, s100, 1
    s_add_u32 s88, s88, s92
    s_lshl_b32 s88, s88, 10
    s_add_u32 s88, s88, 0x1400000
    buffer_store_dwordx4 v[126:129], v130, s[40:43], s88 offen offset:0 sc1
    buffer_store_dwordx4 v[126:129], v130, s[40:43], s88 offen offset:1024 sc1
    s_lshl_b32 s88, s79, 3
    s_add_u32 s88, s88, s80
    s_lshl_b32 s88, s88, 1
    s_add_u32 s88, s88, s100
    s_lshl_b32 s88, s88, 9
    s_lshl_b32 s92, s101, 8
    s_add_u32 s88, s88, s92
    s_add_u32 s88, s88, 0x1680000
    buffer_store_dwordx2 v[126:127], v132, s[40:43], s88 offen offset:0 sc1
    v_lshrrev_b32 v138, 3, v0
    v_lshlrev_b32 v138, 10, v138
    v_and_b32 v139, 7, v0
    v_lshrrev_b32 v140, 4, v0
    v_and_b32 v140, 1, v140
    v_lshlrev_b32 v140, 2, v140
    v_xor_b32 v139, v139, v140
    v_lshlrev_b32 v139, 4, v139
    v_add_u32 v138, v138, v139
    s_lshl_b32 s96, s76, 17
    s_lshl_b32 s97, s80, 7
    s_add_u32 s96, s96, s97
    s_lshl_b32 s97, s76, 14
    s_add_u32 s92, s96, 0x0
    s_add_u32 m0, s97, 57344
    s_nop 0
    buffer_load_dwordx4 v138, s[12:15], s92 offen lds
    s_add_u32 s92, s96, 0x2000
    s_add_u32 m0, s97, 58368
    s_nop 0
    buffer_load_dwordx4 v138, s[12:15], s92 offen lds
    s_add_u32 s92, s96, 0x4000
    s_add_u32 m0, s97, 59392
    s_nop 0
    buffer_load_dwordx4 v138, s[12:15], s92 offen lds
    s_add_u32 s92, s96, 0x6000
    s_add_u32 m0, s97, 60416
    s_nop 0
    buffer_load_dwordx4 v138, s[12:15], s92 offen lds
    s_add_u32 s92, s96, 0x8000
    s_add_u32 m0, s97, 61440
    s_nop 0
    buffer_load_dwordx4 v138, s[12:15], s92 offen lds
    s_add_u32 s92, s96, 0xa000
    s_add_u32 m0, s97, 62464
    s_nop 0
    buffer_load_dwordx4 v138, s[12:15], s92 offen lds
    s_add_u32 s92, s96, 0xc000
    s_add_u32 m0, s97, 63488
    s_nop 0
    buffer_load_dwordx4 v138, s[12:15], s92 offen lds
    s_add_u32 s92, s96, 0xe000
    s_add_u32 m0, s97, 64512
    s_nop 0
    buffer_load_dwordx4 v138, s[12:15], s92 offen lds
    s_add_u32 s92, s96, 0x10000
    s_add_u32 m0, s97, 65536
    s_nop 0
    buffer_load_dwordx4 v138, s[12:15], s92 offen lds
    s_add_u32 s92, s96, 0x12000
    s_add_u32 m0, s97, 66560
    s_nop 0
    buffer_load_dwordx4 v138, s[12:15], s92 offen lds
    s_add_u32 s92, s96, 0x14000
    s_add_u32 m0, s97, 67584
    s_nop 0
    buffer_load_dwordx4 v138, s[12:15], s92 offen lds
    s_add_u32 s92, s96, 0x16000
    s_add_u32 m0, s97, 68608
    s_nop 0
    buffer_load_dwordx4 v138, s[12:15], s92 offen lds
    s_add_u32 s92, s96, 0x18000
    s_add_u32 m0, s97, 69632
    s_nop 0
    buffer_load_dwordx4 v138, s[12:15], s92 offen lds
    s_add_u32 s92, s96, 0x1a000
    s_add_u32 m0, s97, 70656
    s_nop 0
    buffer_load_dwordx4 v138, s[12:15], s92 offen lds
    s_add_u32 s92, s96, 0x1c000
    s_add_u32 m0, s97, 71680
    s_nop 0
    buffer_load_dwordx4 v138, s[12:15], s92 offen lds
    s_add_u32 s92, s96, 0x1e000
    s_add_u32 m0, s97, 72704
    s_nop 0
    buffer_load_dwordx4 v138, s[12:15], s92 offen lds
    v_lshlrev_b32 v136, 4, v0
    s_lshl_b32 s96, s82, 6
    s_lshl_b32 s97, s76, 4
    s_add_u32 s96, s96, s97
    s_mul_i32 s96, s96, 3072
    s_add_u32 s96, s96, 0x1a00000
    s_add_u32 s97, s96, 0x0
    buffer_load_dwordx4 a[0:3], v136, s[40:43], s97 offen offset:0 sc1
    buffer_load_dwordx4 a[4:7], v136, s[40:43], s97 offen offset:1024 sc1
    buffer_load_dwordx4 a[8:11], v136, s[40:43], s97 offen offset:2048 sc1
    s_add_u32 s97, s96, 0xc00
    buffer_load_dwordx4 a[12:15], v136, s[40:43], s97 offen offset:0 sc1
    buffer_load_dwordx4 a[16:19], v136, s[40:43], s97 offen offset:1024 sc1
    buffer_load_dwordx4 a[20:23], v136, s[40:43], s97 offen offset:2048 sc1
    s_add_u32 s97, s96, 0x1800
    buffer_load_dwordx4 a[24:27], v136, s[40:43], s97 offen offset:0 sc1
    buffer_load_dwordx4 a[28:31], v136, s[40:43], s97 offen offset:1024 sc1
    buffer_load_dwordx4 a[32:35], v136, s[40:43], s97 offen offset:2048 sc1
    s_add_u32 s97, s96, 0x2400
    buffer_load_dwordx4 a[36:39], v136, s[40:43], s97 offen offset:0 sc1
    buffer_load_dwordx4 a[40:43], v136, s[40:43], s97 offen offset:1024 sc1
    buffer_load_dwordx4 a[44:47], v136, s[40:43], s97 offen offset:2048 sc1
    s_add_u32 s97, s96, 0x3000
    buffer_load_dwordx4 a[48:51], v136, s[40:43], s97 offen offset:0 sc1
    buffer_load_dwordx4 a[52:55], v136, s[40:43], s97 offen offset:1024 sc1
    buffer_load_dwordx4 a[56:59], v136, s[40:43], s97 offen offset:2048 sc1
    s_add_u32 s97, s96, 0x3c00
    buffer_load_dwordx4 a[60:63], v136, s[40:43], s97 offen offset:0 sc1
    v_mov_b32 v50, 0
    v_mov_b32 v51, 0
    v_mov_b32 v52, 0
    v_mov_b32 v53, 0
    v_mov_b32 v54, 0
    v_mov_b32 v55, 0
    v_mov_b32 v56, 0
    v_mov_b32 v57, 0
    v_mov_b32 v58, 0
    v_mov_b32 v59, 0
    v_mov_b32 v60, 0
    v_mov_b32 v61, 0
    v_mov_b32 v62, 0
    v_mov_b32 v63, 0
    v_mov_b32 v64, 0
    v_mov_b32 v65, 0
    ds_read_b128 v[94:97], v120 offset:8064
    ds_read_b128 v[90:93], v120 offset:9216
    ds_read_b64_tr_b16 v[106:107], v121 offset:0
    ds_read_b64_tr_b16 v[108:109], v121 offset:128
    ds_read_b64_tr_b16 v[110:111], v121 offset:256
    ds_read_b64_tr_b16 v[112:113], v121 offset:384
    v_mul_f32 v66, -1.0, v114
    v_mul_f32 v67, -1.0, v114
    v_mul_f32 v68, -1.0, v114
    v_mul_f32 v69, -1.0, v114
    v_mul_f32 v70, -1.0, v114
    v_mul_f32 v71, -1.0, v114
    v_mul_f32 v72, -1.0, v114
    v_mul_f32 v73, -1.0, v114
    v_mul_f32 v74, -1.0, v114
    v_mul_f32 v75, -1.0, v114
    v_mul_f32 v76, -1.0, v114
    v_mul_f32 v77, -1.0, v114
    v_mul_f32 v78, -1.0, v114
    v_mul_f32 v79, -1.0, v114
    v_mul_f32 v80, -1.0, v114
    v_mul_f32 v81, -1.0, v114
    s_waitcnt lgkmcnt(5)
    s_nop 0
    v_mfma_f32_32x32x16_bf16 v[34:49], v[94:97], v[10:13], v[66:81]
    s_nop 7
    s_nop 3
    s_branch La2b_28
La2s_20:
    v_mov_b32 v126, -1
    v_mov_b32 v127, -1
    v_mov_b32 v128, -1
    v_mov_b32 v129, -1
    v_lshlrev_b32 v130, 4, v0
    v_lshlrev_b32 v131, 3, v0
    v_and_b32 v132, 31, v0
    v_lshlrev_b32 v132, 3, v132
    s_lshl_b32 s88, s81, 1
    s_add_u32 s88, s88, s100
    s_mul_i32 s88, s88, 96
    s_mul_i32 s92, s82, 3
    s_add_u32 s88, s88, s92
    s_lshl_b32 s88, s88, 10
    s_add_u32 s88, s88, 0x1000000
    s_lshl_b32 s92, s101, 9
    s_add_u32 s88, s88, s92
    buffer_store_dwordx2 v[126:127], v131, s[40:43], s88 offen offset:0 sc1
    buffer_store_dwordx2 v[126:127], v131, s[40:43], s88 offen offset:1024 sc1
    buffer_store_dwordx2 v[126:127], v131, s[40:43], s88 offen offset:2048 sc1
    s_lshl_b32 s88, s79, 1
    s_add_u32 s88, s88, s101
    s_lshl_b32 s88, s88, 5
    s_lshl_b32 s92, s80, 2
    s_add_u32 s88, s88, s92
    s_lshl_b32 s92, s100, 1
    s_add_u32 s88, s88, s92
    s_lshl_b32 s88, s88, 10
    s_add_u32 s88, s88, 0x1400000
    buffer_store_dwordx4 v[126:129], v130, s[40:43], s88 offen offset:0 sc1
    buffer_store_dwordx4 v[126:129], v130, s[40:43], s88 offen offset:1024 sc1
    s_lshl_b32 s88, s79, 3
    s_add_u32 s88, s88, s80
    s_lshl_b32 s88, s88, 1
    s_add_u32 s88, s88, s100
    s_lshl_b32 s88, s88, 9
    s_lshl_b32 s92, s101, 8
    s_add_u32 s88, s88, s92
    s_add_u32 s88, s88, 0x1680000
    buffer_store_dwordx2 v[126:127], v132, s[40:43], s88 offen offset:0 sc1
    v_lshrrev_b32 v138, 3, v0
    v_lshlrev_b32 v138, 10, v138
    v_and_b32 v139, 7, v0
    v_lshrrev_b32 v140, 4, v0
    v_and_b32 v140, 1, v140
    v_lshlrev_b32 v140, 2, v140
    v_xor_b32 v139, v139, v140
    v_lshlrev_b32 v139, 4, v139
    v_add_u32 v138, v138, v139
    s_lshl_b32 s96, s76, 17
    s_lshl_b32 s97, s80, 7
    s_add_u32 s96, s96, s97
    s_lshl_b32 s97, s76, 14
    s_add_u32 s92, s96, 0x0
    s_add_u32 m0, s97, 57344
    s_nop 0
    buffer_load_dwordx4 v138, s[12:15], s92 offen lds
    s_add_u32 s92, s96, 0x2000
    s_add_u32 m0, s97, 58368
    s_nop 0
    buffer_load_dwordx4 v138, s[12:15], s92 offen lds
    s_add_u32 s92, s96, 0x4000
    s_add_u32 m0, s97, 59392
    s_nop 0
    buffer_load_dwordx4 v138, s[12:15], s92 offen lds
    s_add_u32 s92, s96, 0x6000
    s_add_u32 m0, s97, 60416
    s_nop 0
    buffer_load_dwordx4 v138, s[12:15], s92 offen lds
    s_add_u32 s92, s96, 0x8000
    s_add_u32 m0, s97, 61440
    s_nop 0
    buffer_load_dwordx4 v138, s[12:15], s92 offen lds
    s_add_u32 s92, s96, 0xa000
    s_add_u32 m0, s97, 62464
    s_nop 0
    buffer_load_dwordx4 v138, s[12:15], s92 offen lds
    s_add_u32 s92, s96, 0xc000
    s_add_u32 m0, s97, 63488
    s_nop 0
    buffer_load_dwordx4 v138, s[12:15], s92 offen lds
    s_add_u32 s92, s96, 0xe000
    s_add_u32 m0, s97, 64512
    s_nop 0
    buffer_load_dwordx4 v138, s[12:15], s92 offen lds
    s_add_u32 s92, s96, 0x10000
    s_add_u32 m0, s97, 65536
    s_nop 0
    buffer_load_dwordx4 v138, s[12:15], s92 offen lds
    s_add_u32 s92, s96, 0x12000
    s_add_u32 m0, s97, 66560
    s_nop 0
    buffer_load_dwordx4 v138, s[12:15], s92 offen lds
    s_add_u32 s92, s96, 0x14000
    s_add_u32 m0, s97, 67584
    s_nop 0
    buffer_load_dwordx4 v138, s[12:15], s92 offen lds
    s_add_u32 s92, s96, 0x16000
    s_add_u32 m0, s97, 68608
    s_nop 0
    buffer_load_dwordx4 v138, s[12:15], s92 offen lds
    s_add_u32 s92, s96, 0x18000
    s_add_u32 m0, s97, 69632
    s_nop 0
    buffer_load_dwordx4 v138, s[12:15], s92 offen lds
    s_add_u32 s92, s96, 0x1a000
    s_add_u32 m0, s97, 70656
    s_nop 0
    buffer_load_dwordx4 v138, s[12:15], s92 offen lds
    s_add_u32 s92, s96, 0x1c000
    s_add_u32 m0, s97, 71680
    s_nop 0
    buffer_load_dwordx4 v138, s[12:15], s92 offen lds
    s_add_u32 s92, s96, 0x1e000
    s_add_u32 m0, s97, 72704
    s_nop 0
    buffer_load_dwordx4 v138, s[12:15], s92 offen lds
    v_lshlrev_b32 v136, 4, v0
    s_lshl_b32 s96, s82, 6
    s_lshl_b32 s97, s76, 4
    s_add_u32 s96, s96, s97
    s_mul_i32 s96, s96, 3072
    s_add_u32 s96, s96, 0x1a00000
    s_add_u32 s97, s96, 0x0
    buffer_load_dwordx4 a[0:3], v136, s[40:43], s97 offen offset:0 sc1
    buffer_load_dwordx4 a[4:7], v136, s[40:43], s97 offen offset:1024 sc1
    buffer_load_dwordx4 a[8:11], v136, s[40:43], s97 offen offset:2048 sc1
    s_add_u32 s97, s96, 0xc00
    buffer_load_dwordx4 a[12:15], v136, s[40:43], s97 offen offset:0 sc1
    buffer_load_dwordx4 a[16:19], v136, s[40:43], s97 offen offset:1024 sc1
    buffer_load_dwordx4 a[20:23], v136, s[40:43], s97 offen offset:2048 sc1
    s_add_u32 s97, s96, 0x1800
    buffer_load_dwordx4 a[24:27], v136, s[40:43], s97 offen offset:0 sc1
    buffer_load_dwordx4 a[28:31], v136, s[40:43], s97 offen offset:1024 sc1
    buffer_load_dwordx4 a[32:35], v136, s[40:43], s97 offen offset:2048 sc1
    s_add_u32 s97, s96, 0x2400
    buffer_load_dwordx4 a[36:39], v136, s[40:43], s97 offen offset:0 sc1
    buffer_load_dwordx4 a[40:43], v136, s[40:43], s97 offen offset:1024 sc1
    buffer_load_dwordx4 a[44:47], v136, s[40:43], s97 offen offset:2048 sc1
    s_add_u32 s97, s96, 0x3000
    buffer_load_dwordx4 a[48:51], v136, s[40:43], s97 offen offset:0 sc1
    buffer_load_dwordx4 a[52:55], v136, s[40:43], s97 offen offset:1024 sc1
    buffer_load_dwordx4 a[56:59], v136, s[40:43], s97 offen offset:2048 sc1
    s_add_u32 s97, s96, 0x3c00
    buffer_load_dwordx4 a[60:63], v136, s[40:43], s97 offen offset:0 sc1
    buffer_load_dwordx4 a[64:67], v136, s[40:43], s97 offen offset:1024 sc1
    buffer_load_dwordx4 a[68:71], v136, s[40:43], s97 offen offset:2048 sc1
    s_add_u32 s97, s96, 0x4800
    buffer_load_dwordx4 a[72:75], v136, s[40:43], s97 offen offset:0 sc1
    buffer_load_dwordx4 a[76:79], v136, s[40:43], s97 offen offset:1024 sc1
    buffer_load_dwordx4 a[80:83], v136, s[40:43], s97 offen offset:2048 sc1
    s_add_u32 s97, s96, 0x5400
    buffer_load_dwordx4 a[84:87], v136, s[40:43], s97 offen offset:0 sc1
    v_mov_b32 v50, 0
    v_mov_b32 v51, 0
    v_mov_b32 v52, 0
    v_mov_b32 v53, 0
    v_mov_b32 v54, 0
    v_mov_b32 v55, 0
    v_mov_b32 v56, 0
    v_mov_b32 v57, 0
    v_mov_b32 v58, 0
    v_mov_b32 v59, 0
    v_mov_b32 v60, 0
    v_mov_b32 v61, 0
    v_mov_b32 v62, 0
    v_mov_b32 v63, 0
    v_mov_b32 v64, 0
    v_mov_b32 v65, 0
    ds_read_b128 v[90:93], v120 offset:9216
    ds_read_b64_tr_b16 v[98:99], v121 offset:0
    ds_read_b64_tr_b16 v[100:101], v121 offset:128
    ds_read_b64_tr_b16 v[102:103], v121 offset:256
    ds_read_b64_tr_b16 v[104:105], v121 offset:384
    v_mul_f32 v66, -1.0, v114
    v_mul_f32 v67, -1.0, v114
    v_mul_f32 v68, -1.0, v114
    v_mul_f32 v69, -1.0, v114
    v_mul_f32 v70, -1.0, v114
    v_mul_f32 v71, -1.0, v114
    v_mul_f32 v72, -1.0, v114
    v_mul_f32 v73, -1.0, v114
    v_mul_f32 v74, -1.0, v114
    v_mul_f32 v75, -1.0, v114
    v_mul_f32 v76, -1.0, v114
    v_mul_f32 v77, -1.0, v114
    v_mul_f32 v78, -1.0, v114
    v_mul_f32 v79, -1.0, v114
    v_mul_f32 v80, -1.0, v114
    v_mul_f32 v81, -1.0, v114
    s_waitcnt lgkmcnt(4)
    s_nop 0
    v_mfma_f32_32x32x16_bf16 v[18:33], v[90:93], v[10:13], v[66:81]
    s_nop 7
    s_nop 3
    s_branch La2b_29
La2s_70:
    s_cmp_eq_u32 s83, 1
    s_cbranch_scc1 La2s_71
    s_cmp_eq_u32 s83, 2
    s_cbranch_scc1 La2s_72
    s_cmp_eq_u32 s83, 3
    s_cbranch_scc1 La2s_73
    s_cmp_eq_u32 s83, 4
    s_cbranch_scc1 La2s_74
    s_cmp_eq_u32 s83, 5
    s_cbranch_scc1 La2s_75
    s_cmp_eq_u32 s83, 6
    s_cbranch_scc1 La2s_76
    s_cmp_eq_u32 s83, 7
    s_cbranch_scc1 La2s_77
    s_cmp_eq_u32 s83, 8
    s_cbranch_scc1 La2s_78
    s_branch La2s_78
La2s_71:
    buffer_load_dwordx4 a[112:115], v136, s[40:43], s97 offen offset:1024 sc1
    buffer_load_dwordx4 a[116:119], v136, s[40:43], s97 offen offset:2048 sc1
    s_add_u32 s97, s96, 0x7800
    buffer_load_dwordx4 a[120:123], v136, s[40:43], s97 offen offset:0 sc1
    buffer_load_dwordx4 a[124:127], v136, s[40:43], s97 offen offset:1024 sc1
    buffer_load_dwordx4 a[128:131], v136, s[40:43], s97 offen offset:2048 sc1
    s_add_u32 s97, s96, 0x8400
    buffer_load_dwordx4 a[132:135], v136, s[40:43], s97 offen offset:0 sc1
    v_mov_b32 v50, 0
    v_mov_b32 v51, 0
    v_mov_b32 v52, 0
    v_mov_b32 v53, 0
    v_mov_b32 v54, 0
    v_mov_b32 v55, 0
    v_mov_b32 v56, 0
    v_mov_b32 v57, 0
    v_mov_b32 v58, 0
    v_mov_b32 v59, 0
    v_mov_b32 v60, 0
    v_mov_b32 v61, 0
    v_mov_b32 v62, 0
    v_mov_b32 v63, 0
    v_mov_b32 v64, 0
    v_mov_b32 v65, 0
    ds_read_b128 v[94:97], v120 offset:14976
    ds_read_b128 v[90:93], v120 offset:16128
    ds_read_b64_tr_b16 v[106:107], v121 offset:0
    ds_read_b64_tr_b16 v[108:109], v121 offset:128
    ds_read_b64_tr_b16 v[110:111], v121 offset:256
    ds_read_b64_tr_b16 v[112:113], v121 offset:384
    v_mul_f32 v66, -1.0, v141
    v_mul_f32 v67, -1.0, v141
    v_mul_f32 v68, -1.0, v141
    v_mul_f32 v69, -1.0, v141
    v_mul_f32 v70, -1.0, v141
    v_mul_f32 v71, -1.0, v141
    v_mul_f32 v72, -1.0, v141
    v_mul_f32 v73, -1.0, v141
    v_mul_f32 v74, -1.0, v141
    v_mul_f32 v75, -1.0, v141
    v_mul_f32 v76, -1.0, v141
    v_mul_f32 v77, -1.0, v141
    v_mul_f32 v78, -1.0, v141
    v_mul_f32 v79, -1.0, v141
    v_mul_f32 v80, -1.0, v141
    v_mul_f32 v81, -1.0, v141
    s_waitcnt lgkmcnt(5)
    s_nop 0
    v_mfma_f32_32x32x16_bf16 v[34:49], v[94:97], v[14:17], v[66:81]
    s_nop 7
    s_nop 3
    s_branch La2b_80
La2s_72:
    buffer_load_dwordx4 a[112:115], v136, s[40:43], s97 offen offset:1024 sc1
    buffer_load_dwordx4 a[116:119], v136, s[40:43], s97 offen offset:2048 sc1
    s_add_u32 s97, s96, 0x7800
    buffer_load_dwordx4 a[120:123], v136, s[40:43], s97 offen offset:0 sc1
    buffer_load_dwordx4 a[124:127], v136, s[40:43], s97 offen offset:1024 sc1
    buffer_load_dwordx4 a[128:131], v136, s[40:43], s97 offen offset:2048 sc1
    s_add_u32 s97, s96, 0x8400
    buffer_load_dwordx4 a[132:135], v136, s[40:43], s97 offen offset:0 sc1
    buffer_load_dwordx4 a[136:139], v136, s[40:43], s97 offen offset:1024 sc1
    buffer_load_dwordx4 a[140:143], v136, s[40:43], s97 offen offset:2048 sc1
    s_add_u32 s97, s96, 0x9000
    buffer_load_dwordx4 a[144:147], v136, s[40:43], s97 offen offset:0 sc1
    buffer_load_dwordx4 a[148:151], v136, s[40:43], s97 offen offset:1024 sc1
    buffer_load_dwordx4 a[152:155], v136, s[40:43], s97 offen offset:2048 sc1
    s_add_u32 s97, s96, 0x9c00
    buffer_load_dwordx4 a[156:159], v136, s[40:43], s97 offen offset:0 sc1
    v_mov_b32 v50, 0
    v_mov_b32 v51, 0
    v_mov_b32 v52, 0
    v_mov_b32 v53, 0
    v_mov_b32 v54, 0
    v_mov_b32 v55, 0
    v_mov_b32 v56, 0
    v_mov_b32 v57, 0
    v_mov_b32 v58, 0
    v_mov_b32 v59, 0
    v_mov_b32 v60, 0
    v_mov_b32 v61, 0
    v_mov_b32 v62, 0
    v_mov_b32 v63, 0
    v_mov_b32 v64, 0
    v_mov_b32 v65, 0
    ds_read_b128 v[90:93], v120 offset:16128
    ds_read_b128 v[94:97], v120 offset:17280
    ds_read_b64_tr_b16 v[98:99], v121 offset:0
    ds_read_b64_tr_b16 v[100:101], v121 offset:128
    ds_read_b64_tr_b16 v[102:103], v121 offset:256
    ds_read_b64_tr_b16 v[104:105], v121 offset:384
    v_mul_f32 v66, -1.0, v141
    v_mul_f32 v67, -1.0, v141
    v_mul_f32 v68, -1.0, v141
    v_mul_f32 v69, -1.0, v141
    v_mul_f32 v70, -1.0, v141
    v_mul_f32 v71, -1.0, v141
    v_mul_f32 v72, -1.0, v141
    v_mul_f32 v73, -1.0, v141
    v_mul_f32 v74, -1.0, v141
    v_mul_f32 v75, -1.0, v141
    v_mul_f32 v76, -1.0, v141
    v_mul_f32 v77, -1.0, v141
    v_mul_f32 v78, -1.0, v141
    v_mul_f32 v79, -1.0, v141
    v_mul_f32 v80, -1.0, v141
    v_mul_f32 v81, -1.0, v141
    s_waitcnt lgkmcnt(5)
    s_nop 0
    v_mfma_f32_32x32x16_bf16 v[18:33], v[90:93], v[14:17], v[66:81]
    s_nop 7
    s_nop 3
    s_branch La2b_81
La2s_73:
    buffer_load_dwordx4 a[112:115], v136, s[40:43], s97 offen offset:1024 sc1
    buffer_load_dwordx4 a[116:119], v136, s[40:43], s97 offen offset:2048 sc1
    s_add_u32 s97, s96, 0x7800
    buffer_load_dwordx4 a[120:123], v136, s[40:43], s97 offen offset:0 sc1
    buffer_load_dwordx4 a[124:127], v136, s[40:43], s97 offen offset:1024 sc1
    buffer_load_dwordx4 a[128:131], v136, s[40:43], s97 offen offset:2048 sc1
    s_add_u32 s97, s96, 0x8400
    buffer_load_dwordx4 a[132:135], v136, s[40:43], s97 offen offset:0 sc1
    buffer_load_dwordx4 a[136:139], v136, s[40:43], s97 offen offset:1024 sc1
    buffer_load_dwordx4 a[140:143], v136, s[40:43], s97 offen offset:2048 sc1
    s_add_u32 s97, s96, 0x9000
    buffer_load_dwordx4 a[144:147], v136, s[40:43], s97 offen offset:0 sc1
    buffer_load_dwordx4 a[148:151], v136, s[40:43], s97 offen offset:1024 sc1
    buffer_load_dwordx4 a[152:155], v136, s[40:43], s97 offen offset:2048 sc1
    s_add_u32 s97, s96, 0x9c00
    buffer_load_dwordx4 a[156:159], v136, s[40:43], s97 offen offset:0 sc1
    buffer_load_dwordx4 a[160:163], v136, s[40:43], s97 offen offset:1024 sc1
    buffer_load_dwordx4 a[164:167], v136, s[40:43], s97 offen offset:2048 sc1
    s_add_u32 s97, s96, 0xa800
    buffer_load_dwordx4 a[168:171], v136, s[40:43], s97 offen offset:0 sc1
    buffer_load_dwordx4 a[172:175], v136, s[40:43], s97 offen offset:1024 sc1
    buffer_load_dwordx4 a[176:179], v136, s[40:43], s97 offen offset:2048 sc1
    s_add_u32 s97, s96, 0xb400
    buffer_load_dwordx4 a[180:183], v136, s[40:43], s97 offen offset:0 sc1
    v_mov_b32 v50, 0
    v_mov_b32 v51, 0
    v_mov_b32 v52, 0
    v_mov_b32 v53, 0
    v_mov_b32 v54, 0
    v_mov_b32 v55, 0
    v_mov_b32 v56, 0
    v_mov_b32 v57, 0
    v_mov_b32 v58, 0
    v_mov_b32 v59, 0
    v_mov_b32 v60, 0
    v_mov_b32 v61, 0
    v_mov_b32 v62, 0
    v_mov_b32 v63, 0
    v_mov_b32 v64, 0
    v_mov_b32 v65, 0
    ds_read_b128 v[94:97], v120 offset:17280
    ds_read_b128 v[90:93], v120 offset:18432
    ds_read_b64_tr_b16 v[106:107], v121 offset:0
    ds_read_b64_tr_b16 v[108:109], v121 offset:128
    ds_read_b64_tr_b16 v[110:111], v121 offset:256
    ds_read_b64_tr_b16 v[112:113], v121 offset:384
    v_mul_f32 v66, -1.0, v141
    v_mul_f32 v67, -1.0, v141
    v_mul_f32 v68, -1.0, v141
    v_mul_f32 v69, -1.0, v141
    v_mul_f32 v70, -1.0, v141
    v_mul_f32 v71, -1.0, v141
    v_mul_f32 v72, -1.0, v141
    v_mul_f32 v73, -1.0, v141
    v_mul_f32 v74, -1.0, v141
    v_mul_f32 v75, -1.0, v141
    v_mul_f32 v76, -1.0, v141
    v_mul_f32 v77, -1.0, v141
    v_mul_f32 v78, -1.0, v141
    v_mul_f32 v79, -1.0, v141
    v_mul_f32 v80, -1.0, v141
    v_mul_f32 v81, -1.0, v141
    s_waitcnt lgkmcnt(5)
    s_nop 0
    v_mfma_f32_32x32x16_bf16 v[34:49], v[94:97], v[14:17], v[66:81]
    s_nop 7
    s_nop 3
    s_branch La2b_82
La2s_74:
    buffer_load_dwordx4 a[112:115], v136, s[40:43], s97 offen offset:1024 sc1
    buffer_load_dwordx4 a[116:119], v136, s[40:43], s97 offen offset:2048 sc1
    s_add_u32 s97, s96, 0x7800
    buffer_load_dwordx4 a[120:123], v136, s[40:43], s97 offen offset:0 sc1
    buffer_load_dwordx4 a[124:127], v136, s[40:43], s97 offen offset:1024 sc1
    buffer_load_dwordx4 a[128:131], v136, s[40:43], s97 offen offset:2048 sc1
    s_add_u32 s97, s96, 0x8400
    buffer_load_dwordx4 a[132:135], v136, s[40:43], s97 offen offset:0 sc1
    buffer_load_dwordx4 a[136:139], v136, s[40:43], s97 offen offset:1024 sc1
    buffer_load_dwordx4 a[140:143], v136, s[40:43], s97 offen offset:2048 sc1
    s_add_u32 s97, s96, 0x9000
    buffer_load_dwordx4 a[144:147], v136, s[40:43], s97 offen offset:0 sc1
    buffer_load_dwordx4 a[148:151], v136, s[40:43], s97 offen offset:1024 sc1
    buffer_load_dwordx4 a[152:155], v136, s[40:43], s97 offen offset:2048 sc1
    s_add_u32 s97, s96, 0x9c00
    buffer_load_dwordx4 a[156:159], v136, s[40:43], s97 offen offset:0 sc1
    buffer_load_dwordx4 a[160:163], v136, s[40:43], s97 offen offset:1024 sc1
    buffer_load_dwordx4 a[164:167], v136, s[40:43], s97 offen offset:2048 sc1
    s_add_u32 s97, s96, 0xa800
    buffer_load_dwordx4 a[168:171], v136, s[40:43], s97 offen offset:0 sc1
    buffer_load_dwordx4 a[172:175], v136, s[40:43], s97 offen offset:1024 sc1
    buffer_load_dwordx4 a[176:179], v136, s[40:43], s97 offen offset:2048 sc1
    s_add_u32 s97, s96, 0xb400
    buffer_load_dwordx4 a[180:183], v136, s[40:43], s97 offen offset:0 sc1
    buffer_load_dwordx4 a[184:187], v136, s[40:43], s97 offen offset:1024 sc1
    buffer_load_dwordx4 a[188:191], v136, s[40:43], s97 offen offset:2048 sc1
    v_mov_b32 v50, 0
    v_mov_b32 v51, 0
    v_mov_b32 v52, 0
    v_mov_b32 v53, 0
    v_mov_b32 v54, 0
    v_mov_b32 v55, 0
    v_mov_b32 v56, 0
    v_mov_b32 v57, 0
    v_mov_b32 v58, 0
    v_mov_b32 v59, 0
    v_mov_b32 v60, 0
    v_mov_b32 v61, 0
    v_mov_b32 v62, 0
    v_mov_b32 v63, 0
    v_mov_b32 v64, 0
    v_mov_b32 v65, 0
    ds_read_b128 v[90:93], v120 offset:18432
    ds_read_b128 v[94:97], v120 offset:19584
    ds_read_b64_tr_b16 v[98:99], v121 offset:0
    ds_read_b64_tr_b16 v[100:101], v121 offset:128
    ds_read_b64_tr_b16 v[102:103], v121 offset:256
    ds_read_b64_tr_b16 v[104:105], v121 offset:384
    v_mul_f32 v66, -1.0, v141
    v_mul_f32 v67, -1.0, v141
    v_mul_f32 v68, -1.0, v141
    v_mul_f32 v69, -1.0, v141
    v_mul_f32 v70, -1.0, v141
    v_mul_f32 v71, -1.0, v141
    v_mul_f32 v72, -1.0, v141
    v_mul_f32 v73, -1.0, v141
    v_mul_f32 v74, -1.0, v141
    v_mul_f32 v75, -1.0, v141
    v_mul_f32 v76, -1.0, v141
    v_mul_f32 v77, -1.0, v141
    v_mul_f32 v78, -1.0, v141
    v_mul_f32 v79, -1.0, v141
    v_mul_f32 v80, -1.0, v141
    v_mul_f32 v81, -1.0, v141
    s_waitcnt lgkmcnt(5)
    s_nop 0
    v_mfma_f32_32x32x16_bf16 v[18:33], v[90:93], v[14:17], v[66:81]
    s_nop 7
    s_nop 3
    s_branch La2b_83
La2s_75:
    buffer_load_dwordx4 a[112:115], v136, s[40:43], s97 offen offset:1024 sc1
    buffer_load_dwordx4 a[116:119], v136, s[40:43], s97 offen offset:2048 sc1
    s_add_u32 s97, s96, 0x7800
    buffer_load_dwordx4 a[120:123], v136, s[40:43], s97 offen offset:0 sc1
    buffer_load_dwordx4 a[124:127], v136, s[40:43], s97 offen offset:1024 sc1
    buffer_load_dwordx4 a[128:131], v136, s[40:43], s97 offen offset:2048 sc1
    s_add_u32 s97, s96, 0x8400
    buffer_load_dwordx4 a[132:135], v136, s[40:43], s97 offen offset:0 sc1
    buffer_load_dwordx4 a[136:139], v136, s[40:43], s97 offen offset:1024 sc1
    buffer_load_dwordx4 a[140:143], v136, s[40:43], s97 offen offset:2048 sc1
    s_add_u32 s97, s96, 0x9000
    buffer_load_dwordx4 a[144:147], v136, s[40:43], s97 offen offset:0 sc1
    buffer_load_dwordx4 a[148:151], v136, s[40:43], s97 offen offset:1024 sc1
    buffer_load_dwordx4 a[152:155], v136, s[40:43], s97 offen offset:2048 sc1
    s_add_u32 s97, s96, 0x9c00
    buffer_load_dwordx4 a[156:159], v136, s[40:43], s97 offen offset:0 sc1
    buffer_load_dwordx4 a[160:163], v136, s[40:43], s97 offen offset:1024 sc1
    buffer_load_dwordx4 a[164:167], v136, s[40:43], s97 offen offset:2048 sc1
    s_add_u32 s97, s96, 0xa800
    buffer_load_dwordx4 a[168:171], v136, s[40:43], s97 offen offset:0 sc1
    buffer_load_dwordx4 a[172:175], v136, s[40:43], s97 offen offset:1024 sc1
    buffer_load_dwordx4 a[176:179], v136, s[40:43], s97 offen offset:2048 sc1
    s_add_u32 s97, s96, 0xb400
    buffer_load_dwordx4 a[180:183], v136, s[40:43], s97 offen offset:0 sc1
    buffer_load_dwordx4 a[184:187], v136, s[40:43], s97 offen offset:1024 sc1
    buffer_load_dwordx4 a[188:191], v136, s[40:43], s97 offen offset:2048 sc1
    v_mov_b32 v50, 0
    v_mov_b32 v51, 0
    v_mov_b32 v52, 0
    v_mov_b32 v53, 0
    v_mov_b32 v54, 0
    v_mov_b32 v55, 0
    v_mov_b32 v56, 0
    v_mov_b32 v57, 0
    v_mov_b32 v58, 0
    v_mov_b32 v59, 0
    v_mov_b32 v60, 0
    v_mov_b32 v61, 0
    v_mov_b32 v62, 0
    v_mov_b32 v63, 0
    v_mov_b32 v64, 0
    v_mov_b32 v65, 0
    ds_read_b128 v[94:97], v120 offset:19584
    ds_read_b128 v[90:93], v120 offset:20736
    ds_read_b64_tr_b16 v[106:107], v121 offset:0
    ds_read_b64_tr_b16 v[108:109], v121 offset:128
    ds_read_b64_tr_b16 v[110:111], v121 offset:256
    ds_read_b64_tr_b16 v[112:113], v121 offset:384
    v_mul_f32 v66, -1.0, v141
    v_mul_f32 v67, -1.0, v141
    v_mul_f32 v68, -1.0, v141
    v_mul_f32 v69, -1.0, v141
    v_mul_f32 v70, -1.0, v141
    v_mul_f32 v71, -1.0, v141
    v_mul_f32 v72, -1.0, v141
    v_mul_f32 v73, -1.0, v141
    v_mul_f32 v74, -1.0, v141
    v_mul_f32 v75, -1.0, v141
    v_mul_f32 v76, -1.0, v141
    v_mul_f32 v77, -1.0, v141
    v_mul_f32 v78, -1.0, v141
    v_mul_f32 v79, -1.0, v141
    v_mul_f32 v80, -1.0, v141
    v_mul_f32 v81, -1.0, v141
    s_waitcnt lgkmcnt(5)
    s_nop 0
    v_mfma_f32_32x32x16_bf16 v[34:49], v[94:97], v[14:17], v[66:81]
    s_nop 7
    s_nop 3
    s_branch La2b_84
La2s_76:
    buffer_load_dwordx4 a[112:115], v136, s[40:43], s97 offen offset:1024 sc1
    buffer_load_dwordx4 a[116:119], v136, s[40:43], s97 offen offset:2048 sc1
    s_add_u32 s97, s96, 0x7800
    buffer_load_dwordx4 a[120:123], v136, s[40:43], s97 offen offset:0 sc1
    buffer_load_dwordx4 a[124:127], v136, s[40:43], s97 offen offset:1024 sc1
    buffer_load_dwordx4 a[128:131], v136, s[40:43], s97 offen offset:2048 sc1
    s_add_u32 s97, s96, 0x8400
    buffer_load_dwordx4 a[132:135], v136, s[40:43], s97 offen offset:0 sc1
    buffer_load_dwordx4 a[136:139], v136, s[40:43], s97 offen offset:1024 sc1
    buffer_load_dwordx4 a[140:143], v136, s[40:43], s97 offen offset:2048 sc1
    s_add_u32 s97, s96, 0x9000
    buffer_load_dwordx4 a[144:147], v136, s[40:43], s97 offen offset:0 sc1
    buffer_load_dwordx4 a[148:151], v136, s[40:43], s97 offen offset:1024 sc1
    buffer_load_dwordx4 a[152:155], v136, s[40:43], s97 offen offset:2048 sc1
    s_add_u32 s97, s96, 0x9c00
    buffer_load_dwordx4 a[156:159], v136, s[40:43], s97 offen offset:0 sc1
    buffer_load_dwordx4 a[160:163], v136, s[40:43], s97 offen offset:1024 sc1
    buffer_load_dwordx4 a[164:167], v136, s[40:43], s97 offen offset:2048 sc1
    s_add_u32 s97, s96, 0xa800
    buffer_load_dwordx4 a[168:171], v136, s[40:43], s97 offen offset:0 sc1
    buffer_load_dwordx4 a[172:175], v136, s[40:43], s97 offen offset:1024 sc1
    buffer_load_dwordx4 a[176:179], v136, s[40:43], s97 offen offset:2048 sc1
    s_add_u32 s97, s96, 0xb400
    buffer_load_dwordx4 a[180:183], v136, s[40:43], s97 offen offset:0 sc1
    buffer_load_dwordx4 a[184:187], v136, s[40:43], s97 offen offset:1024 sc1
    buffer_load_dwordx4 a[188:191], v136, s[40:43], s97 offen offset:2048 sc1
    v_mov_b32 v50, 0
    v_mov_b32 v51, 0
    v_mov_b32 v52, 0
    v_mov_b32 v53, 0
    v_mov_b32 v54, 0
    v_mov_b32 v55, 0
    v_mov_b32 v56, 0
    v_mov_b32 v57, 0
    v_mov_b32 v58, 0
    v_mov_b32 v59, 0
    v_mov_b32 v60, 0
    v_mov_b32 v61, 0
    v_mov_b32 v62, 0
    v_mov_b32 v63, 0
    v_mov_b32 v64, 0
    v_mov_b32 v65, 0
    ds_read_b128 v[90:93], v120 offset:20736
    ds_read_b128 v[94:97], v120 offset:21888
    ds_read_b64_tr_b16 v[98:99], v121 offset:0
    ds_read_b64_tr_b16 v[100:101], v121 offset:128
    ds_read_b64_tr_b16 v[102:103], v121 offset:256
    ds_read_b64_tr_b16 v[104:105], v121 offset:384
    v_mul_f32 v66, -1.0, v141
    v_mul_f32 v67, -1.0, v141
    v_mul_f32 v68, -1.0, v141
    v_mul_f32 v69, -1.0, v141
    v_mul_f32 v70, -1.0, v141
    v_mul_f32 v71, -1.0, v141
    v_mul_f32 v72, -1.0, v141
    v_mul_f32 v73, -1.0, v141
    v_mul_f32 v74, -1.0, v141
    v_mul_f32 v75, -1.0, v141
    v_mul_f32 v76, -1.0, v141
    v_mul_f32 v77, -1.0, v141
    v_mul_f32 v78, -1.0, v141
    v_mul_f32 v79, -1.0, v141
    v_mul_f32 v80, -1.0, v141
    v_mul_f32 v81, -1.0, v141
    s_waitcnt lgkmcnt(5)
    s_nop 0
    v_mfma_f32_32x32x16_bf16 v[18:33], v[90:93], v[14:17], v[66:81]
    s_nop 7
    s_nop 3
    s_branch La2b_85
La2s_77:
    buffer_load_dwordx4 a[112:115], v136, s[40:43], s97 offen offset:1024 sc1
    buffer_load_dwordx4 a[116:119], v136, s[40:43], s97 offen offset:2048 sc1
    s_add_u32 s97, s96, 0x7800
    buffer_load_dwordx4 a[120:123], v136, s[40:43], s97 offen offset:0 sc1
    buffer_load_dwordx4 a[124:127], v136, s[40:43], s97 offen offset:1024 sc1
    buffer_load_dwordx4 a[128:131], v136, s[40:43], s97 offen offset:2048 sc1
    s_add_u32 s97, s96, 0x8400
    buffer_load_dwordx4 a[132:135], v136, s[40:43], s97 offen offset:0 sc1
    buffer_load_dwordx4 a[136:139], v136, s[40:43], s97 offen offset:1024 sc1
    buffer_load_dwordx4 a[140:143], v136, s[40:43], s97 offen offset:2048 sc1
    s_add_u32 s97, s96, 0x9000
    buffer_load_dwordx4 a[144:147], v136, s[40:43], s97 offen offset:0 sc1
    buffer_load_dwordx4 a[148:151], v136, s[40:43], s97 offen offset:1024 sc1
    buffer_load_dwordx4 a[152:155], v136, s[40:43], s97 offen offset:2048 sc1
    s_add_u32 s97, s96, 0x9c00
    buffer_load_dwordx4 a[156:159], v136, s[40:43], s97 offen offset:0 sc1
    buffer_load_dwordx4 a[160:163], v136, s[40:43], s97 offen offset:1024 sc1
    buffer_load_dwordx4 a[164:167], v136, s[40:43], s97 offen offset:2048 sc1
    s_add_u32 s97, s96, 0xa800
    buffer_load_dwordx4 a[168:171], v136, s[40:43], s97 offen offset:0 sc1
    buffer_load_dwordx4 a[172:175], v136, s[40:43], s97 offen offset:1024 sc1
    buffer_load_dwordx4 a[176:179], v136, s[40:43], s97 offen offset:2048 sc1
    s_add_u32 s97, s96, 0xb400
    buffer_load_dwordx4 a[180:183], v136, s[40:43], s97 offen offset:0 sc1
    buffer_load_dwordx4 a[184:187], v136, s[40:43], s97 offen offset:1024 sc1
    buffer_load_dwordx4 a[188:191], v136, s[40:43], s97 offen offset:2048 sc1
    v_mov_b32 v50, 0
    v_mov_b32 v51, 0
    v_mov_b32 v52, 0
    v_mov_b32 v53, 0
    v_mov_b32 v54, 0
    v_mov_b32 v55, 0
    v_mov_b32 v56, 0
    v_mov_b32 v57, 0
    v_mov_b32 v58, 0
    v_mov_b32 v59, 0
    v_mov_b32 v60, 0
    v_mov_b32 v61, 0
    v_mov_b32 v62, 0
    v_mov_b32 v63, 0
    v_mov_b32 v64, 0
    v_mov_b32 v65, 0
    ds_read_b128 v[94:97], v120 offset:21888
    ds_read_b128 v[90:93], v120 offset:23040
    ds_read_b64_tr_b16 v[106:107], v121 offset:0
    ds_read_b64_tr_b16 v[108:109], v121 offset:128
    ds_read_b64_tr_b16 v[110:111], v121 offset:256
    ds_read_b64_tr_b16 v[112:113], v121 offset:384
    v_mul_f32 v66, -1.0, v141
    v_mul_f32 v67, -1.0, v141
    v_mul_f32 v68, -1.0, v141
    v_mul_f32 v69, -1.0, v141
    v_mul_f32 v70, -1.0, v141
    v_mul_f32 v71, -1.0, v141
    v_mul_f32 v72, -1.0, v141
    v_mul_f32 v73, -1.0, v141
    v_mul_f32 v74, -1.0, v141
    v_mul_f32 v75, -1.0, v141
    v_mul_f32 v76, -1.0, v141
    v_mul_f32 v77, -1.0, v141
    v_mul_f32 v78, -1.0, v141
    v_mul_f32 v79, -1.0, v141
    v_mul_f32 v80, -1.0, v141
    v_mul_f32 v81, -1.0, v141
    s_waitcnt lgkmcnt(5)
    s_nop 0
    v_mfma_f32_32x32x16_bf16 v[34:49], v[94:97], v[14:17], v[66:81]
    s_nop 7
    s_nop 3
    s_branch La2b_86
La2s_78:
    buffer_load_dwordx4 a[112:115], v136, s[40:43], s97 offen offset:1024 sc1
    buffer_load_dwordx4 a[116:119], v136, s[40:43], s97 offen offset:2048 sc1
    s_add_u32 s97, s96, 0x7800
    buffer_load_dwordx4 a[120:123], v136, s[40:43], s97 offen offset:0 sc1
    buffer_load_dwordx4 a[124:127], v136, s[40:43], s97 offen offset:1024 sc1
    buffer_load_dwordx4 a[128:131], v136, s[40:43], s97 offen offset:2048 sc1
    s_add_u32 s97, s96, 0x8400
    buffer_load_dwordx4 a[132:135], v136, s[40:43], s97 offen offset:0 sc1
    buffer_load_dwordx4 a[136:139], v136, s[40:43], s97 offen offset:1024 sc1
    buffer_load_dwordx4 a[140:143], v136, s[40:43], s97 offen offset:2048 sc1
    s_add_u32 s97, s96, 0x9000
    buffer_load_dwordx4 a[144:147], v136, s[40:43], s97 offen offset:0 sc1
    buffer_load_dwordx4 a[148:151], v136, s[40:43], s97 offen offset:1024 sc1
    buffer_load_dwordx4 a[152:155], v136, s[40:43], s97 offen offset:2048 sc1
    s_add_u32 s97, s96, 0x9c00
    buffer_load_dwordx4 a[156:159], v136, s[40:43], s97 offen offset:0 sc1
    buffer_load_dwordx4 a[160:163], v136, s[40:43], s97 offen offset:1024 sc1
    buffer_load_dwordx4 a[164:167], v136, s[40:43], s97 offen offset:2048 sc1
    s_add_u32 s97, s96, 0xa800
    buffer_load_dwordx4 a[168:171], v136, s[40:43], s97 offen offset:0 sc1
    buffer_load_dwordx4 a[172:175], v136, s[40:43], s97 offen offset:1024 sc1
    buffer_load_dwordx4 a[176:179], v136, s[40:43], s97 offen offset:2048 sc1
    s_add_u32 s97, s96, 0xb400
    buffer_load_dwordx4 a[180:183], v136, s[40:43], s97 offen offset:0 sc1
    buffer_load_dwordx4 a[184:187], v136, s[40:43], s97 offen offset:1024 sc1
    buffer_load_dwordx4 a[188:191], v136, s[40:43], s97 offen offset:2048 sc1
    v_mov_b32 v50, 0
    v_mov_b32 v51, 0
    v_mov_b32 v52, 0
    v_mov_b32 v53, 0
    v_mov_b32 v54, 0
    v_mov_b32 v55, 0
    v_mov_b32 v56, 0
    v_mov_b32 v57, 0
    v_mov_b32 v58, 0
    v_mov_b32 v59, 0
    v_mov_b32 v60, 0
    v_mov_b32 v61, 0
    v_mov_b32 v62, 0
    v_mov_b32 v63, 0
    v_mov_b32 v64, 0
    v_mov_b32 v65, 0
    ds_read_b128 v[90:93], v120 offset:23040
    ds_read_b64_tr_b16 v[98:99], v121 offset:0
    ds_read_b64_tr_b16 v[100:101], v121 offset:128
    ds_read_b64_tr_b16 v[102:103], v121 offset:256
    ds_read_b64_tr_b16 v[104:105], v121 offset:384
    v_mul_f32 v66, -1.0, v141
    v_mul_f32 v67, -1.0, v141
    v_mul_f32 v68, -1.0, v141
    v_mul_f32 v69, -1.0, v141
    v_mul_f32 v70, -1.0, v141
    v_mul_f32 v71, -1.0, v141
    v_mul_f32 v72, -1.0, v141
    v_mul_f32 v73, -1.0, v141
    v_mul_f32 v74, -1.0, v141
    v_mul_f32 v75, -1.0, v141
    v_mul_f32 v76, -1.0, v141
    v_mul_f32 v77, -1.0, v141
    v_mul_f32 v78, -1.0, v141
    v_mul_f32 v79, -1.0, v141
    v_mul_f32 v80, -1.0, v141
    v_mul_f32 v81, -1.0, v141
    s_waitcnt lgkmcnt(4)
    s_nop 0
    v_mfma_f32_32x32x16_bf16 v[18:33], v[90:93], v[14:17], v[66:81]
    s_nop 7
    s_nop 3
    s_branch La2b_87
Lrt_p3_131:
    s_cmp_eq_u32 s84, 0
    s_cbranch_scc1 Lbk_p3_132
    s_sub_u32 s84, s84, 1
    s_nop 4
    s_add_u32 s89, s86, 0x0
    buffer_load_dwordx4 v[42:45], v122, s[40:43], s89 offen offset:0 sc1
    buffer_load_dwordx4 v[46:49], v122, s[40:43], s89 offen offset:2048 sc1
    s_add_u32 s89, s86, 0x1000
    buffer_load_dwordx4 v[50:53], v122, s[40:43], s89 offen offset:0 sc1
    buffer_load_dwordx4 v[54:57], v122, s[40:43], s89 offen offset:2048 sc1
    s_add_u32 s89, s86, 0x2000
    buffer_load_dwordx4 v[58:61], v122, s[40:43], s89 offen offset:0 sc1
    buffer_load_dwordx4 v[62:65], v122, s[40:43], s89 offen offset:2048 sc1
    s_add_u32 s89, s86, 0x3000
    buffer_load_dwordx4 v[66:69], v122, s[40:43], s89 offen offset:0 sc1
    buffer_load_dwordx4 v[70:73], v122, s[40:43], s89 offen offset:2048 sc1
    s_add_u32 s89, s86, 0x0
    buffer_load_dwordx4 v[74:77], v122, s[40:43], s89 offen offset:1024 sc1
    buffer_load_dwordx4 v[78:81], v122, s[40:43], s89 offen offset:3072 sc1
    s_add_u32 s89, s86, 0x1000
    buffer_load_dwordx4 v[82:85], v122, s[40:43], s89 offen offset:1024 sc1
    buffer_load_dwordx4 v[86:89], v122, s[40:43], s89 offen offset:3072 sc1
    s_add_u32 s89, s86, 0x2000
    buffer_load_dwordx4 v[90:93], v122, s[40:43], s89 offen offset:1024 sc1
    buffer_load_dwordx4 v[94:97], v122, s[40:43], s89 offen offset:3072 sc1
    s_add_u32 s89, s86, 0x3000
    buffer_load_dwordx4 v[98:101], v122, s[40:43], s89 offen offset:1024 sc1
    buffer_load_dwordx4 v[102:105], v122, s[40:43], s89 offen offset:3072 sc1
    s_waitcnt vmcnt(12)
    v_max3_u32 v125, v45, v49, v53
    v_max_u32 v125, v125, v57
    v_cmp_eq_u32 vcc, -1, v125
    s_cbranch_vccnz Lrt_p3_131
    s_branch Lbk_p3_132
Lrt_p3_133:
    s_cmp_eq_u32 s84, 0
    s_cbranch_scc1 Lbk_p3_134
    s_sub_u32 s84, s84, 1
    s_nop 4
    s_add_u32 s89, s86, 0x2000
    buffer_load_dwordx4 v[58:61], v122, s[40:43], s89 offen offset:0 sc1
    buffer_load_dwordx4 v[62:65], v122, s[40:43], s89 offen offset:2048 sc1
    s_add_u32 s89, s86, 0x3000
    buffer_load_dwordx4 v[66:69], v122, s[40:43], s89 offen offset:0 sc1
    buffer_load_dwordx4 v[70:73], v122, s[40:43], s89 offen offset:2048 sc1
    s_add_u32 s89, s86, 0x0
    buffer_load_dwordx4 v[74:77], v122, s[40:43], s89 offen offset:1024 sc1
    buffer_load_dwordx4 v[78:81], v122, s[40:43], s89 offen offset:3072 sc1
    s_add_u32 s89, s86, 0x1000
    buffer_load_dwordx4 v[82:85], v122, s[40:43], s89 offen offset:1024 sc1
    buffer_load_dwordx4 v[86:89], v122, s[40:43], s89 offen offset:3072 sc1
    s_add_u32 s89, s86, 0x2000
    buffer_load_dwordx4 v[90:93], v122, s[40:43], s89 offen offset:1024 sc1
    buffer_load_dwordx4 v[94:97], v122, s[40:43], s89 offen offset:3072 sc1
    s_add_u32 s89, s86, 0x3000
    buffer_load_dwordx4 v[98:101], v122, s[40:43], s89 offen offset:1024 sc1
    buffer_load_dwordx4 v[102:105], v122, s[40:43], s89 offen offset:3072 sc1
    s_waitcnt vmcnt(8)
    v_max3_u32 v125, v61, v65, v69
    v_max_u32 v125, v125, v73
    v_cmp_eq_u32 vcc, -1, v125
    s_cbranch_vccnz Lrt_p3_133
    s_branch Lbk_p3_134
Lrt_p3_135:
    s_cmp_eq_u32 s84, 0
    s_cbranch_scc1 Lbk_p3_136
    s_sub_u32 s84, s84, 1
    s_nop 4
    s_add_u32 s89, s86, 0x0
    buffer_load_dwordx4 v[74:77], v122, s[40:43], s89 offen offset:1024 sc1
    buffer_load_dwordx4 v[78:81], v122, s[40:43], s89 offen offset:3072 sc1
    s_add_u32 s89, s86, 0x1000
    buffer_load_dwordx4 v[82:85], v122, s[40:43], s89 offen offset:1024 sc1
    buffer_load_dwordx4 v[86:89], v122, s[40:43], s89 offen offset:3072 sc1
    s_add_u32 s89, s86, 0x2000
    buffer_load_dwordx4 v[90:93], v122, s[40:43], s89 offen offset:1024 sc1
    buffer_load_dwordx4 v[94:97], v122, s[40:43], s89 offen offset:3072 sc1
    s_add_u32 s89, s86, 0x3000
    buffer_load_dwordx4 v[98:101], v122, s[40:43], s89 offen offset:1024 sc1
    buffer_load_dwordx4 v[102:105], v122, s[40:43], s89 offen offset:3072 sc1
    s_waitcnt vmcnt(4)
    v_max3_u32 v125, v77, v81, v85
    v_max_u32 v125, v125, v89
    v_cmp_eq_u32 vcc, -1, v125
    s_cbranch_vccnz Lrt_p3_135
    s_branch Lbk_p3_136
Lrt_p3_137:
    s_cmp_eq_u32 s84, 0
    s_cbranch_scc1 Lbk_p3_138
    s_sub_u32 s84, s84, 1
    s_nop 4
    s_add_u32 s89, s86, 0x2000
    buffer_load_dwordx4 v[90:93], v122, s[40:43], s89 offen offset:1024 sc1
    buffer_load_dwordx4 v[94:97], v122, s[40:43], s89 offen offset:3072 sc1
    s_add_u32 s89, s86, 0x3000
    buffer_load_dwordx4 v[98:101], v122, s[40:43], s89 offen offset:1024 sc1
    buffer_load_dwordx4 v[102:105], v122, s[40:43], s89 offen offset:3072 sc1
    s_waitcnt vmcnt(0)
    v_max3_u32 v125, v93, v97, v101
    v_max_u32 v125, v125, v105
    v_cmp_eq_u32 vcc, -1, v125
    s_cbranch_vccnz Lrt_p3_137
    s_branch Lbk_p3_138
Lrt_st_141:
    s_cmp_eq_u32 s84, 0
    s_cbranch_scc1 Lbk_st_142
    s_sub_u32 s84, s84, 1
    s_nop 4
    s_add_u32 s89, s86, 0x0
    buffer_load_dwordx2 v[66:67], v63, s[40:43], s89 offen offset:0 sc1
    s_add_u32 s89, s86, 0x400
    buffer_load_dwordx2 v[68:69], v63, s[40:43], s89 offen offset:0 sc1
    s_add_u32 s89, s86, 0x800
    buffer_load_dwordx2 v[70:71], v63, s[40:43], s89 offen offset:0 sc1
    s_add_u32 s89, s86, 0xc00
    buffer_load_dwordx2 v[72:73], v63, s[40:43], s89 offen offset:0 sc1
    s_add_u32 s89, s86, 0x1000
    buffer_load_dwordx2 v[74:75], v63, s[40:43], s89 offen offset:0 sc1
    s_add_u32 s89, s86, 0x1400
    buffer_load_dwordx2 v[76:77], v63, s[40:43], s89 offen offset:0 sc1
    s_add_u32 s89, s86, 0x1800
    buffer_load_dwordx2 v[78:79], v63, s[40:43], s89 offen offset:0 sc1
    s_add_u32 s89, s86, 0x1c00
    buffer_load_dwordx2 v[80:81], v63, s[40:43], s89 offen offset:0 sc1
    s_waitcnt vmcnt(0)
    v_max3_u32 v125, v67, v69, v71
    v_max3_u32 v125, v125, v73, v75
    v_max3_u32 v125, v125, v77, v79
    v_max_u32 v125, v125, v81
    v_cmp_eq_u32 vcc, -1, v125
    s_cbranch_vccnz Lrt_st_141
    s_branch Lbk_st_142
Lrt_p4_143:
    s_cmp_eq_u32 s84, 0
    s_cbranch_scc1 Lbk_p4_144
    s_sub_u32 s84, s84, 1
    s_nop 4
    s_add_u32 s89, s86, 0x0
    buffer_load_dwordx4 v[58:61], v122, s[40:43], s89 offen offset:0 sc1
    buffer_load_dwordx4 v[62:65], v123, s[40:43], s89 offen offset:0 sc1
    buffer_load_dwordx4 v[66:69], v124, s[40:43], s89 offen offset:0 sc1
    buffer_load_dwordx4 v[70:73], v125, s[40:43], s89 offen offset:0 sc1
    s_add_u32 s89, s86, 0x1000
    buffer_load_dwordx4 v[74:77], v122, s[40:43], s89 offen offset:0 sc1
    buffer_load_dwordx4 v[78:81], v123, s[40:43], s89 offen offset:0 sc1
    buffer_load_dwordx4 v[82:85], v124, s[40:43], s89 offen offset:0 sc1
    buffer_load_dwordx4 v[86:89], v125, s[40:43], s89 offen offset:0 sc1
    s_add_u32 s89, s86, 0x2000
    buffer_load_dwordx4 v[90:93], v122, s[40:43], s89 offen offset:0 sc1
    buffer_load_dwordx4 v[94:97], v123, s[40:43], s89 offen offset:0 sc1
    buffer_load_dwordx4 v[98:101], v124, s[40:43], s89 offen offset:0 sc1
    buffer_load_dwordx4 v[102:105], v125, s[40:43], s89 offen offset:0 sc1
    s_add_u32 s89, s86, 0x3000
    buffer_load_dwordx4 v[106:109], v122, s[40:43], s89 offen offset:0 sc1
    buffer_load_dwordx4 v[110:113], v123, s[40:43], s89 offen offset:0 sc1
    buffer_load_dwordx4 v[114:117], v124, s[40:43], s89 offen offset:0 sc1
    buffer_load_dwordx4 v[118:121], v125, s[40:43], s89 offen offset:0 sc1
    s_waitcnt vmcnt(12)
    v_max3_u32 v126, v61, v65, v69
    v_max_u32 v126, v126, v73
    v_cmp_eq_u32 vcc, -1, v126
    s_cbranch_vccnz Lrt_p4_143
    s_branch Lbk_p4_144
Lrt_p4_145:
    s_cmp_eq_u32 s84, 0
    s_cbranch_scc1 Lbk_p4_146
    s_sub_u32 s84, s84, 1
    s_nop 4
    s_add_u32 s89, s86, 0x1000
    buffer_load_dwordx4 v[74:77], v122, s[40:43], s89 offen offset:0 sc1
    buffer_load_dwordx4 v[78:81], v123, s[40:43], s89 offen offset:0 sc1
    buffer_load_dwordx4 v[82:85], v124, s[40:43], s89 offen offset:0 sc1
    buffer_load_dwordx4 v[86:89], v125, s[40:43], s89 offen offset:0 sc1
    s_add_u32 s89, s86, 0x2000
    buffer_load_dwordx4 v[90:93], v122, s[40:43], s89 offen offset:0 sc1
    buffer_load_dwordx4 v[94:97], v123, s[40:43], s89 offen offset:0 sc1
    buffer_load_dwordx4 v[98:101], v124, s[40:43], s89 offen offset:0 sc1
    buffer_load_dwordx4 v[102:105], v125, s[40:43], s89 offen offset:0 sc1
    s_add_u32 s89, s86, 0x3000
    buffer_load_dwordx4 v[106:109], v122, s[40:43], s89 offen offset:0 sc1
    buffer_load_dwordx4 v[110:113], v123, s[40:43], s89 offen offset:0 sc1
    buffer_load_dwordx4 v[114:117], v124, s[40:43], s89 offen offset:0 sc1
    buffer_load_dwordx4 v[118:121], v125, s[40:43], s89 offen offset:0 sc1
    s_waitcnt vmcnt(8)
    v_max3_u32 v126, v77, v81, v85
    v_max_u32 v126, v126, v89
    v_cmp_eq_u32 vcc, -1, v126
    s_cbranch_vccnz Lrt_p4_145
    s_branch Lbk_p4_146
Lrt_p4_147:
    s_cmp_eq_u32 s84, 0
    s_cbranch_scc1 Lbk_p4_148
    s_sub_u32 s84, s84, 1
    s_nop 4
    s_add_u32 s89, s86, 0x2000
    buffer_load_dwordx4 v[90:93], v122, s[40:43], s89 offen offset:0 sc1
    buffer_load_dwordx4 v[94:97], v123, s[40:43], s89 offen offset:0 sc1
    buffer_load_dwordx4 v[98:101], v124, s[40:43], s89 offen offset:0 sc1
    buffer_load_dwordx4 v[102:105], v125, s[40:43], s89 offen offset:0 sc1
    s_add_u32 s89, s86, 0x3000
    buffer_load_dwordx4 v[106:109], v122, s[40:43], s89 offen offset:0 sc1
    buffer_load_dwordx4 v[110:113], v123, s[40:43], s89 offen offset:0 sc1
    buffer_load_dwordx4 v[114:117], v124, s[40:43], s89 offen offset:0 sc1
    buffer_load_dwordx4 v[118:121], v125, s[40:43], s89 offen offset:0 sc1
    s_add_u32 s89, s86, 0x4000
    buffer_load_dwordx4 v[58:61], v122, s[40:43], s89 offen offset:0 sc1
    buffer_load_dwordx4 v[62:65], v123, s[40:43], s89 offen offset:0 sc1
    buffer_load_dwordx4 v[66:69], v124, s[40:43], s89 offen offset:0 sc1
    buffer_load_dwordx4 v[70:73], v125, s[40:43], s89 offen offset:0 sc1
    s_waitcnt vmcnt(8)
    v_max3_u32 v126, v93, v97, v101
    v_max_u32 v126, v126, v105
    v_cmp_eq_u32 vcc, -1, v126
    s_cbranch_vccnz Lrt_p4_147
    s_branch Lbk_p4_148
Lrt_p4_149:
    s_cmp_eq_u32 s84, 0
    s_cbranch_scc1 Lbk_p4_150
    s_sub_u32 s84, s84, 1
    s_nop 4
    s_add_u32 s89, s86, 0x3000
    buffer_load_dwordx4 v[106:109], v122, s[40:43], s89 offen offset:0 sc1
    buffer_load_dwordx4 v[110:113], v123, s[40:43], s89 offen offset:0 sc1
    buffer_load_dwordx4 v[114:117], v124, s[40:43], s89 offen offset:0 sc1
    buffer_load_dwordx4 v[118:121], v125, s[40:43], s89 offen offset:0 sc1
    s_add_u32 s89, s86, 0x4000
    buffer_load_dwordx4 v[58:61], v122, s[40:43], s89 offen offset:0 sc1
    buffer_load_dwordx4 v[62:65], v123, s[40:43], s89 offen offset:0 sc1
    buffer_load_dwordx4 v[66:69], v124, s[40:43], s89 offen offset:0 sc1
    buffer_load_dwordx4 v[70:73], v125, s[40:43], s89 offen offset:0 sc1
    s_add_u32 s89, s86, 0x5000
    buffer_load_dwordx4 v[74:77], v122, s[40:43], s89 offen offset:0 sc1
    buffer_load_dwordx4 v[78:81], v123, s[40:43], s89 offen offset:0 sc1
    buffer_load_dwordx4 v[82:85], v124, s[40:43], s89 offen offset:0 sc1
    buffer_load_dwordx4 v[86:89], v125, s[40:43], s89 offen offset:0 sc1
    s_waitcnt vmcnt(8)
    v_max3_u32 v126, v109, v113, v117
    v_max_u32 v126, v126, v121
    v_cmp_eq_u32 vcc, -1, v126
    s_cbranch_vccnz Lrt_p4_149
    s_branch Lbk_p4_150
Lrt_p4_151:
    s_cmp_eq_u32 s84, 0
    s_cbranch_scc1 Lbk_p4_152
    s_sub_u32 s84, s84, 1
    s_nop 4
    s_add_u32 s89, s86, 0x4000
    buffer_load_dwordx4 v[58:61], v122, s[40:43], s89 offen offset:0 sc1
    buffer_load_dwordx4 v[62:65], v123, s[40:43], s89 offen offset:0 sc1
    buffer_load_dwordx4 v[66:69], v124, s[40:43], s89 offen offset:0 sc1
    buffer_load_dwordx4 v[70:73], v125, s[40:43], s89 offen offset:0 sc1
    s_add_u32 s89, s86, 0x5000
    buffer_load_dwordx4 v[74:77], v122, s[40:43], s89 offen offset:0 sc1
    buffer_load_dwordx4 v[78:81], v123, s[40:43], s89 offen offset:0 sc1
    buffer_load_dwordx4 v[82:85], v124, s[40:43], s89 offen offset:0 sc1
    buffer_load_dwordx4 v[86:89], v125, s[40:43], s89 offen offset:0 sc1
    s_add_u32 s89, s86, 0x6000
    buffer_load_dwordx4 v[90:93], v122, s[40:43], s89 offen offset:0 sc1
    buffer_load_dwordx4 v[94:97], v123, s[40:43], s89 offen offset:0 sc1
    buffer_load_dwordx4 v[98:101], v124, s[40:43], s89 offen offset:0 sc1
    buffer_load_dwordx4 v[102:105], v125, s[40:43], s89 offen offset:0 sc1
    s_waitcnt vmcnt(8)
    v_max3_u32 v126, v61, v65, v69
    v_max_u32 v126, v126, v73
    v_cmp_eq_u32 vcc, -1, v126
    s_cbranch_vccnz Lrt_p4_151
    s_branch Lbk_p4_152
Lrt_p4_153:
    s_cmp_eq_u32 s84, 0
    s_cbranch_scc1 Lbk_p4_154
    s_sub_u32 s84, s84, 1
    s_nop 4
    s_add_u32 s89, s86, 0x5000
    buffer_load_dwordx4 v[74:77], v122, s[40:43], s89 offen offset:0 sc1
    buffer_load_dwordx4 v[78:81], v123, s[40:43], s89 offen offset:0 sc1
    buffer_load_dwordx4 v[82:85], v124, s[40:43], s89 offen offset:0 sc1
    buffer_load_dwordx4 v[86:89], v125, s[40:43], s89 offen offset:0 sc1
    s_add_u32 s89, s86, 0x6000
    buffer_load_dwordx4 v[90:93], v122, s[40:43], s89 offen offset:0 sc1
    buffer_load_dwordx4 v[94:97], v123, s[40:43], s89 offen offset:0 sc1
    buffer_load_dwordx4 v[98:101], v124, s[40:43], s89 offen offset:0 sc1
    buffer_load_dwordx4 v[102:105], v125, s[40:43], s89 offen offset:0 sc1
    s_add_u32 s89, s86, 0x7000
    buffer_load_dwordx4 v[106:109], v122, s[40:43], s89 offen offset:0 sc1
    buffer_load_dwordx4 v[110:113], v123, s[40:43], s89 offen offset:0 sc1
    buffer_load_dwordx4 v[114:117], v124, s[40:43], s89 offen offset:0 sc1
    buffer_load_dwordx4 v[118:121], v125, s[40:43], s89 offen offset:0 sc1
    s_waitcnt vmcnt(8)
    v_max3_u32 v126, v77, v81, v85
    v_max_u32 v126, v126, v89
    v_cmp_eq_u32 vcc, -1, v126
    s_cbranch_vccnz Lrt_p4_153
    s_branch Lbk_p4_154
Lrt_p4_155:
    s_cmp_eq_u32 s84, 0
    s_cbranch_scc1 Lbk_p4_156
    s_sub_u32 s84, s84, 1
    s_nop 4
    s_add_u32 s89, s86, 0x6000
    buffer_load_dwordx4 v[90:93], v122, s[40:43], s89 offen offset:0 sc1
    buffer_load_dwordx4 v[94:97], v123, s[40:43], s89 offen offset:0 sc1
    buffer_load_dwordx4 v[98:101], v124, s[40:43], s89 offen offset:0 sc1
    buffer_load_dwordx4 v[102:105], v125, s[40:43], s89 offen offset:0 sc1
    s_add_u32 s89, s86, 0x7000
    buffer_load_dwordx4 v[106:109], v122, s[40:43], s89 offen offset:0 sc1
    buffer_load_dwordx4 v[110:113], v123, s[40:43], s89 offen offset:0 sc1
    buffer_load_dwordx4 v[114:117], v124, s[40:43], s89 offen offset:0 sc1
    buffer_load_dwordx4 v[118:121], v125, s[40:43], s89 offen offset:0 sc1
    s_add_u32 s89, s86, 0x8000
    buffer_load_dwordx4 v[58:61], v122, s[40:43], s89 offen offset:0 sc1
    buffer_load_dwordx4 v[62:65], v123, s[40:43], s89 offen offset:0 sc1
    buffer_load_dwordx4 v[66:69], v124, s[40:43], s89 offen offset:0 sc1
    buffer_load_dwordx4 v[70:73], v125, s[40:43], s89 offen offset:0 sc1
    s_waitcnt vmcnt(8)
    v_max3_u32 v126, v93, v97, v101
    v_max_u32 v126, v126, v105
    v_cmp_eq_u32 vcc, -1, v126
    s_cbranch_vccnz Lrt_p4_155
    s_branch Lbk_p4_156
Lrt_p4_157:
    s_cmp_eq_u32 s84, 0
    s_cbranch_scc1 Lbk_p4_158
    s_sub_u32 s84, s84, 1
    s_nop 4
    s_add_u32 s89, s86, 0x7000
    buffer_load_dwordx4 v[106:109], v122, s[40:43], s89 offen offset:0 sc1
    buffer_load_dwordx4 v[110:113], v123, s[40:43], s89 offen offset:0 sc1
    buffer_load_dwordx4 v[114:117], v124, s[40:43], s89 offen offset:0 sc1
    buffer_load_dwordx4 v[118:121], v125, s[40:43], s89 offen offset:0 sc1
    s_add_u32 s89, s86, 0x8000
    buffer_load_dwordx4 v[58:61], v122, s[40:43], s89 offen offset:0 sc1
    buffer_load_dwordx4 v[62:65], v123, s[40:43], s89 offen offset:0 sc1
    buffer_load_dwordx4 v[66:69], v124, s[40:43], s89 offen offset:0 sc1
    buffer_load_dwordx4 v[70:73], v125, s[40:43], s89 offen offset:0 sc1
    s_add_u32 s89, s86, 0x9000
    buffer_load_dwordx4 v[74:77], v122, s[40:43], s89 offen offset:0 sc1
    buffer_load_dwordx4 v[78:81], v123, s[40:43], s89 offen offset:0 sc1
    buffer_load_dwordx4 v[82:85], v124, s[40:43], s89 offen offset:0 sc1
    buffer_load_dwordx4 v[86:89], v125, s[40:43], s89 offen offset:0 sc1
    s_waitcnt vmcnt(8)
    v_max3_u32 v126, v109, v113, v117
    v_max_u32 v126, v126, v121
    v_cmp_eq_u32 vcc, -1, v126
    s_cbranch_vccnz Lrt_p4_157
    s_branch Lbk_p4_158
Lrt_p4_159:
    s_cmp_eq_u32 s84, 0
    s_cbranch_scc1 Lbk_p4_160
    s_sub_u32 s84, s84, 1
    s_nop 4
    s_add_u32 s89, s86, 0x8000
    buffer_load_dwordx4 v[58:61], v122, s[40:43], s89 offen offset:0 sc1
    buffer_load_dwordx4 v[62:65], v123, s[40:43], s89 offen offset:0 sc1
    buffer_load_dwordx4 v[66:69], v124, s[40:43], s89 offen offset:0 sc1
    buffer_load_dwordx4 v[70:73], v125, s[40:43], s89 offen offset:0 sc1
    s_add_u32 s89, s86, 0x9000
    buffer_load_dwordx4 v[74:77], v122, s[40:43], s89 offen offset:0 sc1
    buffer_load_dwordx4 v[78:81], v123, s[40:43], s89 offen offset:0 sc1
    buffer_load_dwordx4 v[82:85], v124, s[40:43], s89 offen offset:0 sc1
    buffer_load_dwordx4 v[86:89], v125, s[40:43], s89 offen offset:0 sc1
    s_add_u32 s89, s86, 0xa000
    buffer_load_dwordx4 v[90:93], v122, s[40:43], s89 offen offset:0 sc1
    buffer_load_dwordx4 v[94:97], v123, s[40:43], s89 offen offset:0 sc1
    buffer_load_dwordx4 v[98:101], v124, s[40:43], s89 offen offset:0 sc1
    buffer_load_dwordx4 v[102:105], v125, s[40:43], s89 offen offset:0 sc1
    s_waitcnt vmcnt(8)
    v_max3_u32 v126, v61, v65, v69
    v_max_u32 v126, v126, v73
    v_cmp_eq_u32 vcc, -1, v126
    s_cbranch_vccnz Lrt_p4_159
    s_branch Lbk_p4_160
Lrt_p4_161:
    s_cmp_eq_u32 s84, 0
    s_cbranch_scc1 Lbk_p4_162
    s_sub_u32 s84, s84, 1
    s_nop 4
    s_add_u32 s89, s86, 0x9000
    buffer_load_dwordx4 v[74:77], v122, s[40:43], s89 offen offset:0 sc1
    buffer_load_dwordx4 v[78:81], v123, s[40:43], s89 offen offset:0 sc1
    buffer_load_dwordx4 v[82:85], v124, s[40:43], s89 offen offset:0 sc1
    buffer_load_dwordx4 v[86:89], v125, s[40:43], s89 offen offset:0 sc1
    s_add_u32 s89, s86, 0xa000
    buffer_load_dwordx4 v[90:93], v122, s[40:43], s89 offen offset:0 sc1
    buffer_load_dwordx4 v[94:97], v123, s[40:43], s89 offen offset:0 sc1
    buffer_load_dwordx4 v[98:101], v124, s[40:43], s89 offen offset:0 sc1
    buffer_load_dwordx4 v[102:105], v125, s[40:43], s89 offen offset:0 sc1
    s_add_u32 s89, s86, 0xb000
    buffer_load_dwordx4 v[106:109], v122, s[40:43], s89 offen offset:0 sc1
    buffer_load_dwordx4 v[110:113], v123, s[40:43], s89 offen offset:0 sc1
    buffer_load_dwordx4 v[114:117], v124, s[40:43], s89 offen offset:0 sc1
    buffer_load_dwordx4 v[118:121], v125, s[40:43], s89 offen offset:0 sc1
    s_waitcnt vmcnt(8)
    v_max3_u32 v126, v77, v81, v85
    v_max_u32 v126, v126, v89
    v_cmp_eq_u32 vcc, -1, v126
    s_cbranch_vccnz Lrt_p4_161
    s_branch Lbk_p4_162
Lrt_p4_163:
    s_cmp_eq_u32 s84, 0
    s_cbranch_scc1 Lbk_p4_164
    s_sub_u32 s84, s84, 1
    s_nop 4
    s_add_u32 s89, s86, 0xa000
    buffer_load_dwordx4 v[90:93], v122, s[40:43], s89 offen offset:0 sc1
    buffer_load_dwordx4 v[94:97], v123, s[40:43], s89 offen offset:0 sc1
    buffer_load_dwordx4 v[98:101], v124, s[40:43], s89 offen offset:0 sc1
    buffer_load_dwordx4 v[102:105], v125, s[40:43], s89 offen offset:0 sc1
    s_add_u32 s89, s86, 0xb000
    buffer_load_dwordx4 v[106:109], v122, s[40:43], s89 offen offset:0 sc1
    buffer_load_dwordx4 v[110:113], v123, s[40:43], s89 offen offset:0 sc1
    buffer_load_dwordx4 v[114:117], v124, s[40:43], s89 offen offset:0 sc1
    buffer_load_dwordx4 v[118:121], v125, s[40:43], s89 offen offset:0 sc1
    s_add_u32 s89, s86, 0xc000
    buffer_load_dwordx4 v[58:61], v122, s[40:43], s89 offen offset:0 sc1
    buffer_load_dwordx4 v[62:65], v123, s[40:43], s89 offen offset:0 sc1
    buffer_load_dwordx4 v[66:69], v124, s[40:43], s89 offen offset:0 sc1
    buffer_load_dwordx4 v[70:73], v125, s[40:43], s89 offen offset:0 sc1
    s_waitcnt vmcnt(8)
    v_max3_u32 v126, v93, v97, v101
    v_max_u32 v126, v126, v105
    v_cmp_eq_u32 vcc, -1, v126
    s_cbranch_vccnz Lrt_p4_163
    s_branch Lbk_p4_164
Lrt_p4_165:
    s_cmp_eq_u32 s84, 0
    s_cbranch_scc1 Lbk_p4_166
    s_sub_u32 s84, s84, 1
    s_nop 4
    s_add_u32 s89, s86, 0xb000
    buffer_load_dwordx4 v[106:109], v122, s[40:43], s89 offen offset:0 sc1
    buffer_load_dwordx4 v[110:113], v123, s[40:43], s89 offen offset:0 sc1
    buffer_load_dwordx4 v[114:117], v124, s[40:43], s89 offen offset:0 sc1
    buffer_load_dwordx4 v[118:121], v125, s[40:43], s89 offen offset:0 sc1
    s_add_u32 s89, s86, 0xc000
    buffer_load_dwordx4 v[58:61], v122, s[40:43], s89 offen offset:0 sc1
    buffer_load_dwordx4 v[62:65], v123, s[40:43], s89 offen offset:0 sc1
    buffer_load_dwordx4 v[66:69], v124, s[40:43], s89 offen offset:0 sc1
    buffer_load_dwordx4 v[70:73], v125, s[40:43], s89 offen offset:0 sc1
    s_add_u32 s89, s86, 0xd000
    buffer_load_dwordx4 v[74:77], v122, s[40:43], s89 offen offset:0 sc1
    buffer_load_dwordx4 v[78:81], v123, s[40:43], s89 offen offset:0 sc1
    buffer_load_dwordx4 v[82:85], v124, s[40:43], s89 offen offset:0 sc1
    buffer_load_dwordx4 v[86:89], v125, s[40:43], s89 offen offset:0 sc1
    s_waitcnt vmcnt(8)
    v_max3_u32 v126, v109, v113, v117
    v_max_u32 v126, v126, v121
    v_cmp_eq_u32 vcc, -1, v126
    s_cbranch_vccnz Lrt_p4_165
    s_branch Lbk_p4_166
Lrt_p4_167:
    s_cmp_eq_u32 s84, 0
    s_cbranch_scc1 Lbk_p4_168
    s_sub_u32 s84, s84, 1
    s_nop 4
    s_add_u32 s89, s86, 0xc000
    buffer_load_dwordx4 v[58:61], v122, s[40:43], s89 offen offset:0 sc1
    buffer_load_dwordx4 v[62:65], v123, s[40:43], s89 offen offset:0 sc1
    buffer_load_dwordx4 v[66:69], v124, s[40:43], s89 offen offset:0 sc1
    buffer_load_dwordx4 v[70:73], v125, s[40:43], s89 offen offset:0 sc1
    s_add_u32 s89, s86, 0xd000
    buffer_load_dwordx4 v[74:77], v122, s[40:43], s89 offen offset:0 sc1
    buffer_load_dwordx4 v[78:81], v123, s[40:43], s89 offen offset:0 sc1
    buffer_load_dwordx4 v[82:85], v124, s[40:43], s89 offen offset:0 sc1
    buffer_load_dwordx4 v[86:89], v125, s[40:43], s89 offen offset:0 sc1
    s_add_u32 s89, s86, 0xe000
    buffer_load_dwordx4 v[90:93], v122, s[40:43], s89 offen offset:0 sc1
    buffer_load_dwordx4 v[94:97], v123, s[40:43], s89 offen offset:0 sc1
    buffer_load_dwordx4 v[98:101], v124, s[40:43], s89 offen offset:0 sc1
    buffer_load_dwordx4 v[102:105], v125, s[40:43], s89 offen offset:0 sc1
    s_waitcnt vmcnt(8)
    v_max3_u32 v126, v61, v65, v69
    v_max_u32 v126, v126, v73
    v_cmp_eq_u32 vcc, -1, v126
    s_cbranch_vccnz Lrt_p4_167
    s_branch Lbk_p4_168
Lrt_p4_169:
    s_cmp_eq_u32 s84, 0
    s_cbranch_scc1 Lbk_p4_170
    s_sub_u32 s84, s84, 1
    s_nop 4
    s_add_u32 s89, s86, 0xd000
    buffer_load_dwordx4 v[74:77], v122, s[40:43], s89 offen offset:0 sc1
    buffer_load_dwordx4 v[78:81], v123, s[40:43], s89 offen offset:0 sc1
    buffer_load_dwordx4 v[82:85], v124, s[40:43], s89 offen offset:0 sc1
    buffer_load_dwordx4 v[86:89], v125, s[40:43], s89 offen offset:0 sc1
    s_add_u32 s89, s86, 0xe000
    buffer_load_dwordx4 v[90:93], v122, s[40:43], s89 offen offset:0 sc1
    buffer_load_dwordx4 v[94:97], v123, s[40:43], s89 offen offset:0 sc1
    buffer_load_dwordx4 v[98:101], v124, s[40:43], s89 offen offset:0 sc1
    buffer_load_dwordx4 v[102:105], v125, s[40:43], s89 offen offset:0 sc1
    s_add_u32 s89, s86, 0xf000
    buffer_load_dwordx4 v[106:109], v122, s[40:43], s89 offen offset:0 sc1
    buffer_load_dwordx4 v[110:113], v123, s[40:43], s89 offen offset:0 sc1
    buffer_load_dwordx4 v[114:117], v124, s[40:43], s89 offen offset:0 sc1
    buffer_load_dwordx4 v[118:121], v125, s[40:43], s89 offen offset:0 sc1
    s_waitcnt vmcnt(8)
    v_max3_u32 v126, v77, v81, v85
    v_max_u32 v126, v126, v89
    v_cmp_eq_u32 vcc, -1, v126
    s_cbranch_vccnz Lrt_p4_169
    s_branch Lbk_p4_170
Lrt_p4_171:
    s_cmp_eq_u32 s84, 0
    s_cbranch_scc1 Lbk_p4_172
    s_sub_u32 s84, s84, 1
    s_nop 4
    s_add_u32 s89, s86, 0xe000
    buffer_load_dwordx4 v[90:93], v122, s[40:43], s89 offen offset:0 sc1
    buffer_load_dwordx4 v[94:97], v123, s[40:43], s89 offen offset:0 sc1
    buffer_load_dwordx4 v[98:101], v124, s[40:43], s89 offen offset:0 sc1
    buffer_load_dwordx4 v[102:105], v125, s[40:43], s89 offen offset:0 sc1
    s_add_u32 s89, s86, 0xf000
    buffer_load_dwordx4 v[106:109], v122, s[40:43], s89 offen offset:0 sc1
    buffer_load_dwordx4 v[110:113], v123, s[40:43], s89 offen offset:0 sc1
    buffer_load_dwordx4 v[114:117], v124, s[40:43], s89 offen offset:0 sc1
    buffer_load_dwordx4 v[118:121], v125, s[40:43], s89 offen offset:0 sc1
    s_waitcnt vmcnt(4)
    v_max3_u32 v126, v93, v97, v101
    v_max_u32 v126, v126, v105
    v_cmp_eq_u32 vcc, -1, v126
    s_cbranch_vccnz Lrt_p4_171
    s_branch Lbk_p4_172
Lrt_p4_173:
    s_cmp_eq_u32 s84, 0
    s_cbranch_scc1 Lbk_p4_174
    s_sub_u32 s84, s84, 1
    s_nop 4
    s_add_u32 s89, s86, 0xf000
    buffer_load_dwordx4 v[106:109], v122, s[40:43], s89 offen offset:0 sc1
    buffer_load_dwordx4 v[110:113], v123, s[40:43], s89 offen offset:0 sc1
    buffer_load_dwordx4 v[114:117], v124, s[40:43], s89 offen offset:0 sc1
    buffer_load_dwordx4 v[118:121], v125, s[40:43], s89 offen offset:0 sc1
    s_waitcnt vmcnt(0)
    v_max3_u32 v126, v109, v113, v117
    v_max_u32 v126, v126, v121
    v_cmp_eq_u32 vcc, -1, v126
    s_cbranch_vccnz Lrt_p4_173
    s_branch Lbk_p4_174
Lrt_p5_175:
    s_cmp_eq_u32 s84, 0
    s_cbranch_scc1 Lbk_p5_176
    s_sub_u32 s84, s84, 1
    s_nop 4
    s_add_u32 s89, s87, 0x0
    buffer_load_dwordx4 v[74:77], v134, s[40:43], s89 offen offset:0 sc1
    buffer_load_dwordx4 v[78:81], v133, s[40:43], s89 offen offset:0 sc1
    s_add_u32 s89, s87, 0x0
    buffer_load_dwordx4 v[82:85], v134, s[40:43], s89 offen offset:1024 sc1
    buffer_load_dwordx4 v[86:89], v133, s[40:43], s89 offen offset:1024 sc1
    s_add_u32 s89, s87, 0x0
    buffer_load_dwordx4 v[90:93], v134, s[40:43], s89 offen offset:2048 sc1
    buffer_load_dwordx4 v[94:97], v133, s[40:43], s89 offen offset:2048 sc1
    s_add_u32 s89, s87, 0x0
    buffer_load_dwordx4 v[98:101], v134, s[40:43], s89 offen offset:3072 sc1
    buffer_load_dwordx4 v[102:105], v133, s[40:43], s89 offen offset:3072 sc1
    s_add_u32 s89, s87, 0x1000
    buffer_load_dwordx4 v[106:109], v134, s[40:43], s89 offen offset:0 sc1
    buffer_load_dwordx4 v[110:113], v133, s[40:43], s89 offen offset:0 sc1
    s_add_u32 s89, s87, 0x1000
    buffer_load_dwordx4 v[114:117], v134, s[40:43], s89 offen offset:1024 sc1
    buffer_load_dwordx4 v[118:121], v133, s[40:43], s89 offen offset:1024 sc1
    s_add_u32 s89, s87, 0x1000
    buffer_load_dwordx4 v[122:125], v134, s[40:43], s89 offen offset:2048 sc1
    buffer_load_dwordx4 v[126:129], v133, s[40:43], s89 offen offset:2048 sc1
    s_waitcnt vmcnt(12)
    v_max3_u32 v131, v75, v77, v79
    v_max_u32 v131, v131, v81
    v_cmp_eq_u32 vcc, -1, v131
    s_cbranch_vccnz Lrt_p5_175
    s_branch Lbk_p5_176
Lrt_p5_177:
    s_cmp_eq_u32 s84, 0
    s_cbranch_scc1 Lbk_p5_178
    s_sub_u32 s84, s84, 1
    s_nop 4
    s_add_u32 s89, s87, 0x0
    buffer_load_dwordx4 v[82:85], v134, s[40:43], s89 offen offset:1024 sc1
    buffer_load_dwordx4 v[86:89], v133, s[40:43], s89 offen offset:1024 sc1
    s_add_u32 s89, s87, 0x0
    buffer_load_dwordx4 v[90:93], v134, s[40:43], s89 offen offset:2048 sc1
    buffer_load_dwordx4 v[94:97], v133, s[40:43], s89 offen offset:2048 sc1
    s_add_u32 s89, s87, 0x0
    buffer_load_dwordx4 v[98:101], v134, s[40:43], s89 offen offset:3072 sc1
    buffer_load_dwordx4 v[102:105], v133, s[40:43], s89 offen offset:3072 sc1
    s_add_u32 s89, s87, 0x1000
    buffer_load_dwordx4 v[106:109], v134, s[40:43], s89 offen offset:0 sc1
    buffer_load_dwordx4 v[110:113], v133, s[40:43], s89 offen offset:0 sc1
    s_add_u32 s89, s87, 0x1000
    buffer_load_dwordx4 v[114:117], v134, s[40:43], s89 offen offset:1024 sc1
    buffer_load_dwordx4 v[118:121], v133, s[40:43], s89 offen offset:1024 sc1
    s_add_u32 s89, s87, 0x1000
    buffer_load_dwordx4 v[122:125], v134, s[40:43], s89 offen offset:2048 sc1
    buffer_load_dwordx4 v[126:129], v133, s[40:43], s89 offen offset:2048 sc1
    s_waitcnt vmcnt(10)
    v_max3_u32 v131, v83, v85, v87
    v_max_u32 v131, v131, v89
    v_cmp_eq_u32 vcc, -1, v131
    s_cbranch_vccnz Lrt_p5_177
    s_branch Lbk_p5_178
Lrt_p5_179:
    s_cmp_eq_u32 s84, 0
    s_cbranch_scc1 Lbk_p5_180
    s_sub_u32 s84, s84, 1
    s_nop 4
    s_add_u32 s89, s87, 0x0
    buffer_load_dwordx4 v[90:93], v134, s[40:43], s89 offen offset:2048 sc1
    buffer_load_dwordx4 v[94:97], v133, s[40:43], s89 offen offset:2048 sc1
    s_add_u32 s89, s87, 0x0
    buffer_load_dwordx4 v[98:101], v134, s[40:43], s89 offen offset:3072 sc1
    buffer_load_dwordx4 v[102:105], v133, s[40:43], s89 offen offset:3072 sc1
    s_add_u32 s89, s87, 0x1000
    buffer_load_dwordx4 v[106:109], v134, s[40:43], s89 offen offset:0 sc1
    buffer_load_dwordx4 v[110:113], v133, s[40:43], s89 offen offset:0 sc1
    s_add_u32 s89, s87, 0x1000
    buffer_load_dwordx4 v[114:117], v134, s[40:43], s89 offen offset:1024 sc1
    buffer_load_dwordx4 v[118:121], v133, s[40:43], s89 offen offset:1024 sc1
    s_add_u32 s89, s87, 0x1000
    buffer_load_dwordx4 v[122:125], v134, s[40:43], s89 offen offset:2048 sc1
    buffer_load_dwordx4 v[126:129], v133, s[40:43], s89 offen offset:2048 sc1
    s_add_u32 s89, s87, 0x1000
    buffer_load_dwordx4 v[74:77], v134, s[40:43], s89 offen offset:3072 sc1
    buffer_load_dwordx4 v[78:81], v133, s[40:43], s89 offen offset:3072 sc1
    s_waitcnt vmcnt(10)
    v_max3_u32 v131, v91, v93, v95
    v_max_u32 v131, v131, v97
    v_cmp_eq_u32 vcc, -1, v131
    s_cbranch_vccnz Lrt_p5_179
    s_branch Lbk_p5_180
Lrt_p5_181:
    s_cmp_eq_u32 s84, 0
    s_cbranch_scc1 Lbk_p5_182
    s_sub_u32 s84, s84, 1
    s_nop 4
    s_add_u32 s89, s87, 0x0
    buffer_load_dwordx4 v[98:101], v134, s[40:43], s89 offen offset:3072 sc1
    buffer_load_dwordx4 v[102:105], v133, s[40:43], s89 offen offset:3072 sc1
    s_add_u32 s89, s87, 0x1000
    buffer_load_dwordx4 v[106:109], v134, s[40:43], s89 offen offset:0 sc1
    buffer_load_dwordx4 v[110:113], v133, s[40:43], s89 offen offset:0 sc1
    s_add_u32 s89, s87, 0x1000
    buffer_load_dwordx4 v[114:117], v134, s[40:43], s89 offen offset:1024 sc1
    buffer_load_dwordx4 v[118:121], v133, s[40:43], s89 offen offset:1024 sc1
    s_add_u32 s89, s87, 0x1000
    buffer_load_dwordx4 v[122:125], v134, s[40:43], s89 offen offset:2048 sc1
    buffer_load_dwordx4 v[126:129], v133, s[40:43], s89 offen offset:2048 sc1
    s_add_u32 s89, s87, 0x1000
    buffer_load_dwordx4 v[74:77], v134, s[40:43], s89 offen offset:3072 sc1
    buffer_load_dwordx4 v[78:81], v133, s[40:43], s89 offen offset:3072 sc1
    s_add_u32 s89, s87, 0x2000
    buffer_load_dwordx4 v[82:85], v134, s[40:43], s89 offen offset:0 sc1
    buffer_load_dwordx4 v[86:89], v133, s[40:43], s89 offen offset:0 sc1
    s_waitcnt vmcnt(10)
    v_max3_u32 v131, v99, v101, v103
    v_max_u32 v131, v131, v105
    v_cmp_eq_u32 vcc, -1, v131
    s_cbranch_vccnz Lrt_p5_181
    s_branch Lbk_p5_182
Lrt_p5_183:
    s_cmp_eq_u32 s84, 0
    s_cbranch_scc1 Lbk_p5_184
    s_sub_u32 s84, s84, 1
    s_nop 4
    s_add_u32 s89, s87, 0x1000
    buffer_load_dwordx4 v[106:109], v134, s[40:43], s89 offen offset:0 sc1
    buffer_load_dwordx4 v[110:113], v133, s[40:43], s89 offen offset:0 sc1
    s_add_u32 s89, s87, 0x1000
    buffer_load_dwordx4 v[114:117], v134, s[40:43], s89 offen offset:1024 sc1
    buffer_load_dwordx4 v[118:121], v133, s[40:43], s89 offen offset:1024 sc1
    s_add_u32 s89, s87, 0x1000
    buffer_load_dwordx4 v[122:125], v134, s[40:43], s89 offen offset:2048 sc1
    buffer_load_dwordx4 v[126:129], v133, s[40:43], s89 offen offset:2048 sc1
    s_add_u32 s89, s87, 0x1000
    buffer_load_dwordx4 v[74:77], v134, s[40:43], s89 offen offset:3072 sc1
    buffer_load_dwordx4 v[78:81], v133, s[40:43], s89 offen offset:3072 sc1
    s_add_u32 s89, s87, 0x2000
    buffer_load_dwordx4 v[82:85], v134, s[40:43], s89 offen offset:0 sc1
    buffer_load_dwordx4 v[86:89], v133, s[40:43], s89 offen offset:0 sc1
    s_add_u32 s89, s87, 0x2000
    buffer_load_dwordx4 v[90:93], v134, s[40:43], s89 offen offset:1024 sc1
    buffer_load_dwordx4 v[94:97], v133, s[40:43], s89 offen offset:1024 sc1
    s_waitcnt vmcnt(10)
    v_max3_u32 v131, v107, v109, v111
    v_max_u32 v131, v131, v113
    v_cmp_eq_u32 vcc, -1, v131
    s_cbranch_vccnz Lrt_p5_183
    s_branch Lbk_p5_184
Lrt_p5_185:
    s_cmp_eq_u32 s84, 0
    s_cbranch_scc1 Lbk_p5_186
    s_sub_u32 s84, s84, 1
    s_nop 4
    s_add_u32 s89, s87, 0x1000
    buffer_load_dwordx4 v[114:117], v134, s[40:43], s89 offen offset:1024 sc1
    buffer_load_dwordx4 v[118:121], v133, s[40:43], s89 offen offset:1024 sc1
    s_add_u32 s89, s87, 0x1000
    buffer_load_dwordx4 v[122:125], v134, s[40:43], s89 offen offset:2048 sc1
    buffer_load_dwordx4 v[126:129], v133, s[40:43], s89 offen offset:2048 sc1
    s_add_u32 s89, s87, 0x1000
    buffer_load_dwordx4 v[74:77], v134, s[40:43], s89 offen offset:3072 sc1
    buffer_load_dwordx4 v[78:81], v133, s[40:43], s89 offen offset:3072 sc1
    s_add_u32 s89, s87, 0x2000
    buffer_load_dwordx4 v[82:85], v134, s[40:43], s89 offen offset:0 sc1
    buffer_load_dwordx4 v[86:89], v133, s[40:43], s89 offen offset:0 sc1
    s_add_u32 s89, s87, 0x2000
    buffer_load_dwordx4 v[90:93], v134, s[40:43], s89 offen offset:1024 sc1
    buffer_load_dwordx4 v[94:97], v133, s[40:43], s89 offen offset:1024 sc1
    s_add_u32 s89, s87, 0x2000
    buffer_load_dwordx4 v[98:101], v134, s[40:43], s89 offen offset:2048 sc1
    buffer_load_dwordx4 v[102:105], v133, s[40:43], s89 offen offset:2048 sc1
    s_waitcnt vmcnt(10)
    v_max3_u32 v131, v115, v117, v119
    v_max_u32 v131, v131, v121
    v_cmp_eq_u32 vcc, -1, v131
    s_cbranch_vccnz Lrt_p5_185
    s_branch Lbk_p5_186
Lrt_p5_187:
    s_cmp_eq_u32 s84, 0
    s_cbranch_scc1 Lbk_p5_188
    s_sub_u32 s84, s84, 1
    s_nop 4
    s_add_u32 s89, s87, 0x1000
    buffer_load_dwordx4 v[122:125], v134, s[40:43], s89 offen offset:2048 sc1
    buffer_load_dwordx4 v[126:129], v133, s[40:43], s89 offen offset:2048 sc1
    s_add_u32 s89, s87, 0x1000
    buffer_load_dwordx4 v[74:77], v134, s[40:43], s89 offen offset:3072 sc1
    buffer_load_dwordx4 v[78:81], v133, s[40:43], s89 offen offset:3072 sc1
    s_add_u32 s89, s87, 0x2000
    buffer_load_dwordx4 v[82:85], v134, s[40:43], s89 offen offset:0 sc1
    buffer_load_dwordx4 v[86:89], v133, s[40:43], s89 offen offset:0 sc1
    s_add_u32 s89, s87, 0x2000
    buffer_load_dwordx4 v[90:93], v134, s[40:43], s89 offen offset:1024 sc1
    buffer_load_dwordx4 v[94:97], v133, s[40:43], s89 offen offset:1024 sc1
    s_add_u32 s89, s87, 0x2000
    buffer_load_dwordx4 v[98:101], v134, s[40:43], s89 offen offset:2048 sc1
    buffer_load_dwordx4 v[102:105], v133, s[40:43], s89 offen offset:2048 sc1
    s_add_u32 s89, s87, 0x2000
    buffer_load_dwordx4 v[106:109], v134, s[40:43], s89 offen offset:3072 sc1
    buffer_load_dwordx4 v[110:113], v133, s[40:43], s89 offen offset:3072 sc1
    s_waitcnt vmcnt(10)
    v_max3_u32 v131, v123, v125, v127
    v_max_u32 v131, v131, v129
    v_cmp_eq_u32 vcc, -1, v131
    s_cbranch_vccnz Lrt_p5_187
    s_branch Lbk_p5_188
Lrt_p5_189:
    s_cmp_eq_u32 s84, 0
    s_cbranch_scc1 Lbk_p5_190
    s_sub_u32 s84, s84, 1
    s_nop 4
    s_add_u32 s89, s87, 0x1000
    buffer_load_dwordx4 v[74:77], v134, s[40:43], s89 offen offset:3072 sc1
    buffer_load_dwordx4 v[78:81], v133, s[40:43], s89 offen offset:3072 sc1
    s_add_u32 s89, s87, 0x2000
    buffer_load_dwordx4 v[82:85], v134, s[40:43], s89 offen offset:0 sc1
    buffer_load_dwordx4 v[86:89], v133, s[40:43], s89 offen offset:0 sc1
    s_add_u32 s89, s87, 0x2000
    buffer_load_dwordx4 v[90:93], v134, s[40:43], s89 offen offset:1024 sc1
    buffer_load_dwordx4 v[94:97], v133, s[40:43], s89 offen offset:1024 sc1
    s_add_u32 s89, s87, 0x2000
    buffer_load_dwordx4 v[98:101], v134, s[40:43], s89 offen offset:2048 sc1
    buffer_load_dwordx4 v[102:105], v133, s[40:43], s89 offen offset:2048 sc1
    s_add_u32 s89, s87, 0x2000
    buffer_load_dwordx4 v[106:109], v134, s[40:43], s89 offen offset:3072 sc1
    buffer_load_dwordx4 v[110:113], v133, s[40:43], s89 offen offset:3072 sc1
    s_add_u32 s89, s87, 0x3000
    buffer_load_dwordx4 v[114:117], v134, s[40:43], s89 offen offset:0 sc1
    buffer_load_dwordx4 v[118:121], v133, s[40:43], s89 offen offset:0 sc1
    s_waitcnt vmcnt(10)
    v_max3_u32 v131, v75, v77, v79
    v_max_u32 v131, v131, v81
    v_cmp_eq_u32 vcc, -1, v131
    s_cbranch_vccnz Lrt_p5_189
    s_branch Lbk_p5_190
Lrt_p5_191:
    s_cmp_eq_u32 s84, 0
    s_cbranch_scc1 Lbk_p5_192
    s_sub_u32 s84, s84, 1
    s_nop 4
    s_add_u32 s89, s87, 0x2000
    buffer_load_dwordx4 v[82:85], v134, s[40:43], s89 offen offset:0 sc1
    buffer_load_dwordx4 v[86:89], v133, s[40:43], s89 offen offset:0 sc1
    s_add_u32 s89, s87, 0x2000
    buffer_load_dwordx4 v[90:93], v134, s[40:43], s89 offen offset:1024 sc1
    buffer_load_dwordx4 v[94:97], v133, s[40:43], s89 offen offset:1024 sc1
    s_add_u32 s89, s87, 0x2000
    buffer_load_dwordx4 v[98:101], v134, s[40:43], s89 offen offset:2048 sc1
    buffer_load_dwordx4 v[102:105], v133, s[40:43], s89 offen offset:2048 sc1
    s_add_u32 s89, s87, 0x2000
    buffer_load_dwordx4 v[106:109], v134, s[40:43], s89 offen offset:3072 sc1
    buffer_load_dwordx4 v[110:113], v133, s[40:43], s89 offen offset:3072 sc1
    s_add_u32 s89, s87, 0x3000
    buffer_load_dwordx4 v[114:117], v134, s[40:43], s89 offen offset:0 sc1
    buffer_load_dwordx4 v[118:121], v133, s[40:43], s89 offen offset:0 sc1
    s_add_u32 s89, s87, 0x3000
    buffer_load_dwordx4 v[122:125], v134, s[40:43], s89 offen offset:1024 sc1
    buffer_load_dwordx4 v[126:129], v133, s[40:43], s89 offen offset:1024 sc1
    s_waitcnt vmcnt(10)
    v_max3_u32 v131, v83, v85, v87
    v_max_u32 v131, v131, v89
    v_cmp_eq_u32 vcc, -1, v131
    s_cbranch_vccnz Lrt_p5_191
    s_branch Lbk_p5_192
Lrt_p5_193:
    s_cmp_eq_u32 s84, 0
    s_cbranch_scc1 Lbk_p5_194
    s_sub_u32 s84, s84, 1
    s_nop 4
    s_add_u32 s89, s87, 0x2000
    buffer_load_dwordx4 v[90:93], v134, s[40:43], s89 offen offset:1024 sc1
    buffer_load_dwordx4 v[94:97], v133, s[40:43], s89 offen offset:1024 sc1
    s_add_u32 s89, s87, 0x2000
    buffer_load_dwordx4 v[98:101], v134, s[40:43], s89 offen offset:2048 sc1
    buffer_load_dwordx4 v[102:105], v133, s[40:43], s89 offen offset:2048 sc1
    s_add_u32 s89, s87, 0x2000
    buffer_load_dwordx4 v[106:109], v134, s[40:43], s89 offen offset:3072 sc1
    buffer_load_dwordx4 v[110:113], v133, s[40:43], s89 offen offset:3072 sc1
    s_add_u32 s89, s87, 0x3000
    buffer_load_dwordx4 v[114:117], v134, s[40:43], s89 offen offset:0 sc1
    buffer_load_dwordx4 v[118:121], v133, s[40:43], s89 offen offset:0 sc1
    s_add_u32 s89, s87, 0x3000
    buffer_load_dwordx4 v[122:125], v134, s[40:43], s89 offen offset:1024 sc1
    buffer_load_dwordx4 v[126:129], v133, s[40:43], s89 offen offset:1024 sc1
    s_add_u32 s89, s87, 0x3000
    buffer_load_dwordx4 v[74:77], v134, s[40:43], s89 offen offset:2048 sc1
    buffer_load_dwordx4 v[78:81], v133, s[40:43], s89 offen offset:2048 sc1
    s_waitcnt vmcnt(10)
    v_max3_u32 v131, v91, v93, v95
    v_max_u32 v131, v131, v97
    v_cmp_eq_u32 vcc, -1, v131
    s_cbranch_vccnz Lrt_p5_193
    s_branch Lbk_p5_194
Lrt_p5_195:
    s_cmp_eq_u32 s84, 0
    s_cbranch_scc1 Lbk_p5_196
    s_sub_u32 s84, s84, 1
    s_nop 4
    s_add_u32 s89, s87, 0x2000
    buffer_load_dwordx4 v[98:101], v134, s[40:43], s89 offen offset:2048 sc1
    buffer_load_dwordx4 v[102:105], v133, s[40:43], s89 offen offset:2048 sc1
    s_add_u32 s89, s87, 0x2000
    buffer_load_dwordx4 v[106:109], v134, s[40:43], s89 offen offset:3072 sc1
    buffer_load_dwordx4 v[110:113], v133, s[40:43], s89 offen offset:3072 sc1
    s_add_u32 s89, s87, 0x3000
    buffer_load_dwordx4 v[114:117], v134, s[40:43], s89 offen offset:0 sc1
    buffer_load_dwordx4 v[118:121], v133, s[40:43], s89 offen offset:0 sc1
    s_add_u32 s89, s87, 0x3000
    buffer_load_dwordx4 v[122:125], v134, s[40:43], s89 offen offset:1024 sc1
    buffer_load_dwordx4 v[126:129], v133, s[40:43], s89 offen offset:1024 sc1
    s_add_u32 s89, s87, 0x3000
    buffer_load_dwordx4 v[74:77], v134, s[40:43], s89 offen offset:2048 sc1
    buffer_load_dwordx4 v[78:81], v133, s[40:43], s89 offen offset:2048 sc1
    s_add_u32 s89, s87, 0x3000
    buffer_load_dwordx4 v[82:85], v134, s[40:43], s89 offen offset:3072 sc1
    buffer_load_dwordx4 v[86:89], v133, s[40:43], s89 offen offset:3072 sc1
    s_waitcnt vmcnt(10)
    v_max3_u32 v131, v99, v101, v103
    v_max_u32 v131, v131, v105
    v_cmp_eq_u32 vcc, -1, v131
    s_cbranch_vccnz Lrt_p5_195
    s_branch Lbk_p5_196
Lrt_p5_197:
    s_cmp_eq_u32 s84, 0
    s_cbranch_scc1 Lbk_p5_198
    s_sub_u32 s84, s84, 1
    s_nop 4
    s_add_u32 s89, s87, 0x2000
    buffer_load_dwordx4 v[106:109], v134, s[40:43], s89 offen offset:3072 sc1
    buffer_load_dwordx4 v[110:113], v133, s[40:43], s89 offen offset:3072 sc1
    s_add_u32 s89, s87, 0x3000
    buffer_load_dwordx4 v[114:117], v134, s[40:43], s89 offen offset:0 sc1
    buffer_load_dwordx4 v[118:121], v133, s[40:43], s89 offen offset:0 sc1
    s_add_u32 s89, s87, 0x3000
    buffer_load_dwordx4 v[122:125], v134, s[40:43], s89 offen offset:1024 sc1
    buffer_load_dwordx4 v[126:129], v133, s[40:43], s89 offen offset:1024 sc1
    s_add_u32 s89, s87, 0x3000
    buffer_load_dwordx4 v[74:77], v134, s[40:43], s89 offen offset:2048 sc1
    buffer_load_dwordx4 v[78:81], v133, s[40:43], s89 offen offset:2048 sc1
    s_add_u32 s89, s87, 0x3000
    buffer_load_dwordx4 v[82:85], v134, s[40:43], s89 offen offset:3072 sc1
    buffer_load_dwordx4 v[86:89], v133, s[40:43], s89 offen offset:3072 sc1
    s_add_u32 s89, s87, 0x4000
    buffer_load_dwordx4 v[90:93], v134, s[40:43], s89 offen offset:0 sc1
    buffer_load_dwordx4 v[94:97], v133, s[40:43], s89 offen offset:0 sc1
    s_waitcnt vmcnt(10)
    v_max3_u32 v131, v107, v109, v111
    v_max_u32 v131, v131, v113
    v_cmp_eq_u32 vcc, -1, v131
    s_cbranch_vccnz Lrt_p5_197
    s_branch Lbk_p5_198
Lrt_p5_199:
    s_cmp_eq_u32 s84, 0
    s_cbranch_scc1 Lbk_p5_200
    s_sub_u32 s84, s84, 1
    s_nop 4
    s_add_u32 s89, s87, 0x3000
    buffer_load_dwordx4 v[114:117], v134, s[40:43], s89 offen offset:0 sc1
    buffer_load_dwordx4 v[118:121], v133, s[40:43], s89 offen offset:0 sc1
    s_add_u32 s89, s87, 0x3000
    buffer_load_dwordx4 v[122:125], v134, s[40:43], s89 offen offset:1024 sc1
    buffer_load_dwordx4 v[126:129], v133, s[40:43], s89 offen offset:1024 sc1
    s_add_u32 s89, s87, 0x3000
    buffer_load_dwordx4 v[74:77], v134, s[40:43], s89 offen offset:2048 sc1
    buffer_load_dwordx4 v[78:81], v133, s[40:43], s89 offen offset:2048 sc1
    s_add_u32 s89, s87, 0x3000
    buffer_load_dwordx4 v[82:85], v134, s[40:43], s89 offen offset:3072 sc1
    buffer_load_dwordx4 v[86:89], v133, s[40:43], s89 offen offset:3072 sc1
    s_add_u32 s89, s87, 0x4000
    buffer_load_dwordx4 v[90:93], v134, s[40:43], s89 offen offset:0 sc1
    buffer_load_dwordx4 v[94:97], v133, s[40:43], s89 offen offset:0 sc1
    s_add_u32 s89, s87, 0x4000
    buffer_load_dwordx4 v[98:101], v134, s[40:43], s89 offen offset:1024 sc1
    buffer_load_dwordx4 v[102:105], v133, s[40:43], s89 offen offset:1024 sc1
    s_waitcnt vmcnt(10)
    v_max3_u32 v131, v115, v117, v119
    v_max_u32 v131, v131, v121
    v_cmp_eq_u32 vcc, -1, v131
    s_cbranch_vccnz Lrt_p5_199
    s_branch Lbk_p5_200
Lrt_p5_201:
    s_cmp_eq_u32 s84, 0
    s_cbranch_scc1 Lbk_p5_202
    s_sub_u32 s84, s84, 1
    s_nop 4
    s_add_u32 s89, s87, 0x3000
    buffer_load_dwordx4 v[122:125], v134, s[40:43], s89 offen offset:1024 sc1
    buffer_load_dwordx4 v[126:129], v133, s[40:43], s89 offen offset:1024 sc1
    s_add_u32 s89, s87, 0x3000
    buffer_load_dwordx4 v[74:77], v134, s[40:43], s89 offen offset:2048 sc1
    buffer_load_dwordx4 v[78:81], v133, s[40:43], s89 offen offset:2048 sc1
    s_add_u32 s89, s87, 0x3000
    buffer_load_dwordx4 v[82:85], v134, s[40:43], s89 offen offset:3072 sc1
    buffer_load_dwordx4 v[86:89], v133, s[40:43], s89 offen offset:3072 sc1
    s_add_u32 s89, s87, 0x4000
    buffer_load_dwordx4 v[90:93], v134, s[40:43], s89 offen offset:0 sc1
    buffer_load_dwordx4 v[94:97], v133, s[40:43], s89 offen offset:0 sc1
    s_add_u32 s89, s87, 0x4000
    buffer_load_dwordx4 v[98:101], v134, s[40:43], s89 offen offset:1024 sc1
    buffer_load_dwordx4 v[102:105], v133, s[40:43], s89 offen offset:1024 sc1
    s_add_u32 s89, s87, 0x4000
    buffer_load_dwordx4 v[106:109], v134, s[40:43], s89 offen offset:2048 sc1
    buffer_load_dwordx4 v[110:113], v133, s[40:43], s89 offen offset:2048 sc1
    s_waitcnt vmcnt(10)
    v_max3_u32 v131, v123, v125, v127
    v_max_u32 v131, v131, v129
    v_cmp_eq_u32 vcc, -1, v131
    s_cbranch_vccnz Lrt_p5_201
    s_branch Lbk_p5_202
Lrt_p5_203:
    s_cmp_eq_u32 s84, 0
    s_cbranch_scc1 Lbk_p5_204
    s_sub_u32 s84, s84, 1
    s_nop 4
    s_add_u32 s89, s87, 0x3000
    buffer_load_dwordx4 v[74:77], v134, s[40:43], s89 offen offset:2048 sc1
    buffer_load_dwordx4 v[78:81], v133, s[40:43], s89 offen offset:2048 sc1
    s_add_u32 s89, s87, 0x3000
    buffer_load_dwordx4 v[82:85], v134, s[40:43], s89 offen offset:3072 sc1
    buffer_load_dwordx4 v[86:89], v133, s[40:43], s89 offen offset:3072 sc1
    s_add_u32 s89, s87, 0x4000
    buffer_load_dwordx4 v[90:93], v134, s[40:43], s89 offen offset:0 sc1
    buffer_load_dwordx4 v[94:97], v133, s[40:43], s89 offen offset:0 sc1
    s_add_u32 s89, s87, 0x4000
    buffer_load_dwordx4 v[98:101], v134, s[40:43], s89 offen offset:1024 sc1
    buffer_load_dwordx4 v[102:105], v133, s[40:43], s89 offen offset:1024 sc1
    s_add_u32 s89, s87, 0x4000
    buffer_load_dwordx4 v[106:109], v134, s[40:43], s89 offen offset:2048 sc1
    buffer_load_dwordx4 v[110:113], v133, s[40:43], s89 offen offset:2048 sc1
    s_add_u32 s89, s87, 0x4000
    buffer_load_dwordx4 v[114:117], v134, s[40:43], s89 offen offset:3072 sc1
    buffer_load_dwordx4 v[118:121], v133, s[40:43], s89 offen offset:3072 sc1
    s_waitcnt vmcnt(10)
    v_max3_u32 v131, v75, v77, v79
    v_max_u32 v131, v131, v81
    v_cmp_eq_u32 vcc, -1, v131
    s_cbranch_vccnz Lrt_p5_203
    s_branch Lbk_p5_204
Lrt_p5_205:
    s_cmp_eq_u32 s84, 0
    s_cbranch_scc1 Lbk_p5_206
    s_sub_u32 s84, s84, 1
    s_nop 4
    s_add_u32 s89, s87, 0x3000
    buffer_load_dwordx4 v[82:85], v134, s[40:43], s89 offen offset:3072 sc1
    buffer_load_dwordx4 v[86:89], v133, s[40:43], s89 offen offset:3072 sc1
    s_add_u32 s89, s87, 0x4000
    buffer_load_dwordx4 v[90:93], v134, s[40:43], s89 offen offset:0 sc1
    buffer_load_dwordx4 v[94:97], v133, s[40:43], s89 offen offset:0 sc1
    s_add_u32 s89, s87, 0x4000
    buffer_load_dwordx4 v[98:101], v134, s[40:43], s89 offen offset:1024 sc1
    buffer_load_dwordx4 v[102:105], v133, s[40:43], s89 offen offset:1024 sc1
    s_add_u32 s89, s87, 0x4000
    buffer_load_dwordx4 v[106:109], v134, s[40:43], s89 offen offset:2048 sc1
    buffer_load_dwordx4 v[110:113], v133, s[40:43], s89 offen offset:2048 sc1
    s_add_u32 s89, s87, 0x4000
    buffer_load_dwordx4 v[114:117], v134, s[40:43], s89 offen offset:3072 sc1
    buffer_load_dwordx4 v[118:121], v133, s[40:43], s89 offen offset:3072 sc1
    s_add_u32 s89, s88, 20
    s_min_u32 s89, s89, 85
    s_lshl_b32 s89, s89, 10
    s_add_u32 s89, s89, s86
    buffer_load_dwordx4 v[122:125], v134, s[40:43], s89 offen offset:0 sc1
    buffer_load_dwordx4 v[126:129], v133, s[40:43], s89 offen offset:0 sc1
    s_waitcnt vmcnt(10)
    v_max3_u32 v131, v83, v85, v87
    v_max_u32 v131, v131, v89
    v_cmp_eq_u32 vcc, -1, v131
    s_cbranch_vccnz Lrt_p5_205
    s_branch Lbk_p5_206
Lrt_p5_207:
    s_cmp_eq_u32 s84, 0
    s_cbranch_scc1 Lbk_p5_208
    s_sub_u32 s84, s84, 1
    s_nop 4
    s_add_u32 s89, s87, 0x4000
    buffer_load_dwordx4 v[90:93], v134, s[40:43], s89 offen offset:0 sc1
    buffer_load_dwordx4 v[94:97], v133, s[40:43], s89 offen offset:0 sc1
    s_add_u32 s89, s87, 0x4000
    buffer_load_dwordx4 v[98:101], v134, s[40:43], s89 offen offset:1024 sc1
    buffer_load_dwordx4 v[102:105], v133, s[40:43], s89 offen offset:1024 sc1
    s_add_u32 s89, s87, 0x4000
    buffer_load_dwordx4 v[106:109], v134, s[40:43], s89 offen offset:2048 sc1
    buffer_load_dwordx4 v[110:113], v133, s[40:43], s89 offen offset:2048 sc1
    s_add_u32 s89, s87, 0x4000
    buffer_load_dwordx4 v[114:117], v134, s[40:43], s89 offen offset:3072 sc1
    buffer_load_dwordx4 v[118:121], v133, s[40:43], s89 offen offset:3072 sc1
    s_add_u32 s89, s88, 20
    s_min_u32 s89, s89, 85
    s_lshl_b32 s89, s89, 10
    s_add_u32 s89, s89, s86
    buffer_load_dwordx4 v[122:125], v134, s[40:43], s89 offen offset:0 sc1
    buffer_load_dwordx4 v[126:129], v133, s[40:43], s89 offen offset:0 sc1
    s_add_u32 s89, s88, 21
    s_min_u32 s89, s89, 85
    s_lshl_b32 s89, s89, 10
    s_add_u32 s89, s89, s86
    buffer_load_dwordx4 v[74:77], v134, s[40:43], s89 offen offset:0 sc1
    buffer_load_dwordx4 v[78:81], v133, s[40:43], s89 offen offset:0 sc1
    s_waitcnt vmcnt(10)
    v_max3_u32 v131, v91, v93, v95
    v_max_u32 v131, v131, v97
    v_cmp_eq_u32 vcc, -1, v131
    s_cbranch_vccnz Lrt_p5_207
    s_branch Lbk_p5_208
Lrt_p5_209:
    s_cmp_eq_u32 s84, 0
    s_cbranch_scc1 Lbk_p5_210
    s_sub_u32 s84, s84, 1
    s_nop 4
    s_add_u32 s89, s87, 0x4000
    buffer_load_dwordx4 v[98:101], v134, s[40:43], s89 offen offset:1024 sc1
    buffer_load_dwordx4 v[102:105], v133, s[40:43], s89 offen offset:1024 sc1
    s_add_u32 s89, s87, 0x4000
    buffer_load_dwordx4 v[106:109], v134, s[40:43], s89 offen offset:2048 sc1
    buffer_load_dwordx4 v[110:113], v133, s[40:43], s89 offen offset:2048 sc1
    s_add_u32 s89, s87, 0x4000
    buffer_load_dwordx4 v[114:117], v134, s[40:43], s89 offen offset:3072 sc1
    buffer_load_dwordx4 v[118:121], v133, s[40:43], s89 offen offset:3072 sc1
    s_add_u32 s89, s88, 20
    s_min_u32 s89, s89, 85
    s_lshl_b32 s89, s89, 10
    s_add_u32 s89, s89, s86
    buffer_load_dwordx4 v[122:125], v134, s[40:43], s89 offen offset:0 sc1
    buffer_load_dwordx4 v[126:129], v133, s[40:43], s89 offen offset:0 sc1
    s_add_u32 s89, s88, 21
    s_min_u32 s89, s89, 85
    s_lshl_b32 s89, s89, 10
    s_add_u32 s89, s89, s86
    buffer_load_dwordx4 v[74:77], v134, s[40:43], s89 offen offset:0 sc1
    buffer_load_dwordx4 v[78:81], v133, s[40:43], s89 offen offset:0 sc1
    s_waitcnt vmcnt(8)
    v_max3_u32 v131, v99, v101, v103
    v_max_u32 v131, v131, v105
    v_cmp_eq_u32 vcc, -1, v131
    s_cbranch_vccnz Lrt_p5_209
    s_branch Lbk_p5_210
Lrt_p5_211:
    s_cmp_eq_u32 s84, 0
    s_cbranch_scc1 Lbk_p5_212
    s_sub_u32 s84, s84, 1
    s_nop 4
    s_add_u32 s89, s87, 0x4000
    buffer_load_dwordx4 v[106:109], v134, s[40:43], s89 offen offset:2048 sc1
    buffer_load_dwordx4 v[110:113], v133, s[40:43], s89 offen offset:2048 sc1
    s_add_u32 s89, s87, 0x4000
    buffer_load_dwordx4 v[114:117], v134, s[40:43], s89 offen offset:3072 sc1
    buffer_load_dwordx4 v[118:121], v133, s[40:43], s89 offen offset:3072 sc1
    s_add_u32 s89, s88, 20
    s_min_u32 s89, s89, 85
    s_lshl_b32 s89, s89, 10
    s_add_u32 s89, s89, s86
    buffer_load_dwordx4 v[122:125], v134, s[40:43], s89 offen offset:0 sc1
    buffer_load_dwordx4 v[126:129], v133, s[40:43], s89 offen offset:0 sc1
    s_add_u32 s89, s88, 21
    s_min_u32 s89, s89, 85
    s_lshl_b32 s89, s89, 10
    s_add_u32 s89, s89, s86
    buffer_load_dwordx4 v[74:77], v134, s[40:43], s89 offen offset:0 sc1
    buffer_load_dwordx4 v[78:81], v133, s[40:43], s89 offen offset:0 sc1
    s_waitcnt vmcnt(6)
    v_max3_u32 v131, v107, v109, v111
    v_max_u32 v131, v131, v113
    v_cmp_eq_u32 vcc, -1, v131
    s_cbranch_vccnz Lrt_p5_211
    s_branch Lbk_p5_212
Lrt_p5_213:
    s_cmp_eq_u32 s84, 0
    s_cbranch_scc1 Lbk_p5_214
    s_sub_u32 s84, s84, 1
    s_nop 4
    s_add_u32 s89, s87, 0x4000
    buffer_load_dwordx4 v[114:117], v134, s[40:43], s89 offen offset:3072 sc1
    buffer_load_dwordx4 v[118:121], v133, s[40:43], s89 offen offset:3072 sc1
    s_add_u32 s89, s88, 20
    s_min_u32 s89, s89, 85
    s_lshl_b32 s89, s89, 10
    s_add_u32 s89, s89, s86
    buffer_load_dwordx4 v[122:125], v134, s[40:43], s89 offen offset:0 sc1
    buffer_load_dwordx4 v[126:129], v133, s[40:43], s89 offen offset:0 sc1
    s_add_u32 s89, s88, 21
    s_min_u32 s89, s89, 85
    s_lshl_b32 s89, s89, 10
    s_add_u32 s89, s89, s86
    buffer_load_dwordx4 v[74:77], v134, s[40:43], s89 offen offset:0 sc1
    buffer_load_dwordx4 v[78:81], v133, s[40:43], s89 offen offset:0 sc1
    s_waitcnt vmcnt(4)
    v_max3_u32 v131, v115, v117, v119
    v_max_u32 v131, v131, v121
    v_cmp_eq_u32 vcc, -1, v131
    s_cbranch_vccnz Lrt_p5_213
    s_branch Lbk_p5_214
Lrt_p5_215:
    s_cmp_eq_u32 s84, 0
    s_cbranch_scc1 Lbk_p5_216
    s_sub_u32 s84, s84, 1
    s_nop 4
    s_add_u32 s89, s88, 20
    s_min_u32 s89, s89, 85
    s_lshl_b32 s89, s89, 10
    s_add_u32 s89, s89, s86
    buffer_load_dwordx4 v[122:125], v134, s[40:43], s89 offen offset:0 sc1
    buffer_load_dwordx4 v[126:129], v133, s[40:43], s89 offen offset:0 sc1
    s_add_u32 s89, s88, 21
    s_min_u32 s89, s89, 85
    s_lshl_b32 s89, s89, 10
    s_add_u32 s89, s89, s86
    buffer_load_dwordx4 v[74:77], v134, s[40:43], s89 offen offset:0 sc1
    buffer_load_dwordx4 v[78:81], v133, s[40:43], s89 offen offset:0 sc1
    s_waitcnt vmcnt(2)
    v_max3_u32 v131, v123, v125, v127
    v_max_u32 v131, v131, v129
    v_cmp_eq_u32 vcc, -1, v131
    s_cbranch_vccnz Lrt_p5_215
    s_branch Lbk_p5_216
Lrt_p5_217:
    s_cmp_eq_u32 s84, 0
    s_cbranch_scc1 Lbk_p5_218
    s_sub_u32 s84, s84, 1
    s_nop 4
    s_add_u32 s89, s88, 21
    s_min_u32 s89, s89, 85
    s_lshl_b32 s89, s89, 10
    s_add_u32 s89, s89, s86
    buffer_load_dwordx4 v[74:77], v134, s[40:43], s89 offen offset:0 sc1
    buffer_load_dwordx4 v[78:81], v133, s[40:43], s89 offen offset:0 sc1
    s_waitcnt vmcnt(0)
    v_max3_u32 v131, v75, v77, v79
    v_max_u32 v131, v131, v81
    v_cmp_eq_u32 vcc, -1, v131
    s_cbranch_vccnz Lrt_p5_217
    s_branch Lbk_p5_218
Lrt_p1_223:
    s_cmp_eq_u32 s84, 0
    s_cbranch_scc1 Lbk_p1_224
    s_sub_u32 s84, s84, 1
    s_nop 4
    s_add_u32 s89, s86, 0x0
    buffer_load_dwordx4 v[58:61], v130, s[40:43], s89 offen offset:0 sc1
    s_add_u32 s89, s86, 0x0
    buffer_load_dwordx4 v[62:65], v130, s[40:43], s89 offen offset:1024 sc1
    s_add_u32 s89, s86, 0x0
    buffer_load_dwordx4 v[66:69], v130, s[40:43], s89 offen offset:2048 sc1
    s_add_u32 s89, s86, 0x0
    buffer_load_dwordx4 v[70:73], v130, s[40:43], s89 offen offset:3072 sc1
    s_add_u32 s89, s86, 0x1000
    buffer_load_dwordx4 v[74:77], v130, s[40:43], s89 offen offset:0 sc1
    s_add_u32 s89, s86, 0x1000
    buffer_load_dwordx4 v[78:81], v130, s[40:43], s89 offen offset:1024 sc1
    s_add_u32 s89, s86, 0x1000
    buffer_load_dwordx4 v[82:85], v130, s[40:43], s89 offen offset:2048 sc1
    s_add_u32 s89, s86, 0x1000
    buffer_load_dwordx4 v[86:89], v130, s[40:43], s89 offen offset:3072 sc1
    s_add_u32 s89, s86, 0x2000
    buffer_load_dwordx4 v[90:93], v130, s[40:43], s89 offen offset:0 sc1
    s_add_u32 s89, s86, 0x2000
    buffer_load_dwordx4 v[94:97], v130, s[40:43], s89 offen offset:1024 sc1
    s_add_u32 s89, s86, 0x2000
    buffer_load_dwordx4 v[98:101], v130, s[40:43], s89 offen offset:2048 sc1
    s_add_u32 s89, s86, 0x2000
    buffer_load_dwordx4 v[102:105], v130, s[40:43], s89 offen offset:3072 sc1
    s_waitcnt vmcnt(8)
    v_max3_u32 v133, v61, v65, v69
    v_max_u32 v133, v133, v73
    v_cmp_eq_u32 vcc, -1, v133
    s_cbranch_vccnz Lrt_p1_223
    s_branch Lbk_p1_224
Lrt_p1_225:
    s_cmp_eq_u32 s84, 0
    s_cbranch_scc1 Lbk_p1_226
    s_sub_u32 s84, s84, 1
    s_nop 4
    s_add_u32 s89, s86, 0x1000
    buffer_load_dwordx4 v[74:77], v130, s[40:43], s89 offen offset:0 sc1
    s_add_u32 s89, s86, 0x1000
    buffer_load_dwordx4 v[78:81], v130, s[40:43], s89 offen offset:1024 sc1
    s_add_u32 s89, s86, 0x1000
    buffer_load_dwordx4 v[82:85], v130, s[40:43], s89 offen offset:2048 sc1
    s_add_u32 s89, s86, 0x1000
    buffer_load_dwordx4 v[86:89], v130, s[40:43], s89 offen offset:3072 sc1
    s_add_u32 s89, s86, 0x2000
    buffer_load_dwordx4 v[90:93], v130, s[40:43], s89 offen offset:0 sc1
    s_add_u32 s89, s86, 0x2000
    buffer_load_dwordx4 v[94:97], v130, s[40:43], s89 offen offset:1024 sc1
    s_add_u32 s89, s86, 0x2000
    buffer_load_dwordx4 v[98:101], v130, s[40:43], s89 offen offset:2048 sc1
    s_add_u32 s89, s86, 0x2000
    buffer_load_dwordx4 v[102:105], v130, s[40:43], s89 offen offset:3072 sc1
    s_waitcnt vmcnt(4)
    v_max3_u32 v133, v77, v81, v85
    v_max_u32 v133, v133, v89
    v_cmp_eq_u32 vcc, -1, v133
    s_cbranch_vccnz Lrt_p1_225
    s_branch Lbk_p1_226
Lrt_p1_227:
    s_cmp_eq_u32 s84, 0
    s_cbranch_scc1 Lbk_p1_228
    s_sub_u32 s84, s84, 1
    s_nop 4
    s_add_u32 s89, s86, 0x2000
    buffer_load_dwordx4 v[90:93], v130, s[40:43], s89 offen offset:0 sc1
    s_add_u32 s89, s86, 0x2000
    buffer_load_dwordx4 v[94:97], v130, s[40:43], s89 offen offset:1024 sc1
    s_add_u32 s89, s86, 0x2000
    buffer_load_dwordx4 v[98:101], v130, s[40:43], s89 offen offset:2048 sc1
    s_add_u32 s89, s86, 0x2000
    buffer_load_dwordx4 v[102:105], v130, s[40:43], s89 offen offset:3072 sc1
    s_add_u32 s89, s86, 0x3000
    buffer_load_dwordx4 v[58:61], v130, s[40:43], s89 offen offset:0 sc1
    s_add_u32 s89, s86, 0x3000
    buffer_load_dwordx4 v[62:65], v130, s[40:43], s89 offen offset:1024 sc1
    s_add_u32 s89, s86, 0x3000
    buffer_load_dwordx4 v[66:69], v130, s[40:43], s89 offen offset:2048 sc1
    s_add_u32 s89, s86, 0x3000
    buffer_load_dwordx4 v[70:73], v130, s[40:43], s89 offen offset:3072 sc1
    s_waitcnt vmcnt(4)
    v_max3_u32 v133, v93, v97, v101
    v_max_u32 v133, v133, v105
    v_cmp_eq_u32 vcc, -1, v133
    s_cbranch_vccnz Lrt_p1_227
    s_branch Lbk_p1_228
Lrt_p1_229:
    s_cmp_eq_u32 s84, 0
    s_cbranch_scc1 Lbk_p1_230
    s_sub_u32 s84, s84, 1
    s_nop 4
    s_add_u32 s89, s86, 0x3000
    buffer_load_dwordx4 v[58:61], v130, s[40:43], s89 offen offset:0 sc1
    s_add_u32 s89, s86, 0x3000
    buffer_load_dwordx4 v[62:65], v130, s[40:43], s89 offen offset:1024 sc1
    s_add_u32 s89, s86, 0x3000
    buffer_load_dwordx4 v[66:69], v130, s[40:43], s89 offen offset:2048 sc1
    s_add_u32 s89, s86, 0x3000
    buffer_load_dwordx4 v[70:73], v130, s[40:43], s89 offen offset:3072 sc1
    s_add_u32 s89, s86, 0x4000
    buffer_load_dwordx4 v[74:77], v130, s[40:43], s89 offen offset:0 sc1
    s_add_u32 s89, s86, 0x4000
    buffer_load_dwordx4 v[78:81], v130, s[40:43], s89 offen offset:1024 sc1
    s_add_u32 s89, s86, 0x4000
    buffer_load_dwordx4 v[82:85], v130, s[40:43], s89 offen offset:2048 sc1
    s_add_u32 s89, s86, 0x4000
    buffer_load_dwordx4 v[86:89], v130, s[40:43], s89 offen offset:3072 sc1
    s_waitcnt vmcnt(4)
    v_max3_u32 v133, v61, v65, v69
    v_max_u32 v133, v133, v73
    v_cmp_eq_u32 vcc, -1, v133
    s_cbranch_vccnz Lrt_p1_229
    s_branch Lbk_p1_230
Lrt_p1_231:
    s_cmp_eq_u32 s84, 0
    s_cbranch_scc1 Lbk_p1_232
    s_sub_u32 s84, s84, 1
    s_nop 4
    s_add_u32 s89, s86, 0x4000
    buffer_load_dwordx4 v[74:77], v130, s[40:43], s89 offen offset:0 sc1
    s_add_u32 s89, s86, 0x4000
    buffer_load_dwordx4 v[78:81], v130, s[40:43], s89 offen offset:1024 sc1
    s_add_u32 s89, s86, 0x4000
    buffer_load_dwordx4 v[82:85], v130, s[40:43], s89 offen offset:2048 sc1
    s_add_u32 s89, s86, 0x4000
    buffer_load_dwordx4 v[86:89], v130, s[40:43], s89 offen offset:3072 sc1
    s_add_u32 s89, s86, 0x5000
    buffer_load_dwordx4 v[90:93], v130, s[40:43], s89 offen offset:0 sc1
    s_add_u32 s89, s86, 0x5000
    buffer_load_dwordx4 v[94:97], v130, s[40:43], s89 offen offset:1024 sc1
    s_add_u32 s89, s86, 0x5000
    buffer_load_dwordx4 v[98:101], v130, s[40:43], s89 offen offset:2048 sc1
    s_add_u32 s89, s86, 0x5000
    buffer_load_dwordx4 v[102:105], v130, s[40:43], s89 offen offset:3072 sc1
    s_waitcnt vmcnt(4)
    v_max3_u32 v133, v77, v81, v85
    v_max_u32 v133, v133, v89
    v_cmp_eq_u32 vcc, -1, v133
    s_cbranch_vccnz Lrt_p1_231
    s_branch Lbk_p1_232
Lrt_p1_233:
    s_cmp_eq_u32 s84, 0
    s_cbranch_scc1 Lbk_p1_234
    s_sub_u32 s84, s84, 1
    s_nop 4
    s_add_u32 s89, s86, 0x5000
    buffer_load_dwordx4 v[90:93], v130, s[40:43], s89 offen offset:0 sc1
    s_add_u32 s89, s86, 0x5000
    buffer_load_dwordx4 v[94:97], v130, s[40:43], s89 offen offset:1024 sc1
    s_add_u32 s89, s86, 0x5000
    buffer_load_dwordx4 v[98:101], v130, s[40:43], s89 offen offset:2048 sc1
    s_add_u32 s89, s86, 0x5000
    buffer_load_dwordx4 v[102:105], v130, s[40:43], s89 offen offset:3072 sc1
    s_add_u32 s89, s86, 0x6000
    buffer_load_dwordx4 v[58:61], v130, s[40:43], s89 offen offset:0 sc1
    s_add_u32 s89, s86, 0x6000
    buffer_load_dwordx4 v[62:65], v130, s[40:43], s89 offen offset:1024 sc1
    s_add_u32 s89, s86, 0x6000
    buffer_load_dwordx4 v[66:69], v130, s[40:43], s89 offen offset:2048 sc1
    s_add_u32 s89, s86, 0x6000
    buffer_load_dwordx4 v[70:73], v130, s[40:43], s89 offen offset:3072 sc1
    s_waitcnt vmcnt(4)
    v_max3_u32 v133, v93, v97, v101
    v_max_u32 v133, v133, v105
    v_cmp_eq_u32 vcc, -1, v133
    s_cbranch_vccnz Lrt_p1_233
    s_branch Lbk_p1_234
Lrt_p1_235:
    s_cmp_eq_u32 s84, 0
    s_cbranch_scc1 Lbk_p1_236
    s_sub_u32 s84, s84, 1
    s_nop 4
    s_add_u32 s89, s86, 0x6000
    buffer_load_dwordx4 v[58:61], v130, s[40:43], s89 offen offset:0 sc1
    s_add_u32 s89, s86, 0x6000
    buffer_load_dwordx4 v[62:65], v130, s[40:43], s89 offen offset:1024 sc1
    s_add_u32 s89, s86, 0x6000
    buffer_load_dwordx4 v[66:69], v130, s[40:43], s89 offen offset:2048 sc1
    s_add_u32 s89, s86, 0x6000
    buffer_load_dwordx4 v[70:73], v130, s[40:43], s89 offen offset:3072 sc1
    s_add_u32 s89, s86, 0x7000
    buffer_load_dwordx4 v[74:77], v130, s[40:43], s89 offen offset:0 sc1
    s_add_u32 s89, s86, 0x7000
    buffer_load_dwordx4 v[78:81], v130, s[40:43], s89 offen offset:1024 sc1
    s_add_u32 s89, s86, 0x7000
    buffer_load_dwordx4 v[82:85], v130, s[40:43], s89 offen offset:2048 sc1
    s_add_u32 s89, s86, 0x7000
    buffer_load_dwordx4 v[86:89], v130, s[40:43], s89 offen offset:3072 sc1
    s_waitcnt vmcnt(4)
    v_max3_u32 v133, v61, v65, v69
    v_max_u32 v133, v133, v73
    v_cmp_eq_u32 vcc, -1, v133
    s_cbranch_vccnz Lrt_p1_235
    s_branch Lbk_p1_236
Lrt_p1_237:
    s_cmp_eq_u32 s84, 0
    s_cbranch_scc1 Lbk_p1_238
    s_sub_u32 s84, s84, 1
    s_nop 4
    s_add_u32 s89, s86, 0x7000
    buffer_load_dwordx4 v[74:77], v130, s[40:43], s89 offen offset:0 sc1
    s_add_u32 s89, s86, 0x7000
    buffer_load_dwordx4 v[78:81], v130, s[40:43], s89 offen offset:1024 sc1
    s_add_u32 s89, s86, 0x7000
    buffer_load_dwordx4 v[82:85], v130, s[40:43], s89 offen offset:2048 sc1
    s_add_u32 s89, s86, 0x7000
    buffer_load_dwordx4 v[86:89], v130, s[40:43], s89 offen offset:3072 sc1
    s_waitcnt vmcnt(0)
    v_max3_u32 v133, v77, v81, v85
    v_max_u32 v133, v133, v89
    v_cmp_eq_u32 vcc, -1, v133
    s_cbranch_vccnz Lrt_p1_237
    s_branch Lbk_p1_238
Lrt_st2_239:
    s_cmp_eq_u32 s84, 0
    s_cbranch_scc1 Lbk_st2_240
    s_sub_u32 s84, s84, 1
    s_nop 4
    s_add_u32 s89, s87, 0x0
    buffer_load_dwordx2 v[90:91], v134, s[40:43], s89 offen offset:0 sc1
    s_add_u32 s89, s87, 0x400
    buffer_load_dwordx2 v[92:93], v134, s[40:43], s89 offen offset:0 sc1
    s_add_u32 s89, s87, 0x800
    buffer_load_dwordx2 v[94:95], v134, s[40:43], s89 offen offset:0 sc1
    s_add_u32 s89, s87, 0xc00
    buffer_load_dwordx2 v[96:97], v134, s[40:43], s89 offen offset:0 sc1
    s_add_u32 s89, s87, 0x1000
    buffer_load_dwordx2 v[98:99], v134, s[40:43], s89 offen offset:0 sc1
    s_add_u32 s89, s87, 0x1400
    buffer_load_dwordx2 v[100:101], v134, s[40:43], s89 offen offset:0 sc1
    s_add_u32 s89, s87, 0x1800
    buffer_load_dwordx2 v[102:103], v134, s[40:43], s89 offen offset:0 sc1
    s_add_u32 s89, s87, 0x1c00
    buffer_load_dwordx2 v[104:105], v134, s[40:43], s89 offen offset:0 sc1
    s_waitcnt vmcnt(0)
    v_max3_u32 v133, v91, v93, v95
    v_max3_u32 v133, v133, v97, v99
    v_max3_u32 v133, v133, v101, v103
    v_max_u32 v133, v133, v105
    v_cmp_eq_u32 vcc, -1, v133
    s_cbranch_vccnz Lrt_st2_239
    s_branch Lbk_st2_240
Lrt_halo_241:
    s_cmp_eq_u32 s84, 0
    s_cbranch_scc1 Lbk_halo_242
    s_sub_u32 s84, s84, 1
    s_nop 4
    s_add_u32 s89, s87, 0
    s_max_u32 s89, s89, 8
    s_sub_u32 s89, s89, 8
    s_lshl_b32 s89, s89, 10
    s_add_u32 s89, s89, s86
    buffer_load_dwordx4 v[18:21], v124, s[40:43], s89 offen offset:0 sc1
    s_add_u32 s89, s87, 1
    s_max_u32 s89, s89, 8
    s_sub_u32 s89, s89, 8
    s_lshl_b32 s89, s89, 10
    s_add_u32 s89, s89, s86
    buffer_load_dwordx4 v[22:25], v124, s[40:43], s89 offen offset:0 sc1
    s_add_u32 s89, s87, 2
    s_max_u32 s89, s89, 8
    s_sub_u32 s89, s89, 8
    s_lshl_b32 s89, s89, 10
    s_add_u32 s89, s89, s86
    buffer_load_dwordx4 v[26:29], v124, s[40:43], s89 offen offset:0 sc1
    s_add_u32 s89, s87, 3
    s_max_u32 s89, s89, 8
    s_sub_u32 s89, s89, 8
    s_lshl_b32 s89, s89, 10
    s_add_u32 s89, s89, s86
    buffer_load_dwordx4 v[30:33], v124, s[40:43], s89 offen offset:0 sc1
    s_add_u32 s89, s87, 4
    s_max_u32 s89, s89, 8
    s_sub_u32 s89, s89, 8
    s_lshl_b32 s89, s89, 10
    s_add_u32 s89, s89, s86
    buffer_load_dwordx4 v[34:37], v124, s[40:43], s89 offen offset:0 sc1
    s_add_u32 s89, s87, 5
    s_max_u32 s89, s89, 8
    s_sub_u32 s89, s89, 8
    s_lshl_b32 s89, s89, 10
    s_add_u32 s89, s89, s86
    buffer_load_dwordx4 v[38:41], v124, s[40:43], s89 offen offset:0 sc1
    s_add_u32 s89, s87, 6
    s_max_u32 s89, s89, 8
    s_sub_u32 s89, s89, 8
    s_lshl_b32 s89, s89, 10
    s_add_u32 s89, s89, s86
    buffer_load_dwordx4 v[42:45], v124, s[40:43], s89 offen offset:0 sc1
    s_add_u32 s89, s87, 7
    s_max_u32 s89, s89, 8
    s_sub_u32 s89, s89, 8
    s_lshl_b32 s89, s89, 10
    s_add_u32 s89, s89, s86
    buffer_load_dwordx4 v[46:49], v124, s[40:43], s89 offen offset:0 sc1
    s_waitcnt vmcnt(0)
    v_max3_u32 v116, v21, v25, v29
    v_max3_u32 v116, v116, v33, v37
    v_max3_u32 v116, v116, v41, v45
    v_max_u32 v116, v116, v49
    v_cmp_eq_u32 vcc, -1, v116
    s_cbranch_vccnz Lrt_halo_241
    s_branch Lbk_halo_242
La2s_243:
    s_cmp_eq_u32 s83, 1
    s_cbranch_scc1 La2s_244
    s_cmp_eq_u32 s83, 2
    s_cbranch_scc1 La2s_245
    s_cmp_eq_u32 s83, 3
    s_cbranch_scc1 La2s_246
    s_cmp_eq_u32 s83, 4
    s_cbranch_scc1 La2s_247
    s_cmp_eq_u32 s83, 5
    s_cbranch_scc1 La2s_248
    s_cmp_eq_u32 s83, 6
    s_cbranch_scc1 La2s_249
    s_cmp_eq_u32 s83, 7
    s_cbranch_scc1 La2s_250
    s_cmp_eq_u32 s83, 8
    s_cbranch_scc1 La2s_251
    s_branch La2s_251
La2s_244:
    v_lshrrev_b32 v138, 3, v0
    v_lshlrev_b32 v138, 10, v138
    v_and_b32 v139, 7, v0
    v_lshrrev_b32 v140, 4, v0
    v_and_b32 v140, 1, v140
    v_lshlrev_b32 v140, 2, v140
    v_xor_b32 v139, v139, v140
    v_lshlrev_b32 v139, 4, v139
    v_add_u32 v138, v138, v139
    s_lshl_b32 s96, s76, 17
    s_lshl_b32 s97, s80, 7
    s_add_u32 s96, s96, s97
    s_lshl_b32 s97, s76, 14
    s_add_u32 s92, s96, 0x0
    s_add_u32 m0, s97, 57344
    s_nop 0
    buffer_load_dwordx4 v138, s[12:15], s92 offen lds
    v_mov_b32 v50, 0
    v_mov_b32 v51, 0
    v_mov_b32 v52, 0
    v_mov_b32 v53, 0
    v_mov_b32 v54, 0
    v_mov_b32 v55, 0
    v_mov_b32 v56, 0
    v_mov_b32 v57, 0
    v_mov_b32 v58, 0
    v_mov_b32 v59, 0
    v_mov_b32 v60, 0
    v_mov_b32 v61, 0
    v_mov_b32 v62, 0
    v_mov_b32 v63, 0
    v_mov_b32 v64, 0
    v_mov_b32 v65, 0
    ds_read_b128 v[94:97], v120 offset:1152
    ds_read_b128 v[90:93], v120 offset:2304
    ds_read_b64_tr_b16 v[106:107], v121 offset:0
    ds_read_b64_tr_b16 v[108:109], v121 offset:128
    ds_read_b64_tr_b16 v[110:111], v121 offset:256
    ds_read_b64_tr_b16 v[112:113], v121 offset:384
    v_mul_f32 v66, -1.0, v114
    v_mul_f32 v67, -1.0, v114
    v_mul_f32 v68, -1.0, v114
    v_mul_f32 v69, -1.0, v114
    v_mul_f32 v70, -1.0, v114
    v_mul_f32 v71, -1.0, v114
    v_mul_f32 v72, -1.0, v114
    v_mul_f32 v73, -1.0, v114
    v_mul_f32 v74, -1.0, v114
    v_mul_f32 v75, -1.0, v114
    v_mul_f32 v76, -1.0, v114
    v_mul_f32 v77, -1.0, v114
    v_mul_f32 v78, -1.0, v114
    v_mul_f32 v79, -1.0, v114
    v_mul_f32 v80, -1.0, v114
    v_mul_f32 v81, -1.0, v114
    s_waitcnt lgkmcnt(5)
    s_nop 0
    v_mfma_f32_32x32x16_bf16 v[34:49], v[94:97], v[10:13], v[66:81]
    s_nop 7
    s_nop 3
    s_branch La2b_253
La2s_245:
    v_lshrrev_b32 v138, 3, v0
    v_lshlrev_b32 v138, 10, v138
    v_and_b32 v139, 7, v0
    v_lshrrev_b32 v140, 4, v0
    v_and_b32 v140, 1, v140
    v_lshlrev_b32 v140, 2, v140
    v_xor_b32 v139, v139, v140
    v_lshlrev_b32 v139, 4, v139
    v_add_u32 v138, v138, v139
    s_lshl_b32 s96, s76, 17
    s_lshl_b32 s97, s80, 7
    s_add_u32 s96, s96, s97
    s_lshl_b32 s97, s76, 14
    s_add_u32 s92, s96, 0x0
    s_add_u32 m0, s97, 57344
    s_nop 0
    buffer_load_dwordx4 v138, s[12:15], s92 offen lds
    s_add_u32 s92, s96, 0x2000
    s_add_u32 m0, s97, 58368
    s_nop 0
    buffer_load_dwordx4 v138, s[12:15], s92 offen lds
    s_add_u32 s92, s96, 0x4000
    s_add_u32 m0, s97, 59392
    s_nop 0
    buffer_load_dwordx4 v138, s[12:15], s92 offen lds
    v_mov_b32 v50, 0
    v_mov_b32 v51, 0
    v_mov_b32 v52, 0
    v_mov_b32 v53, 0
    v_mov_b32 v54, 0
    v_mov_b32 v55, 0
    v_mov_b32 v56, 0
    v_mov_b32 v57, 0
    v_mov_b32 v58, 0
    v_mov_b32 v59, 0
    v_mov_b32 v60, 0
    v_mov_b32 v61, 0
    v_mov_b32 v62, 0
    v_mov_b32 v63, 0
    v_mov_b32 v64, 0
    v_mov_b32 v65, 0
    ds_read_b128 v[90:93], v120 offset:2304
    ds_read_b128 v[94:97], v120 offset:3456
    ds_read_b64_tr_b16 v[98:99], v121 offset:0
    ds_read_b64_tr_b16 v[100:101], v121 offset:128
    ds_read_b64_tr_b16 v[102:103], v121 offset:256
    ds_read_b64_tr_b16 v[104:105], v121 offset:384
    v_mul_f32 v66, -1.0, v114
    v_mul_f32 v67, -1.0, v114
    v_mul_f32 v68, -1.0, v114
    v_mul_f32 v69, -1.0, v114
    v_mul_f32 v70, -1.0, v114
    v_mul_f32 v71, -1.0, v114
    v_mul_f32 v72, -1.0, v114
    v_mul_f32 v73, -1.0, v114
    v_mul_f32 v74, -1.0, v114
    v_mul_f32 v75, -1.0, v114
    v_mul_f32 v76, -1.0, v114
    v_mul_f32 v77, -1.0, v114
    v_mul_f32 v78, -1.0, v114
    v_mul_f32 v79, -1.0, v114
    v_mul_f32 v80, -1.0, v114
    v_mul_f32 v81, -1.0, v114
    s_waitcnt lgkmcnt(5)
    s_nop 0
    v_mfma_f32_32x32x16_bf16 v[18:33], v[90:93], v[10:13], v[66:81]
    s_nop 7
    s_nop 3
    s_branch La2b_254
La2s_246:
    v_lshrrev_b32 v138, 3, v0
    v_lshlrev_b32 v138, 10, v138
    v_and_b32 v139, 7, v0
    v_lshrrev_b32 v140, 4, v0
    v_and_b32 v140, 1, v140
    v_lshlrev_b32 v140, 2, v140
    v_xor_b32 v139, v139, v140
    v_lshlrev_b32 v139, 4, v139
    v_add_u32 v138, v138, v139
    s_lshl_b32 s96, s76, 17
    s_lshl_b32 s97, s80, 7
    s_add_u32 s96, s96, s97
    s_lshl_b32 s97, s76, 14
    s_add_u32 s92, s96, 0x0
    s_add_u32 m0, s97, 57344
    s_nop 0
    buffer_load_dwordx4 v138, s[12:15], s92 offen lds
    s_add_u32 s92, s96, 0x2000
    s_add_u32 m0, s97, 58368
    s_nop 0
    buffer_load_dwordx4 v138, s[12:15], s92 offen lds
    s_add_u32 s92, s96, 0x4000
    s_add_u32 m0, s97, 59392
    s_nop 0
    buffer_load_dwordx4 v138, s[12:15], s92 offen lds
    s_add_u32 s92, s96, 0x6000
    s_add_u32 m0, s97, 60416
    s_nop 0
    buffer_load_dwordx4 v138, s[12:15], s92 offen lds
    s_add_u32 s92, s96, 0x8000
    s_add_u32 m0, s97, 61440
    s_nop 0
    buffer_load_dwordx4 v138, s[12:15], s92 offen lds
    v_mov_b32 v50, 0
    v_mov_b32 v51, 0
    v_mov_b32 v52, 0
    v_mov_b32 v53, 0
    v_mov_b32 v54, 0
    v_mov_b32 v55, 0
    v_mov_b32 v56, 0
    v_mov_b32 v57, 0
    v_mov_b32 v58, 0
    v_mov_b32 v59, 0
    v_mov_b32 v60, 0
    v_mov_b32 v61, 0
    v_mov_b32 v62, 0
    v_mov_b32 v63, 0
    v_mov_b32 v64, 0
    v_mov_b32 v65, 0
    ds_read_b128 v[94:97], v120 offset:3456
    ds_read_b128 v[90:93], v120 offset:4608
    ds_read_b64_tr_b16 v[106:107], v121 offset:0
    ds_read_b64_tr_b16 v[108:109], v121 offset:128
    ds_read_b64_tr_b16 v[110:111], v121 offset:256
    ds_read_b64_tr_b16 v[112:113], v121 offset:384
    v_mul_f32 v66, -1.0, v114
    v_mul_f32 v67, -1.0, v114
    v_mul_f32 v68, -1.0, v114
    v_mul_f32 v69, -1.0, v114
    v_mul_f32 v70, -1.0, v114
    v_mul_f32 v71, -1.0, v114
    v_mul_f32 v72, -1.0, v114
    v_mul_f32 v73, -1.0, v114
    v_mul_f32 v74, -1.0, v114
    v_mul_f32 v75, -1.0, v114
    v_mul_f32 v76, -1.0, v114
    v_mul_f32 v77, -1.0, v114
    v_mul_f32 v78, -1.0, v114
    v_mul_f32 v79, -1.0, v114
    v_mul_f32 v80, -1.0, v114
    v_mul_f32 v81, -1.0, v114
    s_waitcnt lgkmcnt(5)
    s_nop 0
    v_mfma_f32_32x32x16_bf16 v[34:49], v[94:97], v[10:13], v[66:81]
    s_nop 7
    s_nop 3
    s_branch La2b_255
La2s_247:
    v_lshrrev_b32 v138, 3, v0
    v_lshlrev_b32 v138, 10, v138
    v_and_b32 v139, 7, v0
    v_lshrrev_b32 v140, 4, v0
    v_and_b32 v140, 1, v140
    v_lshlrev_b32 v140, 2, v140
    v_xor_b32 v139, v139, v140
    v_lshlrev_b32 v139, 4, v139
    v_add_u32 v138, v138, v139
    s_lshl_b32 s96, s76, 17
    s_lshl_b32 s97, s80, 7
    s_add_u32 s96, s96, s97
    s_lshl_b32 s97, s76, 14
    s_add_u32 s92, s96, 0x0
    s_add_u32 m0, s97, 57344
    s_nop 0
    buffer_load_dwordx4 v138, s[12:15], s92 offen lds
    s_add_u32 s92, s96, 0x2000
    s_add_u32 m0, s97, 58368
    s_nop 0
    buffer_load_dwordx4 v138, s[12:15], s92 offen lds
    s_add_u32 s92, s96, 0x4000
    s_add_u32 m0, s97, 59392
    s_nop 0
    buffer_load_dwordx4 v138, s[12:15], s92 offen lds
    s_add_u32 s92, s96, 0x6000
    s_add_u32 m0, s97, 60416
    s_nop 0
    buffer_load_dwordx4 v138, s[12:15], s92 offen lds
    s_add_u32 s92, s96, 0x8000
    s_add_u32 m0, s97, 61440
    s_nop 0
    buffer_load_dwordx4 v138, s[12:15], s92 offen lds
    s_add_u32 s92, s96, 0xa000
    s_add_u32 m0, s97, 62464
    s_nop 0
    buffer_load_dwordx4 v138, s[12:15], s92 offen lds
    s_add_u32 s92, s96, 0xc000
    s_add_u32 m0, s97, 63488
    s_nop 0
    buffer_load_dwordx4 v138, s[12:15], s92 offen lds
    v_mov_b32 v50, 0
    v_mov_b32 v51, 0
    v_mov_b32 v52, 0
    v_mov_b32 v53, 0
    v_mov_b32 v54, 0
    v_mov_b32 v55, 0
    v_mov_b32 v56, 0
    v_mov_b32 v57, 0
    v_mov_b32 v58, 0
    v_mov_b32 v59, 0
    v_mov_b32 v60, 0
    v_mov_b32 v61, 0
    v_mov_b32 v62, 0
    v_mov_b32 v63, 0
    v_mov_b32 v64, 0
    v_mov_b32 v65, 0
    ds_read_b128 v[90:93], v120 offset:4608
    ds_read_b128 v[94:97], v120 offset:5760
    ds_read_b64_tr_b16 v[98:99], v121 offset:0
    ds_read_b64_tr_b16 v[100:101], v121 offset:128
    ds_read_b64_tr_b16 v[102:103], v121 offset:256
    ds_read_b64_tr_b16 v[104:105], v121 offset:384
    v_mul_f32 v66, -1.0, v114
    v_mul_f32 v67, -1.0, v114
    v_mul_f32 v68, -1.0, v114
    v_mul_f32 v69, -1.0, v114
    v_mul_f32 v70, -1.0, v114
    v_mul_f32 v71, -1.0, v114
    v_mul_f32 v72, -1.0, v114
    v_mul_f32 v73, -1.0, v114
    v_mul_f32 v74, -1.0, v114
    v_mul_f32 v75, -1.0, v114
    v_mul_f32 v76, -1.0, v114
    v_mul_f32 v77, -1.0, v114
    v_mul_f32 v78, -1.0, v114
    v_mul_f32 v79, -1.0, v114
    v_mul_f32 v80, -1.0, v114
    v_mul_f32 v81, -1.0, v114
    s_waitcnt lgkmcnt(5)
    s_nop 0
    v_mfma_f32_32x32x16_bf16 v[18:33], v[90:93], v[10:13], v[66:81]
    s_nop 7
    s_nop 3
    s_branch La2b_256
La2s_248:
    v_lshrrev_b32 v138, 3, v0
    v_lshlrev_b32 v138, 10, v138
    v_and_b32 v139, 7, v0
    v_lshrrev_b32 v140, 4, v0
    v_and_b32 v140, 1, v140
    v_lshlrev_b32 v140, 2, v140
    v_xor_b32 v139, v139, v140
    v_lshlrev_b32 v139, 4, v139
    v_add_u32 v138, v138, v139
    s_lshl_b32 s96, s76, 17
    s_lshl_b32 s97, s80, 7
    s_add_u32 s96, s96, s97
    s_lshl_b32 s97, s76, 14
    s_add_u32 s92, s96, 0x0
    s_add_u32 m0, s97, 57344
    s_nop 0
    buffer_load_dwordx4 v138, s[12:15], s92 offen lds
    s_add_u32 s92, s96, 0x2000
    s_add_u32 m0, s97, 58368
    s_nop 0
    buffer_load_dwordx4 v138, s[12:15], s92 offen lds
    s_add_u32 s92, s96, 0x4000
    s_add_u32 m0, s97, 59392
    s_nop 0
    buffer_load_dwordx4 v138, s[12:15], s92 offen lds
    s_add_u32 s92, s96, 0x6000
    s_add_u32 m0, s97, 60416
    s_nop 0
    buffer_load_dwordx4 v138, s[12:15], s92 offen lds
    s_add_u32 s92, s96, 0x8000
    s_add_u32 m0, s97, 61440
    s_nop 0
    buffer_load_dwordx4 v138, s[12:15], s92 offen lds
    s_add_u32 s92, s96, 0xa000
    s_add_u32 m0, s97, 62464
    s_nop 0
    buffer_load_dwordx4 v138, s[12:15], s92 offen lds
    s_add_u32 s92, s96, 0xc000
    s_add_u32 m0, s97, 63488
    s_nop 0
    buffer_load_dwordx4 v138, s[12:15], s92 offen lds
    s_add_u32 s92, s96, 0xe000
    s_add_u32 m0, s97, 64512
    s_nop 0
    buffer_load_dwordx4 v138, s[12:15], s92 offen lds
    s_add_u32 s92, s96, 0x10000
    s_add_u32 m0, s97, 65536
    s_nop 0
    buffer_load_dwordx4 v138, s[12:15], s92 offen lds
    v_mov_b32 v50, 0
    v_mov_b32 v51, 0
    v_mov_b32 v52, 0
    v_mov_b32 v53, 0
    v_mov_b32 v54, 0
    v_mov_b32 v55, 0
    v_mov_b32 v56, 0
    v_mov_b32 v57, 0
    v_mov_b32 v58, 0
    v_mov_b32 v59, 0
    v_mov_b32 v60, 0
    v_mov_b32 v61, 0
    v_mov_b32 v62, 0
    v_mov_b32 v63, 0
    v_mov_b32 v64, 0
    v_mov_b32 v65, 0
    ds_read_b128 v[94:97], v120 offset:5760
    ds_read_b128 v[90:93], v120 offset:6912
    ds_read_b64_tr_b16 v[106:107], v121 offset:0
    ds_read_b64_tr_b16 v[108:109], v121 offset:128
    ds_read_b64_tr_b16 v[110:111], v121 offset:256
    ds_read_b64_tr_b16 v[112:113], v121 offset:384
    v_mul_f32 v66, -1.0, v114
    v_mul_f32 v67, -1.0, v114
    v_mul_f32 v68, -1.0, v114
    v_mul_f32 v69, -1.0, v114
    v_mul_f32 v70, -1.0, v114
    v_mul_f32 v71, -1.0, v114
    v_mul_f32 v72, -1.0, v114
    v_mul_f32 v73, -1.0, v114
    v_mul_f32 v74, -1.0, v114
    v_mul_f32 v75, -1.0, v114
    v_mul_f32 v76, -1.0, v114
    v_mul_f32 v77, -1.0, v114
    v_mul_f32 v78, -1.0, v114
    v_mul_f32 v79, -1.0, v114
    v_mul_f32 v80, -1.0, v114
    v_mul_f32 v81, -1.0, v114
    s_waitcnt lgkmcnt(5)
    s_nop 0
    v_mfma_f32_32x32x16_bf16 v[34:49], v[94:97], v[10:13], v[66:81]
    s_nop 7
    s_nop 3
    s_branch La2b_257
La2s_249:
    v_lshrrev_b32 v138, 3, v0
    v_lshlrev_b32 v138, 10, v138
    v_and_b32 v139, 7, v0
    v_lshrrev_b32 v140, 4, v0
    v_and_b32 v140, 1, v140
    v_lshlrev_b32 v140, 2, v140
    v_xor_b32 v139, v139, v140
    v_lshlrev_b32 v139, 4, v139
    v_add_u32 v138, v138, v139
    s_lshl_b32 s96, s76, 17
    s_lshl_b32 s97, s80, 7
    s_add_u32 s96, s96, s97
    s_lshl_b32 s97, s76, 14
    s_add_u32 s92, s96, 0x0
    s_add_u32 m0, s97, 57344
    s_nop 0
    buffer_load_dwordx4 v138, s[12:15], s92 offen lds
    s_add_u32 s92, s96, 0x2000
    s_add_u32 m0, s97, 58368
    s_nop 0
    buffer_load_dwordx4 v138, s[12:15], s92 offen lds
    s_add_u32 s92, s96, 0x4000
    s_add_u32 m0, s97, 59392
    s_nop 0
    buffer_load_dwordx4 v138, s[12:15], s92 offen lds
    s_add_u32 s92, s96, 0x6000
    s_add_u32 m0, s97, 60416
    s_nop 0
    buffer_load_dwordx4 v138, s[12:15], s92 offen lds
    s_add_u32 s92, s96, 0x8000
    s_add_u32 m0, s97, 61440
    s_nop 0
    buffer_load_dwordx4 v138, s[12:15], s92 offen lds
    s_add_u32 s92, s96, 0xa000
    s_add_u32 m0, s97, 62464
    s_nop 0
    buffer_load_dwordx4 v138, s[12:15], s92 offen lds
    s_add_u32 s92, s96, 0xc000
    s_add_u32 m0, s97, 63488
    s_nop 0
    buffer_load_dwordx4 v138, s[12:15], s92 offen lds
    s_add_u32 s92, s96, 0xe000
    s_add_u32 m0, s97, 64512
    s_nop 0
    buffer_load_dwordx4 v138, s[12:15], s92 offen lds
    s_add_u32 s92, s96, 0x10000
    s_add_u32 m0, s97, 65536
    s_nop 0
    buffer_load_dwordx4 v138, s[12:15], s92 offen lds
    s_add_u32 s92, s96, 0x12000
    s_add_u32 m0, s97, 66560
    s_nop 0
    buffer_load_dwordx4 v138, s[12:15], s92 offen lds
    s_add_u32 s92, s96, 0x14000
    s_add_u32 m0, s97, 67584
    s_nop 0
    buffer_load_dwordx4 v138, s[12:15], s92 offen lds
    v_mov_b32 v50, 0
    v_mov_b32 v51, 0
    v_mov_b32 v52, 0
    v_mov_b32 v53, 0
    v_mov_b32 v54, 0
    v_mov_b32 v55, 0
    v_mov_b32 v56, 0
    v_mov_b32 v57, 0
    v_mov_b32 v58, 0
    v_mov_b32 v59, 0
    v_mov_b32 v60, 0
    v_mov_b32 v61, 0
    v_mov_b32 v62, 0
    v_mov_b32 v63, 0
    v_mov_b32 v64, 0
    v_mov_b32 v65, 0
    ds_read_b128 v[90:93], v120 offset:6912
    ds_read_b128 v[94:97], v120 offset:8064
    ds_read_b64_tr_b16 v[98:99], v121 offset:0
    ds_read_b64_tr_b16 v[100:101], v121 offset:128
    ds_read_b64_tr_b16 v[102:103], v121 offset:256
    ds_read_b64_tr_b16 v[104:105], v121 offset:384
    v_mul_f32 v66, -1.0, v114
    v_mul_f32 v67, -1.0, v114
    v_mul_f32 v68, -1.0, v114
    v_mul_f32 v69, -1.0, v114
    v_mul_f32 v70, -1.0, v114
    v_mul_f32 v71, -1.0, v114
    v_mul_f32 v72, -1.0, v114
    v_mul_f32 v73, -1.0, v114
    v_mul_f32 v74, -1.0, v114
    v_mul_f32 v75, -1.0, v114
    v_mul_f32 v76, -1.0, v114
    v_mul_f32 v77, -1.0, v114
    v_mul_f32 v78, -1.0, v114
    v_mul_f32 v79, -1.0, v114
    v_mul_f32 v80, -1.0, v114
    v_mul_f32 v81, -1.0, v114
    s_waitcnt lgkmcnt(5)
    s_nop 0
    v_mfma_f32_32x32x16_bf16 v[18:33], v[90:93], v[10:13], v[66:81]
    s_nop 7
    s_nop 3
    s_branch La2b_258
La2s_250:
    v_lshrrev_b32 v138, 3, v0
    v_lshlrev_b32 v138, 10, v138
    v_and_b32 v139, 7, v0
    v_lshrrev_b32 v140, 4, v0
    v_and_b32 v140, 1, v140
    v_lshlrev_b32 v140, 2, v140
    v_xor_b32 v139, v139, v140
    v_lshlrev_b32 v139, 4, v139
    v_add_u32 v138, v138, v139
    s_lshl_b32 s96, s76, 17
    s_lshl_b32 s97, s80, 7
    s_add_u32 s96, s96, s97
    s_lshl_b32 s97, s76, 14
    s_add_u32 s92, s96, 0x0
    s_add_u32 m0, s97, 57344
    s_nop 0
    buffer_load_dwordx4 v138, s[12:15], s92 offen lds
    s_add_u32 s92, s96, 0x2000
    s_add_u32 m0, s97, 58368
    s_nop 0
    buffer_load_dwordx4 v138, s[12:15], s92 offen lds
    s_add_u32 s92, s96, 0x4000
    s_add_u32 m0, s97, 59392
    s_nop 0
    buffer_load_dwordx4 v138, s[12:15], s92 offen lds
    s_add_u32 s92, s96, 0x6000
    s_add_u32 m0, s97, 60416
    s_nop 0
    buffer_load_dwordx4 v138, s[12:15], s92 offen lds
    s_add_u32 s92, s96, 0x8000
    s_add_u32 m0, s97, 61440
    s_nop 0
    buffer_load_dwordx4 v138, s[12:15], s92 offen lds
    s_add_u32 s92, s96, 0xa000
    s_add_u32 m0, s97, 62464
    s_nop 0
    buffer_load_dwordx4 v138, s[12:15], s92 offen lds
    s_add_u32 s92, s96, 0xc000
    s_add_u32 m0, s97, 63488
    s_nop 0
    buffer_load_dwordx4 v138, s[12:15], s92 offen lds
    s_add_u32 s92, s96, 0xe000
    s_add_u32 m0, s97, 64512
    s_nop 0
    buffer_load_dwordx4 v138, s[12:15], s92 offen lds
    s_add_u32 s92, s96, 0x10000
    s_add_u32 m0, s97, 65536
    s_nop 0
    buffer_load_dwordx4 v138, s[12:15], s92 offen lds
    s_add_u32 s92, s96, 0x12000
    s_add_u32 m0, s97, 66560
    s_nop 0
    buffer_load_dwordx4 v138, s[12:15], s92 offen lds
    s_add_u32 s92, s96, 0x14000
    s_add_u32 m0, s97, 67584
    s_nop 0
    buffer_load_dwordx4 v138, s[12:15], s92 offen lds
    s_add_u32 s92, s96, 0x16000
    s_add_u32 m0, s97, 68608
    s_nop 0
    buffer_load_dwordx4 v138, s[12:15], s92 offen lds
    s_add_u32 s92, s96, 0x18000
    s_add_u32 m0, s97, 69632
    s_nop 0
    buffer_load_dwordx4 v138, s[12:15], s92 offen lds
    v_mov_b32 v50, 0
    v_mov_b32 v51, 0
    v_mov_b32 v52, 0
    v_mov_b32 v53, 0
    v_mov_b32 v54, 0
    v_mov_b32 v55, 0
    v_mov_b32 v56, 0
    v_mov_b32 v57, 0
    v_mov_b32 v58, 0
    v_mov_b32 v59, 0
    v_mov_b32 v60, 0
    v_mov_b32 v61, 0
    v_mov_b32 v62, 0
    v_mov_b32 v63, 0
    v_mov_b32 v64, 0
    v_mov_b32 v65, 0
    ds_read_b128 v[94:97], v120 offset:8064
    ds_read_b128 v[90:93], v120 offset:9216
    ds_read_b64_tr_b16 v[106:107], v121 offset:0
    ds_read_b64_tr_b16 v[108:109], v121 offset:128
    ds_read_b64_tr_b16 v[110:111], v121 offset:256
    ds_read_b64_tr_b16 v[112:113], v121 offset:384
    v_mul_f32 v66, -1.0, v114
    v_mul_f32 v67, -1.0, v114
    v_mul_f32 v68, -1.0, v114
    v_mul_f32 v69, -1.0, v114
    v_mul_f32 v70, -1.0, v114
    v_mul_f32 v71, -1.0, v114
    v_mul_f32 v72, -1.0, v114
    v_mul_f32 v73, -1.0, v114
    v_mul_f32 v74, -1.0, v114
    v_mul_f32 v75, -1.0, v114
    v_mul_f32 v76, -1.0, v114
    v_mul_f32 v77, -1.0, v114
    v_mul_f32 v78, -1.0, v114
    v_mul_f32 v79, -1.0, v114
    v_mul_f32 v80, -1.0, v114
    v_mul_f32 v81, -1.0, v114
    s_waitcnt lgkmcnt(5)
    s_nop 0
    v_mfma_f32_32x32x16_bf16 v[34:49], v[94:97], v[10:13], v[66:81]
    s_nop 7
    s_nop 3
    s_branch La2b_259
La2s_251:
    v_lshrrev_b32 v138, 3, v0
    v_lshlrev_b32 v138, 10, v138
    v_and_b32 v139, 7, v0
    v_lshrrev_b32 v140, 4, v0
    v_and_b32 v140, 1, v140
    v_lshlrev_b32 v140, 2, v140
    v_xor_b32 v139, v139, v140
    v_lshlrev_b32 v139, 4, v139
    v_add_u32 v138, v138, v139
    s_lshl_b32 s96, s76, 17
    s_lshl_b32 s97, s80, 7
    s_add_u32 s96, s96, s97
    s_lshl_b32 s97, s76, 14
    s_add_u32 s92, s96, 0x0
    s_add_u32 m0, s97, 57344
    s_nop 0
    buffer_load_dwordx4 v138, s[12:15], s92 offen lds
    s_add_u32 s92, s96, 0x2000
    s_add_u32 m0, s97, 58368
    s_nop 0
    buffer_load_dwordx4 v138, s[12:15], s92 offen lds
    s_add_u32 s92, s96, 0x4000
    s_add_u32 m0, s97, 59392
    s_nop 0
    buffer_load_dwordx4 v138, s[12:15], s92 offen lds
    s_add_u32 s92, s96, 0x6000
    s_add_u32 m0, s97, 60416
    s_nop 0
    buffer_load_dwordx4 v138, s[12:15], s92 offen lds
    s_add_u32 s92, s96, 0x8000
    s_add_u32 m0, s97, 61440
    s_nop 0
    buffer_load_dwordx4 v138, s[12:15], s92 offen lds
    s_add_u32 s92, s96, 0xa000
    s_add_u32 m0, s97, 62464
    s_nop 0
    buffer_load_dwordx4 v138, s[12:15], s92 offen lds
    s_add_u32 s92, s96, 0xc000
    s_add_u32 m0, s97, 63488
    s_nop 0
    buffer_load_dwordx4 v138, s[12:15], s92 offen lds
    s_add_u32 s92, s96, 0xe000
    s_add_u32 m0, s97, 64512
    s_nop 0
    buffer_load_dwordx4 v138, s[12:15], s92 offen lds
    s_add_u32 s92, s96, 0x10000
    s_add_u32 m0, s97, 65536
    s_nop 0
    buffer_load_dwordx4 v138, s[12:15], s92 offen lds
    s_add_u32 s92, s96, 0x12000
    s_add_u32 m0, s97, 66560
    s_nop 0
    buffer_load_dwordx4 v138, s[12:15], s92 offen lds
    s_add_u32 s92, s96, 0x14000
    s_add_u32 m0, s97, 67584
    s_nop 0
    buffer_load_dwordx4 v138, s[12:15], s92 offen lds
    s_add_u32 s92, s96, 0x16000
    s_add_u32 m0, s97, 68608
    s_nop 0
    buffer_load_dwordx4 v138, s[12:15], s92 offen lds
    s_add_u32 s92, s96, 0x18000
    s_add_u32 m0, s97, 69632
    s_nop 0
    buffer_load_dwordx4 v138, s[12:15], s92 offen lds
    s_add_u32 s92, s96, 0x1a000
    s_add_u32 m0, s97, 70656
    s_nop 0
    buffer_load_dwordx4 v138, s[12:15], s92 offen lds
    s_add_u32 s92, s96, 0x1c000
    s_add_u32 m0, s97, 71680
    s_nop 0
    buffer_load_dwordx4 v138, s[12:15], s92 offen lds
    v_mov_b32 v50, 0
    v_mov_b32 v51, 0
    v_mov_b32 v52, 0
    v_mov_b32 v53, 0
    v_mov_b32 v54, 0
    v_mov_b32 v55, 0
    v_mov_b32 v56, 0
    v_mov_b32 v57, 0
    v_mov_b32 v58, 0
    v_mov_b32 v59, 0
    v_mov_b32 v60, 0
    v_mov_b32 v61, 0
    v_mov_b32 v62, 0
    v_mov_b32 v63, 0
    v_mov_b32 v64, 0
    v_mov_b32 v65, 0
    ds_read_b128 v[90:93], v120 offset:9216
    ds_read_b64_tr_b16 v[98:99], v121 offset:0
    ds_read_b64_tr_b16 v[100:101], v121 offset:128
    ds_read_b64_tr_b16 v[102:103], v121 offset:256
    ds_read_b64_tr_b16 v[104:105], v121 offset:384
    v_mul_f32 v66, -1.0, v114
    v_mul_f32 v67, -1.0, v114
    v_mul_f32 v68, -1.0, v114
    v_mul_f32 v69, -1.0, v114
    v_mul_f32 v70, -1.0, v114
    v_mul_f32 v71, -1.0, v114
    v_mul_f32 v72, -1.0, v114
    v_mul_f32 v73, -1.0, v114
    v_mul_f32 v74, -1.0, v114
    v_mul_f32 v75, -1.0, v114
    v_mul_f32 v76, -1.0, v114
    v_mul_f32 v77, -1.0, v114
    v_mul_f32 v78, -1.0, v114
    v_mul_f32 v79, -1.0, v114
    v_mul_f32 v80, -1.0, v114
    v_mul_f32 v81, -1.0, v114
    s_waitcnt lgkmcnt(4)
    s_nop 0
    v_mfma_f32_32x32x16_bf16 v[18:33], v[90:93], v[10:13], v[66:81]
    s_nop 7
    s_nop 3
    s_branch La2b_260
La2s_301:
    s_cmp_eq_u32 s83, 1
    s_cbranch_scc1 La2s_302
    s_cmp_eq_u32 s83, 2
    s_cbranch_scc1 La2s_303
    s_cmp_eq_u32 s83, 3
    s_cbranch_scc1 La2s_304
    s_cmp_eq_u32 s83, 4
    s_cbranch_scc1 La2s_305
    s_cmp_eq_u32 s83, 5
    s_cbranch_scc1 La2s_306
    s_cmp_eq_u32 s83, 6
    s_cbranch_scc1 La2s_307
    s_cmp_eq_u32 s83, 7
    s_cbranch_scc1 La2s_308
    s_cmp_eq_u32 s83, 8
    s_cbranch_scc1 La2s_309
    s_branch La2s_309
La2s_302:
    v_mov_b32 v50, 0
    v_mov_b32 v51, 0
    v_mov_b32 v52, 0
    v_mov_b32 v53, 0
    v_mov_b32 v54, 0
    v_mov_b32 v55, 0
    v_mov_b32 v56, 0
    v_mov_b32 v57, 0
    v_mov_b32 v58, 0
    v_mov_b32 v59, 0
    v_mov_b32 v60, 0
    v_mov_b32 v61, 0
    v_mov_b32 v62, 0
    v_mov_b32 v63, 0
    v_mov_b32 v64, 0
    v_mov_b32 v65, 0
    ds_read_b128 v[94:97], v120 offset:14976
    ds_read_b128 v[90:93], v120 offset:16128
    ds_read_b64_tr_b16 v[106:107], v121 offset:0
    ds_read_b64_tr_b16 v[108:109], v121 offset:128
    ds_read_b64_tr_b16 v[110:111], v121 offset:256
    ds_read_b64_tr_b16 v[112:113], v121 offset:384
    v_mul_f32 v66, -1.0, v141
    v_mul_f32 v67, -1.0, v141
    v_mul_f32 v68, -1.0, v141
    v_mul_f32 v69, -1.0, v141
    v_mul_f32 v70, -1.0, v141
    v_mul_f32 v71, -1.0, v141
    v_mul_f32 v72, -1.0, v141
    v_mul_f32 v73, -1.0, v141
    v_mul_f32 v74, -1.0, v141
    v_mul_f32 v75, -1.0, v141
    v_mul_f32 v76, -1.0, v141
    v_mul_f32 v77, -1.0, v141
    v_mul_f32 v78, -1.0, v141
    v_mul_f32 v79, -1.0, v141
    v_mul_f32 v80, -1.0, v141
    v_mul_f32 v81, -1.0, v141
    s_waitcnt lgkmcnt(5)
    s_nop 0
    v_mfma_f32_32x32x16_bf16 v[34:49], v[94:97], v[14:17], v[66:81]
    s_nop 7
    s_nop 3
    s_branch La2b_311
La2s_303:
    v_mov_b32 v50, 0
    v_mov_b32 v51, 0
    v_mov_b32 v52, 0
    v_mov_b32 v53, 0
    v_mov_b32 v54, 0
    v_mov_b32 v55, 0
    v_mov_b32 v56, 0
    v_mov_b32 v57, 0
    v_mov_b32 v58, 0
    v_mov_b32 v59, 0
    v_mov_b32 v60, 0
    v_mov_b32 v61, 0
    v_mov_b32 v62, 0
    v_mov_b32 v63, 0
    v_mov_b32 v64, 0
    v_mov_b32 v65, 0
    ds_read_b128 v[90:93], v120 offset:16128
    ds_read_b128 v[94:97], v120 offset:17280
    ds_read_b64_tr_b16 v[98:99], v121 offset:0
    ds_read_b64_tr_b16 v[100:101], v121 offset:128
    ds_read_b64_tr_b16 v[102:103], v121 offset:256
    ds_read_b64_tr_b16 v[104:105], v121 offset:384
    v_mul_f32 v66, -1.0, v141
    v_mul_f32 v67, -1.0, v141
    v_mul_f32 v68, -1.0, v141
    v_mul_f32 v69, -1.0, v141
    v_mul_f32 v70, -1.0, v141
    v_mul_f32 v71, -1.0, v141
    v_mul_f32 v72, -1.0, v141
    v_mul_f32 v73, -1.0, v141
    v_mul_f32 v74, -1.0, v141
    v_mul_f32 v75, -1.0, v141
    v_mul_f32 v76, -1.0, v141
    v_mul_f32 v77, -1.0, v141
    v_mul_f32 v78, -1.0, v141
    v_mul_f32 v79, -1.0, v141
    v_mul_f32 v80, -1.0, v141
    v_mul_f32 v81, -1.0, v141
    s_waitcnt lgkmcnt(5)
    s_nop 0
    v_mfma_f32_32x32x16_bf16 v[18:33], v[90:93], v[14:17], v[66:81]
    s_nop 7
    s_nop 3
    s_branch La2b_312
La2s_304:
    v_mov_b32 v50, 0
    v_mov_b32 v51, 0
    v_mov_b32 v52, 0
    v_mov_b32 v53, 0
    v_mov_b32 v54, 0
    v_mov_b32 v55, 0
    v_mov_b32 v56, 0
    v_mov_b32 v57, 0
    v_mov_b32 v58, 0
    v_mov_b32 v59, 0
    v_mov_b32 v60, 0
    v_mov_b32 v61, 0
    v_mov_b32 v62, 0
    v_mov_b32 v63, 0
    v_mov_b32 v64, 0
    v_mov_b32 v65, 0
    ds_read_b128 v[94:97], v120 offset:17280
    ds_read_b128 v[90:93], v120 offset:18432
    ds_read_b64_tr_b16 v[106:107], v121 offset:0
    ds_read_b64_tr_b16 v[108:109], v121 offset:128
    ds_read_b64_tr_b16 v[110:111], v121 offset:256
    ds_read_b64_tr_b16 v[112:113], v121 offset:384
    v_mul_f32 v66, -1.0, v141
    v_mul_f32 v67, -1.0, v141
    v_mul_f32 v68, -1.0, v141
    v_mul_f32 v69, -1.0, v141
    v_mul_f32 v70, -1.0, v141
    v_mul_f32 v71, -1.0, v141
    v_mul_f32 v72, -1.0, v141
    v_mul_f32 v73, -1.0, v141
    v_mul_f32 v74, -1.0, v141
    v_mul_f32 v75, -1.0, v141
    v_mul_f32 v76, -1.0, v141
    v_mul_f32 v77, -1.0, v141
    v_mul_f32 v78, -1.0, v141
    v_mul_f32 v79, -1.0, v141
    v_mul_f32 v80, -1.0, v141
    v_mul_f32 v81, -1.0, v141
    s_waitcnt lgkmcnt(5)
    s_nop 0
    v_mfma_f32_32x32x16_bf16 v[34:49], v[94:97], v[14:17], v[66:81]
    s_nop 7
    s_nop 3
    s_branch La2b_313
La2s_305:
    v_mov_b32 v50, 0
    v_mov_b32 v51, 0
    v_mov_b32 v52, 0
    v_mov_b32 v53, 0
    v_mov_b32 v54, 0
    v_mov_b32 v55, 0
    v_mov_b32 v56, 0
    v_mov_b32 v57, 0
    v_mov_b32 v58, 0
    v_mov_b32 v59, 0
    v_mov_b32 v60, 0
    v_mov_b32 v61, 0
    v_mov_b32 v62, 0
    v_mov_b32 v63, 0
    v_mov_b32 v64, 0
    v_mov_b32 v65, 0
    ds_read_b128 v[90:93], v120 offset:18432
    ds_read_b128 v[94:97], v120 offset:19584
    ds_read_b64_tr_b16 v[98:99], v121 offset:0
    ds_read_b64_tr_b16 v[100:101], v121 offset:128
    ds_read_b64_tr_b16 v[102:103], v121 offset:256
    ds_read_b64_tr_b16 v[104:105], v121 offset:384
    v_mul_f32 v66, -1.0, v141
    v_mul_f32 v67, -1.0, v141
    v_mul_f32 v68, -1.0, v141
    v_mul_f32 v69, -1.0, v141
    v_mul_f32 v70, -1.0, v141
    v_mul_f32 v71, -1.0, v141
    v_mul_f32 v72, -1.0, v141
    v_mul_f32 v73, -1.0, v141
    v_mul_f32 v74, -1.0, v141
    v_mul_f32 v75, -1.0, v141
    v_mul_f32 v76, -1.0, v141
    v_mul_f32 v77, -1.0, v141
    v_mul_f32 v78, -1.0, v141
    v_mul_f32 v79, -1.0, v141
    v_mul_f32 v80, -1.0, v141
    v_mul_f32 v81, -1.0, v141
    s_waitcnt lgkmcnt(5)
    s_nop 0
    v_mfma_f32_32x32x16_bf16 v[18:33], v[90:93], v[14:17], v[66:81]
    s_nop 7
    s_nop 3
    s_branch La2b_314
La2s_306:
    v_mov_b32 v50, 0
    v_mov_b32 v51, 0
    v_mov_b32 v52, 0
    v_mov_b32 v53, 0
    v_mov_b32 v54, 0
    v_mov_b32 v55, 0
    v_mov_b32 v56, 0
    v_mov_b32 v57, 0
    v_mov_b32 v58, 0
    v_mov_b32 v59, 0
    v_mov_b32 v60, 0
    v_mov_b32 v61, 0
    v_mov_b32 v62, 0
    v_mov_b32 v63, 0
    v_mov_b32 v64, 0
    v_mov_b32 v65, 0
    ds_read_b128 v[94:97], v120 offset:19584
    ds_read_b128 v[90:93], v120 offset:20736
    ds_read_b64_tr_b16 v[106:107], v121 offset:0
    ds_read_b64_tr_b16 v[108:109], v121 offset:128
    ds_read_b64_tr_b16 v[110:111], v121 offset:256
    ds_read_b64_tr_b16 v[112:113], v121 offset:384
    v_mul_f32 v66, -1.0, v141
    v_mul_f32 v67, -1.0, v141
    v_mul_f32 v68, -1.0, v141
    v_mul_f32 v69, -1.0, v141
    v_mul_f32 v70, -1.0, v141
    v_mul_f32 v71, -1.0, v141
    v_mul_f32 v72, -1.0, v141
    v_mul_f32 v73, -1.0, v141
    v_mul_f32 v74, -1.0, v141
    v_mul_f32 v75, -1.0, v141
    v_mul_f32 v76, -1.0, v141
    v_mul_f32 v77, -1.0, v141
    v_mul_f32 v78, -1.0, v141
    v_mul_f32 v79, -1.0, v141
    v_mul_f32 v80, -1.0, v141
    v_mul_f32 v81, -1.0, v141
    s_waitcnt lgkmcnt(5)
    s_nop 0
    v_mfma_f32_32x32x16_bf16 v[34:49], v[94:97], v[14:17], v[66:81]
    s_nop 7
    s_nop 3
    s_branch La2b_315
La2s_307:
    v_mov_b32 v50, 0
    v_mov_b32 v51, 0
    v_mov_b32 v52, 0
    v_mov_b32 v53, 0
    v_mov_b32 v54, 0
    v_mov_b32 v55, 0
    v_mov_b32 v56, 0
    v_mov_b32 v57, 0
    v_mov_b32 v58, 0
    v_mov_b32 v59, 0
    v_mov_b32 v60, 0
    v_mov_b32 v61, 0
    v_mov_b32 v62, 0
    v_mov_b32 v63, 0
    v_mov_b32 v64, 0
    v_mov_b32 v65, 0
    ds_read_b128 v[90:93], v120 offset:20736
    ds_read_b128 v[94:97], v120 offset:21888
    ds_read_b64_tr_b16 v[98:99], v121 offset:0
    ds_read_b64_tr_b16 v[100:101], v121 offset:128
    ds_read_b64_tr_b16 v[102:103], v121 offset:256
    ds_read_b64_tr_b16 v[104:105], v121 offset:384
    v_mul_f32 v66, -1.0, v141
    v_mul_f32 v67, -1.0, v141
    v_mul_f32 v68, -1.0, v141
    v_mul_f32 v69, -1.0, v141
    v_mul_f32 v70, -1.0, v141
    v_mul_f32 v71, -1.0, v141
    v_mul_f32 v72, -1.0, v141
    v_mul_f32 v73, -1.0, v141
    v_mul_f32 v74, -1.0, v141
    v_mul_f32 v75, -1.0, v141
    v_mul_f32 v76, -1.0, v141
    v_mul_f32 v77, -1.0, v141
    v_mul_f32 v78, -1.0, v141
    v_mul_f32 v79, -1.0, v141
    v_mul_f32 v80, -1.0, v141
    v_mul_f32 v81, -1.0, v141
    s_waitcnt lgkmcnt(5)
    s_nop 0
    v_mfma_f32_32x32x16_bf16 v[18:33], v[90:93], v[14:17], v[66:81]
    s_nop 7
    s_nop 3
    s_branch La2b_316
La2s_308:
    v_mov_b32 v50, 0
    v_mov_b32 v51, 0
    v_mov_b32 v52, 0
    v_mov_b32 v53, 0
    v_mov_b32 v54, 0
    v_mov_b32 v55, 0
    v_mov_b32 v56, 0
    v_mov_b32 v57, 0
    v_mov_b32 v58, 0
    v_mov_b32 v59, 0
    v_mov_b32 v60, 0
    v_mov_b32 v61, 0
    v_mov_b32 v62, 0
    v_mov_b32 v63, 0
    v_mov_b32 v64, 0
    v_mov_b32 v65, 0
    ds_read_b128 v[94:97], v120 offset:21888
    ds_read_b128 v[90:93], v120 offset:23040
    ds_read_b64_tr_b16 v[106:107], v121 offset:0
    ds_read_b64_tr_b16 v[108:109], v121 offset:128
    ds_read_b64_tr_b16 v[110:111], v121 offset:256
    ds_read_b64_tr_b16 v[112:113], v121 offset:384
    v_mul_f32 v66, -1.0, v141
    v_mul_f32 v67, -1.0, v141
    v_mul_f32 v68, -1.0, v141
    v_mul_f32 v69, -1.0, v141
    v_mul_f32 v70, -1.0, v141
    v_mul_f32 v71, -1.0, v141
    v_mul_f32 v72, -1.0, v141
    v_mul_f32 v73, -1.0, v141
    v_mul_f32 v74, -1.0, v141
    v_mul_f32 v75, -1.0, v141
    v_mul_f32 v76, -1.0, v141
    v_mul_f32 v77, -1.0, v141
    v_mul_f32 v78, -1.0, v141
    v_mul_f32 v79, -1.0, v141
    v_mul_f32 v80, -1.0, v141
    v_mul_f32 v81, -1.0, v141
    s_waitcnt lgkmcnt(5)
    s_nop 0
    v_mfma_f32_32x32x16_bf16 v[34:49], v[94:97], v[14:17], v[66:81]
    s_nop 7
    s_nop 3
    s_branch La2b_317
La2s_309:
    v_mov_b32 v50, 0
    v_mov_b32 v51, 0
    v_mov_b32 v52, 0
    v_mov_b32 v53, 0
    v_mov_b32 v54, 0
    v_mov_b32 v55, 0
    v_mov_b32 v56, 0
    v_mov_b32 v57, 0
    v_mov_b32 v58, 0
    v_mov_b32 v59, 0
    v_mov_b32 v60, 0
    v_mov_b32 v61, 0
    v_mov_b32 v62, 0
    v_mov_b32 v63, 0
    v_mov_b32 v64, 0
    v_mov_b32 v65, 0
    ds_read_b128 v[90:93], v120 offset:23040
    ds_read_b64_tr_b16 v[98:99], v121 offset:0
    ds_read_b64_tr_b16 v[100:101], v121 offset:128
    ds_read_b64_tr_b16 v[102:103], v121 offset:256
    ds_read_b64_tr_b16 v[104:105], v121 offset:384
    v_mul_f32 v66, -1.0, v141
    v_mul_f32 v67, -1.0, v141
    v_mul_f32 v68, -1.0, v141
    v_mul_f32 v69, -1.0, v141
    v_mul_f32 v70, -1.0, v141
    v_mul_f32 v71, -1.0, v141
    v_mul_f32 v72, -1.0, v141
    v_mul_f32 v73, -1.0, v141
    v_mul_f32 v74, -1.0, v141
    v_mul_f32 v75, -1.0, v141
    v_mul_f32 v76, -1.0, v141
    v_mul_f32 v77, -1.0, v141
    v_mul_f32 v78, -1.0, v141
    v_mul_f32 v79, -1.0, v141
    v_mul_f32 v80, -1.0, v141
    v_mul_f32 v81, -1.0, v141
    s_waitcnt lgkmcnt(4)
    s_nop 0
    v_mfma_f32_32x32x16_bf16 v[18:33], v[90:93], v[14:17], v[66:81]
    s_nop 7
    s_nop 3
    s_branch La2b_318
Lrt_p3_359:
    s_cmp_eq_u32 s84, 0
    s_cbranch_scc1 Lbk_p3_360
    s_sub_u32 s84, s84, 1
    s_nop 4
    s_add_u32 s89, s86, 0x0
    buffer_load_dwordx4 v[42:45], v122, s[40:43], s89 offen offset:0 sc1
    buffer_load_dwordx4 v[46:49], v122, s[40:43], s89 offen offset:2048 sc1
    s_add_u32 s89, s86, 0x1000
    buffer_load_dwordx4 v[50:53], v122, s[40:43], s89 offen offset:0 sc1
    buffer_load_dwordx4 v[54:57], v122, s[40:43], s89 offen offset:2048 sc1
    s_add_u32 s89, s86, 0x2000
    buffer_load_dwordx4 v[58:61], v122, s[40:43], s89 offen offset:0 sc1
    buffer_load_dwordx4 v[62:65], v122, s[40:43], s89 offen offset:2048 sc1
    s_add_u32 s89, s86, 0x3000
    buffer_load_dwordx4 v[66:69], v122, s[40:43], s89 offen offset:0 sc1
    buffer_load_dwordx4 v[70:73], v122, s[40:43], s89 offen offset:2048 sc1
    s_add_u32 s89, s86, 0x0
    buffer_load_dwordx4 v[74:77], v122, s[40:43], s89 offen offset:1024 sc1
    buffer_load_dwordx4 v[78:81], v122, s[40:43], s89 offen offset:3072 sc1
    s_add_u32 s89, s86, 0x1000
    buffer_load_dwordx4 v[82:85], v122, s[40:43], s89 offen offset:1024 sc1
    buffer_load_dwordx4 v[86:89], v122, s[40:43], s89 offen offset:3072 sc1
    s_add_u32 s89, s86, 0x2000
    buffer_load_dwordx4 v[90:93], v122, s[40:43], s89 offen offset:1024 sc1
    buffer_load_dwordx4 v[94:97], v122, s[40:43], s89 offen offset:3072 sc1
    s_add_u32 s89, s86, 0x3000
    buffer_load_dwordx4 v[98:101], v122, s[40:43], s89 offen offset:1024 sc1
    buffer_load_dwordx4 v[102:105], v122, s[40:43], s89 offen offset:3072 sc1
    s_waitcnt vmcnt(12)
    v_max3_u32 v125, v45, v49, v53
    v_max_u32 v125, v125, v57
    v_cmp_eq_u32 vcc, -1, v125
    s_cbranch_vccnz Lrt_p3_359
    s_branch Lbk_p3_360
Lrt_p3_361:
    s_cmp_eq_u32 s84, 0
    s_cbranch_scc1 Lbk_p3_362
    s_sub_u32 s84, s84, 1
    s_nop 4
    s_add_u32 s89, s86, 0x2000
    buffer_load_dwordx4 v[58:61], v122, s[40:43], s89 offen offset:0 sc1
    buffer_load_dwordx4 v[62:65], v122, s[40:43], s89 offen offset:2048 sc1
    s_add_u32 s89, s86, 0x3000
    buffer_load_dwordx4 v[66:69], v122, s[40:43], s89 offen offset:0 sc1
    buffer_load_dwordx4 v[70:73], v122, s[40:43], s89 offen offset:2048 sc1
    s_add_u32 s89, s86, 0x0
    buffer_load_dwordx4 v[74:77], v122, s[40:43], s89 offen offset:1024 sc1
    buffer_load_dwordx4 v[78:81], v122, s[40:43], s89 offen offset:3072 sc1
    s_add_u32 s89, s86, 0x1000
    buffer_load_dwordx4 v[82:85], v122, s[40:43], s89 offen offset:1024 sc1
    buffer_load_dwordx4 v[86:89], v122, s[40:43], s89 offen offset:3072 sc1
    s_add_u32 s89, s86, 0x2000
    buffer_load_dwordx4 v[90:93], v122, s[40:43], s89 offen offset:1024 sc1
    buffer_load_dwordx4 v[94:97], v122, s[40:43], s89 offen offset:3072 sc1
    s_add_u32 s89, s86, 0x3000
    buffer_load_dwordx4 v[98:101], v122, s[40:43], s89 offen offset:1024 sc1
    buffer_load_dwordx4 v[102:105], v122, s[40:43], s89 offen offset:3072 sc1
    s_waitcnt vmcnt(8)
    v_max3_u32 v125, v61, v65, v69
    v_max_u32 v125, v125, v73
    v_cmp_eq_u32 vcc, -1, v125
    s_cbranch_vccnz Lrt_p3_361
    s_branch Lbk_p3_362
Lrt_p3_363:
    s_cmp_eq_u32 s84, 0
    s_cbranch_scc1 Lbk_p3_364
    s_sub_u32 s84, s84, 1
    s_nop 4
    s_add_u32 s89, s86, 0x0
    buffer_load_dwordx4 v[74:77], v122, s[40:43], s89 offen offset:1024 sc1
    buffer_load_dwordx4 v[78:81], v122, s[40:43], s89 offen offset:3072 sc1
    s_add_u32 s89, s86, 0x1000
    buffer_load_dwordx4 v[82:85], v122, s[40:43], s89 offen offset:1024 sc1
    buffer_load_dwordx4 v[86:89], v122, s[40:43], s89 offen offset:3072 sc1
    s_add_u32 s89, s86, 0x2000
    buffer_load_dwordx4 v[90:93], v122, s[40:43], s89 offen offset:1024 sc1
    buffer_load_dwordx4 v[94:97], v122, s[40:43], s89 offen offset:3072 sc1
    s_add_u32 s89, s86, 0x3000
    buffer_load_dwordx4 v[98:101], v122, s[40:43], s89 offen offset:1024 sc1
    buffer_load_dwordx4 v[102:105], v122, s[40:43], s89 offen offset:3072 sc1
    s_waitcnt vmcnt(4)
    v_max3_u32 v125, v77, v81, v85
    v_max_u32 v125, v125, v89
    v_cmp_eq_u32 vcc, -1, v125
    s_cbranch_vccnz Lrt_p3_363
    s_branch Lbk_p3_364
Lrt_p3_365:
    s_cmp_eq_u32 s84, 0
    s_cbranch_scc1 Lbk_p3_366
    s_sub_u32 s84, s84, 1
    s_nop 4
    s_add_u32 s89, s86, 0x2000
    buffer_load_dwordx4 v[90:93], v122, s[40:43], s89 offen offset:1024 sc1
    buffer_load_dwordx4 v[94:97], v122, s[40:43], s89 offen offset:3072 sc1
    s_add_u32 s89, s86, 0x3000
    buffer_load_dwordx4 v[98:101], v122, s[40:43], s89 offen offset:1024 sc1
    buffer_load_dwordx4 v[102:105], v122, s[40:43], s89 offen offset:3072 sc1
    s_waitcnt vmcnt(0)
    v_max3_u32 v125, v93, v97, v101
    v_max_u32 v125, v125, v105
    v_cmp_eq_u32 vcc, -1, v125
    s_cbranch_vccnz Lrt_p3_365
    s_branch Lbk_p3_366
Lrt_st_369:
    s_cmp_eq_u32 s84, 0
    s_cbranch_scc1 Lbk_st_370
    s_sub_u32 s84, s84, 1
    s_nop 4
    s_add_u32 s89, s86, 0x0
    buffer_load_dwordx2 v[66:67], v63, s[40:43], s89 offen offset:0 sc1
    s_add_u32 s89, s86, 0x400
    buffer_load_dwordx2 v[68:69], v63, s[40:43], s89 offen offset:0 sc1
    s_add_u32 s89, s86, 0x800
    buffer_load_dwordx2 v[70:71], v63, s[40:43], s89 offen offset:0 sc1
    s_add_u32 s89, s86, 0xc00
    buffer_load_dwordx2 v[72:73], v63, s[40:43], s89 offen offset:0 sc1
    s_add_u32 s89, s86, 0x1000
    buffer_load_dwordx2 v[74:75], v63, s[40:43], s89 offen offset:0 sc1
    s_add_u32 s89, s86, 0x1400
    buffer_load_dwordx2 v[76:77], v63, s[40:43], s89 offen offset:0 sc1
    s_add_u32 s89, s86, 0x1800
    buffer_load_dwordx2 v[78:79], v63, s[40:43], s89 offen offset:0 sc1
    s_add_u32 s89, s86, 0x1c00
    buffer_load_dwordx2 v[80:81], v63, s[40:43], s89 offen offset:0 sc1
    s_waitcnt vmcnt(0)
    v_max3_u32 v125, v67, v69, v71
    v_max3_u32 v125, v125, v73, v75
    v_max3_u32 v125, v125, v77, v79
    v_max_u32 v125, v125, v81
    v_cmp_eq_u32 vcc, -1, v125
    s_cbranch_vccnz Lrt_st_369
    s_branch Lbk_st_370
Lrt_p4_371:
    s_cmp_eq_u32 s84, 0
    s_cbranch_scc1 Lbk_p4_372
    s_sub_u32 s84, s84, 1
    s_nop 4
    s_add_u32 s89, s86, 0x0
    buffer_load_dwordx4 v[58:61], v122, s[40:43], s89 offen offset:0 sc1
    buffer_load_dwordx4 v[62:65], v123, s[40:43], s89 offen offset:0 sc1
    buffer_load_dwordx4 v[66:69], v124, s[40:43], s89 offen offset:0 sc1
    buffer_load_dwordx4 v[70:73], v125, s[40:43], s89 offen offset:0 sc1
    s_add_u32 s89, s86, 0x1000
    buffer_load_dwordx4 v[74:77], v122, s[40:43], s89 offen offset:0 sc1
    buffer_load_dwordx4 v[78:81], v123, s[40:43], s89 offen offset:0 sc1
    buffer_load_dwordx4 v[82:85], v124, s[40:43], s89 offen offset:0 sc1
    buffer_load_dwordx4 v[86:89], v125, s[40:43], s89 offen offset:0 sc1
    s_add_u32 s89, s86, 0x2000
    buffer_load_dwordx4 v[90:93], v122, s[40:43], s89 offen offset:0 sc1
    buffer_load_dwordx4 v[94:97], v123, s[40:43], s89 offen offset:0 sc1
    buffer_load_dwordx4 v[98:101], v124, s[40:43], s89 offen offset:0 sc1
    buffer_load_dwordx4 v[102:105], v125, s[40:43], s89 offen offset:0 sc1
    s_add_u32 s89, s86, 0x3000
    buffer_load_dwordx4 v[106:109], v122, s[40:43], s89 offen offset:0 sc1
    buffer_load_dwordx4 v[110:113], v123, s[40:43], s89 offen offset:0 sc1
    buffer_load_dwordx4 v[114:117], v124, s[40:43], s89 offen offset:0 sc1
    buffer_load_dwordx4 v[118:121], v125, s[40:43], s89 offen offset:0 sc1
    s_waitcnt vmcnt(12)
    v_max3_u32 v126, v61, v65, v69
    v_max_u32 v126, v126, v73
    v_cmp_eq_u32 vcc, -1, v126
    s_cbranch_vccnz Lrt_p4_371
    s_branch Lbk_p4_372
Lrt_p4_373:
    s_cmp_eq_u32 s84, 0
    s_cbranch_scc1 Lbk_p4_374
    s_sub_u32 s84, s84, 1
    s_nop 4
    s_add_u32 s89, s86, 0x1000
    buffer_load_dwordx4 v[74:77], v122, s[40:43], s89 offen offset:0 sc1
    buffer_load_dwordx4 v[78:81], v123, s[40:43], s89 offen offset:0 sc1
    buffer_load_dwordx4 v[82:85], v124, s[40:43], s89 offen offset:0 sc1
    buffer_load_dwordx4 v[86:89], v125, s[40:43], s89 offen offset:0 sc1
    s_add_u32 s89, s86, 0x2000
    buffer_load_dwordx4 v[90:93], v122, s[40:43], s89 offen offset:0 sc1
    buffer_load_dwordx4 v[94:97], v123, s[40:43], s89 offen offset:0 sc1
    buffer_load_dwordx4 v[98:101], v124, s[40:43], s89 offen offset:0 sc1
    buffer_load_dwordx4 v[102:105], v125, s[40:43], s89 offen offset:0 sc1
    s_add_u32 s89, s86, 0x3000
    buffer_load_dwordx4 v[106:109], v122, s[40:43], s89 offen offset:0 sc1
    buffer_load_dwordx4 v[110:113], v123, s[40:43], s89 offen offset:0 sc1
    buffer_load_dwordx4 v[114:117], v124, s[40:43], s89 offen offset:0 sc1
    buffer_load_dwordx4 v[118:121], v125, s[40:43], s89 offen offset:0 sc1
    s_waitcnt vmcnt(8)
    v_max3_u32 v126, v77, v81, v85
    v_max_u32 v126, v126, v89
    v_cmp_eq_u32 vcc, -1, v126
    s_cbranch_vccnz Lrt_p4_373
    s_branch Lbk_p4_374
Lrt_p4_375:
    s_cmp_eq_u32 s84, 0
    s_cbranch_scc1 Lbk_p4_376
    s_sub_u32 s84, s84, 1
    s_nop 4
    s_add_u32 s89, s86, 0x2000
    buffer_load_dwordx4 v[90:93], v122, s[40:43], s89 offen offset:0 sc1
    buffer_load_dwordx4 v[94:97], v123, s[40:43], s89 offen offset:0 sc1
    buffer_load_dwordx4 v[98:101], v124, s[40:43], s89 offen offset:0 sc1
    buffer_load_dwordx4 v[102:105], v125, s[40:43], s89 offen offset:0 sc1
    s_add_u32 s89, s86, 0x3000
    buffer_load_dwordx4 v[106:109], v122, s[40:43], s89 offen offset:0 sc1
    buffer_load_dwordx4 v[110:113], v123, s[40:43], s89 offen offset:0 sc1
    buffer_load_dwordx4 v[114:117], v124, s[40:43], s89 offen offset:0 sc1
    buffer_load_dwordx4 v[118:121], v125, s[40:43], s89 offen offset:0 sc1
    s_add_u32 s89, s86, 0x4000
    buffer_load_dwordx4 v[58:61], v122, s[40:43], s89 offen offset:0 sc1
    buffer_load_dwordx4 v[62:65], v123, s[40:43], s89 offen offset:0 sc1
    buffer_load_dwordx4 v[66:69], v124, s[40:43], s89 offen offset:0 sc1
    buffer_load_dwordx4 v[70:73], v125, s[40:43], s89 offen offset:0 sc1
    s_waitcnt vmcnt(8)
    v_max3_u32 v126, v93, v97, v101
    v_max_u32 v126, v126, v105
    v_cmp_eq_u32 vcc, -1, v126
    s_cbranch_vccnz Lrt_p4_375
    s_branch Lbk_p4_376
Lrt_p4_377:
    s_cmp_eq_u32 s84, 0
    s_cbranch_scc1 Lbk_p4_378
    s_sub_u32 s84, s84, 1
    s_nop 4
    s_add_u32 s89, s86, 0x3000
    buffer_load_dwordx4 v[106:109], v122, s[40:43], s89 offen offset:0 sc1
    buffer_load_dwordx4 v[110:113], v123, s[40:43], s89 offen offset:0 sc1
    buffer_load_dwordx4 v[114:117], v124, s[40:43], s89 offen offset:0 sc1
    buffer_load_dwordx4 v[118:121], v125, s[40:43], s89 offen offset:0 sc1
    s_add_u32 s89, s86, 0x4000
    buffer_load_dwordx4 v[58:61], v122, s[40:43], s89 offen offset:0 sc1
    buffer_load_dwordx4 v[62:65], v123, s[40:43], s89 offen offset:0 sc1
    buffer_load_dwordx4 v[66:69], v124, s[40:43], s89 offen offset:0 sc1
    buffer_load_dwordx4 v[70:73], v125, s[40:43], s89 offen offset:0 sc1
    s_add_u32 s89, s86, 0x5000
    buffer_load_dwordx4 v[74:77], v122, s[40:43], s89 offen offset:0 sc1
    buffer_load_dwordx4 v[78:81], v123, s[40:43], s89 offen offset:0 sc1
    buffer_load_dwordx4 v[82:85], v124, s[40:43], s89 offen offset:0 sc1
    buffer_load_dwordx4 v[86:89], v125, s[40:43], s89 offen offset:0 sc1
    s_waitcnt vmcnt(8)
    v_max3_u32 v126, v109, v113, v117
    v_max_u32 v126, v126, v121
    v_cmp_eq_u32 vcc, -1, v126
    s_cbranch_vccnz Lrt_p4_377
    s_branch Lbk_p4_378
Lrt_p4_379:
    s_cmp_eq_u32 s84, 0
    s_cbranch_scc1 Lbk_p4_380
    s_sub_u32 s84, s84, 1
    s_nop 4
    s_add_u32 s89, s86, 0x4000
    buffer_load_dwordx4 v[58:61], v122, s[40:43], s89 offen offset:0 sc1
    buffer_load_dwordx4 v[62:65], v123, s[40:43], s89 offen offset:0 sc1
    buffer_load_dwordx4 v[66:69], v124, s[40:43], s89 offen offset:0 sc1
    buffer_load_dwordx4 v[70:73], v125, s[40:43], s89 offen offset:0 sc1
    s_add_u32 s89, s86, 0x5000
    buffer_load_dwordx4 v[74:77], v122, s[40:43], s89 offen offset:0 sc1
    buffer_load_dwordx4 v[78:81], v123, s[40:43], s89 offen offset:0 sc1
    buffer_load_dwordx4 v[82:85], v124, s[40:43], s89 offen offset:0 sc1
    buffer_load_dwordx4 v[86:89], v125, s[40:43], s89 offen offset:0 sc1
    s_add_u32 s89, s86, 0x6000
    buffer_load_dwordx4 v[90:93], v122, s[40:43], s89 offen offset:0 sc1
    buffer_load_dwordx4 v[94:97], v123, s[40:43], s89 offen offset:0 sc1
    buffer_load_dwordx4 v[98:101], v124, s[40:43], s89 offen offset:0 sc1
    buffer_load_dwordx4 v[102:105], v125, s[40:43], s89 offen offset:0 sc1
    s_waitcnt vmcnt(8)
    v_max3_u32 v126, v61, v65, v69
    v_max_u32 v126, v126, v73
    v_cmp_eq_u32 vcc, -1, v126
    s_cbranch_vccnz Lrt_p4_379
    s_branch Lbk_p4_380
Lrt_p4_381:
    s_cmp_eq_u32 s84, 0
    s_cbranch_scc1 Lbk_p4_382
    s_sub_u32 s84, s84, 1
    s_nop 4
    s_add_u32 s89, s86, 0x5000
    buffer_load_dwordx4 v[74:77], v122, s[40:43], s89 offen offset:0 sc1
    buffer_load_dwordx4 v[78:81], v123, s[40:43], s89 offen offset:0 sc1
    buffer_load_dwordx4 v[82:85], v124, s[40:43], s89 offen offset:0 sc1
    buffer_load_dwordx4 v[86:89], v125, s[40:43], s89 offen offset:0 sc1
    s_add_u32 s89, s86, 0x6000
    buffer_load_dwordx4 v[90:93], v122, s[40:43], s89 offen offset:0 sc1
    buffer_load_dwordx4 v[94:97], v123, s[40:43], s89 offen offset:0 sc1
    buffer_load_dwordx4 v[98:101], v124, s[40:43], s89 offen offset:0 sc1
    buffer_load_dwordx4 v[102:105], v125, s[40:43], s89 offen offset:0 sc1
    s_add_u32 s89, s86, 0x7000
    buffer_load_dwordx4 v[106:109], v122, s[40:43], s89 offen offset:0 sc1
    buffer_load_dwordx4 v[110:113], v123, s[40:43], s89 offen offset:0 sc1
    buffer_load_dwordx4 v[114:117], v124, s[40:43], s89 offen offset:0 sc1
    buffer_load_dwordx4 v[118:121], v125, s[40:43], s89 offen offset:0 sc1
    s_waitcnt vmcnt(8)
    v_max3_u32 v126, v77, v81, v85
    v_max_u32 v126, v126, v89
    v_cmp_eq_u32 vcc, -1, v126
    s_cbranch_vccnz Lrt_p4_381
    s_branch Lbk_p4_382
Lrt_p4_383:
    s_cmp_eq_u32 s84, 0
    s_cbranch_scc1 Lbk_p4_384
    s_sub_u32 s84, s84, 1
    s_nop 4
    s_add_u32 s89, s86, 0x6000
    buffer_load_dwordx4 v[90:93], v122, s[40:43], s89 offen offset:0 sc1
    buffer_load_dwordx4 v[94:97], v123, s[40:43], s89 offen offset:0 sc1
    buffer_load_dwordx4 v[98:101], v124, s[40:43], s89 offen offset:0 sc1
    buffer_load_dwordx4 v[102:105], v125, s[40:43], s89 offen offset:0 sc1
    s_add_u32 s89, s86, 0x7000
    buffer_load_dwordx4 v[106:109], v122, s[40:43], s89 offen offset:0 sc1
    buffer_load_dwordx4 v[110:113], v123, s[40:43], s89 offen offset:0 sc1
    buffer_load_dwordx4 v[114:117], v124, s[40:43], s89 offen offset:0 sc1
    buffer_load_dwordx4 v[118:121], v125, s[40:43], s89 offen offset:0 sc1
    s_add_u32 s89, s86, 0x8000
    buffer_load_dwordx4 v[58:61], v122, s[40:43], s89 offen offset:0 sc1
    buffer_load_dwordx4 v[62:65], v123, s[40:43], s89 offen offset:0 sc1
    buffer_load_dwordx4 v[66:69], v124, s[40:43], s89 offen offset:0 sc1
    buffer_load_dwordx4 v[70:73], v125, s[40:43], s89 offen offset:0 sc1
    s_waitcnt vmcnt(8)
    v_max3_u32 v126, v93, v97, v101
    v_max_u32 v126, v126, v105
    v_cmp_eq_u32 vcc, -1, v126
    s_cbranch_vccnz Lrt_p4_383
    s_branch Lbk_p4_384
Lrt_p4_385:
    s_cmp_eq_u32 s84, 0
    s_cbranch_scc1 Lbk_p4_386
    s_sub_u32 s84, s84, 1
    s_nop 4
    s_add_u32 s89, s86, 0x7000
    buffer_load_dwordx4 v[106:109], v122, s[40:43], s89 offen offset:0 sc1
    buffer_load_dwordx4 v[110:113], v123, s[40:43], s89 offen offset:0 sc1
    buffer_load_dwordx4 v[114:117], v124, s[40:43], s89 offen offset:0 sc1
    buffer_load_dwordx4 v[118:121], v125, s[40:43], s89 offen offset:0 sc1
    s_add_u32 s89, s86, 0x8000
    buffer_load_dwordx4 v[58:61], v122, s[40:43], s89 offen offset:0 sc1
    buffer_load_dwordx4 v[62:65], v123, s[40:43], s89 offen offset:0 sc1
    buffer_load_dwordx4 v[66:69], v124, s[40:43], s89 offen offset:0 sc1
    buffer_load_dwordx4 v[70:73], v125, s[40:43], s89 offen offset:0 sc1
    s_add_u32 s89, s86, 0x9000
    buffer_load_dwordx4 v[74:77], v122, s[40:43], s89 offen offset:0 sc1
    buffer_load_dwordx4 v[78:81], v123, s[40:43], s89 offen offset:0 sc1
    buffer_load_dwordx4 v[82:85], v124, s[40:43], s89 offen offset:0 sc1
    buffer_load_dwordx4 v[86:89], v125, s[40:43], s89 offen offset:0 sc1
    s_waitcnt vmcnt(8)
    v_max3_u32 v126, v109, v113, v117
    v_max_u32 v126, v126, v121
    v_cmp_eq_u32 vcc, -1, v126
    s_cbranch_vccnz Lrt_p4_385
    s_branch Lbk_p4_386
Lrt_p4_387:
    s_cmp_eq_u32 s84, 0
    s_cbranch_scc1 Lbk_p4_388
    s_sub_u32 s84, s84, 1
    s_nop 4
    s_add_u32 s89, s86, 0x8000
    buffer_load_dwordx4 v[58:61], v122, s[40:43], s89 offen offset:0 sc1
    buffer_load_dwordx4 v[62:65], v123, s[40:43], s89 offen offset:0 sc1
    buffer_load_dwordx4 v[66:69], v124, s[40:43], s89 offen offset:0 sc1
    buffer_load_dwordx4 v[70:73], v125, s[40:43], s89 offen offset:0 sc1
    s_add_u32 s89, s86, 0x9000
    buffer_load_dwordx4 v[74:77], v122, s[40:43], s89 offen offset:0 sc1
    buffer_load_dwordx4 v[78:81], v123, s[40:43], s89 offen offset:0 sc1
    buffer_load_dwordx4 v[82:85], v124, s[40:43], s89 offen offset:0 sc1
    buffer_load_dwordx4 v[86:89], v125, s[40:43], s89 offen offset:0 sc1
    s_add_u32 s89, s86, 0xa000
    buffer_load_dwordx4 v[90:93], v122, s[40:43], s89 offen offset:0 sc1
    buffer_load_dwordx4 v[94:97], v123, s[40:43], s89 offen offset:0 sc1
    buffer_load_dwordx4 v[98:101], v124, s[40:43], s89 offen offset:0 sc1
    buffer_load_dwordx4 v[102:105], v125, s[40:43], s89 offen offset:0 sc1
    s_waitcnt vmcnt(8)
    v_max3_u32 v126, v61, v65, v69
    v_max_u32 v126, v126, v73
    v_cmp_eq_u32 vcc, -1, v126
    s_cbranch_vccnz Lrt_p4_387
    s_branch Lbk_p4_388
Lrt_p4_389:
    s_cmp_eq_u32 s84, 0
    s_cbranch_scc1 Lbk_p4_390
    s_sub_u32 s84, s84, 1
    s_nop 4
    s_add_u32 s89, s86, 0x9000
    buffer_load_dwordx4 v[74:77], v122, s[40:43], s89 offen offset:0 sc1
    buffer_load_dwordx4 v[78:81], v123, s[40:43], s89 offen offset:0 sc1
    buffer_load_dwordx4 v[82:85], v124, s[40:43], s89 offen offset:0 sc1
    buffer_load_dwordx4 v[86:89], v125, s[40:43], s89 offen offset:0 sc1
    s_add_u32 s89, s86, 0xa000
    buffer_load_dwordx4 v[90:93], v122, s[40:43], s89 offen offset:0 sc1
    buffer_load_dwordx4 v[94:97], v123, s[40:43], s89 offen offset:0 sc1
    buffer_load_dwordx4 v[98:101], v124, s[40:43], s89 offen offset:0 sc1
    buffer_load_dwordx4 v[102:105], v125, s[40:43], s89 offen offset:0 sc1
    s_add_u32 s89, s86, 0xb000
    buffer_load_dwordx4 v[106:109], v122, s[40:43], s89 offen offset:0 sc1
    buffer_load_dwordx4 v[110:113], v123, s[40:43], s89 offen offset:0 sc1
    buffer_load_dwordx4 v[114:117], v124, s[40:43], s89 offen offset:0 sc1
    buffer_load_dwordx4 v[118:121], v125, s[40:43], s89 offen offset:0 sc1
    s_waitcnt vmcnt(8)
    v_max3_u32 v126, v77, v81, v85
    v_max_u32 v126, v126, v89
    v_cmp_eq_u32 vcc, -1, v126
    s_cbranch_vccnz Lrt_p4_389
    s_branch Lbk_p4_390
Lrt_p4_391:
    s_cmp_eq_u32 s84, 0
    s_cbranch_scc1 Lbk_p4_392
    s_sub_u32 s84, s84, 1
    s_nop 4
    s_add_u32 s89, s86, 0xa000
    buffer_load_dwordx4 v[90:93], v122, s[40:43], s89 offen offset:0 sc1
    buffer_load_dwordx4 v[94:97], v123, s[40:43], s89 offen offset:0 sc1
    buffer_load_dwordx4 v[98:101], v124, s[40:43], s89 offen offset:0 sc1
    buffer_load_dwordx4 v[102:105], v125, s[40:43], s89 offen offset:0 sc1
    s_add_u32 s89, s86, 0xb000
    buffer_load_dwordx4 v[106:109], v122, s[40:43], s89 offen offset:0 sc1
    buffer_load_dwordx4 v[110:113], v123, s[40:43], s89 offen offset:0 sc1
    buffer_load_dwordx4 v[114:117], v124, s[40:43], s89 offen offset:0 sc1
    buffer_load_dwordx4 v[118:121], v125, s[40:43], s89 offen offset:0 sc1
    s_add_u32 s89, s86, 0xc000
    buffer_load_dwordx4 v[58:61], v122, s[40:43], s89 offen offset:0 sc1
    buffer_load_dwordx4 v[62:65], v123, s[40:43], s89 offen offset:0 sc1
    buffer_load_dwordx4 v[66:69], v124, s[40:43], s89 offen offset:0 sc1
    buffer_load_dwordx4 v[70:73], v125, s[40:43], s89 offen offset:0 sc1
    s_waitcnt vmcnt(8)
    v_max3_u32 v126, v93, v97, v101
    v_max_u32 v126, v126, v105
    v_cmp_eq_u32 vcc, -1, v126
    s_cbranch_vccnz Lrt_p4_391
    s_branch Lbk_p4_392
Lrt_p4_393:
    s_cmp_eq_u32 s84, 0
    s_cbranch_scc1 Lbk_p4_394
    s_sub_u32 s84, s84, 1
    s_nop 4
    s_add_u32 s89, s86, 0xb000
    buffer_load_dwordx4 v[106:109], v122, s[40:43], s89 offen offset:0 sc1
    buffer_load_dwordx4 v[110:113], v123, s[40:43], s89 offen offset:0 sc1
    buffer_load_dwordx4 v[114:117], v124, s[40:43], s89 offen offset:0 sc1
    buffer_load_dwordx4 v[118:121], v125, s[40:43], s89 offen offset:0 sc1
    s_add_u32 s89, s86, 0xc000
    buffer_load_dwordx4 v[58:61], v122, s[40:43], s89 offen offset:0 sc1
    buffer_load_dwordx4 v[62:65], v123, s[40:43], s89 offen offset:0 sc1
    buffer_load_dwordx4 v[66:69], v124, s[40:43], s89 offen offset:0 sc1
    buffer_load_dwordx4 v[70:73], v125, s[40:43], s89 offen offset:0 sc1
    s_add_u32 s89, s86, 0xd000
    buffer_load_dwordx4 v[74:77], v122, s[40:43], s89 offen offset:0 sc1
    buffer_load_dwordx4 v[78:81], v123, s[40:43], s89 offen offset:0 sc1
    buffer_load_dwordx4 v[82:85], v124, s[40:43], s89 offen offset:0 sc1
    buffer_load_dwordx4 v[86:89], v125, s[40:43], s89 offen offset:0 sc1
    s_waitcnt vmcnt(8)
    v_max3_u32 v126, v109, v113, v117
    v_max_u32 v126, v126, v121
    v_cmp_eq_u32 vcc, -1, v126
    s_cbranch_vccnz Lrt_p4_393
    s_branch Lbk_p4_394
Lrt_p4_395:
    s_cmp_eq_u32 s84, 0
    s_cbranch_scc1 Lbk_p4_396
    s_sub_u32 s84, s84, 1
    s_nop 4
    s_add_u32 s89, s86, 0xc000
    buffer_load_dwordx4 v[58:61], v122, s[40:43], s89 offen offset:0 sc1
    buffer_load_dwordx4 v[62:65], v123, s[40:43], s89 offen offset:0 sc1
    buffer_load_dwordx4 v[66:69], v124, s[40:43], s89 offen offset:0 sc1
    buffer_load_dwordx4 v[70:73], v125, s[40:43], s89 offen offset:0 sc1
    s_add_u32 s89, s86, 0xd000
    buffer_load_dwordx4 v[74:77], v122, s[40:43], s89 offen offset:0 sc1
    buffer_load_dwordx4 v[78:81], v123, s[40:43], s89 offen offset:0 sc1
    buffer_load_dwordx4 v[82:85], v124, s[40:43], s89 offen offset:0 sc1
    buffer_load_dwordx4 v[86:89], v125, s[40:43], s89 offen offset:0 sc1
    s_add_u32 s89, s86, 0xe000
    buffer_load_dwordx4 v[90:93], v122, s[40:43], s89 offen offset:0 sc1
    buffer_load_dwordx4 v[94:97], v123, s[40:43], s89 offen offset:0 sc1
    buffer_load_dwordx4 v[98:101], v124, s[40:43], s89 offen offset:0 sc1
    buffer_load_dwordx4 v[102:105], v125, s[40:43], s89 offen offset:0 sc1
    s_waitcnt vmcnt(8)
    v_max3_u32 v126, v61, v65, v69
    v_max_u32 v126, v126, v73
    v_cmp_eq_u32 vcc, -1, v126
    s_cbranch_vccnz Lrt_p4_395
    s_branch Lbk_p4_396
Lrt_p4_397:
    s_cmp_eq_u32 s84, 0
    s_cbranch_scc1 Lbk_p4_398
    s_sub_u32 s84, s84, 1
    s_nop 4
    s_add_u32 s89, s86, 0xd000
    buffer_load_dwordx4 v[74:77], v122, s[40:43], s89 offen offset:0 sc1
    buffer_load_dwordx4 v[78:81], v123, s[40:43], s89 offen offset:0 sc1
    buffer_load_dwordx4 v[82:85], v124, s[40:43], s89 offen offset:0 sc1
    buffer_load_dwordx4 v[86:89], v125, s[40:43], s89 offen offset:0 sc1
    s_add_u32 s89, s86, 0xe000
    buffer_load_dwordx4 v[90:93], v122, s[40:43], s89 offen offset:0 sc1
    buffer_load_dwordx4 v[94:97], v123, s[40:43], s89 offen offset:0 sc1
    buffer_load_dwordx4 v[98:101], v124, s[40:43], s89 offen offset:0 sc1
    buffer_load_dwordx4 v[102:105], v125, s[40:43], s89 offen offset:0 sc1
    s_add_u32 s89, s86, 0xf000
    buffer_load_dwordx4 v[106:109], v122, s[40:43], s89 offen offset:0 sc1
    buffer_load_dwordx4 v[110:113], v123, s[40:43], s89 offen offset:0 sc1
    buffer_load_dwordx4 v[114:117], v124, s[40:43], s89 offen offset:0 sc1
    buffer_load_dwordx4 v[118:121], v125, s[40:43], s89 offen offset:0 sc1
    s_waitcnt vmcnt(8)
    v_max3_u32 v126, v77, v81, v85
    v_max_u32 v126, v126, v89
    v_cmp_eq_u32 vcc, -1, v126
    s_cbranch_vccnz Lrt_p4_397
    s_branch Lbk_p4_398
Lrt_p4_399:
    s_cmp_eq_u32 s84, 0
    s_cbranch_scc1 Lbk_p4_400
    s_sub_u32 s84, s84, 1
    s_nop 4
    s_add_u32 s89, s86, 0xe000
    buffer_load_dwordx4 v[90:93], v122, s[40:43], s89 offen offset:0 sc1
    buffer_load_dwordx4 v[94:97], v123, s[40:43], s89 offen offset:0 sc1
    buffer_load_dwordx4 v[98:101], v124, s[40:43], s89 offen offset:0 sc1
    buffer_load_dwordx4 v[102:105], v125, s[40:43], s89 offen offset:0 sc1
    s_add_u32 s89, s86, 0xf000
    buffer_load_dwordx4 v[106:109], v122, s[40:43], s89 offen offset:0 sc1
    buffer_load_dwordx4 v[110:113], v123, s[40:43], s89 offen offset:0 sc1
    buffer_load_dwordx4 v[114:117], v124, s[40:43], s89 offen offset:0 sc1
    buffer_load_dwordx4 v[118:121], v125, s[40:43], s89 offen offset:0 sc1
    s_waitcnt vmcnt(4)
    v_max3_u32 v126, v93, v97, v101
    v_max_u32 v126, v126, v105
    v_cmp_eq_u32 vcc, -1, v126
    s_cbranch_vccnz Lrt_p4_399
    s_branch Lbk_p4_400
Lrt_p4_401:
    s_cmp_eq_u32 s84, 0
    s_cbranch_scc1 Lbk_p4_402
    s_sub_u32 s84, s84, 1
    s_nop 4
    s_add_u32 s89, s86, 0xf000
    buffer_load_dwordx4 v[106:109], v122, s[40:43], s89 offen offset:0 sc1
    buffer_load_dwordx4 v[110:113], v123, s[40:43], s89 offen offset:0 sc1
    buffer_load_dwordx4 v[114:117], v124, s[40:43], s89 offen offset:0 sc1
    buffer_load_dwordx4 v[118:121], v125, s[40:43], s89 offen offset:0 sc1
    s_waitcnt vmcnt(0)
    v_max3_u32 v126, v109, v113, v117
    v_max_u32 v126, v126, v121
    v_cmp_eq_u32 vcc, -1, v126
    s_cbranch_vccnz Lrt_p4_401
    s_branch Lbk_p4_402
Lrt_p5_403:
    s_cmp_eq_u32 s84, 0
    s_cbranch_scc1 Lbk_p5_404
    s_sub_u32 s84, s84, 1
    s_nop 4
    s_add_u32 s89, s87, 0x0
    buffer_load_dwordx4 v[74:77], v134, s[40:43], s89 offen offset:0 sc1
    buffer_load_dwordx4 v[78:81], v133, s[40:43], s89 offen offset:0 sc1
    s_add_u32 s89, s87, 0x0
    buffer_load_dwordx4 v[82:85], v134, s[40:43], s89 offen offset:1024 sc1
    buffer_load_dwordx4 v[86:89], v133, s[40:43], s89 offen offset:1024 sc1
    s_add_u32 s89, s87, 0x0
    buffer_load_dwordx4 v[90:93], v134, s[40:43], s89 offen offset:2048 sc1
    buffer_load_dwordx4 v[94:97], v133, s[40:43], s89 offen offset:2048 sc1
    s_add_u32 s89, s87, 0x0
    buffer_load_dwordx4 v[98:101], v134, s[40:43], s89 offen offset:3072 sc1
    buffer_load_dwordx4 v[102:105], v133, s[40:43], s89 offen offset:3072 sc1
    s_add_u32 s89, s87, 0x1000
    buffer_load_dwordx4 v[106:109], v134, s[40:43], s89 offen offset:0 sc1
    buffer_load_dwordx4 v[110:113], v133, s[40:43], s89 offen offset:0 sc1
    s_add_u32 s89, s87, 0x1000
    buffer_load_dwordx4 v[114:117], v134, s[40:43], s89 offen offset:1024 sc1
    buffer_load_dwordx4 v[118:121], v133, s[40:43], s89 offen offset:1024 sc1
    s_add_u32 s89, s87, 0x1000
    buffer_load_dwordx4 v[122:125], v134, s[40:43], s89 offen offset:2048 sc1
    buffer_load_dwordx4 v[126:129], v133, s[40:43], s89 offen offset:2048 sc1
    s_waitcnt vmcnt(12)
    v_max3_u32 v131, v75, v77, v79
    v_max_u32 v131, v131, v81
    v_cmp_eq_u32 vcc, -1, v131
    s_cbranch_vccnz Lrt_p5_403
    s_branch Lbk_p5_404
Lrt_p5_405:
    s_cmp_eq_u32 s84, 0
    s_cbranch_scc1 Lbk_p5_406
    s_sub_u32 s84, s84, 1
    s_nop 4
    s_add_u32 s89, s87, 0x0
    buffer_load_dwordx4 v[82:85], v134, s[40:43], s89 offen offset:1024 sc1
    buffer_load_dwordx4 v[86:89], v133, s[40:43], s89 offen offset:1024 sc1
    s_add_u32 s89, s87, 0x0
    buffer_load_dwordx4 v[90:93], v134, s[40:43], s89 offen offset:2048 sc1
    buffer_load_dwordx4 v[94:97], v133, s[40:43], s89 offen offset:2048 sc1
    s_add_u32 s89, s87, 0x0
    buffer_load_dwordx4 v[98:101], v134, s[40:43], s89 offen offset:3072 sc1
    buffer_load_dwordx4 v[102:105], v133, s[40:43], s89 offen offset:3072 sc1
    s_add_u32 s89, s87, 0x1000
    buffer_load_dwordx4 v[106:109], v134, s[40:43], s89 offen offset:0 sc1
    buffer_load_dwordx4 v[110:113], v133, s[40:43], s89 offen offset:0 sc1
    s_add_u32 s89, s87, 0x1000
    buffer_load_dwordx4 v[114:117], v134, s[40:43], s89 offen offset:1024 sc1
    buffer_load_dwordx4 v[118:121], v133, s[40:43], s89 offen offset:1024 sc1
    s_add_u32 s89, s87, 0x1000
    buffer_load_dwordx4 v[122:125], v134, s[40:43], s89 offen offset:2048 sc1
    buffer_load_dwordx4 v[126:129], v133, s[40:43], s89 offen offset:2048 sc1
    s_waitcnt vmcnt(10)
    v_max3_u32 v131, v83, v85, v87
    v_max_u32 v131, v131, v89
    v_cmp_eq_u32 vcc, -1, v131
    s_cbranch_vccnz Lrt_p5_405
    s_branch Lbk_p5_406
Lrt_p5_407:
    s_cmp_eq_u32 s84, 0
    s_cbranch_scc1 Lbk_p5_408
    s_sub_u32 s84, s84, 1
    s_nop 4
    s_add_u32 s89, s87, 0x0
    buffer_load_dwordx4 v[90:93], v134, s[40:43], s89 offen offset:2048 sc1
    buffer_load_dwordx4 v[94:97], v133, s[40:43], s89 offen offset:2048 sc1
    s_add_u32 s89, s87, 0x0
    buffer_load_dwordx4 v[98:101], v134, s[40:43], s89 offen offset:3072 sc1
    buffer_load_dwordx4 v[102:105], v133, s[40:43], s89 offen offset:3072 sc1
    s_add_u32 s89, s87, 0x1000
    buffer_load_dwordx4 v[106:109], v134, s[40:43], s89 offen offset:0 sc1
    buffer_load_dwordx4 v[110:113], v133, s[40:43], s89 offen offset:0 sc1
    s_add_u32 s89, s87, 0x1000
    buffer_load_dwordx4 v[114:117], v134, s[40:43], s89 offen offset:1024 sc1
    buffer_load_dwordx4 v[118:121], v133, s[40:43], s89 offen offset:1024 sc1
    s_add_u32 s89, s87, 0x1000
    buffer_load_dwordx4 v[122:125], v134, s[40:43], s89 offen offset:2048 sc1
    buffer_load_dwordx4 v[126:129], v133, s[40:43], s89 offen offset:2048 sc1
    s_add_u32 s89, s87, 0x1000
    buffer_load_dwordx4 v[74:77], v134, s[40:43], s89 offen offset:3072 sc1
    buffer_load_dwordx4 v[78:81], v133, s[40:43], s89 offen offset:3072 sc1
    s_waitcnt vmcnt(10)
    v_max3_u32 v131, v91, v93, v95
    v_max_u32 v131, v131, v97
    v_cmp_eq_u32 vcc, -1, v131
    s_cbranch_vccnz Lrt_p5_407
    s_branch Lbk_p5_408
Lrt_p5_409:
    s_cmp_eq_u32 s84, 0
    s_cbranch_scc1 Lbk_p5_410
    s_sub_u32 s84, s84, 1
    s_nop 4
    s_add_u32 s89, s87, 0x0
    buffer_load_dwordx4 v[98:101], v134, s[40:43], s89 offen offset:3072 sc1
    buffer_load_dwordx4 v[102:105], v133, s[40:43], s89 offen offset:3072 sc1
    s_add_u32 s89, s87, 0x1000
    buffer_load_dwordx4 v[106:109], v134, s[40:43], s89 offen offset:0 sc1
    buffer_load_dwordx4 v[110:113], v133, s[40:43], s89 offen offset:0 sc1
    s_add_u32 s89, s87, 0x1000
    buffer_load_dwordx4 v[114:117], v134, s[40:43], s89 offen offset:1024 sc1
    buffer_load_dwordx4 v[118:121], v133, s[40:43], s89 offen offset:1024 sc1
    s_add_u32 s89, s87, 0x1000
    buffer_load_dwordx4 v[122:125], v134, s[40:43], s89 offen offset:2048 sc1
    buffer_load_dwordx4 v[126:129], v133, s[40:43], s89 offen offset:2048 sc1
    s_add_u32 s89, s87, 0x1000
    buffer_load_dwordx4 v[74:77], v134, s[40:43], s89 offen offset:3072 sc1
    buffer_load_dwordx4 v[78:81], v133, s[40:43], s89 offen offset:3072 sc1
    s_add_u32 s89, s87, 0x2000
    buffer_load_dwordx4 v[82:85], v134, s[40:43], s89 offen offset:0 sc1
    buffer_load_dwordx4 v[86:89], v133, s[40:43], s89 offen offset:0 sc1
    s_waitcnt vmcnt(10)
    v_max3_u32 v131, v99, v101, v103
    v_max_u32 v131, v131, v105
    v_cmp_eq_u32 vcc, -1, v131
    s_cbranch_vccnz Lrt_p5_409
    s_branch Lbk_p5_410
Lrt_p5_411:
    s_cmp_eq_u32 s84, 0
    s_cbranch_scc1 Lbk_p5_412
    s_sub_u32 s84, s84, 1
    s_nop 4
    s_add_u32 s89, s87, 0x1000
    buffer_load_dwordx4 v[106:109], v134, s[40:43], s89 offen offset:0 sc1
    buffer_load_dwordx4 v[110:113], v133, s[40:43], s89 offen offset:0 sc1
    s_add_u32 s89, s87, 0x1000
    buffer_load_dwordx4 v[114:117], v134, s[40:43], s89 offen offset:1024 sc1
    buffer_load_dwordx4 v[118:121], v133, s[40:43], s89 offen offset:1024 sc1
    s_add_u32 s89, s87, 0x1000
    buffer_load_dwordx4 v[122:125], v134, s[40:43], s89 offen offset:2048 sc1
    buffer_load_dwordx4 v[126:129], v133, s[40:43], s89 offen offset:2048 sc1
    s_add_u32 s89, s87, 0x1000
    buffer_load_dwordx4 v[74:77], v134, s[40:43], s89 offen offset:3072 sc1
    buffer_load_dwordx4 v[78:81], v133, s[40:43], s89 offen offset:3072 sc1
    s_add_u32 s89, s87, 0x2000
    buffer_load_dwordx4 v[82:85], v134, s[40:43], s89 offen offset:0 sc1
    buffer_load_dwordx4 v[86:89], v133, s[40:43], s89 offen offset:0 sc1
    s_add_u32 s89, s87, 0x2000
    buffer_load_dwordx4 v[90:93], v134, s[40:43], s89 offen offset:1024 sc1
    buffer_load_dwordx4 v[94:97], v133, s[40:43], s89 offen offset:1024 sc1
    s_waitcnt vmcnt(10)
    v_max3_u32 v131, v107, v109, v111
    v_max_u32 v131, v131, v113
    v_cmp_eq_u32 vcc, -1, v131
    s_cbranch_vccnz Lrt_p5_411
    s_branch Lbk_p5_412
Lrt_p5_413:
    s_cmp_eq_u32 s84, 0
    s_cbranch_scc1 Lbk_p5_414
    s_sub_u32 s84, s84, 1
    s_nop 4
    s_add_u32 s89, s87, 0x1000
    buffer_load_dwordx4 v[114:117], v134, s[40:43], s89 offen offset:1024 sc1
    buffer_load_dwordx4 v[118:121], v133, s[40:43], s89 offen offset:1024 sc1
    s_add_u32 s89, s87, 0x1000
    buffer_load_dwordx4 v[122:125], v134, s[40:43], s89 offen offset:2048 sc1
    buffer_load_dwordx4 v[126:129], v133, s[40:43], s89 offen offset:2048 sc1
    s_add_u32 s89, s87, 0x1000
    buffer_load_dwordx4 v[74:77], v134, s[40:43], s89 offen offset:3072 sc1
    buffer_load_dwordx4 v[78:81], v133, s[40:43], s89 offen offset:3072 sc1
    s_add_u32 s89, s87, 0x2000
    buffer_load_dwordx4 v[82:85], v134, s[40:43], s89 offen offset:0 sc1
    buffer_load_dwordx4 v[86:89], v133, s[40:43], s89 offen offset:0 sc1
    s_add_u32 s89, s87, 0x2000
    buffer_load_dwordx4 v[90:93], v134, s[40:43], s89 offen offset:1024 sc1
    buffer_load_dwordx4 v[94:97], v133, s[40:43], s89 offen offset:1024 sc1
    s_add_u32 s89, s87, 0x2000
    buffer_load_dwordx4 v[98:101], v134, s[40:43], s89 offen offset:2048 sc1
    buffer_load_dwordx4 v[102:105], v133, s[40:43], s89 offen offset:2048 sc1
    s_waitcnt vmcnt(10)
    v_max3_u32 v131, v115, v117, v119
    v_max_u32 v131, v131, v121
    v_cmp_eq_u32 vcc, -1, v131
    s_cbranch_vccnz Lrt_p5_413
    s_branch Lbk_p5_414
Lrt_p5_415:
    s_cmp_eq_u32 s84, 0
    s_cbranch_scc1 Lbk_p5_416
    s_sub_u32 s84, s84, 1
    s_nop 4
    s_add_u32 s89, s87, 0x1000
    buffer_load_dwordx4 v[122:125], v134, s[40:43], s89 offen offset:2048 sc1
    buffer_load_dwordx4 v[126:129], v133, s[40:43], s89 offen offset:2048 sc1
    s_add_u32 s89, s87, 0x1000
    buffer_load_dwordx4 v[74:77], v134, s[40:43], s89 offen offset:3072 sc1
    buffer_load_dwordx4 v[78:81], v133, s[40:43], s89 offen offset:3072 sc1
    s_add_u32 s89, s87, 0x2000
    buffer_load_dwordx4 v[82:85], v134, s[40:43], s89 offen offset:0 sc1
    buffer_load_dwordx4 v[86:89], v133, s[40:43], s89 offen offset:0 sc1
    s_add_u32 s89, s87, 0x2000
    buffer_load_dwordx4 v[90:93], v134, s[40:43], s89 offen offset:1024 sc1
    buffer_load_dwordx4 v[94:97], v133, s[40:43], s89 offen offset:1024 sc1
    s_add_u32 s89, s87, 0x2000
    buffer_load_dwordx4 v[98:101], v134, s[40:43], s89 offen offset:2048 sc1
    buffer_load_dwordx4 v[102:105], v133, s[40:43], s89 offen offset:2048 sc1
    s_add_u32 s89, s87, 0x2000
    buffer_load_dwordx4 v[106:109], v134, s[40:43], s89 offen offset:3072 sc1
    buffer_load_dwordx4 v[110:113], v133, s[40:43], s89 offen offset:3072 sc1
    s_waitcnt vmcnt(10)
    v_max3_u32 v131, v123, v125, v127
    v_max_u32 v131, v131, v129
    v_cmp_eq_u32 vcc, -1, v131
    s_cbranch_vccnz Lrt_p5_415
    s_branch Lbk_p5_416
Lrt_p5_417:
    s_cmp_eq_u32 s84, 0
    s_cbranch_scc1 Lbk_p5_418
    s_sub_u32 s84, s84, 1
    s_nop 4
    s_add_u32 s89, s87, 0x1000
    buffer_load_dwordx4 v[74:77], v134, s[40:43], s89 offen offset:3072 sc1
    buffer_load_dwordx4 v[78:81], v133, s[40:43], s89 offen offset:3072 sc1
    s_add_u32 s89, s87, 0x2000
    buffer_load_dwordx4 v[82:85], v134, s[40:43], s89 offen offset:0 sc1
    buffer_load_dwordx4 v[86:89], v133, s[40:43], s89 offen offset:0 sc1
    s_add_u32 s89, s87, 0x2000
    buffer_load_dwordx4 v[90:93], v134, s[40:43], s89 offen offset:1024 sc1
    buffer_load_dwordx4 v[94:97], v133, s[40:43], s89 offen offset:1024 sc1
    s_add_u32 s89, s87, 0x2000
    buffer_load_dwordx4 v[98:101], v134, s[40:43], s89 offen offset:2048 sc1
    buffer_load_dwordx4 v[102:105], v133, s[40:43], s89 offen offset:2048 sc1
    s_add_u32 s89, s87, 0x2000
    buffer_load_dwordx4 v[106:109], v134, s[40:43], s89 offen offset:3072 sc1
    buffer_load_dwordx4 v[110:113], v133, s[40:43], s89 offen offset:3072 sc1
    s_add_u32 s89, s87, 0x3000
    buffer_load_dwordx4 v[114:117], v134, s[40:43], s89 offen offset:0 sc1
    buffer_load_dwordx4 v[118:121], v133, s[40:43], s89 offen offset:0 sc1
    s_waitcnt vmcnt(10)
    v_max3_u32 v131, v75, v77, v79
    v_max_u32 v131, v131, v81
    v_cmp_eq_u32 vcc, -1, v131
    s_cbranch_vccnz Lrt_p5_417
    s_branch Lbk_p5_418
Lrt_p5_419:
    s_cmp_eq_u32 s84, 0
    s_cbranch_scc1 Lbk_p5_420
    s_sub_u32 s84, s84, 1
    s_nop 4
    s_add_u32 s89, s87, 0x2000
    buffer_load_dwordx4 v[82:85], v134, s[40:43], s89 offen offset:0 sc1
    buffer_load_dwordx4 v[86:89], v133, s[40:43], s89 offen offset:0 sc1
    s_add_u32 s89, s87, 0x2000
    buffer_load_dwordx4 v[90:93], v134, s[40:43], s89 offen offset:1024 sc1
    buffer_load_dwordx4 v[94:97], v133, s[40:43], s89 offen offset:1024 sc1
    s_add_u32 s89, s87, 0x2000
    buffer_load_dwordx4 v[98:101], v134, s[40:43], s89 offen offset:2048 sc1
    buffer_load_dwordx4 v[102:105], v133, s[40:43], s89 offen offset:2048 sc1
    s_add_u32 s89, s87, 0x2000
    buffer_load_dwordx4 v[106:109], v134, s[40:43], s89 offen offset:3072 sc1
    buffer_load_dwordx4 v[110:113], v133, s[40:43], s89 offen offset:3072 sc1
    s_add_u32 s89, s87, 0x3000
    buffer_load_dwordx4 v[114:117], v134, s[40:43], s89 offen offset:0 sc1
    buffer_load_dwordx4 v[118:121], v133, s[40:43], s89 offen offset:0 sc1
    s_add_u32 s89, s87, 0x3000
    buffer_load_dwordx4 v[122:125], v134, s[40:43], s89 offen offset:1024 sc1
    buffer_load_dwordx4 v[126:129], v133, s[40:43], s89 offen offset:1024 sc1
    s_waitcnt vmcnt(10)
    v_max3_u32 v131, v83, v85, v87
    v_max_u32 v131, v131, v89
    v_cmp_eq_u32 vcc, -1, v131
    s_cbranch_vccnz Lrt_p5_419
    s_branch Lbk_p5_420
Lrt_p5_421:
    s_cmp_eq_u32 s84, 0
    s_cbranch_scc1 Lbk_p5_422
    s_sub_u32 s84, s84, 1
    s_nop 4
    s_add_u32 s89, s87, 0x2000
    buffer_load_dwordx4 v[90:93], v134, s[40:43], s89 offen offset:1024 sc1
    buffer_load_dwordx4 v[94:97], v133, s[40:43], s89 offen offset:1024 sc1
    s_add_u32 s89, s87, 0x2000
    buffer_load_dwordx4 v[98:101], v134, s[40:43], s89 offen offset:2048 sc1
    buffer_load_dwordx4 v[102:105], v133, s[40:43], s89 offen offset:2048 sc1
    s_add_u32 s89, s87, 0x2000
    buffer_load_dwordx4 v[106:109], v134, s[40:43], s89 offen offset:3072 sc1
    buffer_load_dwordx4 v[110:113], v133, s[40:43], s89 offen offset:3072 sc1
    s_add_u32 s89, s87, 0x3000
    buffer_load_dwordx4 v[114:117], v134, s[40:43], s89 offen offset:0 sc1
    buffer_load_dwordx4 v[118:121], v133, s[40:43], s89 offen offset:0 sc1
    s_add_u32 s89, s87, 0x3000
    buffer_load_dwordx4 v[122:125], v134, s[40:43], s89 offen offset:1024 sc1
    buffer_load_dwordx4 v[126:129], v133, s[40:43], s89 offen offset:1024 sc1
    s_add_u32 s89, s87, 0x3000
    buffer_load_dwordx4 v[74:77], v134, s[40:43], s89 offen offset:2048 sc1
    buffer_load_dwordx4 v[78:81], v133, s[40:43], s89 offen offset:2048 sc1
    s_waitcnt vmcnt(10)
    v_max3_u32 v131, v91, v93, v95
    v_max_u32 v131, v131, v97
    v_cmp_eq_u32 vcc, -1, v131
    s_cbranch_vccnz Lrt_p5_421
    s_branch Lbk_p5_422
Lrt_p5_423:
    s_cmp_eq_u32 s84, 0
    s_cbranch_scc1 Lbk_p5_424
    s_sub_u32 s84, s84, 1
    s_nop 4
    s_add_u32 s89, s87, 0x2000
    buffer_load_dwordx4 v[98:101], v134, s[40:43], s89 offen offset:2048 sc1
    buffer_load_dwordx4 v[102:105], v133, s[40:43], s89 offen offset:2048 sc1
    s_add_u32 s89, s87, 0x2000
    buffer_load_dwordx4 v[106:109], v134, s[40:43], s89 offen offset:3072 sc1
    buffer_load_dwordx4 v[110:113], v133, s[40:43], s89 offen offset:3072 sc1
    s_add_u32 s89, s87, 0x3000
    buffer_load_dwordx4 v[114:117], v134, s[40:43], s89 offen offset:0 sc1
    buffer_load_dwordx4 v[118:121], v133, s[40:43], s89 offen offset:0 sc1
    s_add_u32 s89, s87, 0x3000
    buffer_load_dwordx4 v[122:125], v134, s[40:43], s89 offen offset:1024 sc1
    buffer_load_dwordx4 v[126:129], v133, s[40:43], s89 offen offset:1024 sc1
    s_add_u32 s89, s87, 0x3000
    buffer_load_dwordx4 v[74:77], v134, s[40:43], s89 offen offset:2048 sc1
    buffer_load_dwordx4 v[78:81], v133, s[40:43], s89 offen offset:2048 sc1
    s_add_u32 s89, s87, 0x3000
    buffer_load_dwordx4 v[82:85], v134, s[40:43], s89 offen offset:3072 sc1
    buffer_load_dwordx4 v[86:89], v133, s[40:43], s89 offen offset:3072 sc1
    s_waitcnt vmcnt(10)
    v_max3_u32 v131, v99, v101, v103
    v_max_u32 v131, v131, v105
    v_cmp_eq_u32 vcc, -1, v131
    s_cbranch_vccnz Lrt_p5_423
    s_branch Lbk_p5_424
Lrt_p5_425:
    s_cmp_eq_u32 s84, 0
    s_cbranch_scc1 Lbk_p5_426
    s_sub_u32 s84, s84, 1
    s_nop 4
    s_add_u32 s89, s87, 0x2000
    buffer_load_dwordx4 v[106:109], v134, s[40:43], s89 offen offset:3072 sc1
    buffer_load_dwordx4 v[110:113], v133, s[40:43], s89 offen offset:3072 sc1
    s_add_u32 s89, s87, 0x3000
    buffer_load_dwordx4 v[114:117], v134, s[40:43], s89 offen offset:0 sc1
    buffer_load_dwordx4 v[118:121], v133, s[40:43], s89 offen offset:0 sc1
    s_add_u32 s89, s87, 0x3000
    buffer_load_dwordx4 v[122:125], v134, s[40:43], s89 offen offset:1024 sc1
    buffer_load_dwordx4 v[126:129], v133, s[40:43], s89 offen offset:1024 sc1
    s_add_u32 s89, s87, 0x3000
    buffer_load_dwordx4 v[74:77], v134, s[40:43], s89 offen offset:2048 sc1
    buffer_load_dwordx4 v[78:81], v133, s[40:43], s89 offen offset:2048 sc1
    s_add_u32 s89, s87, 0x3000
    buffer_load_dwordx4 v[82:85], v134, s[40:43], s89 offen offset:3072 sc1
    buffer_load_dwordx4 v[86:89], v133, s[40:43], s89 offen offset:3072 sc1
    s_add_u32 s89, s87, 0x4000
    buffer_load_dwordx4 v[90:93], v134, s[40:43], s89 offen offset:0 sc1
    buffer_load_dwordx4 v[94:97], v133, s[40:43], s89 offen offset:0 sc1
    s_waitcnt vmcnt(10)
    v_max3_u32 v131, v107, v109, v111
    v_max_u32 v131, v131, v113
    v_cmp_eq_u32 vcc, -1, v131
    s_cbranch_vccnz Lrt_p5_425
    s_branch Lbk_p5_426
Lrt_p5_427:
    s_cmp_eq_u32 s84, 0
    s_cbranch_scc1 Lbk_p5_428
    s_sub_u32 s84, s84, 1
    s_nop 4
    s_add_u32 s89, s87, 0x3000
    buffer_load_dwordx4 v[114:117], v134, s[40:43], s89 offen offset:0 sc1
    buffer_load_dwordx4 v[118:121], v133, s[40:43], s89 offen offset:0 sc1
    s_add_u32 s89, s87, 0x3000
    buffer_load_dwordx4 v[122:125], v134, s[40:43], s89 offen offset:1024 sc1
    buffer_load_dwordx4 v[126:129], v133, s[40:43], s89 offen offset:1024 sc1
    s_add_u32 s89, s87, 0x3000
    buffer_load_dwordx4 v[74:77], v134, s[40:43], s89 offen offset:2048 sc1
    buffer_load_dwordx4 v[78:81], v133, s[40:43], s89 offen offset:2048 sc1
    s_add_u32 s89, s87, 0x3000
    buffer_load_dwordx4 v[82:85], v134, s[40:43], s89 offen offset:3072 sc1
    buffer_load_dwordx4 v[86:89], v133, s[40:43], s89 offen offset:3072 sc1
    s_add_u32 s89, s87, 0x4000
    buffer_load_dwordx4 v[90:93], v134, s[40:43], s89 offen offset:0 sc1
    buffer_load_dwordx4 v[94:97], v133, s[40:43], s89 offen offset:0 sc1
    s_add_u32 s89, s87, 0x4000
    buffer_load_dwordx4 v[98:101], v134, s[40:43], s89 offen offset:1024 sc1
    buffer_load_dwordx4 v[102:105], v133, s[40:43], s89 offen offset:1024 sc1
    s_waitcnt vmcnt(10)
    v_max3_u32 v131, v115, v117, v119
    v_max_u32 v131, v131, v121
    v_cmp_eq_u32 vcc, -1, v131
    s_cbranch_vccnz Lrt_p5_427
    s_branch Lbk_p5_428
Lrt_p5_429:
    s_cmp_eq_u32 s84, 0
    s_cbranch_scc1 Lbk_p5_430
    s_sub_u32 s84, s84, 1
    s_nop 4
    s_add_u32 s89, s87, 0x3000
    buffer_load_dwordx4 v[122:125], v134, s[40:43], s89 offen offset:1024 sc1
    buffer_load_dwordx4 v[126:129], v133, s[40:43], s89 offen offset:1024 sc1
    s_add_u32 s89, s87, 0x3000
    buffer_load_dwordx4 v[74:77], v134, s[40:43], s89 offen offset:2048 sc1
    buffer_load_dwordx4 v[78:81], v133, s[40:43], s89 offen offset:2048 sc1
    s_add_u32 s89, s87, 0x3000
    buffer_load_dwordx4 v[82:85], v134, s[40:43], s89 offen offset:3072 sc1
    buffer_load_dwordx4 v[86:89], v133, s[40:43], s89 offen offset:3072 sc1
    s_add_u32 s89, s87, 0x4000
    buffer_load_dwordx4 v[90:93], v134, s[40:43], s89 offen offset:0 sc1
    buffer_load_dwordx4 v[94:97], v133, s[40:43], s89 offen offset:0 sc1
    s_add_u32 s89, s87, 0x4000
    buffer_load_dwordx4 v[98:101], v134, s[40:43], s89 offen offset:1024 sc1
    buffer_load_dwordx4 v[102:105], v133, s[40:43], s89 offen offset:1024 sc1
    s_add_u32 s89, s87, 0x4000
    buffer_load_dwordx4 v[106:109], v134, s[40:43], s89 offen offset:2048 sc1
    buffer_load_dwordx4 v[110:113], v133, s[40:43], s89 offen offset:2048 sc1
    s_waitcnt vmcnt(10)
    v_max3_u32 v131, v123, v125, v127
    v_max_u32 v131, v131, v129
    v_cmp_eq_u32 vcc, -1, v131
    s_cbranch_vccnz Lrt_p5_429
    s_branch Lbk_p5_430
Lrt_p5_431:
    s_cmp_eq_u32 s84, 0
    s_cbranch_scc1 Lbk_p5_432
    s_sub_u32 s84, s84, 1
    s_nop 4
    s_add_u32 s89, s87, 0x3000
    buffer_load_dwordx4 v[74:77], v134, s[40:43], s89 offen offset:2048 sc1
    buffer_load_dwordx4 v[78:81], v133, s[40:43], s89 offen offset:2048 sc1
    s_add_u32 s89, s87, 0x3000
    buffer_load_dwordx4 v[82:85], v134, s[40:43], s89 offen offset:3072 sc1
    buffer_load_dwordx4 v[86:89], v133, s[40:43], s89 offen offset:3072 sc1
    s_add_u32 s89, s87, 0x4000
    buffer_load_dwordx4 v[90:93], v134, s[40:43], s89 offen offset:0 sc1
    buffer_load_dwordx4 v[94:97], v133, s[40:43], s89 offen offset:0 sc1
    s_add_u32 s89, s87, 0x4000
    buffer_load_dwordx4 v[98:101], v134, s[40:43], s89 offen offset:1024 sc1
    buffer_load_dwordx4 v[102:105], v133, s[40:43], s89 offen offset:1024 sc1
    s_add_u32 s89, s87, 0x4000
    buffer_load_dwordx4 v[106:109], v134, s[40:43], s89 offen offset:2048 sc1
    buffer_load_dwordx4 v[110:113], v133, s[40:43], s89 offen offset:2048 sc1
    s_add_u32 s89, s87, 0x4000
    buffer_load_dwordx4 v[114:117], v134, s[40:43], s89 offen offset:3072 sc1
    buffer_load_dwordx4 v[118:121], v133, s[40:43], s89 offen offset:3072 sc1
    s_waitcnt vmcnt(10)
    v_max3_u32 v131, v75, v77, v79
    v_max_u32 v131, v131, v81
    v_cmp_eq_u32 vcc, -1, v131
    s_cbranch_vccnz Lrt_p5_431
    s_branch Lbk_p5_432
Lrt_p5_433:
    s_cmp_eq_u32 s84, 0
    s_cbranch_scc1 Lbk_p5_434
    s_sub_u32 s84, s84, 1
    s_nop 4
    s_add_u32 s89, s87, 0x3000
    buffer_load_dwordx4 v[82:85], v134, s[40:43], s89 offen offset:3072 sc1
    buffer_load_dwordx4 v[86:89], v133, s[40:43], s89 offen offset:3072 sc1
    s_add_u32 s89, s87, 0x4000
    buffer_load_dwordx4 v[90:93], v134, s[40:43], s89 offen offset:0 sc1
    buffer_load_dwordx4 v[94:97], v133, s[40:43], s89 offen offset:0 sc1
    s_add_u32 s89, s87, 0x4000
    buffer_load_dwordx4 v[98:101], v134, s[40:43], s89 offen offset:1024 sc1
    buffer_load_dwordx4 v[102:105], v133, s[40:43], s89 offen offset:1024 sc1
    s_add_u32 s89, s87, 0x4000
    buffer_load_dwordx4 v[106:109], v134, s[40:43], s89 offen offset:2048 sc1
    buffer_load_dwordx4 v[110:113], v133, s[40:43], s89 offen offset:2048 sc1
    s_add_u32 s89, s87, 0x4000
    buffer_load_dwordx4 v[114:117], v134, s[40:43], s89 offen offset:3072 sc1
    buffer_load_dwordx4 v[118:121], v133, s[40:43], s89 offen offset:3072 sc1
    s_add_u32 s89, s88, 20
    s_min_u32 s89, s89, 85
    s_lshl_b32 s89, s89, 10
    s_add_u32 s89, s89, s86
    buffer_load_dwordx4 v[122:125], v134, s[40:43], s89 offen offset:0 sc1
    buffer_load_dwordx4 v[126:129], v133, s[40:43], s89 offen offset:0 sc1
    s_waitcnt vmcnt(10)
    v_max3_u32 v131, v83, v85, v87
    v_max_u32 v131, v131, v89
    v_cmp_eq_u32 vcc, -1, v131
    s_cbranch_vccnz Lrt_p5_433
    s_branch Lbk_p5_434
Lrt_p5_435:
    s_cmp_eq_u32 s84, 0
    s_cbranch_scc1 Lbk_p5_436
    s_sub_u32 s84, s84, 1
    s_nop 4
    s_add_u32 s89, s87, 0x4000
    buffer_load_dwordx4 v[90:93], v134, s[40:43], s89 offen offset:0 sc1
    buffer_load_dwordx4 v[94:97], v133, s[40:43], s89 offen offset:0 sc1
    s_add_u32 s89, s87, 0x4000
    buffer_load_dwordx4 v[98:101], v134, s[40:43], s89 offen offset:1024 sc1
    buffer_load_dwordx4 v[102:105], v133, s[40:43], s89 offen offset:1024 sc1
    s_add_u32 s89, s87, 0x4000
    buffer_load_dwordx4 v[106:109], v134, s[40:43], s89 offen offset:2048 sc1
    buffer_load_dwordx4 v[110:113], v133, s[40:43], s89 offen offset:2048 sc1
    s_add_u32 s89, s87, 0x4000
    buffer_load_dwordx4 v[114:117], v134, s[40:43], s89 offen offset:3072 sc1
    buffer_load_dwordx4 v[118:121], v133, s[40:43], s89 offen offset:3072 sc1
    s_add_u32 s89, s88, 20
    s_min_u32 s89, s89, 85
    s_lshl_b32 s89, s89, 10
    s_add_u32 s89, s89, s86
    buffer_load_dwordx4 v[122:125], v134, s[40:43], s89 offen offset:0 sc1
    buffer_load_dwordx4 v[126:129], v133, s[40:43], s89 offen offset:0 sc1
    s_add_u32 s89, s88, 21
    s_min_u32 s89, s89, 85
    s_lshl_b32 s89, s89, 10
    s_add_u32 s89, s89, s86
    buffer_load_dwordx4 v[74:77], v134, s[40:43], s89 offen offset:0 sc1
    buffer_load_dwordx4 v[78:81], v133, s[40:43], s89 offen offset:0 sc1
    s_waitcnt vmcnt(10)
    v_max3_u32 v131, v91, v93, v95
    v_max_u32 v131, v131, v97
    v_cmp_eq_u32 vcc, -1, v131
    s_cbranch_vccnz Lrt_p5_435
    s_branch Lbk_p5_436
Lrt_p5_437:
    s_cmp_eq_u32 s84, 0
    s_cbranch_scc1 Lbk_p5_438
    s_sub_u32 s84, s84, 1
    s_nop 4
    s_add_u32 s89, s87, 0x4000
    buffer_load_dwordx4 v[98:101], v134, s[40:43], s89 offen offset:1024 sc1
    buffer_load_dwordx4 v[102:105], v133, s[40:43], s89 offen offset:1024 sc1
    s_add_u32 s89, s87, 0x4000
    buffer_load_dwordx4 v[106:109], v134, s[40:43], s89 offen offset:2048 sc1
    buffer_load_dwordx4 v[110:113], v133, s[40:43], s89 offen offset:2048 sc1
    s_add_u32 s89, s87, 0x4000
    buffer_load_dwordx4 v[114:117], v134, s[40:43], s89 offen offset:3072 sc1
    buffer_load_dwordx4 v[118:121], v133, s[40:43], s89 offen offset:3072 sc1
    s_add_u32 s89, s88, 20
    s_min_u32 s89, s89, 85
    s_lshl_b32 s89, s89, 10
    s_add_u32 s89, s89, s86
    buffer_load_dwordx4 v[122:125], v134, s[40:43], s89 offen offset:0 sc1
    buffer_load_dwordx4 v[126:129], v133, s[40:43], s89 offen offset:0 sc1
    s_add_u32 s89, s88, 21
    s_min_u32 s89, s89, 85
    s_lshl_b32 s89, s89, 10
    s_add_u32 s89, s89, s86
    buffer_load_dwordx4 v[74:77], v134, s[40:43], s89 offen offset:0 sc1
    buffer_load_dwordx4 v[78:81], v133, s[40:43], s89 offen offset:0 sc1
    s_waitcnt vmcnt(8)
    v_max3_u32 v131, v99, v101, v103
    v_max_u32 v131, v131, v105
    v_cmp_eq_u32 vcc, -1, v131
    s_cbranch_vccnz Lrt_p5_437
    s_branch Lbk_p5_438
Lrt_p5_439:
    s_cmp_eq_u32 s84, 0
    s_cbranch_scc1 Lbk_p5_440
    s_sub_u32 s84, s84, 1
    s_nop 4
    s_add_u32 s89, s87, 0x4000
    buffer_load_dwordx4 v[106:109], v134, s[40:43], s89 offen offset:2048 sc1
    buffer_load_dwordx4 v[110:113], v133, s[40:43], s89 offen offset:2048 sc1
    s_add_u32 s89, s87, 0x4000
    buffer_load_dwordx4 v[114:117], v134, s[40:43], s89 offen offset:3072 sc1
    buffer_load_dwordx4 v[118:121], v133, s[40:43], s89 offen offset:3072 sc1
    s_add_u32 s89, s88, 20
    s_min_u32 s89, s89, 85
    s_lshl_b32 s89, s89, 10
    s_add_u32 s89, s89, s86
    buffer_load_dwordx4 v[122:125], v134, s[40:43], s89 offen offset:0 sc1
    buffer_load_dwordx4 v[126:129], v133, s[40:43], s89 offen offset:0 sc1
    s_add_u32 s89, s88, 21
    s_min_u32 s89, s89, 85
    s_lshl_b32 s89, s89, 10
    s_add_u32 s89, s89, s86
    buffer_load_dwordx4 v[74:77], v134, s[40:43], s89 offen offset:0 sc1
    buffer_load_dwordx4 v[78:81], v133, s[40:43], s89 offen offset:0 sc1
    s_waitcnt vmcnt(6)
    v_max3_u32 v131, v107, v109, v111
    v_max_u32 v131, v131, v113
    v_cmp_eq_u32 vcc, -1, v131
    s_cbranch_vccnz Lrt_p5_439
    s_branch Lbk_p5_440
Lrt_p5_441:
    s_cmp_eq_u32 s84, 0
    s_cbranch_scc1 Lbk_p5_442
    s_sub_u32 s84, s84, 1
    s_nop 4
    s_add_u32 s89, s87, 0x4000
    buffer_load_dwordx4 v[114:117], v134, s[40:43], s89 offen offset:3072 sc1
    buffer_load_dwordx4 v[118:121], v133, s[40:43], s89 offen offset:3072 sc1
    s_add_u32 s89, s88, 20
    s_min_u32 s89, s89, 85
    s_lshl_b32 s89, s89, 10
    s_add_u32 s89, s89, s86
    buffer_load_dwordx4 v[122:125], v134, s[40:43], s89 offen offset:0 sc1
    buffer_load_dwordx4 v[126:129], v133, s[40:43], s89 offen offset:0 sc1
    s_add_u32 s89, s88, 21
    s_min_u32 s89, s89, 85
    s_lshl_b32 s89, s89, 10
    s_add_u32 s89, s89, s86
    buffer_load_dwordx4 v[74:77], v134, s[40:43], s89 offen offset:0 sc1
    buffer_load_dwordx4 v[78:81], v133, s[40:43], s89 offen offset:0 sc1
    s_waitcnt vmcnt(4)
    v_max3_u32 v131, v115, v117, v119
    v_max_u32 v131, v131, v121
    v_cmp_eq_u32 vcc, -1, v131
    s_cbranch_vccnz Lrt_p5_441
    s_branch Lbk_p5_442
Lrt_p5_443:
    s_cmp_eq_u32 s84, 0
    s_cbranch_scc1 Lbk_p5_444
    s_sub_u32 s84, s84, 1
    s_nop 4
    s_add_u32 s89, s88, 20
    s_min_u32 s89, s89, 85
    s_lshl_b32 s89, s89, 10
    s_add_u32 s89, s89, s86
    buffer_load_dwordx4 v[122:125], v134, s[40:43], s89 offen offset:0 sc1
    buffer_load_dwordx4 v[126:129], v133, s[40:43], s89 offen offset:0 sc1
    s_add_u32 s89, s88, 21
    s_min_u32 s89, s89, 85
    s_lshl_b32 s89, s89, 10
    s_add_u32 s89, s89, s86
    buffer_load_dwordx4 v[74:77], v134, s[40:43], s89 offen offset:0 sc1
    buffer_load_dwordx4 v[78:81], v133, s[40:43], s89 offen offset:0 sc1
    s_waitcnt vmcnt(2)
    v_max3_u32 v131, v123, v125, v127
    v_max_u32 v131, v131, v129
    v_cmp_eq_u32 vcc, -1, v131
    s_cbranch_vccnz Lrt_p5_443
    s_branch Lbk_p5_444
Lrt_p5_445:
    s_cmp_eq_u32 s84, 0
    s_cbranch_scc1 Lbk_p5_446
    s_sub_u32 s84, s84, 1
    s_nop 4
    s_add_u32 s89, s88, 21
    s_min_u32 s89, s89, 85
    s_lshl_b32 s89, s89, 10
    s_add_u32 s89, s89, s86
    buffer_load_dwordx4 v[74:77], v134, s[40:43], s89 offen offset:0 sc1
    buffer_load_dwordx4 v[78:81], v133, s[40:43], s89 offen offset:0 sc1
    s_waitcnt vmcnt(0)
    v_max3_u32 v131, v75, v77, v79
    v_max_u32 v131, v131, v81
    v_cmp_eq_u32 vcc, -1, v131
    s_cbranch_vccnz Lrt_p5_445
    s_branch Lbk_p5_446
L_WARM_END:
La1s_32:
    s_cmp_eq_u32 s83, 1
    s_cbranch_scc1 La1s_33
    s_cmp_eq_u32 s83, 2
    s_cbranch_scc1 La1s_34
    s_cmp_eq_u32 s83, 3
    s_cbranch_scc1 La1s_35
    s_cmp_eq_u32 s83, 4
    s_cbranch_scc1 La1s_36
    s_cmp_eq_u32 s83, 5
    s_cbranch_scc1 La1s_37
    s_cmp_eq_u32 s83, 6
    s_cbranch_scc1 La1s_38
    s_cmp_eq_u32 s83, 7
    s_cbranch_scc1 La1s_39
    s_cmp_eq_u32 s83, 8
    s_cbranch_scc1 La1s_40
    s_branch La1s_40
La1s_33:
    v_mfma_f32_32x32x16_bf16 v[34:49], v[70:73], v[10:13], 0
    v_mfma_f32_32x32x16_bf16 v[50:65], v[74:77], v[10:13], 0
    s_nop 7
    s_nop 1
    s_branch La1b_42
La1s_34:
    v_mfma_f32_32x32x16_bf16 v[50:65], v[74:77], v[10:13], 0
    v_mfma_f32_32x32x16_bf16 v[18:33], v[78:81], v[10:13], 0
    s_nop 7
    s_nop 1
    s_branch La1b_43
La1s_35:
    v_mfma_f32_32x32x16_bf16 v[18:33], v[78:81], v[10:13], 0
    v_mfma_f32_32x32x16_bf16 v[34:49], v[82:85], v[10:13], 0
    s_nop 7
    s_nop 1
    s_branch La1b_44
La1s_36:
    v_mfma_f32_32x32x16_bf16 v[34:49], v[82:85], v[10:13], 0
    v_mfma_f32_32x32x16_bf16 v[50:65], v[86:89], v[10:13], 0
    s_nop 7
    s_nop 1
    s_branch La1b_45
La1s_37:
    v_mfma_f32_32x32x16_bf16 v[50:65], v[86:89], v[10:13], 0
    v_mfma_f32_32x32x16_bf16 v[18:33], v[90:93], v[10:13], 0
    s_nop 7
    s_nop 1
    s_branch La1b_46
La1s_38:
    v_mfma_f32_32x32x16_bf16 v[18:33], v[90:93], v[10:13], 0
    v_mfma_f32_32x32x16_bf16 v[34:49], v[94:97], v[10:13], 0
    s_nop 7
    s_nop 1
    s_branch La1b_47
La1s_39:
    v_mfma_f32_32x32x16_bf16 v[34:49], v[94:97], v[10:13], 0
    v_mfma_f32_32x32x16_bf16 v[50:65], v[98:101], v[10:13], 0
    s_nop 7
    s_nop 1
    s_branch La1b_48
La1s_40:
    v_mfma_f32_32x32x16_bf16 v[50:65], v[98:101], v[10:13], 0
    s_nop 7
    s_nop 1
    s_branch La1b_49
La2s_50:
    s_cmp_eq_u32 s83, 1
    s_cbranch_scc1 La2s_51
    s_cmp_eq_u32 s83, 2
    s_cbranch_scc1 La2s_52
    s_cmp_eq_u32 s83, 3
    s_cbranch_scc1 La2s_53
    s_cmp_eq_u32 s83, 4
    s_cbranch_scc1 La2s_54
    s_cmp_eq_u32 s83, 5
    s_cbranch_scc1 La2s_55
    s_cmp_eq_u32 s83, 6
    s_cbranch_scc1 La2s_56
    s_cmp_eq_u32 s83, 7
    s_cbranch_scc1 La2s_57
    s_cmp_eq_u32 s83, 8
    s_cbranch_scc1 La2s_58
    s_branch La2s_58
La2s_51:
    v_mov_b32 v50, 0
    v_mov_b32 v51, 0
    v_mov_b32 v52, 0
    v_mov_b32 v53, 0
    v_mov_b32 v54, 0
    v_mov_b32 v55, 0
    v_mov_b32 v56, 0
    v_mov_b32 v57, 0
    v_mov_b32 v58, 0
    v_mov_b32 v59, 0
    v_mov_b32 v60, 0
    v_mov_b32 v61, 0
    v_mov_b32 v62, 0
    v_mov_b32 v63, 0
    v_mov_b32 v64, 0
    v_mov_b32 v65, 0
    ds_read_b128 v[94:97], v120 offset:1152
    ds_read_b128 v[90:93], v120 offset:2304
    ds_read_b64_tr_b16 v[106:107], v121 offset:0
    ds_read_b64_tr_b16 v[108:109], v121 offset:128
    ds_read_b64_tr_b16 v[110:111], v121 offset:256
    ds_read_b64_tr_b16 v[112:113], v121 offset:384
    s_waitcnt lgkmcnt(5)
    v_mfma_f32_32x32x16_bf16 v[34:49], v[94:97], v[10:13], v[66:81]
    s_nop 7
    s_nop 3
    s_branch La2b_60
La2s_52:
    v_mov_b32 v50, 0
    v_mov_b32 v51, 0
    v_mov_b32 v52, 0
    v_mov_b32 v53, 0
    v_mov_b32 v54, 0
    v_mov_b32 v55, 0
    v_mov_b32 v56, 0
    v_mov_b32 v57, 0
    v_mov_b32 v58, 0
    v_mov_b32 v59, 0
    v_mov_b32 v60, 0
    v_mov_b32 v61, 0
    v_mov_b32 v62, 0
    v_mov_b32 v63, 0
    v_mov_b32 v64, 0
    v_mov_b32 v65, 0
    ds_read_b128 v[90:93], v120 offset:2304
    ds_read_b128 v[94:97], v120 offset:3456
    ds_read_b64_tr_b16 v[98:99], v121 offset:0
    ds_read_b64_tr_b16 v[100:101], v121 offset:128
    ds_read_b64_tr_b16 v[102:103], v121 offset:256
    ds_read_b64_tr_b16 v[104:105], v121 offset:384
    s_waitcnt lgkmcnt(5)
    v_mfma_f32_32x32x16_bf16 v[18:33], v[90:93], v[10:13], v[66:81]
    s_nop 7
    s_nop 3
    s_branch La2b_61
La2s_53:
    v_mov_b32 v50, 0
    v_mov_b32 v51, 0
    v_mov_b32 v52, 0
    v_mov_b32 v53, 0
    v_mov_b32 v54, 0
    v_mov_b32 v55, 0
    v_mov_b32 v56, 0
    v_mov_b32 v57, 0
    v_mov_b32 v58, 0
    v_mov_b32 v59, 0
    v_mov_b32 v60, 0
    v_mov_b32 v61, 0
    v_mov_b32 v62, 0
    v_mov_b32 v63, 0
    v_mov_b32 v64, 0
    v_mov_b32 v65, 0
    ds_read_b128 v[94:97], v120 offset:3456
    ds_read_b128 v[90:93], v120 offset:4608
    ds_read_b64_tr_b16 v[106:107], v121 offset:0
    ds_read_b64_tr_b16 v[108:109], v121 offset:128
    ds_read_b64_tr_b16 v[110:111], v121 offset:256
    ds_read_b64_tr_b16 v[112:113], v121 offset:384
    s_waitcnt lgkmcnt(5)
    v_mfma_f32_32x32x16_bf16 v[34:49], v[94:97], v[10:13], v[66:81]
    s_nop 7
    s_nop 3
    s_branch La2b_62
La2s_54:
    v_mov_b32 v50, 0
    v_mov_b32 v51, 0
    v_mov_b32 v52, 0
    v_mov_b32 v53, 0
    v_mov_b32 v54, 0
    v_mov_b32 v55, 0
    v_mov_b32 v56, 0
    v_mov_b32 v57, 0
    v_mov_b32 v58, 0
    v_mov_b32 v59, 0
    v_mov_b32 v60, 0
    v_mov_b32 v61, 0
    v_mov_b32 v62, 0
    v_mov_b32 v63, 0
    v_mov_b32 v64, 0
    v_mov_b32 v65, 0
    ds_read_b128 v[90:93], v120 offset:4608
    ds_read_b128 v[94:97], v120 offset:5760
    ds_read_b64_tr_b16 v[98:99], v121 offset:0
    ds_read_b64_tr_b16 v[100:101], v121 offset:128
    ds_read_b64_tr_b16 v[102:103], v121 offset:256
    ds_read_b64_tr_b16 v[104:105], v121 offset:384
    s_waitcnt lgkmcnt(5)
    v_mfma_f32_32x32x16_bf16 v[18:33], v[90:93], v[10:13], v[66:81]
    s_nop 7
    s_nop 3
    s_branch La2b_63
La2s_55:
    v_mov_b32 v50, 0
    v_mov_b32 v51, 0
    v_mov_b32 v52, 0
    v_mov_b32 v53, 0
    v_mov_b32 v54, 0
    v_mov_b32 v55, 0
    v_mov_b32 v56, 0
    v_mov_b32 v57, 0
    v_mov_b32 v58, 0
    v_mov_b32 v59, 0
    v_mov_b32 v60, 0
    v_mov_b32 v61, 0
    v_mov_b32 v62, 0
    v_mov_b32 v63, 0
    v_mov_b32 v64, 0
    v_mov_b32 v65, 0
    ds_read_b128 v[94:97], v120 offset:5760
    ds_read_b128 v[90:93], v120 offset:6912
    ds_read_b64_tr_b16 v[106:107], v121 offset:0
    ds_read_b64_tr_b16 v[108:109], v121 offset:128
    ds_read_b64_tr_b16 v[110:111], v121 offset:256
    ds_read_b64_tr_b16 v[112:113], v121 offset:384
    s_waitcnt lgkmcnt(5)
    v_mfma_f32_32x32x16_bf16 v[34:49], v[94:97], v[10:13], v[66:81]
    s_nop 7
    s_nop 3
    s_branch La2b_64
La2s_56:
    v_mov_b32 v50, 0
    v_mov_b32 v51, 0
    v_mov_b32 v52, 0
    v_mov_b32 v53, 0
    v_mov_b32 v54, 0
    v_mov_b32 v55, 0
    v_mov_b32 v56, 0
    v_mov_b32 v57, 0
    v_mov_b32 v58, 0
    v_mov_b32 v59, 0
    v_mov_b32 v60, 0
    v_mov_b32 v61, 0
    v_mov_b32 v62, 0
    v_mov_b32 v63, 0
    v_mov_b32 v64, 0
    v_mov_b32 v65, 0
    ds_read_b128 v[90:93], v120 offset:6912
    ds_read_b128 v[94:97], v120 offset:8064
    ds_read_b64_tr_b16 v[98:99], v121 offset:0
    ds_read_b64_tr_b16 v[100:101], v121 offset:128
    ds_read_b64_tr_b16 v[102:103], v121 offset:256
    ds_read_b64_tr_b16 v[104:105], v121 offset:384
    s_waitcnt lgkmcnt(5)
    v_mfma_f32_32x32x16_bf16 v[18:33], v[90:93], v[10:13], v[66:81]
    s_nop 7
    s_nop 3
    s_branch La2b_65
La2s_57:
    v_mov_b32 v50, 0
    v_mov_b32 v51, 0
    v_mov_b32 v52, 0
    v_mov_b32 v53, 0
    v_mov_b32 v54, 0
    v_mov_b32 v55, 0
    v_mov_b32 v56, 0
    v_mov_b32 v57, 0
    v_mov_b32 v58, 0
    v_mov_b32 v59, 0
    v_mov_b32 v60, 0
    v_mov_b32 v61, 0
    v_mov_b32 v62, 0
    v_mov_b32 v63, 0
    v_mov_b32 v64, 0
    v_mov_b32 v65, 0
    ds_read_b128 v[94:97], v120 offset:8064
    ds_read_b128 v[90:93], v120 offset:9216
    ds_read_b64_tr_b16 v[106:107], v121 offset:0
    ds_read_b64_tr_b16 v[108:109], v121 offset:128
    ds_read_b64_tr_b16 v[110:111], v121 offset:256
    ds_read_b64_tr_b16 v[112:113], v121 offset:384
    s_waitcnt lgkmcnt(5)
    v_mfma_f32_32x32x16_bf16 v[34:49], v[94:97], v[10:13], v[66:81]
    s_nop 7
    s_nop 3
    s_branch La2b_66
La2s_58:
    v_mov_b32 v50, 0
    v_mov_b32 v51, 0
    v_mov_b32 v52, 0
    v_mov_b32 v53, 0
    v_mov_b32 v54, 0
    v_mov_b32 v55, 0
    v_mov_b32 v56, 0
    v_mov_b32 v57, 0
    v_mov_b32 v58, 0
    v_mov_b32 v59, 0
    v_mov_b32 v60, 0
    v_mov_b32 v61, 0
    v_mov_b32 v62, 0
    v_mov_b32 v63, 0
    v_mov_b32 v64, 0
    v_mov_b32 v65, 0
    ds_read_b128 v[90:93], v120 offset:9216
    ds_read_b64_tr_b16 v[98:99], v121 offset:0
    ds_read_b64_tr_b16 v[100:101], v121 offset:128
    ds_read_b64_tr_b16 v[102:103], v121 offset:256
    ds_read_b64_tr_b16 v[104:105], v121 offset:384
    s_waitcnt lgkmcnt(4)
    v_mfma_f32_32x32x16_bf16 v[18:33], v[90:93], v[10:13], v[66:81]
    s_nop 7
    s_nop 3
    s_branch La2b_67
Lredo_30:
    s_nop 7
    ds_read_b128 v[66:69], v120 offset:0
    ds_read_b128 v[70:73], v120 offset:1152
    ds_read_b128 v[74:77], v120 offset:2304
    ds_read_b128 v[78:81], v120 offset:3456
    ds_read_b128 v[82:85], v120 offset:4608
    ds_read_b128 v[86:89], v120 offset:5760
    ds_read_b128 v[90:93], v120 offset:6912
    ds_read_b128 v[94:97], v120 offset:8064
    ds_read_b128 v[98:101], v120 offset:9216
    v_mov_b32 v114, v118
    v_mov_b32 v115, v118
    s_waitcnt lgkmcnt(0)
    s_cmp_lg_u32 s83, 0
    s_cbranch_scc1 La1s_32
    v_mfma_f32_32x32x16_bf16 v[18:33], v[66:69], v[10:13], 0
    v_mfma_f32_32x32x16_bf16 v[34:49], v[70:73], v[10:13], 0
    s_nop 7
    s_nop 1
La1b_41:
    v_mfma_f32_32x32x16_bf16 v[50:65], v[74:77], v[10:13], 0
    v_cndmask_b32 v18, v18, v118, s[44:45]
    v_cndmask_b32 v19, v19, v118, s[46:47]
    v_cndmask_b32 v20, v20, v118, s[48:49]
    v_cndmask_b32 v21, v21, v118, s[50:51]
    v_cndmask_b32 v22, v22, v118, s[52:53]
    v_cndmask_b32 v23, v23, v118, s[54:55]
    v_cndmask_b32 v24, v24, v118, s[56:57]
    v_cndmask_b32 v25, v25, v118, s[58:59]
    v_cndmask_b32 v26, v26, v118, s[60:61]
    v_cndmask_b32 v27, v27, v118, s[62:63]
    v_cndmask_b32 v28, v28, v118, s[64:65]
    v_cndmask_b32 v29, v29, v118, s[66:67]
    v_cndmask_b32 v30, v30, v118, s[68:69]
    v_cndmask_b32 v31, v31, v118, s[70:71]
    v_cndmask_b32 v32, v32, v118, s[72:73]
    v_cndmask_b32 v33, v33, v118, s[74:75]
    v_max3_f32 v114, v114, v18, v19
    v_max3_f32 v115, v115, v20, v21
    v_max3_f32 v114, v114, v22, v23
    v_max3_f32 v115, v115, v24, v25
    v_max3_f32 v114, v114, v26, v27
    v_max3_f32 v115, v115, v28, v29
    v_max3_f32 v114, v114, v30, v31
    v_max3_f32 v115, v115, v32, v33
La1b_42:
    v_mfma_f32_32x32x16_bf16 v[18:33], v[78:81], v[10:13], 0
    v_max3_f32 v114, v114, v34, v35
    v_max3_f32 v115, v115, v36, v37
    v_max3_f32 v114, v114, v38, v39
    v_max3_f32 v115, v115, v40, v41
    v_max3_f32 v114, v114, v42, v43
    v_max3_f32 v115, v115, v44, v45
    v_max3_f32 v114, v114, v46, v47
    v_max3_f32 v115, v115, v48, v49
La1b_43:
    v_mfma_f32_32x32x16_bf16 v[34:49], v[82:85], v[10:13], 0
    v_max3_f32 v114, v114, v50, v51
    v_max3_f32 v115, v115, v52, v53
    v_max3_f32 v114, v114, v54, v55
    v_max3_f32 v115, v115, v56, v57
    v_max3_f32 v114, v114, v58, v59
    v_max3_f32 v115, v115, v60, v61
    v_max3_f32 v114, v114, v62, v63
    v_max3_f32 v115, v115, v64, v65
La1b_44:
    v_mfma_f32_32x32x16_bf16 v[50:65], v[86:89], v[10:13], 0
    v_max3_f32 v114, v114, v18, v19
    v_max3_f32 v115, v115, v20, v21
    v_max3_f32 v114, v114, v22, v23
    v_max3_f32 v115, v115, v24, v25
    v_max3_f32 v114, v114, v26, v27
    v_max3_f32 v115, v115, v28, v29
    v_max3_f32 v114, v114, v30, v31
    v_max3_f32 v115, v115, v32, v33
La1b_45:
    v_mfma_f32_32x32x16_bf16 v[18:33], v[90:93], v[10:13], 0
    v_max3_f32 v114, v114, v34, v35
    v_max3_f32 v115, v115, v36, v37
    v_max3_f32 v114, v114, v38, v39
    v_max3_f32 v115, v115, v40, v41
    v_max3_f32 v114, v114, v42, v43
    v_max3_f32 v115, v115, v44, v45
    v_max3_f32 v114, v114, v46, v47
    v_max3_f32 v115, v115, v48, v49
La1b_46:
    v_mfma_f32_32x32x16_bf16 v[34:49], v[94:97], v[10:13], 0
    v_max3_f32 v114, v114, v50, v51
    v_max3_f32 v115, v115, v52, v53
    v_max3_f32 v114, v114, v54, v55
    v_max3_f32 v115, v115, v56, v57
    v_max3_f32 v114, v114, v58, v59
    v_max3_f32 v115, v115, v60, v61
    v_max3_f32 v114, v114, v62, v63
    v_max3_f32 v115, v115, v64, v65
La1b_47:
    v_mfma_f32_32x32x16_bf16 v[50:65], v[98:101], v[10:13], 0
    v_max3_f32 v114, v114, v18, v19
    v_max3_f32 v115, v115, v20, v21
    v_max3_f32 v114, v114, v22, v23
    v_max3_f32 v115, v115, v24, v25
    v_max3_f32 v114, v114, v26, v27
    v_max3_f32 v115, v115, v28, v29
    v_max3_f32 v114, v114, v30, v31
    v_max3_f32 v115, v115, v32, v33
La1b_48:
    v_max3_f32 v114, v114, v34, v35
    v_max3_f32 v115, v115, v36, v37
    v_max3_f32 v114, v114, v38, v39
    v_max3_f32 v115, v115, v40, v41
    v_max3_f32 v114, v114, v42, v43
    v_max3_f32 v115, v115, v44, v45
    v_max3_f32 v114, v114, v46, v47
    v_max3_f32 v115, v115, v48, v49
La1b_49:
    v_cndmask_b32 v50, v118, v50, s[44:45]
    v_cndmask_b32 v51, v118, v51, s[46:47]
    v_cndmask_b32 v52, v118, v52, s[48:49]
    v_cndmask_b32 v53, v118, v53, s[50:51]
    v_cndmask_b32 v54, v118, v54, s[52:53]
    v_cndmask_b32 v55, v118, v55, s[54:55]
    v_cndmask_b32 v56, v118, v56, s[56:57]
    v_cndmask_b32 v57, v118, v57, s[58:59]
    v_cndmask_b32 v58, v118, v58, s[60:61]
    v_cndmask_b32 v59, v118, v59, s[62:63]
    v_cndmask_b32 v60, v118, v60, s[64:65]
    v_cndmask_b32 v61, v118, v61, s[66:67]
    v_cndmask_b32 v62, v118, v62, s[68:69]
    v_cndmask_b32 v63, v118, v63, s[70:71]
    v_cndmask_b32 v64, v118, v64, s[72:73]
    v_cndmask_b32 v65, v118, v65, s[74:75]
    v_max3_f32 v114, v114, v50, v51
    v_max3_f32 v115, v115, v52, v53
    v_max3_f32 v114, v114, v54, v55
    v_max3_f32 v115, v115, v56, v57
    v_max3_f32 v114, v114, v58, v59
    v_max3_f32 v115, v115, v60, v61
    v_max3_f32 v114, v114, v62, v63
    v_max3_f32 v115, v115, v64, v65
    v_max_f32 v114, v114, v115
    v_mov_b32 v116, v114
    s_nop 1
    v_permlane32_swap_b32 v114, v116
    v_max_f32 v114, v114, v116
    v_mul_f32 v66, -1.0, v114
    v_mul_f32 v67, -1.0, v114
    v_mul_f32 v68, -1.0, v114
    v_mul_f32 v69, -1.0, v114
    v_mul_f32 v70, -1.0, v114
    v_mul_f32 v71, -1.0, v114
    v_mul_f32 v72, -1.0, v114
    v_mul_f32 v73, -1.0, v114
    v_mul_f32 v74, -1.0, v114
    v_mul_f32 v75, -1.0, v114
    v_mul_f32 v76, -1.0, v114
    v_mul_f32 v77, -1.0, v114
    v_mul_f32 v78, -1.0, v114
    v_mul_f32 v79, -1.0, v114
    v_mul_f32 v80, -1.0, v114
    v_mul_f32 v81, -1.0, v114
    v_mov_b32 v121, v123
    s_cmp_lg_u32 s83, 0
    s_cbranch_scc1 La2s_50
    ds_read_b128 v[90:93], v120 offset:0
    ds_read_b128 v[94:97], v120 offset:1152
    ds_read_b64_tr_b16 v[98:99], v121 offset:0
    ds_read_b64_tr_b16 v[100:101], v121 offset:128
    ds_read_b64_tr_b16 v[102:103], v121 offset:256
    ds_read_b64_tr_b16 v[104:105], v121 offset:384
    s_waitcnt lgkmcnt(5)
    v_mfma_f32_32x32x16_bf16 v[18:33], v[90:93], v[10:13], v[66:81]
    s_nop 7
    s_nop 3
La2b_59:
    v_exp_f32 v18, v18
    v_exp_f32 v19, v19
    v_exp_f32 v20, v20
    v_exp_f32 v21, v21
    s_waitcnt lgkmcnt(4)
    v_mfma_f32_32x32x16_bf16 v[34:49], v[94:97], v[10:13], v[66:81]
    v_exp_f32 v22, v22
    v_exp_f32 v23, v23
    v_exp_f32 v24, v24
    v_exp_f32 v25, v25
    ds_read_b128 v[90:93], v120 offset:2304
    v_cvt_pk_bf16_f32 v82, v18, v19
    v_cvt_pk_bf16_f32 v83, v20, v21
    v_cvt_pk_bf16_f32 v84, v22, v23
    v_cvt_pk_bf16_f32 v85, v24, v25
    v_bfi_b32 v82, v144, 0, v82
    v_bfi_b32 v83, v145, 0, v83
    v_bfi_b32 v84, v146, 0, v84
    v_bfi_b32 v85, v147, 0, v85
    v_exp_f32 v26, v26
    v_exp_f32 v27, v27
    s_waitcnt lgkmcnt(1)
    v_mfma_f32_32x32x16_bf16 v[50:65], v[98:101], v[82:85], 0
    v_exp_f32 v28, v28
    v_exp_f32 v29, v29
    v_exp_f32 v30, v30
    v_add_u32 v121, v121, v122
    ds_read_b64_tr_b16 v[106:107], v121 offset:0
    ds_read_b64_tr_b16 v[108:109], v121 offset:128
    v_exp_f32 v31, v31
    v_exp_f32 v32, v32
    v_exp_f32 v33, v33
    v_cvt_pk_bf16_f32 v86, v26, v27
    v_cvt_pk_bf16_f32 v87, v28, v29
    v_cvt_pk_bf16_f32 v88, v30, v31
    v_cvt_pk_bf16_f32 v89, v32, v33
    v_bfi_b32 v86, v148, 0, v86
    v_bfi_b32 v87, v149, 0, v87
    v_bfi_b32 v88, v150, 0, v88
    v_bfi_b32 v89, v151, 0, v89
    ds_read_b64_tr_b16 v[110:111], v121 offset:256
    ds_read_b64_tr_b16 v[112:113], v121 offset:384
    v_mfma_f32_32x32x16_bf16 v[50:65], v[102:105], v[86:89], v[50:65]
La2b_60:
    v_exp_f32 v34, v34
    v_exp_f32 v35, v35
    v_exp_f32 v36, v36
    v_exp_f32 v37, v37
    s_waitcnt lgkmcnt(4)
    v_mfma_f32_32x32x16_bf16 v[18:33], v[90:93], v[10:13], v[66:81]
    v_exp_f32 v38, v38
    v_exp_f32 v39, v39
    v_exp_f32 v40, v40
    v_exp_f32 v41, v41
    ds_read_b128 v[94:97], v120 offset:3456
    v_cvt_pk_bf16_f32 v82, v34, v35
    v_cvt_pk_bf16_f32 v83, v36, v37
    v_cvt_pk_bf16_f32 v84, v38, v39
    v_cvt_pk_bf16_f32 v85, v40, v41
    v_exp_f32 v42, v42
    v_exp_f32 v43, v43
    s_waitcnt lgkmcnt(1)
    v_mfma_f32_32x32x16_bf16 v[50:65], v[106:109], v[82:85], v[50:65]
    v_exp_f32 v44, v44
    v_exp_f32 v45, v45
    v_exp_f32 v46, v46
    v_add_u32 v121, v121, v122
    ds_read_b64_tr_b16 v[98:99], v121 offset:0
    ds_read_b64_tr_b16 v[100:101], v121 offset:128
    v_exp_f32 v47, v47
    v_exp_f32 v48, v48
    v_exp_f32 v49, v49
    v_cvt_pk_bf16_f32 v86, v42, v43
    v_cvt_pk_bf16_f32 v87, v44, v45
    v_cvt_pk_bf16_f32 v88, v46, v47
    v_cvt_pk_bf16_f32 v89, v48, v49
    ds_read_b64_tr_b16 v[102:103], v121 offset:256
    ds_read_b64_tr_b16 v[104:105], v121 offset:384
    v_mfma_f32_32x32x16_bf16 v[50:65], v[110:113], v[86:89], v[50:65]
La2b_61:
    v_exp_f32 v18, v18
    v_exp_f32 v19, v19
    v_exp_f32 v20, v20
    v_exp_f32 v21, v21
    s_waitcnt lgkmcnt(4)
    v_mfma_f32_32x32x16_bf16 v[34:49], v[94:97], v[10:13], v[66:81]
    v_exp_f32 v22, v22
    v_exp_f32 v23, v23
    v_exp_f32 v24, v24
    v_exp_f32 v25, v25
    ds_read_b128 v[90:93], v120 offset:4608
    v_cvt_pk_bf16_f32 v82, v18, v19
    v_cvt_pk_bf16_f32 v83, v20, v21
    v_cvt_pk_bf16_f32 v84, v22, v23
    v_cvt_pk_bf16_f32 v85, v24, v25
    v_exp_f32 v26, v26
    v_exp_f32 v27, v27
    s_waitcnt lgkmcnt(1)
    v_mfma_f32_32x32x16_bf16 v[50:65], v[98:101], v[82:85], v[50:65]
    v_exp_f32 v28, v28
    v_exp_f32 v29, v29
    v_exp_f32 v30, v30
    v_add_u32 v121, v121, v122
    ds_read_b64_tr_b16 v[106:107], v121 offset:0
    ds_read_b64_tr_b16 v[108:109], v121 offset:128
    v_exp_f32 v31, v31
    v_exp_f32 v32, v32
    v_exp_f32 v33, v33
    v_cvt_pk_bf16_f32 v86, v26, v27
    v_cvt_pk_bf16_f32 v87, v28, v29
    v_cvt_pk_bf16_f32 v88, v30, v31
    v_cvt_pk_bf16_f32 v89, v32, v33
    ds_read_b64_tr_b16 v[110:111], v121 offset:256
    ds_read_b64_tr_b16 v[112:113], v121 offset:384
    v_mfma_f32_32x32x16_bf16 v[50:65], v[102:105], v[86:89], v[50:65]
La2b_62:
    v_exp_f32 v34, v34
    v_exp_f32 v35, v35
    v_exp_f32 v36, v36
    v_exp_f32 v37, v37
    s_waitcnt lgkmcnt(4)
    v_mfma_f32_32x32x16_bf16 v[18:33], v[90:93], v[10:13], v[66:81]
    v_exp_f32 v38, v38
    v_exp_f32 v39, v39
    v_exp_f32 v40, v40
    v_exp_f32 v41, v41
    ds_read_b128 v[94:97], v120 offset:5760
    v_cvt_pk_bf16_f32 v82, v34, v35
    v_cvt_pk_bf16_f32 v83, v36, v37
    v_cvt_pk_bf16_f32 v84, v38, v39
    v_cvt_pk_bf16_f32 v85, v40, v41
    v_exp_f32 v42, v42
    v_exp_f32 v43, v43
    s_waitcnt lgkmcnt(1)
    v_mfma_f32_32x32x16_bf16 v[50:65], v[106:109], v[82:85], v[50:65]
    v_exp_f32 v44, v44
    v_exp_f32 v45, v45
    v_exp_f32 v46, v46
    v_add_u32 v121, v121, v122
    ds_read_b64_tr_b16 v[98:99], v121 offset:0
    ds_read_b64_tr_b16 v[100:101], v121 offset:128
    v_exp_f32 v47, v47
    v_exp_f32 v48, v48
    v_exp_f32 v49, v49
    v_cvt_pk_bf16_f32 v86, v42, v43
    v_cvt_pk_bf16_f32 v87, v44, v45
    v_cvt_pk_bf16_f32 v88, v46, v47
    v_cvt_pk_bf16_f32 v89, v48, v49
    ds_read_b64_tr_b16 v[102:103], v121 offset:256
    ds_read_b64_tr_b16 v[104:105], v121 offset:384
    v_mfma_f32_32x32x16_bf16 v[50:65], v[110:113], v[86:89], v[50:65]
La2b_63:
    v_exp_f32 v18, v18
    v_exp_f32 v19, v19
    v_exp_f32 v20, v20
    v_exp_f32 v21, v21
    s_waitcnt lgkmcnt(4)
    v_mfma_f32_32x32x16_bf16 v[34:49], v[94:97], v[10:13], v[66:81]
    v_exp_f32 v22, v22
    v_exp_f32 v23, v23
    v_exp_f32 v24, v24
    v_exp_f32 v25, v25
    ds_read_b128 v[90:93], v120 offset:6912
    v_cvt_pk_bf16_f32 v82, v18, v19
    v_cvt_pk_bf16_f32 v83, v20, v21
    v_cvt_pk_bf16_f32 v84, v22, v23
    v_cvt_pk_bf16_f32 v85, v24, v25
    v_exp_f32 v26, v26
    v_exp_f32 v27, v27
    s_waitcnt lgkmcnt(1)
    v_mfma_f32_32x32x16_bf16 v[50:65], v[98:101], v[82:85], v[50:65]
    v_exp_f32 v28, v28
    v_exp_f32 v29, v29
    v_exp_f32 v30, v30
    v_add_u32 v121, v121, v122
    ds_read_b64_tr_b16 v[106:107], v121 offset:0
    ds_read_b64_tr_b16 v[108:109], v121 offset:128
    v_exp_f32 v31, v31
    v_exp_f32 v32, v32
    v_exp_f32 v33, v33
    v_cvt_pk_bf16_f32 v86, v26, v27
    v_cvt_pk_bf16_f32 v87, v28, v29
    v_cvt_pk_bf16_f32 v88, v30, v31
    v_cvt_pk_bf16_f32 v89, v32, v33
    ds_read_b64_tr_b16 v[110:111], v121 offset:256
    ds_read_b64_tr_b16 v[112:113], v121 offset:384
    v_mfma_f32_32x32x16_bf16 v[50:65], v[102:105], v[86:89], v[50:65]
La2b_64:
    v_exp_f32 v34, v34
    v_exp_f32 v35, v35
    v_exp_f32 v36, v36
    v_exp_f32 v37, v37
    s_waitcnt lgkmcnt(4)
    v_mfma_f32_32x32x16_bf16 v[18:33], v[90:93], v[10:13], v[66:81]
    v_exp_f32 v38, v38
    v_exp_f32 v39, v39
    v_exp_f32 v40, v40
    v_exp_f32 v41, v41
    ds_read_b128 v[94:97], v120 offset:8064
    v_cvt_pk_bf16_f32 v82, v34, v35
    v_cvt_pk_bf16_f32 v83, v36, v37
    v_cvt_pk_bf16_f32 v84, v38, v39
    v_cvt_pk_bf16_f32 v85, v40, v41
    v_exp_f32 v42, v42
    v_exp_f32 v43, v43
    s_waitcnt lgkmcnt(1)
    v_mfma_f32_32x32x16_bf16 v[50:65], v[106:109], v[82:85], v[50:65]
    v_exp_f32 v44, v44
    v_exp_f32 v45, v45
    v_exp_f32 v46, v46
    v_add_u32 v121, v121, v122
    ds_read_b64_tr_b16 v[98:99], v121 offset:0
    ds_read_b64_tr_b16 v[100:101], v121 offset:128
    v_exp_f32 v47, v47
    v_exp_f32 v48, v48
    v_exp_f32 v49, v49
    v_cvt_pk_bf16_f32 v86, v42, v43
    v_cvt_pk_bf16_f32 v87, v44, v45
    v_cvt_pk_bf16_f32 v88, v46, v47
    v_cvt_pk_bf16_f32 v89, v48, v49
    ds_read_b64_tr_b16 v[102:103], v121 offset:256
    ds_read_b64_tr_b16 v[104:105], v121 offset:384
    v_mfma_f32_32x32x16_bf16 v[50:65], v[110:113], v[86:89], v[50:65]
La2b_65:
    v_exp_f32 v18, v18
    v_exp_f32 v19, v19
    v_exp_f32 v20, v20
    v_exp_f32 v21, v21
    s_waitcnt lgkmcnt(4)
    v_mfma_f32_32x32x16_bf16 v[34:49], v[94:97], v[10:13], v[66:81]
    v_exp_f32 v22, v22
    v_exp_f32 v23, v23
    v_exp_f32 v24, v24
    v_exp_f32 v25, v25
    ds_read_b128 v[90:93], v120 offset:9216
    v_cvt_pk_bf16_f32 v82, v18, v19
    v_cvt_pk_bf16_f32 v83, v20, v21
    v_cvt_pk_bf16_f32 v84, v22, v23
    v_cvt_pk_bf16_f32 v85, v24, v25
    v_exp_f32 v26, v26
    v_exp_f32 v27, v27
    s_waitcnt lgkmcnt(1)
    v_mfma_f32_32x32x16_bf16 v[50:65], v[98:101], v[82:85], v[50:65]
    v_exp_f32 v28, v28
    v_exp_f32 v29, v29
    v_exp_f32 v30, v30
    v_add_u32 v121, v121, v122
    ds_read_b64_tr_b16 v[106:107], v121 offset:0
    ds_read_b64_tr_b16 v[108:109], v121 offset:128
    v_exp_f32 v31, v31
    v_exp_f32 v32, v32
    v_exp_f32 v33, v33
    v_cvt_pk_bf16_f32 v86, v26, v27
    v_cvt_pk_bf16_f32 v87, v28, v29
    v_cvt_pk_bf16_f32 v88, v30, v31
    v_cvt_pk_bf16_f32 v89, v32, v33
    ds_read_b64_tr_b16 v[110:111], v121 offset:256
    ds_read_b64_tr_b16 v[112:113], v121 offset:384
    v_mfma_f32_32x32x16_bf16 v[50:65], v[102:105], v[86:89], v[50:65]
La2b_66:
    v_exp_f32 v34, v34
    v_exp_f32 v35, v35
    v_exp_f32 v36, v36
    v_exp_f32 v37, v37
    s_waitcnt lgkmcnt(4)
    v_mfma_f32_32x32x16_bf16 v[18:33], v[90:93], v[10:13], v[66:81]
    v_exp_f32 v38, v38
    v_exp_f32 v39, v39
    v_exp_f32 v40, v40
    v_exp_f32 v41, v41
    v_cvt_pk_bf16_f32 v82, v34, v35
    v_cvt_pk_bf16_f32 v83, v36, v37
    v_cvt_pk_bf16_f32 v84, v38, v39
    v_cvt_pk_bf16_f32 v85, v40, v41
    v_exp_f32 v42, v42
    v_exp_f32 v43, v43
    s_waitcnt lgkmcnt(0)
    v_mfma_f32_32x32x16_bf16 v[50:65], v[106:109], v[82:85], v[50:65]
    v_exp_f32 v44, v44
    v_exp_f32 v45, v45
    v_exp_f32 v46, v46
    v_add_u32 v121, v121, v122
    ds_read_b64_tr_b16 v[98:99], v121 offset:0
    ds_read_b64_tr_b16 v[100:101], v121 offset:128
    v_exp_f32 v47, v47
    v_exp_f32 v48, v48
    v_exp_f32 v49, v49
    v_cvt_pk_bf16_f32 v86, v42, v43
    v_cvt_pk_bf16_f32 v87, v44, v45
    v_cvt_pk_bf16_f32 v88, v46, v47
    v_cvt_pk_bf16_f32 v89, v48, v49
    ds_read_b64_tr_b16 v[102:103], v121 offset:256
    ds_read_b64_tr_b16 v[104:105], v121 offset:384
    v_mfma_f32_32x32x16_bf16 v[50:65], v[110:113], v[86:89], v[50:65]
La2b_67:
    v_exp_f32 v18, v18
    v_exp_f32 v19, v19
    v_exp_f32 v20, v20
    v_exp_f32 v21, v21
    v_exp_f32 v22, v22
    v_exp_f32 v23, v23
    v_exp_f32 v24, v24
    v_exp_f32 v25, v25
    v_cvt_pk_bf16_f32 v82, v18, v19
    v_cvt_pk_bf16_f32 v83, v20, v21
    v_cvt_pk_bf16_f32 v84, v22, v23
    v_cvt_pk_bf16_f32 v85, v24, v25
    v_and_b32 v82, v144, v82
    v_and_b32 v83, v145, v83
    v_and_b32 v84, v146, v84
    v_and_b32 v85, v147, v85
    v_exp_f32 v26, v26
    v_exp_f32 v27, v27
    s_waitcnt lgkmcnt(0)
    v_mfma_f32_32x32x16_bf16 v[50:65], v[98:101], v[82:85], v[50:65]
    v_exp_f32 v28, v28
    v_exp_f32 v29, v29
    v_exp_f32 v30, v30
    v_exp_f32 v31, v31
    v_exp_f32 v32, v32
    v_exp_f32 v33, v33
    v_cvt_pk_bf16_f32 v86, v26, v27
    v_cvt_pk_bf16_f32 v87, v28, v29
    v_cvt_pk_bf16_f32 v88, v30, v31
    v_cvt_pk_bf16_f32 v89, v32, v33
    v_and_b32 v86, v148, v86
    v_and_b32 v87, v149, v87
    v_and_b32 v88, v150, v88
    v_and_b32 v89, v151, v89
    s_nop 1
    v_mfma_f32_32x32x16_bf16 v[50:65], v[102:105], v[86:89], v[50:65]
    s_waitcnt lgkmcnt(0)
    s_nop 7
    s_nop 7
    s_branch Lredone_31
La1s_90:
    s_cmp_eq_u32 s83, 1
    s_cbranch_scc1 La1s_91
    s_cmp_eq_u32 s83, 2
    s_cbranch_scc1 La1s_92
    s_cmp_eq_u32 s83, 3
    s_cbranch_scc1 La1s_93
    s_cmp_eq_u32 s83, 4
    s_cbranch_scc1 La1s_94
    s_cmp_eq_u32 s83, 5
    s_cbranch_scc1 La1s_95
    s_cmp_eq_u32 s83, 6
    s_cbranch_scc1 La1s_96
    s_cmp_eq_u32 s83, 7
    s_cbranch_scc1 La1s_97
    s_cmp_eq_u32 s83, 8
    s_cbranch_scc1 La1s_98
    s_branch La1s_98
La1s_91:
    v_mfma_f32_32x32x16_bf16 v[34:49], v[70:73], v[14:17], 0
    v_mfma_f32_32x32x16_bf16 v[50:65], v[74:77], v[14:17], 0
    s_nop 7
    s_nop 1
    s_branch La1b_100
La1s_92:
    v_mfma_f32_32x32x16_bf16 v[50:65], v[74:77], v[14:17], 0
    v_mfma_f32_32x32x16_bf16 v[18:33], v[78:81], v[14:17], 0
    s_nop 7
    s_nop 1
    s_branch La1b_101
La1s_93:
    v_mfma_f32_32x32x16_bf16 v[18:33], v[78:81], v[14:17], 0
    v_mfma_f32_32x32x16_bf16 v[34:49], v[82:85], v[14:17], 0
    s_nop 7
    s_nop 1
    s_branch La1b_102
La1s_94:
    v_mfma_f32_32x32x16_bf16 v[34:49], v[82:85], v[14:17], 0
    v_mfma_f32_32x32x16_bf16 v[50:65], v[86:89], v[14:17], 0
    s_nop 7
    s_nop 1
    s_branch La1b_103
La1s_95:
    v_mfma_f32_32x32x16_bf16 v[50:65], v[86:89], v[14:17], 0
    v_mfma_f32_32x32x16_bf16 v[18:33], v[90:93], v[14:17], 0
    s_nop 7
    s_nop 1
    s_branch La1b_104
La1s_96:
    v_mfma_f32_32x32x16_bf16 v[18:33], v[90:93], v[14:17], 0
    v_mfma_f32_32x32x16_bf16 v[34:49], v[94:97], v[14:17], 0
    s_nop 7
    s_nop 1
    s_branch La1b_105
La1s_97:
    v_mfma_f32_32x32x16_bf16 v[34:49], v[94:97], v[14:17], 0
    v_mfma_f32_32x32x16_bf16 v[50:65], v[98:101], v[14:17], 0
    s_nop 7
    s_nop 1
    s_branch La1b_106
La1s_98:
    v_mfma_f32_32x32x16_bf16 v[50:65], v[98:101], v[14:17], 0
    s_nop 7
    s_nop 1
    s_branch La1b_107
La2s_108:
    s_cmp_eq_u32 s83, 1
    s_cbranch_scc1 La2s_109
    s_cmp_eq_u32 s83, 2
    s_cbranch_scc1 La2s_110
    s_cmp_eq_u32 s83, 3
    s_cbranch_scc1 La2s_111
    s_cmp_eq_u32 s83, 4
    s_cbranch_scc1 La2s_112
    s_cmp_eq_u32 s83, 5
    s_cbranch_scc1 La2s_113
    s_cmp_eq_u32 s83, 6
    s_cbranch_scc1 La2s_114
    s_cmp_eq_u32 s83, 7
    s_cbranch_scc1 La2s_115
    s_cmp_eq_u32 s83, 8
    s_cbranch_scc1 La2s_116
    s_branch La2s_116
La2s_109:
    v_mov_b32 v50, 0
    v_mov_b32 v51, 0
    v_mov_b32 v52, 0
    v_mov_b32 v53, 0
    v_mov_b32 v54, 0
    v_mov_b32 v55, 0
    v_mov_b32 v56, 0
    v_mov_b32 v57, 0
    v_mov_b32 v58, 0
    v_mov_b32 v59, 0
    v_mov_b32 v60, 0
    v_mov_b32 v61, 0
    v_mov_b32 v62, 0
    v_mov_b32 v63, 0
    v_mov_b32 v64, 0
    v_mov_b32 v65, 0
    ds_read_b128 v[94:97], v120 offset:14976
    ds_read_b128 v[90:93], v120 offset:16128
    ds_read_b64_tr_b16 v[106:107], v121 offset:0
    ds_read_b64_tr_b16 v[108:109], v121 offset:128
    ds_read_b64_tr_b16 v[110:111], v121 offset:256
    ds_read_b64_tr_b16 v[112:113], v121 offset:384
    s_waitcnt lgkmcnt(5)
    v_mfma_f32_32x32x16_bf16 v[34:49], v[94:97], v[14:17], v[66:81]
    s_nop 7
    s_nop 3
    s_branch La2b_118
La2s_110:
    v_mov_b32 v50, 0
    v_mov_b32 v51, 0
    v_mov_b32 v52, 0
    v_mov_b32 v53, 0
    v_mov_b32 v54, 0
    v_mov_b32 v55, 0
    v_mov_b32 v56, 0
    v_mov_b32 v57, 0
    v_mov_b32 v58, 0
    v_mov_b32 v59, 0
    v_mov_b32 v60, 0
    v_mov_b32 v61, 0
    v_mov_b32 v62, 0
    v_mov_b32 v63, 0
    v_mov_b32 v64, 0
    v_mov_b32 v65, 0
    ds_read_b128 v[90:93], v120 offset:16128
    ds_read_b128 v[94:97], v120 offset:17280
    ds_read_b64_tr_b16 v[98:99], v121 offset:0
    ds_read_b64_tr_b16 v[100:101], v121 offset:128
    ds_read_b64_tr_b16 v[102:103], v121 offset:256
    ds_read_b64_tr_b16 v[104:105], v121 offset:384
    s_waitcnt lgkmcnt(5)
    v_mfma_f32_32x32x16_bf16 v[18:33], v[90:93], v[14:17], v[66:81]
    s_nop 7
    s_nop 3
    s_branch La2b_119
La2s_111:
    v_mov_b32 v50, 0
    v_mov_b32 v51, 0
    v_mov_b32 v52, 0
    v_mov_b32 v53, 0
    v_mov_b32 v54, 0
    v_mov_b32 v55, 0
    v_mov_b32 v56, 0
    v_mov_b32 v57, 0
    v_mov_b32 v58, 0
    v_mov_b32 v59, 0
    v_mov_b32 v60, 0
    v_mov_b32 v61, 0
    v_mov_b32 v62, 0
    v_mov_b32 v63, 0
    v_mov_b32 v64, 0
    v_mov_b32 v65, 0
    ds_read_b128 v[94:97], v120 offset:17280
    ds_read_b128 v[90:93], v120 offset:18432
    ds_read_b64_tr_b16 v[106:107], v121 offset:0
    ds_read_b64_tr_b16 v[108:109], v121 offset:128
    ds_read_b64_tr_b16 v[110:111], v121 offset:256
    ds_read_b64_tr_b16 v[112:113], v121 offset:384
    s_waitcnt lgkmcnt(5)
    v_mfma_f32_32x32x16_bf16 v[34:49], v[94:97], v[14:17], v[66:81]
    s_nop 7
    s_nop 3
    s_branch La2b_120
La2s_112:
    v_mov_b32 v50, 0
    v_mov_b32 v51, 0
    v_mov_b32 v52, 0
    v_mov_b32 v53, 0
    v_mov_b32 v54, 0
    v_mov_b32 v55, 0
    v_mov_b32 v56, 0
    v_mov_b32 v57, 0
    v_mov_b32 v58, 0
    v_mov_b32 v59, 0
    v_mov_b32 v60, 0
    v_mov_b32 v61, 0
    v_mov_b32 v62, 0
    v_mov_b32 v63, 0
    v_mov_b32 v64, 0
    v_mov_b32 v65, 0
    ds_read_b128 v[90:93], v120 offset:18432
    ds_read_b128 v[94:97], v120 offset:19584
    ds_read_b64_tr_b16 v[98:99], v121 offset:0
    ds_read_b64_tr_b16 v[100:101], v121 offset:128
    ds_read_b64_tr_b16 v[102:103], v121 offset:256
    ds_read_b64_tr_b16 v[104:105], v121 offset:384
    s_waitcnt lgkmcnt(5)
    v_mfma_f32_32x32x16_bf16 v[18:33], v[90:93], v[14:17], v[66:81]
    s_nop 7
    s_nop 3
    s_branch La2b_121
La2s_113:
    v_mov_b32 v50, 0
    v_mov_b32 v51, 0
    v_mov_b32 v52, 0
    v_mov_b32 v53, 0
    v_mov_b32 v54, 0
    v_mov_b32 v55, 0
    v_mov_b32 v56, 0
    v_mov_b32 v57, 0
    v_mov_b32 v58, 0
    v_mov_b32 v59, 0
    v_mov_b32 v60, 0
    v_mov_b32 v61, 0
    v_mov_b32 v62, 0
    v_mov_b32 v63, 0
    v_mov_b32 v64, 0
    v_mov_b32 v65, 0
    ds_read_b128 v[94:97], v120 offset:19584
    ds_read_b128 v[90:93], v120 offset:20736
    ds_read_b64_tr_b16 v[106:107], v121 offset:0
    ds_read_b64_tr_b16 v[108:109], v121 offset:128
    ds_read_b64_tr_b16 v[110:111], v121 offset:256
    ds_read_b64_tr_b16 v[112:113], v121 offset:384
    s_waitcnt lgkmcnt(5)
    v_mfma_f32_32x32x16_bf16 v[34:49], v[94:97], v[14:17], v[66:81]
    s_nop 7
    s_nop 3
    s_branch La2b_122
La2s_114:
    v_mov_b32 v50, 0
    v_mov_b32 v51, 0
    v_mov_b32 v52, 0
    v_mov_b32 v53, 0
    v_mov_b32 v54, 0
    v_mov_b32 v55, 0
    v_mov_b32 v56, 0
    v_mov_b32 v57, 0
    v_mov_b32 v58, 0
    v_mov_b32 v59, 0
    v_mov_b32 v60, 0
    v_mov_b32 v61, 0
    v_mov_b32 v62, 0
    v_mov_b32 v63, 0
    v_mov_b32 v64, 0
    v_mov_b32 v65, 0
    ds_read_b128 v[90:93], v120 offset:20736
    ds_read_b128 v[94:97], v120 offset:21888
    ds_read_b64_tr_b16 v[98:99], v121 offset:0
    ds_read_b64_tr_b16 v[100:101], v121 offset:128
    ds_read_b64_tr_b16 v[102:103], v121 offset:256
    ds_read_b64_tr_b16 v[104:105], v121 offset:384
    s_waitcnt lgkmcnt(5)
    v_mfma_f32_32x32x16_bf16 v[18:33], v[90:93], v[14:17], v[66:81]
    s_nop 7
    s_nop 3
    s_branch La2b_123
La2s_115:
    v_mov_b32 v50, 0
    v_mov_b32 v51, 0
    v_mov_b32 v52, 0
    v_mov_b32 v53, 0
    v_mov_b32 v54, 0
    v_mov_b32 v55, 0
    v_mov_b32 v56, 0
    v_mov_b32 v57, 0
    v_mov_b32 v58, 0
    v_mov_b32 v59, 0
    v_mov_b32 v60, 0
    v_mov_b32 v61, 0
    v_mov_b32 v62, 0
    v_mov_b32 v63, 0
    v_mov_b32 v64, 0
    v_mov_b32 v65, 0
    ds_read_b128 v[94:97], v120 offset:21888
    ds_read_b128 v[90:93], v120 offset:23040
    ds_read_b64_tr_b16 v[106:107], v121 offset:0
    ds_read_b64_tr_b16 v[108:109], v121 offset:128
    ds_read_b64_tr_b16 v[110:111], v121 offset:256
    ds_read_b64_tr_b16 v[112:113], v121 offset:384
    s_waitcnt lgkmcnt(5)
    v_mfma_f32_32x32x16_bf16 v[34:49], v[94:97], v[14:17], v[66:81]
    s_nop 7
    s_nop 3
    s_branch La2b_124
La2s_116:
    v_mov_b32 v50, 0
    v_mov_b32 v51, 0
    v_mov_b32 v52, 0
    v_mov_b32 v53, 0
    v_mov_b32 v54, 0
    v_mov_b32 v55, 0
    v_mov_b32 v56, 0
    v_mov_b32 v57, 0
    v_mov_b32 v58, 0
    v_mov_b32 v59, 0
    v_mov_b32 v60, 0
    v_mov_b32 v61, 0
    v_mov_b32 v62, 0
    v_mov_b32 v63, 0
    v_mov_b32 v64, 0
    v_mov_b32 v65, 0
    ds_read_b128 v[90:93], v120 offset:23040
    ds_read_b64_tr_b16 v[98:99], v121 offset:0
    ds_read_b64_tr_b16 v[100:101], v121 offset:128
    ds_read_b64_tr_b16 v[102:103], v121 offset:256
    ds_read_b64_tr_b16 v[104:105], v121 offset:384
    s_waitcnt lgkmcnt(4)
    v_mfma_f32_32x32x16_bf16 v[18:33], v[90:93], v[14:17], v[66:81]
    s_nop 7
    s_nop 3
    s_branch La2b_125
Lredo_88:
    s_nop 7
    ds_read_b128 v[66:69], v120 offset:13824
    ds_read_b128 v[70:73], v120 offset:14976
    ds_read_b128 v[74:77], v120 offset:16128
    ds_read_b128 v[78:81], v120 offset:17280
    ds_read_b128 v[82:85], v120 offset:18432
    ds_read_b128 v[86:89], v120 offset:19584
    ds_read_b128 v[90:93], v120 offset:20736
    ds_read_b128 v[94:97], v120 offset:21888
    ds_read_b128 v[98:101], v120 offset:23040
    v_mov_b32 v114, v118
    v_mov_b32 v115, v118
    s_waitcnt lgkmcnt(0)
    s_cmp_lg_u32 s83, 0
    s_cbranch_scc1 La1s_90
    v_mfma_f32_32x32x16_bf16 v[18:33], v[66:69], v[14:17], 0
    v_mfma_f32_32x32x16_bf16 v[34:49], v[70:73], v[14:17], 0
    s_nop 7
    s_nop 1
La1b_99:
    v_mfma_f32_32x32x16_bf16 v[50:65], v[74:77], v[14:17], 0
    v_cndmask_b32 v18, v18, v118, s[44:45]
    v_cndmask_b32 v19, v19, v118, s[46:47]
    v_cndmask_b32 v20, v20, v118, s[48:49]
    v_cndmask_b32 v21, v21, v118, s[50:51]
    v_cndmask_b32 v22, v22, v118, s[52:53]
    v_cndmask_b32 v23, v23, v118, s[54:55]
    v_cndmask_b32 v24, v24, v118, s[56:57]
    v_cndmask_b32 v25, v25, v118, s[58:59]
    v_cndmask_b32 v26, v26, v118, s[60:61]
    v_cndmask_b32 v27, v27, v118, s[62:63]
    v_cndmask_b32 v28, v28, v118, s[64:65]
    v_cndmask_b32 v29, v29, v118, s[66:67]
    v_cndmask_b32 v30, v30, v118, s[68:69]
    v_cndmask_b32 v31, v31, v118, s[70:71]
    v_cndmask_b32 v32, v32, v118, s[72:73]
    v_cndmask_b32 v33, v33, v118, s[74:75]
    v_max3_f32 v114, v114, v18, v19
    v_max3_f32 v115, v115, v20, v21
    v_max3_f32 v114, v114, v22, v23
    v_max3_f32 v115, v115, v24, v25
    v_max3_f32 v114, v114, v26, v27
    v_max3_f32 v115, v115, v28, v29
    v_max3_f32 v114, v114, v30, v31
    v_max3_f32 v115, v115, v32, v33
La1b_100:
    v_mfma_f32_32x32x16_bf16 v[18:33], v[78:81], v[14:17], 0
    v_max3_f32 v114, v114, v34, v35
    v_max3_f32 v115, v115, v36, v37
    v_max3_f32 v114, v114, v38, v39
    v_max3_f32 v115, v115, v40, v41
    v_max3_f32 v114, v114, v42, v43
    v_max3_f32 v115, v115, v44, v45
    v_max3_f32 v114, v114, v46, v47
    v_max3_f32 v115, v115, v48, v49
La1b_101:
    v_mfma_f32_32x32x16_bf16 v[34:49], v[82:85], v[14:17], 0
    v_max3_f32 v114, v114, v50, v51
    v_max3_f32 v115, v115, v52, v53
    v_max3_f32 v114, v114, v54, v55
    v_max3_f32 v115, v115, v56, v57
    v_max3_f32 v114, v114, v58, v59
    v_max3_f32 v115, v115, v60, v61
    v_max3_f32 v114, v114, v62, v63
    v_max3_f32 v115, v115, v64, v65
La1b_102:
    v_mfma_f32_32x32x16_bf16 v[50:65], v[86:89], v[14:17], 0
    v_max3_f32 v114, v114, v18, v19
    v_max3_f32 v115, v115, v20, v21
    v_max3_f32 v114, v114, v22, v23
    v_max3_f32 v115, v115, v24, v25
    v_max3_f32 v114, v114, v26, v27
    v_max3_f32 v115, v115, v28, v29
    v_max3_f32 v114, v114, v30, v31
    v_max3_f32 v115, v115, v32, v33
La1b_103:
    v_mfma_f32_32x32x16_bf16 v[18:33], v[90:93], v[14:17], 0
    v_max3_f32 v114, v114, v34, v35
    v_max3_f32 v115, v115, v36, v37
    v_max3_f32 v114, v114, v38, v39
    v_max3_f32 v115, v115, v40, v41
    v_max3_f32 v114, v114, v42, v43
    v_max3_f32 v115, v115, v44, v45
    v_max3_f32 v114, v114, v46, v47
    v_max3_f32 v115, v115, v48, v49
La1b_104:
    v_mfma_f32_32x32x16_bf16 v[34:49], v[94:97], v[14:17], 0
    v_max3_f32 v114, v114, v50, v51
    v_max3_f32 v115, v115, v52, v53
    v_max3_f32 v114, v114, v54, v55
    v_max3_f32 v115, v115, v56, v57
    v_max3_f32 v114, v114, v58, v59
    v_max3_f32 v115, v115, v60, v61
    v_max3_f32 v114, v114, v62, v63
    v_max3_f32 v115, v115, v64, v65
La1b_105:
    v_mfma_f32_32x32x16_bf16 v[50:65], v[98:101], v[14:17], 0
    v_max3_f32 v114, v114, v18, v19
    v_max3_f32 v115, v115, v20, v21
    v_max3_f32 v114, v114, v22, v23
    v_max3_f32 v115, v115, v24, v25
    v_max3_f32 v114, v114, v26, v27
    v_max3_f32 v115, v115, v28, v29
    v_max3_f32 v114, v114, v30, v31
    v_max3_f32 v115, v115, v32, v33
La1b_106:
    v_max3_f32 v114, v114, v34, v35
    v_max3_f32 v115, v115, v36, v37
    v_max3_f32 v114, v114, v38, v39
    v_max3_f32 v115, v115, v40, v41
    v_max3_f32 v114, v114, v42, v43
    v_max3_f32 v115, v115, v44, v45
    v_max3_f32 v114, v114, v46, v47
    v_max3_f32 v115, v115, v48, v49
La1b_107:
    v_cndmask_b32 v50, v118, v50, s[44:45]
    v_cndmask_b32 v51, v118, v51, s[46:47]
    v_cndmask_b32 v52, v118, v52, s[48:49]
    v_cndmask_b32 v53, v118, v53, s[50:51]
    v_cndmask_b32 v54, v118, v54, s[52:53]
    v_cndmask_b32 v55, v118, v55, s[54:55]
    v_cndmask_b32 v56, v118, v56, s[56:57]
    v_cndmask_b32 v57, v118, v57, s[58:59]
    v_cndmask_b32 v58, v118, v58, s[60:61]
    v_cndmask_b32 v59, v118, v59, s[62:63]
    v_cndmask_b32 v60, v118, v60, s[64:65]
    v_cndmask_b32 v61, v118, v61, s[66:67]
    v_cndmask_b32 v62, v118, v62, s[68:69]
    v_cndmask_b32 v63, v118, v63, s[70:71]
    v_cndmask_b32 v64, v118, v64, s[72:73]
    v_cndmask_b32 v65, v118, v65, s[74:75]
    v_max3_f32 v114, v114, v50, v51
    v_max3_f32 v115, v115, v52, v53
    v_max3_f32 v114, v114, v54, v55
    v_max3_f32 v115, v115, v56, v57
    v_max3_f32 v114, v114, v58, v59
    v_max3_f32 v115, v115, v60, v61
    v_max3_f32 v114, v114, v62, v63
    v_max3_f32 v115, v115, v64, v65
    v_max_f32 v114, v114, v115
    v_mov_b32 v116, v114
    s_nop 1
    v_permlane32_swap_b32 v114, v116
    v_max_f32 v114, v114, v116
    v_mul_f32 v66, -1.0, v114
    v_mul_f32 v67, -1.0, v114
    v_mul_f32 v68, -1.0, v114
    v_mul_f32 v69, -1.0, v114
    v_mul_f32 v70, -1.0, v114
    v_mul_f32 v71, -1.0, v114
    v_mul_f32 v72, -1.0, v114
    v_mul_f32 v73, -1.0, v114
    v_mul_f32 v74, -1.0, v114
    v_mul_f32 v75, -1.0, v114
    v_mul_f32 v76, -1.0, v114
    v_mul_f32 v77, -1.0, v114
    v_mul_f32 v78, -1.0, v114
    v_mul_f32 v79, -1.0, v114
    v_mul_f32 v80, -1.0, v114
    v_mul_f32 v81, -1.0, v114
    v_mov_b32 v121, v123
    v_mov_b32 v116, 13824
    v_cmp_ne_u32 vcc, 0, v122
    v_mov_b32 v117, 0
    s_nop 0
    v_cndmask_b32 v116, v117, v116, vcc
    v_add_u32 v121, v121, v116
    s_cmp_lg_u32 s83, 0
    s_cbranch_scc1 La2s_108
    ds_read_b128 v[90:93], v120 offset:13824
    ds_read_b128 v[94:97], v120 offset:14976
    ds_read_b64_tr_b16 v[98:99], v121 offset:0
    ds_read_b64_tr_b16 v[100:101], v121 offset:128
    ds_read_b64_tr_b16 v[102:103], v121 offset:256
    ds_read_b64_tr_b16 v[104:105], v121 offset:384
    s_waitcnt lgkmcnt(5)
    v_mfma_f32_32x32x16_bf16 v[18:33], v[90:93], v[14:17], v[66:81]
    s_nop 7
    s_nop 3
La2b_117:
    v_exp_f32 v18, v18
    v_exp_f32 v19, v19
    v_exp_f32 v20, v20
    v_exp_f32 v21, v21
    s_waitcnt lgkmcnt(4)
    v_mfma_f32_32x32x16_bf16 v[34:49], v[94:97], v[14:17], v[66:81]
    v_exp_f32 v22, v22
    v_exp_f32 v23, v23
    v_exp_f32 v24, v24
    v_exp_f32 v25, v25
    ds_read_b128 v[90:93], v120 offset:16128
    v_cvt_pk_bf16_f32 v82, v18, v19
    v_cvt_pk_bf16_f32 v83, v20, v21
    v_cvt_pk_bf16_f32 v84, v22, v23
    v_cvt_pk_bf16_f32 v85, v24, v25
    v_bfi_b32 v82, v144, 0, v82
    v_bfi_b32 v83, v145, 0, v83
    v_bfi_b32 v84, v146, 0, v84
    v_bfi_b32 v85, v147, 0, v85
    v_exp_f32 v26, v26
    v_exp_f32 v27, v27
    s_waitcnt lgkmcnt(1)
    v_mfma_f32_32x32x16_bf16 v[50:65], v[98:101], v[82:85], 0
    v_exp_f32 v28, v28
    v_exp_f32 v29, v29
    v_exp_f32 v30, v30
    v_add_u32 v121, v121, v122
    ds_read_b64_tr_b16 v[106:107], v121 offset:0
    ds_read_b64_tr_b16 v[108:109], v121 offset:128
    v_exp_f32 v31, v31
    v_exp_f32 v32, v32
    v_exp_f32 v33, v33
    v_cvt_pk_bf16_f32 v86, v26, v27
    v_cvt_pk_bf16_f32 v87, v28, v29
    v_cvt_pk_bf16_f32 v88, v30, v31
    v_cvt_pk_bf16_f32 v89, v32, v33
    v_bfi_b32 v86, v148, 0, v86
    v_bfi_b32 v87, v149, 0, v87
    v_bfi_b32 v88, v150, 0, v88
    v_bfi_b32 v89, v151, 0, v89
    ds_read_b64_tr_b16 v[110:111], v121 offset:256
    ds_read_b64_tr_b16 v[112:113], v121 offset:384
    v_mfma_f32_32x32x16_bf16 v[50:65], v[102:105], v[86:89], v[50:65]
La2b_118:
    v_exp_f32 v34, v34
    v_exp_f32 v35, v35
    v_exp_f32 v36, v36
    v_exp_f32 v37, v37
    s_waitcnt lgkmcnt(4)
    v_mfma_f32_32x32x16_bf16 v[18:33], v[90:93], v[14:17], v[66:81]
    v_exp_f32 v38, v38
    v_exp_f32 v39, v39
    v_exp_f32 v40, v40
    v_exp_f32 v41, v41
    ds_read_b128 v[94:97], v120 offset:17280
    v_cvt_pk_bf16_f32 v82, v34, v35
    v_cvt_pk_bf16_f32 v83, v36, v37
    v_cvt_pk_bf16_f32 v84, v38, v39
    v_cvt_pk_bf16_f32 v85, v40, v41
    v_exp_f32 v42, v42
    v_exp_f32 v43, v43
    s_waitcnt lgkmcnt(1)
    v_mfma_f32_32x32x16_bf16 v[50:65], v[106:109], v[82:85], v[50:65]
    v_exp_f32 v44, v44
    v_exp_f32 v45, v45
    v_exp_f32 v46, v46
    v_add_u32 v121, v121, v122
    ds_read_b64_tr_b16 v[98:99], v121 offset:0
    ds_read_b64_tr_b16 v[100:101], v121 offset:128
    v_exp_f32 v47, v47
    v_exp_f32 v48, v48
    v_exp_f32 v49, v49
    v_cvt_pk_bf16_f32 v86, v42, v43
    v_cvt_pk_bf16_f32 v87, v44, v45
    v_cvt_pk_bf16_f32 v88, v46, v47
    v_cvt_pk_bf16_f32 v89, v48, v49
    ds_read_b64_tr_b16 v[102:103], v121 offset:256
    ds_read_b64_tr_b16 v[104:105], v121 offset:384
    v_mfma_f32_32x32x16_bf16 v[50:65], v[110:113], v[86:89], v[50:65]
La2b_119:
    v_exp_f32 v18, v18
    v_exp_f32 v19, v19
    v_exp_f32 v20, v20
    v_exp_f32 v21, v21
    s_waitcnt lgkmcnt(4)
    v_mfma_f32_32x32x16_bf16 v[34:49], v[94:97], v[14:17], v[66:81]
    v_exp_f32 v22, v22
    v_exp_f32 v23, v23
    v_exp_f32 v24, v24
    v_exp_f32 v25, v25
    ds_read_b128 v[90:93], v120 offset:18432
    v_cvt_pk_bf16_f32 v82, v18, v19
    v_cvt_pk_bf16_f32 v83, v20, v21
    v_cvt_pk_bf16_f32 v84, v22, v23
    v_cvt_pk_bf16_f32 v85, v24, v25
    v_exp_f32 v26, v26
    v_exp_f32 v27, v27
    s_waitcnt lgkmcnt(1)
    v_mfma_f32_32x32x16_bf16 v[50:65], v[98:101], v[82:85], v[50:65]
    v_exp_f32 v28, v28
    v_exp_f32 v29, v29
    v_exp_f32 v30, v30
    v_add_u32 v121, v121, v122
    ds_read_b64_tr_b16 v[106:107], v121 offset:0
    ds_read_b64_tr_b16 v[108:109], v121 offset:128
    v_exp_f32 v31, v31
    v_exp_f32 v32, v32
    v_exp_f32 v33, v33
    v_cvt_pk_bf16_f32 v86, v26, v27
    v_cvt_pk_bf16_f32 v87, v28, v29
    v_cvt_pk_bf16_f32 v88, v30, v31
    v_cvt_pk_bf16_f32 v89, v32, v33
    ds_read_b64_tr_b16 v[110:111], v121 offset:256
    ds_read_b64_tr_b16 v[112:113], v121 offset:384
    v_mfma_f32_32x32x16_bf16 v[50:65], v[102:105], v[86:89], v[50:65]
La2b_120:
    v_exp_f32 v34, v34
    v_exp_f32 v35, v35
    v_exp_f32 v36, v36
    v_exp_f32 v37, v37
    s_waitcnt lgkmcnt(4)
    v_mfma_f32_32x32x16_bf16 v[18:33], v[90:93], v[14:17], v[66:81]
    v_exp_f32 v38, v38
    v_exp_f32 v39, v39
    v_exp_f32 v40, v40
    v_exp_f32 v41, v41
    ds_read_b128 v[94:97], v120 offset:19584
    v_cvt_pk_bf16_f32 v82, v34, v35
    v_cvt_pk_bf16_f32 v83, v36, v37
    v_cvt_pk_bf16_f32 v84, v38, v39
    v_cvt_pk_bf16_f32 v85, v40, v41
    v_exp_f32 v42, v42
    v_exp_f32 v43, v43
    s_waitcnt lgkmcnt(1)
    v_mfma_f32_32x32x16_bf16 v[50:65], v[106:109], v[82:85], v[50:65]
    v_exp_f32 v44, v44
    v_exp_f32 v45, v45
    v_exp_f32 v46, v46
    v_add_u32 v121, v121, v122
    ds_read_b64_tr_b16 v[98:99], v121 offset:0
    ds_read_b64_tr_b16 v[100:101], v121 offset:128
    v_exp_f32 v47, v47
    v_exp_f32 v48, v48
    v_exp_f32 v49, v49
    v_cvt_pk_bf16_f32 v86, v42, v43
    v_cvt_pk_bf16_f32 v87, v44, v45
    v_cvt_pk_bf16_f32 v88, v46, v47
    v_cvt_pk_bf16_f32 v89, v48, v49
    ds_read_b64_tr_b16 v[102:103], v121 offset:256
    ds_read_b64_tr_b16 v[104:105], v121 offset:384
    v_mfma_f32_32x32x16_bf16 v[50:65], v[110:113], v[86:89], v[50:65]
La2b_121:
    v_exp_f32 v18, v18
    v_exp_f32 v19, v19
    v_exp_f32 v20, v20
    v_exp_f32 v21, v21
    s_waitcnt lgkmcnt(4)
    v_mfma_f32_32x32x16_bf16 v[34:49], v[94:97], v[14:17], v[66:81]
    v_exp_f32 v22, v22
    v_exp_f32 v23, v23
    v_exp_f32 v24, v24
    v_exp_f32 v25, v25
    ds_read_b128 v[90:93], v120 offset:20736
    v_cvt_pk_bf16_f32 v82, v18, v19
    v_cvt_pk_bf16_f32 v83, v20, v21
    v_cvt_pk_bf16_f32 v84, v22, v23
    v_cvt_pk_bf16_f32 v85, v24, v25
    v_exp_f32 v26, v26
    v_exp_f32 v27, v27
    s_waitcnt lgkmcnt(1)
    v_mfma_f32_32x32x16_bf16 v[50:65], v[98:101], v[82:85], v[50:65]
    v_exp_f32 v28, v28
    v_exp_f32 v29, v29
    v_exp_f32 v30, v30
    v_add_u32 v121, v121, v122
    ds_read_b64_tr_b16 v[106:107], v121 offset:0
    ds_read_b64_tr_b16 v[108:109], v121 offset:128
    v_exp_f32 v31, v31
    v_exp_f32 v32, v32
    v_exp_f32 v33, v33
    v_cvt_pk_bf16_f32 v86, v26, v27
    v_cvt_pk_bf16_f32 v87, v28, v29
    v_cvt_pk_bf16_f32 v88, v30, v31
    v_cvt_pk_bf16_f32 v89, v32, v33
    ds_read_b64_tr_b16 v[110:111], v121 offset:256
    ds_read_b64_tr_b16 v[112:113], v121 offset:384
    v_mfma_f32_32x32x16_bf16 v[50:65], v[102:105], v[86:89], v[50:65]
La2b_122:
    v_exp_f32 v34, v34
    v_exp_f32 v35, v35
    v_exp_f32 v36, v36
    v_exp_f32 v37, v37
    s_waitcnt lgkmcnt(4)
    v_mfma_f32_32x32x16_bf16 v[18:33], v[90:93], v[14:17], v[66:81]
    v_exp_f32 v38, v38
    v_exp_f32 v39, v39
    v_exp_f32 v40, v40
    v_exp_f32 v41, v41
    ds_read_b128 v[94:97], v120 offset:21888
    v_cvt_pk_bf16_f32 v82, v34, v35
    v_cvt_pk_bf16_f32 v83, v36, v37
    v_cvt_pk_bf16_f32 v84, v38, v39
    v_cvt_pk_bf16_f32 v85, v40, v41
    v_exp_f32 v42, v42
    v_exp_f32 v43, v43
    s_waitcnt lgkmcnt(1)
    v_mfma_f32_32x32x16_bf16 v[50:65], v[106:109], v[82:85], v[50:65]
    v_exp_f32 v44, v44
    v_exp_f32 v45, v45
    v_exp_f32 v46, v46
    v_add_u32 v121, v121, v122
    ds_read_b64_tr_b16 v[98:99], v121 offset:0
    ds_read_b64_tr_b16 v[100:101], v121 offset:128
    v_exp_f32 v47, v47
    v_exp_f32 v48, v48
    v_exp_f32 v49, v49
    v_cvt_pk_bf16_f32 v86, v42, v43
    v_cvt_pk_bf16_f32 v87, v44, v45
    v_cvt_pk_bf16_f32 v88, v46, v47
    v_cvt_pk_bf16_f32 v89, v48, v49
    ds_read_b64_tr_b16 v[102:103], v121 offset:256
    ds_read_b64_tr_b16 v[104:105], v121 offset:384
    v_mfma_f32_32x32x16_bf16 v[50:65], v[110:113], v[86:89], v[50:65]
La2b_123:
    v_exp_f32 v18, v18
    v_exp_f32 v19, v19
    v_exp_f32 v20, v20
    v_exp_f32 v21, v21
    s_waitcnt lgkmcnt(4)
    v_mfma_f32_32x32x16_bf16 v[34:49], v[94:97], v[14:17], v[66:81]
    v_exp_f32 v22, v22
    v_exp_f32 v23, v23
    v_exp_f32 v24, v24
    v_exp_f32 v25, v25
    ds_read_b128 v[90:93], v120 offset:23040
    v_cvt_pk_bf16_f32 v82, v18, v19
    v_cvt_pk_bf16_f32 v83, v20, v21
    v_cvt_pk_bf16_f32 v84, v22, v23
    v_cvt_pk_bf16_f32 v85, v24, v25
    v_exp_f32 v26, v26
    v_exp_f32 v27, v27
    s_waitcnt lgkmcnt(1)
    v_mfma_f32_32x32x16_bf16 v[50:65], v[98:101], v[82:85], v[50:65]
    v_exp_f32 v28, v28
    v_exp_f32 v29, v29
    v_exp_f32 v30, v30
    v_add_u32 v121, v121, v122
    ds_read_b64_tr_b16 v[106:107], v121 offset:0
    ds_read_b64_tr_b16 v[108:109], v121 offset:128
    v_exp_f32 v31, v31
    v_exp_f32 v32, v32
    v_exp_f32 v33, v33
    v_cvt_pk_bf16_f32 v86, v26, v27
    v_cvt_pk_bf16_f32 v87, v28, v29
    v_cvt_pk_bf16_f32 v88, v30, v31
    v_cvt_pk_bf16_f32 v89, v32, v33
    ds_read_b64_tr_b16 v[110:111], v121 offset:256
    ds_read_b64_tr_b16 v[112:113], v121 offset:384
    v_mfma_f32_32x32x16_bf16 v[50:65], v[102:105], v[86:89], v[50:65]
La2b_124:
    v_exp_f32 v34, v34
    v_exp_f32 v35, v35
    v_exp_f32 v36, v36
    v_exp_f32 v37, v37
    s_waitcnt lgkmcnt(4)
    v_mfma_f32_32x32x16_bf16 v[18:33], v[90:93], v[14:17], v[66:81]
    v_exp_f32 v38, v38
    v_exp_f32 v39, v39
    v_exp_f32 v40, v40
    v_exp_f32 v41, v41
    v_cvt_pk_bf16_f32 v82, v34, v35
    v_cvt_pk_bf16_f32 v83, v36, v37
    v_cvt_pk_bf16_f32 v84, v38, v39
    v_cvt_pk_bf16_f32 v85, v40, v41
    v_exp_f32 v42, v42
    v_exp_f32 v43, v43
    s_waitcnt lgkmcnt(0)
    v_mfma_f32_32x32x16_bf16 v[50:65], v[106:109], v[82:85], v[50:65]
    v_exp_f32 v44, v44
    v_exp_f32 v45, v45
    v_exp_f32 v46, v46
    v_add_u32 v121, v121, v122
    ds_read_b64_tr_b16 v[98:99], v121 offset:0
    ds_read_b64_tr_b16 v[100:101], v121 offset:128
    v_exp_f32 v47, v47
    v_exp_f32 v48, v48
    v_exp_f32 v49, v49
    v_cvt_pk_bf16_f32 v86, v42, v43
    v_cvt_pk_bf16_f32 v87, v44, v45
    v_cvt_pk_bf16_f32 v88, v46, v47
    v_cvt_pk_bf16_f32 v89, v48, v49
    ds_read_b64_tr_b16 v[102:103], v121 offset:256
    ds_read_b64_tr_b16 v[104:105], v121 offset:384
    v_mfma_f32_32x32x16_bf16 v[50:65], v[110:113], v[86:89], v[50:65]
La2b_125:
    v_exp_f32 v18, v18
    v_exp_f32 v19, v19
    v_exp_f32 v20, v20
    v_exp_f32 v21, v21
    v_exp_f32 v22, v22
    v_exp_f32 v23, v23
    v_exp_f32 v24, v24
    v_exp_f32 v25, v25
    v_cvt_pk_bf16_f32 v82, v18, v19
    v_cvt_pk_bf16_f32 v83, v20, v21
    v_cvt_pk_bf16_f32 v84, v22, v23
    v_cvt_pk_bf16_f32 v85, v24, v25
    v_and_b32 v82, v144, v82
    v_and_b32 v83, v145, v83
    v_and_b32 v84, v146, v84
    v_and_b32 v85, v147, v85
    v_exp_f32 v26, v26
    v_exp_f32 v27, v27
    s_waitcnt lgkmcnt(0)
    v_mfma_f32_32x32x16_bf16 v[50:65], v[98:101], v[82:85], v[50:65]
    v_exp_f32 v28, v28
    v_exp_f32 v29, v29
    v_exp_f32 v30, v30
    v_exp_f32 v31, v31
    v_exp_f32 v32, v32
    v_exp_f32 v33, v33
    v_cvt_pk_bf16_f32 v86, v26, v27
    v_cvt_pk_bf16_f32 v87, v28, v29
    v_cvt_pk_bf16_f32 v88, v30, v31
    v_cvt_pk_bf16_f32 v89, v32, v33
    v_and_b32 v86, v148, v86
    v_and_b32 v87, v149, v87
    v_and_b32 v88, v150, v88
    v_and_b32 v89, v151, v89
    s_nop 1
    v_mfma_f32_32x32x16_bf16 v[50:65], v[102:105], v[86:89], v[50:65]
    s_waitcnt lgkmcnt(0)
    s_nop 7
    s_nop 7
    s_branch Lredone_89
La1s_263:
    s_cmp_eq_u32 s83, 1
    s_cbranch_scc1 La1s_264
    s_cmp_eq_u32 s83, 2
    s_cbranch_scc1 La1s_265
    s_cmp_eq_u32 s83, 3
    s_cbranch_scc1 La1s_266
    s_cmp_eq_u32 s83, 4
    s_cbranch_scc1 La1s_267
    s_cmp_eq_u32 s83, 5
    s_cbranch_scc1 La1s_268
    s_cmp_eq_u32 s83, 6
    s_cbranch_scc1 La1s_269
    s_cmp_eq_u32 s83, 7
    s_cbranch_scc1 La1s_270
    s_cmp_eq_u32 s83, 8
    s_cbranch_scc1 La1s_271
    s_branch La1s_271
La1s_264:
    v_mfma_f32_32x32x16_bf16 v[34:49], v[70:73], v[10:13], 0
    v_mfma_f32_32x32x16_bf16 v[50:65], v[74:77], v[10:13], 0
    s_nop 7
    s_nop 1
    s_branch La1b_273
La1s_265:
    v_mfma_f32_32x32x16_bf16 v[50:65], v[74:77], v[10:13], 0
    v_mfma_f32_32x32x16_bf16 v[18:33], v[78:81], v[10:13], 0
    s_nop 7
    s_nop 1
    s_branch La1b_274
La1s_266:
    v_mfma_f32_32x32x16_bf16 v[18:33], v[78:81], v[10:13], 0
    v_mfma_f32_32x32x16_bf16 v[34:49], v[82:85], v[10:13], 0
    s_nop 7
    s_nop 1
    s_branch La1b_275
La1s_267:
    v_mfma_f32_32x32x16_bf16 v[34:49], v[82:85], v[10:13], 0
    v_mfma_f32_32x32x16_bf16 v[50:65], v[86:89], v[10:13], 0
    s_nop 7
    s_nop 1
    s_branch La1b_276
La1s_268:
    v_mfma_f32_32x32x16_bf16 v[50:65], v[86:89], v[10:13], 0
    v_mfma_f32_32x32x16_bf16 v[18:33], v[90:93], v[10:13], 0
    s_nop 7
    s_nop 1
    s_branch La1b_277
La1s_269:
    v_mfma_f32_32x32x16_bf16 v[18:33], v[90:93], v[10:13], 0
    v_mfma_f32_32x32x16_bf16 v[34:49], v[94:97], v[10:13], 0
    s_nop 7
    s_nop 1
    s_branch La1b_278
La1s_270:
    v_mfma_f32_32x32x16_bf16 v[34:49], v[94:97], v[10:13], 0
    v_mfma_f32_32x32x16_bf16 v[50:65], v[98:101], v[10:13], 0
    s_nop 7
    s_nop 1
    s_branch La1b_279
La1s_271:
    v_mfma_f32_32x32x16_bf16 v[50:65], v[98:101], v[10:13], 0
    s_nop 7
    s_nop 1
    s_branch La1b_280
La2s_281:
    s_cmp_eq_u32 s83, 1
    s_cbranch_scc1 La2s_282
    s_cmp_eq_u32 s83, 2
    s_cbranch_scc1 La2s_283
    s_cmp_eq_u32 s83, 3
    s_cbranch_scc1 La2s_284
    s_cmp_eq_u32 s83, 4
    s_cbranch_scc1 La2s_285
    s_cmp_eq_u32 s83, 5
    s_cbranch_scc1 La2s_286
    s_cmp_eq_u32 s83, 6
    s_cbranch_scc1 La2s_287
    s_cmp_eq_u32 s83, 7
    s_cbranch_scc1 La2s_288
    s_cmp_eq_u32 s83, 8
    s_cbranch_scc1 La2s_289
    s_branch La2s_289
La2s_282:
    v_mov_b32 v50, 0
    v_mov_b32 v51, 0
    v_mov_b32 v52, 0
    v_mov_b32 v53, 0
    v_mov_b32 v54, 0
    v_mov_b32 v55, 0
    v_mov_b32 v56, 0
    v_mov_b32 v57, 0
    v_mov_b32 v58, 0
    v_mov_b32 v59, 0
    v_mov_b32 v60, 0
    v_mov_b32 v61, 0
    v_mov_b32 v62, 0
    v_mov_b32 v63, 0
    v_mov_b32 v64, 0
    v_mov_b32 v65, 0
    ds_read_b128 v[94:97], v120 offset:1152
    ds_read_b128 v[90:93], v120 offset:2304
    ds_read_b64_tr_b16 v[106:107], v121 offset:0
    ds_read_b64_tr_b16 v[108:109], v121 offset:128
    ds_read_b64_tr_b16 v[110:111], v121 offset:256
    ds_read_b64_tr_b16 v[112:113], v121 offset:384
    s_waitcnt lgkmcnt(5)
    v_mfma_f32_32x32x16_bf16 v[34:49], v[94:97], v[10:13], v[66:81]
    s_nop 7
    s_nop 3
    s_branch La2b_291
La2s_283:
    v_mov_b32 v50, 0
    v_mov_b32 v51, 0
    v_mov_b32 v52, 0
    v_mov_b32 v53, 0
    v_mov_b32 v54, 0
    v_mov_b32 v55, 0
    v_mov_b32 v56, 0
    v_mov_b32 v57, 0
    v_mov_b32 v58, 0
    v_mov_b32 v59, 0
    v_mov_b32 v60, 0
    v_mov_b32 v61, 0
    v_mov_b32 v62, 0
    v_mov_b32 v63, 0
    v_mov_b32 v64, 0
    v_mov_b32 v65, 0
    ds_read_b128 v[90:93], v120 offset:2304
    ds_read_b128 v[94:97], v120 offset:3456
    ds_read_b64_tr_b16 v[98:99], v121 offset:0
    ds_read_b64_tr_b16 v[100:101], v121 offset:128
    ds_read_b64_tr_b16 v[102:103], v121 offset:256
    ds_read_b64_tr_b16 v[104:105], v121 offset:384
    s_waitcnt lgkmcnt(5)
    v_mfma_f32_32x32x16_bf16 v[18:33], v[90:93], v[10:13], v[66:81]
    s_nop 7
    s_nop 3
    s_branch La2b_292
La2s_284:
    v_mov_b32 v50, 0
    v_mov_b32 v51, 0
    v_mov_b32 v52, 0
    v_mov_b32 v53, 0
    v_mov_b32 v54, 0
    v_mov_b32 v55, 0
    v_mov_b32 v56, 0
    v_mov_b32 v57, 0
    v_mov_b32 v58, 0
    v_mov_b32 v59, 0
    v_mov_b32 v60, 0
    v_mov_b32 v61, 0
    v_mov_b32 v62, 0
    v_mov_b32 v63, 0
    v_mov_b32 v64, 0
    v_mov_b32 v65, 0
    ds_read_b128 v[94:97], v120 offset:3456
    ds_read_b128 v[90:93], v120 offset:4608
    ds_read_b64_tr_b16 v[106:107], v121 offset:0
    ds_read_b64_tr_b16 v[108:109], v121 offset:128
    ds_read_b64_tr_b16 v[110:111], v121 offset:256
    ds_read_b64_tr_b16 v[112:113], v121 offset:384
    s_waitcnt lgkmcnt(5)
    v_mfma_f32_32x32x16_bf16 v[34:49], v[94:97], v[10:13], v[66:81]
    s_nop 7
    s_nop 3
    s_branch La2b_293
La2s_285:
    v_mov_b32 v50, 0
    v_mov_b32 v51, 0
    v_mov_b32 v52, 0
    v_mov_b32 v53, 0
    v_mov_b32 v54, 0
    v_mov_b32 v55, 0
    v_mov_b32 v56, 0
    v_mov_b32 v57, 0
    v_mov_b32 v58, 0
    v_mov_b32 v59, 0
    v_mov_b32 v60, 0
    v_mov_b32 v61, 0
    v_mov_b32 v62, 0
    v_mov_b32 v63, 0
    v_mov_b32 v64, 0
    v_mov_b32 v65, 0
    ds_read_b128 v[90:93], v120 offset:4608
    ds_read_b128 v[94:97], v120 offset:5760
    ds_read_b64_tr_b16 v[98:99], v121 offset:0
    ds_read_b64_tr_b16 v[100:101], v121 offset:128
    ds_read_b64_tr_b16 v[102:103], v121 offset:256
    ds_read_b64_tr_b16 v[104:105], v121 offset:384
    s_waitcnt lgkmcnt(5)
    v_mfma_f32_32x32x16_bf16 v[18:33], v[90:93], v[10:13], v[66:81]
    s_nop 7
    s_nop 3
    s_branch La2b_294
La2s_286:
    v_mov_b32 v50, 0
    v_mov_b32 v51, 0
    v_mov_b32 v52, 0
    v_mov_b32 v53, 0
    v_mov_b32 v54, 0
    v_mov_b32 v55, 0
    v_mov_b32 v56, 0
    v_mov_b32 v57, 0
    v_mov_b32 v58, 0
    v_mov_b32 v59, 0
    v_mov_b32 v60, 0
    v_mov_b32 v61, 0
    v_mov_b32 v62, 0
    v_mov_b32 v63, 0
    v_mov_b32 v64, 0
    v_mov_b32 v65, 0
    ds_read_b128 v[94:97], v120 offset:5760
    ds_read_b128 v[90:93], v120 offset:6912
    ds_read_b64_tr_b16 v[106:107], v121 offset:0
    ds_read_b64_tr_b16 v[108:109], v121 offset:128
    ds_read_b64_tr_b16 v[110:111], v121 offset:256
    ds_read_b64_tr_b16 v[112:113], v121 offset:384
    s_waitcnt lgkmcnt(5)
    v_mfma_f32_32x32x16_bf16 v[34:49], v[94:97], v[10:13], v[66:81]
    s_nop 7
    s_nop 3
    s_branch La2b_295
La2s_287:
    v_mov_b32 v50, 0
    v_mov_b32 v51, 0
    v_mov_b32 v52, 0
    v_mov_b32 v53, 0
    v_mov_b32 v54, 0
    v_mov_b32 v55, 0
    v_mov_b32 v56, 0
    v_mov_b32 v57, 0
    v_mov_b32 v58, 0
    v_mov_b32 v59, 0
    v_mov_b32 v60, 0
    v_mov_b32 v61, 0
    v_mov_b32 v62, 0
    v_mov_b32 v63, 0
    v_mov_b32 v64, 0
    v_mov_b32 v65, 0
    ds_read_b128 v[90:93], v120 offset:6912
    ds_read_b128 v[94:97], v120 offset:8064
    ds_read_b64_tr_b16 v[98:99], v121 offset:0
    ds_read_b64_tr_b16 v[100:101], v121 offset:128
    ds_read_b64_tr_b16 v[102:103], v121 offset:256
    ds_read_b64_tr_b16 v[104:105], v121 offset:384
    s_waitcnt lgkmcnt(5)
    v_mfma_f32_32x32x16_bf16 v[18:33], v[90:93], v[10:13], v[66:81]
    s_nop 7
    s_nop 3
    s_branch La2b_296
La2s_288:
    v_mov_b32 v50, 0
    v_mov_b32 v51, 0
    v_mov_b32 v52, 0
    v_mov_b32 v53, 0
    v_mov_b32 v54, 0
    v_mov_b32 v55, 0
    v_mov_b32 v56, 0
    v_mov_b32 v57, 0
    v_mov_b32 v58, 0
    v_mov_b32 v59, 0
    v_mov_b32 v60, 0
    v_mov_b32 v61, 0
    v_mov_b32 v62, 0
    v_mov_b32 v63, 0
    v_mov_b32 v64, 0
    v_mov_b32 v65, 0
    ds_read_b128 v[94:97], v120 offset:8064
    ds_read_b128 v[90:93], v120 offset:9216
    ds_read_b64_tr_b16 v[106:107], v121 offset:0
    ds_read_b64_tr_b16 v[108:109], v121 offset:128
    ds_read_b64_tr_b16 v[110:111], v121 offset:256
    ds_read_b64_tr_b16 v[112:113], v121 offset:384
    s_waitcnt lgkmcnt(5)
    v_mfma_f32_32x32x16_bf16 v[34:49], v[94:97], v[10:13], v[66:81]
    s_nop 7
    s_nop 3
    s_branch La2b_297
La2s_289:
    v_mov_b32 v50, 0
    v_mov_b32 v51, 0
    v_mov_b32 v52, 0
    v_mov_b32 v53, 0
    v_mov_b32 v54, 0
    v_mov_b32 v55, 0
    v_mov_b32 v56, 0
    v_mov_b32 v57, 0
    v_mov_b32 v58, 0
    v_mov_b32 v59, 0
    v_mov_b32 v60, 0
    v_mov_b32 v61, 0
    v_mov_b32 v62, 0
    v_mov_b32 v63, 0
    v_mov_b32 v64, 0
    v_mov_b32 v65, 0
    ds_read_b128 v[90:93], v120 offset:9216
    ds_read_b64_tr_b16 v[98:99], v121 offset:0
    ds_read_b64_tr_b16 v[100:101], v121 offset:128
    ds_read_b64_tr_b16 v[102:103], v121 offset:256
    ds_read_b64_tr_b16 v[104:105], v121 offset:384
    s_waitcnt lgkmcnt(4)
    v_mfma_f32_32x32x16_bf16 v[18:33], v[90:93], v[10:13], v[66:81]
    s_nop 7
    s_nop 3
    s_branch La2b_298
Lredo_261:
    s_nop 7
    ds_read_b128 v[66:69], v120 offset:0
    ds_read_b128 v[70:73], v120 offset:1152
    ds_read_b128 v[74:77], v120 offset:2304
    ds_read_b128 v[78:81], v120 offset:3456
    ds_read_b128 v[82:85], v120 offset:4608
    ds_read_b128 v[86:89], v120 offset:5760
    ds_read_b128 v[90:93], v120 offset:6912
    ds_read_b128 v[94:97], v120 offset:8064
    ds_read_b128 v[98:101], v120 offset:9216
    v_mov_b32 v114, v118
    v_mov_b32 v115, v118
    s_waitcnt lgkmcnt(0)
    s_cmp_lg_u32 s83, 0
    s_cbranch_scc1 La1s_263
    v_mfma_f32_32x32x16_bf16 v[18:33], v[66:69], v[10:13], 0
    v_mfma_f32_32x32x16_bf16 v[34:49], v[70:73], v[10:13], 0
    s_nop 7
    s_nop 1
La1b_272:
    v_mfma_f32_32x32x16_bf16 v[50:65], v[74:77], v[10:13], 0
    v_cndmask_b32 v18, v18, v118, s[44:45]
    v_cndmask_b32 v19, v19, v118, s[46:47]
    v_cndmask_b32 v20, v20, v118, s[48:49]
    v_cndmask_b32 v21, v21, v118, s[50:51]
    v_cndmask_b32 v22, v22, v118, s[52:53]
    v_cndmask_b32 v23, v23, v118, s[54:55]
    v_cndmask_b32 v24, v24, v118, s[56:57]
    v_cndmask_b32 v25, v25, v118, s[58:59]
    v_cndmask_b32 v26, v26, v118, s[60:61]
    v_cndmask_b32 v27, v27, v118, s[62:63]
    v_cndmask_b32 v28, v28, v118, s[64:65]
    v_cndmask_b32 v29, v29, v118, s[66:67]
    v_cndmask_b32 v30, v30, v118, s[68:69]
    v_cndmask_b32 v31, v31, v118, s[70:71]
    v_cndmask_b32 v32, v32, v118, s[72:73]
    v_cndmask_b32 v33, v33, v118, s[74:75]
    v_max3_f32 v114, v114, v18, v19
    v_max3_f32 v115, v115, v20, v21
    v_max3_f32 v114, v114, v22, v23
    v_max3_f32 v115, v115, v24, v25
    v_max3_f32 v114, v114, v26, v27
    v_max3_f32 v115, v115, v28, v29
    v_max3_f32 v114, v114, v30, v31
    v_max3_f32 v115, v115, v32, v33
La1b_273:
    v_mfma_f32_32x32x16_bf16 v[18:33], v[78:81], v[10:13], 0
    v_max3_f32 v114, v114, v34, v35
    v_max3_f32 v115, v115, v36, v37
    v_max3_f32 v114, v114, v38, v39
    v_max3_f32 v115, v115, v40, v41
    v_max3_f32 v114, v114, v42, v43
    v_max3_f32 v115, v115, v44, v45
    v_max3_f32 v114, v114, v46, v47
    v_max3_f32 v115, v115, v48, v49
La1b_274:
    v_mfma_f32_32x32x16_bf16 v[34:49], v[82:85], v[10:13], 0
    v_max3_f32 v114, v114, v50, v51
    v_max3_f32 v115, v115, v52, v53
    v_max3_f32 v114, v114, v54, v55
    v_max3_f32 v115, v115, v56, v57
    v_max3_f32 v114, v114, v58, v59
    v_max3_f32 v115, v115, v60, v61
    v_max3_f32 v114, v114, v62, v63
    v_max3_f32 v115, v115, v64, v65
La1b_275:
    v_mfma_f32_32x32x16_bf16 v[50:65], v[86:89], v[10:13], 0
    v_max3_f32 v114, v114, v18, v19
    v_max3_f32 v115, v115, v20, v21
    v_max3_f32 v114, v114, v22, v23
    v_max3_f32 v115, v115, v24, v25
    v_max3_f32 v114, v114, v26, v27
    v_max3_f32 v115, v115, v28, v29
    v_max3_f32 v114, v114, v30, v31
    v_max3_f32 v115, v115, v32, v33
La1b_276:
    v_mfma_f32_32x32x16_bf16 v[18:33], v[90:93], v[10:13], 0
    v_max3_f32 v114, v114, v34, v35
    v_max3_f32 v115, v115, v36, v37
    v_max3_f32 v114, v114, v38, v39
    v_max3_f32 v115, v115, v40, v41
    v_max3_f32 v114, v114, v42, v43
    v_max3_f32 v115, v115, v44, v45
    v_max3_f32 v114, v114, v46, v47
    v_max3_f32 v115, v115, v48, v49
La1b_277:
    v_mfma_f32_32x32x16_bf16 v[34:49], v[94:97], v[10:13], 0
    v_max3_f32 v114, v114, v50, v51
    v_max3_f32 v115, v115, v52, v53
    v_max3_f32 v114, v114, v54, v55
    v_max3_f32 v115, v115, v56, v57
    v_max3_f32 v114, v114, v58, v59
    v_max3_f32 v115, v115, v60, v61
    v_max3_f32 v114, v114, v62, v63
    v_max3_f32 v115, v115, v64, v65
La1b_278:
    v_mfma_f32_32x32x16_bf16 v[50:65], v[98:101], v[10:13], 0
    v_max3_f32 v114, v114, v18, v19
    v_max3_f32 v115, v115, v20, v21
    v_max3_f32 v114, v114, v22, v23
    v_max3_f32 v115, v115, v24, v25
    v_max3_f32 v114, v114, v26, v27
    v_max3_f32 v115, v115, v28, v29
    v_max3_f32 v114, v114, v30, v31
    v_max3_f32 v115, v115, v32, v33
La1b_279:
    v_max3_f32 v114, v114, v34, v35
    v_max3_f32 v115, v115, v36, v37
    v_max3_f32 v114, v114, v38, v39
    v_max3_f32 v115, v115, v40, v41
    v_max3_f32 v114, v114, v42, v43
    v_max3_f32 v115, v115, v44, v45
    v_max3_f32 v114, v114, v46, v47
    v_max3_f32 v115, v115, v48, v49
La1b_280:
    v_cndmask_b32 v50, v118, v50, s[44:45]
    v_cndmask_b32 v51, v118, v51, s[46:47]
    v_cndmask_b32 v52, v118, v52, s[48:49]
    v_cndmask_b32 v53, v118, v53, s[50:51]
    v_cndmask_b32 v54, v118, v54, s[52:53]
    v_cndmask_b32 v55, v118, v55, s[54:55]
    v_cndmask_b32 v56, v118, v56, s[56:57]
    v_cndmask_b32 v57, v118, v57, s[58:59]
    v_cndmask_b32 v58, v118, v58, s[60:61]
    v_cndmask_b32 v59, v118, v59, s[62:63]
    v_cndmask_b32 v60, v118, v60, s[64:65]
    v_cndmask_b32 v61, v118, v61, s[66:67]
    v_cndmask_b32 v62, v118, v62, s[68:69]
    v_cndmask_b32 v63, v118, v63, s[70:71]
    v_cndmask_b32 v64, v118, v64, s[72:73]
    v_cndmask_b32 v65, v118, v65, s[74:75]
    v_max3_f32 v114, v114, v50, v51
    v_max3_f32 v115, v115, v52, v53
    v_max3_f32 v114, v114, v54, v55
    v_max3_f32 v115, v115, v56, v57
    v_max3_f32 v114, v114, v58, v59
    v_max3_f32 v115, v115, v60, v61
    v_max3_f32 v114, v114, v62, v63
    v_max3_f32 v115, v115, v64, v65
    v_max_f32 v114, v114, v115
    v_mov_b32 v116, v114
    s_nop 1
    v_permlane32_swap_b32 v114, v116
    v_max_f32 v114, v114, v116
    v_mul_f32 v66, -1.0, v114
    v_mul_f32 v67, -1.0, v114
    v_mul_f32 v68, -1.0, v114
    v_mul_f32 v69, -1.0, v114
    v_mul_f32 v70, -1.0, v114
    v_mul_f32 v71, -1.0, v114
    v_mul_f32 v72, -1.0, v114
    v_mul_f32 v73, -1.0, v114
    v_mul_f32 v74, -1.0, v114
    v_mul_f32 v75, -1.0, v114
    v_mul_f32 v76, -1.0, v114
    v_mul_f32 v77, -1.0, v114
    v_mul_f32 v78, -1.0, v114
    v_mul_f32 v79, -1.0, v114
    v_mul_f32 v80, -1.0, v114
    v_mul_f32 v81, -1.0, v114
    v_mov_b32 v121, v123
    s_cmp_lg_u32 s83, 0
    s_cbranch_scc1 La2s_281
    ds_read_b128 v[90:93], v120 offset:0
    ds_read_b128 v[94:97], v120 offset:1152
    ds_read_b64_tr_b16 v[98:99], v121 offset:0
    ds_read_b64_tr_b16 v[100:101], v121 offset:128
    ds_read_b64_tr_b16 v[102:103], v121 offset:256
    ds_read_b64_tr_b16 v[104:105], v121 offset:384
    s_waitcnt lgkmcnt(5)
    v_mfma_f32_32x32x16_bf16 v[18:33], v[90:93], v[10:13], v[66:81]
    s_nop 7
    s_nop 3
La2b_290:
    v_exp_f32 v18, v18
    v_exp_f32 v19, v19
    v_exp_f32 v20, v20
    v_exp_f32 v21, v21
    s_waitcnt lgkmcnt(4)
    v_mfma_f32_32x32x16_bf16 v[34:49], v[94:97], v[10:13], v[66:81]
    v_exp_f32 v22, v22
    v_exp_f32 v23, v23
    v_exp_f32 v24, v24
    v_exp_f32 v25, v25
    ds_read_b128 v[90:93], v120 offset:2304
    v_cvt_pk_bf16_f32 v82, v18, v19
    v_cvt_pk_bf16_f32 v83, v20, v21
    v_cvt_pk_bf16_f32 v84, v22, v23
    v_cvt_pk_bf16_f32 v85, v24, v25
    v_bfi_b32 v82, v126, 0, v82
    v_bfi_b32 v83, v127, 0, v83
    v_bfi_b32 v84, v128, 0, v84
    v_bfi_b32 v85, v129, 0, v85
    v_exp_f32 v26, v26
    v_exp_f32 v27, v27
    s_waitcnt lgkmcnt(1)
    v_mfma_f32_32x32x16_bf16 v[50:65], v[98:101], v[82:85], 0
    v_exp_f32 v28, v28
    v_exp_f32 v29, v29
    v_exp_f32 v30, v30
    v_add_u32 v121, v121, v122
    ds_read_b64_tr_b16 v[106:107], v121 offset:0
    ds_read_b64_tr_b16 v[108:109], v121 offset:128
    v_exp_f32 v31, v31
    v_exp_f32 v32, v32
    v_exp_f32 v33, v33
    v_cvt_pk_bf16_f32 v86, v26, v27
    v_cvt_pk_bf16_f32 v87, v28, v29
    v_cvt_pk_bf16_f32 v88, v30, v31
    v_cvt_pk_bf16_f32 v89, v32, v33
    v_bfi_b32 v86, v130, 0, v86
    v_bfi_b32 v87, v131, 0, v87
    v_bfi_b32 v88, v132, 0, v88
    v_bfi_b32 v89, v133, 0, v89
    ds_read_b64_tr_b16 v[110:111], v121 offset:256
    ds_read_b64_tr_b16 v[112:113], v121 offset:384
    v_mfma_f32_32x32x16_bf16 v[50:65], v[102:105], v[86:89], v[50:65]
La2b_291:
    v_exp_f32 v34, v34
    v_exp_f32 v35, v35
    v_exp_f32 v36, v36
    v_exp_f32 v37, v37
    s_waitcnt lgkmcnt(4)
    v_mfma_f32_32x32x16_bf16 v[18:33], v[90:93], v[10:13], v[66:81]
    v_exp_f32 v38, v38
    v_exp_f32 v39, v39
    v_exp_f32 v40, v40
    v_exp_f32 v41, v41
    ds_read_b128 v[94:97], v120 offset:3456
    v_cvt_pk_bf16_f32 v82, v34, v35
    v_cvt_pk_bf16_f32 v83, v36, v37
    v_cvt_pk_bf16_f32 v84, v38, v39
    v_cvt_pk_bf16_f32 v85, v40, v41
    v_exp_f32 v42, v42
    v_exp_f32 v43, v43
    s_waitcnt lgkmcnt(1)
    v_mfma_f32_32x32x16_bf16 v[50:65], v[106:109], v[82:85], v[50:65]
    v_exp_f32 v44, v44
    v_exp_f32 v45, v45
    v_exp_f32 v46, v46
    v_add_u32 v121, v121, v122
    ds_read_b64_tr_b16 v[98:99], v121 offset:0
    ds_read_b64_tr_b16 v[100:101], v121 offset:128
    v_exp_f32 v47, v47
    v_exp_f32 v48, v48
    v_exp_f32 v49, v49
    v_cvt_pk_bf16_f32 v86, v42, v43
    v_cvt_pk_bf16_f32 v87, v44, v45
    v_cvt_pk_bf16_f32 v88, v46, v47
    v_cvt_pk_bf16_f32 v89, v48, v49
    ds_read_b64_tr_b16 v[102:103], v121 offset:256
    ds_read_b64_tr_b16 v[104:105], v121 offset:384
    v_mfma_f32_32x32x16_bf16 v[50:65], v[110:113], v[86:89], v[50:65]
La2b_292:
    v_exp_f32 v18, v18
    v_exp_f32 v19, v19
    v_exp_f32 v20, v20
    v_exp_f32 v21, v21
    s_waitcnt lgkmcnt(4)
    v_mfma_f32_32x32x16_bf16 v[34:49], v[94:97], v[10:13], v[66:81]
    v_exp_f32 v22, v22
    v_exp_f32 v23, v23
    v_exp_f32 v24, v24
    v_exp_f32 v25, v25
    ds_read_b128 v[90:93], v120 offset:4608
    v_cvt_pk_bf16_f32 v82, v18, v19
    v_cvt_pk_bf16_f32 v83, v20, v21
    v_cvt_pk_bf16_f32 v84, v22, v23
    v_cvt_pk_bf16_f32 v85, v24, v25
    v_exp_f32 v26, v26
    v_exp_f32 v27, v27
    s_waitcnt lgkmcnt(1)
    v_mfma_f32_32x32x16_bf16 v[50:65], v[98:101], v[82:85], v[50:65]
    v_exp_f32 v28, v28
    v_exp_f32 v29, v29
    v_exp_f32 v30, v30
    v_add_u32 v121, v121, v122
    ds_read_b64_tr_b16 v[106:107], v121 offset:0
    ds_read_b64_tr_b16 v[108:109], v121 offset:128
    v_exp_f32 v31, v31
    v_exp_f32 v32, v32
    v_exp_f32 v33, v33
    v_cvt_pk_bf16_f32 v86, v26, v27
    v_cvt_pk_bf16_f32 v87, v28, v29
    v_cvt_pk_bf16_f32 v88, v30, v31
    v_cvt_pk_bf16_f32 v89, v32, v33
    ds_read_b64_tr_b16 v[110:111], v121 offset:256
    ds_read_b64_tr_b16 v[112:113], v121 offset:384
    v_mfma_f32_32x32x16_bf16 v[50:65], v[102:105], v[86:89], v[50:65]
La2b_293:
    v_exp_f32 v34, v34
    v_exp_f32 v35, v35
    v_exp_f32 v36, v36
    v_exp_f32 v37, v37
    s_waitcnt lgkmcnt(4)
    v_mfma_f32_32x32x16_bf16 v[18:33], v[90:93], v[10:13], v[66:81]
    v_exp_f32 v38, v38
    v_exp_f32 v39, v39
    v_exp_f32 v40, v40
    v_exp_f32 v41, v41
    ds_read_b128 v[94:97], v120 offset:5760
    v_cvt_pk_bf16_f32 v82, v34, v35
    v_cvt_pk_bf16_f32 v83, v36, v37
    v_cvt_pk_bf16_f32 v84, v38, v39
    v_cvt_pk_bf16_f32 v85, v40, v41
    v_exp_f32 v42, v42
    v_exp_f32 v43, v43
    s_waitcnt lgkmcnt(1)
    v_mfma_f32_32x32x16_bf16 v[50:65], v[106:109], v[82:85], v[50:65]
    v_exp_f32 v44, v44
    v_exp_f32 v45, v45
    v_exp_f32 v46, v46
    v_add_u32 v121, v121, v122
    ds_read_b64_tr_b16 v[98:99], v121 offset:0
    ds_read_b64_tr_b16 v[100:101], v121 offset:128
    v_exp_f32 v47, v47
    v_exp_f32 v48, v48
    v_exp_f32 v49, v49
    v_cvt_pk_bf16_f32 v86, v42, v43
    v_cvt_pk_bf16_f32 v87, v44, v45
    v_cvt_pk_bf16_f32 v88, v46, v47
    v_cvt_pk_bf16_f32 v89, v48, v49
    ds_read_b64_tr_b16 v[102:103], v121 offset:256
    ds_read_b64_tr_b16 v[104:105], v121 offset:384
    v_mfma_f32_32x32x16_bf16 v[50:65], v[110:113], v[86:89], v[50:65]
La2b_294:
    v_exp_f32 v18, v18
    v_exp_f32 v19, v19
    v_exp_f32 v20, v20
    v_exp_f32 v21, v21
    s_waitcnt lgkmcnt(4)
    v_mfma_f32_32x32x16_bf16 v[34:49], v[94:97], v[10:13], v[66:81]
    v_exp_f32 v22, v22
    v_exp_f32 v23, v23
    v_exp_f32 v24, v24
    v_exp_f32 v25, v25
    ds_read_b128 v[90:93], v120 offset:6912
    v_cvt_pk_bf16_f32 v82, v18, v19
    v_cvt_pk_bf16_f32 v83, v20, v21
    v_cvt_pk_bf16_f32 v84, v22, v23
    v_cvt_pk_bf16_f32 v85, v24, v25
    v_exp_f32 v26, v26
    v_exp_f32 v27, v27
    s_waitcnt lgkmcnt(1)
    v_mfma_f32_32x32x16_bf16 v[50:65], v[98:101], v[82:85], v[50:65]
    v_exp_f32 v28, v28
    v_exp_f32 v29, v29
    v_exp_f32 v30, v30
    v_add_u32 v121, v121, v122
    ds_read_b64_tr_b16 v[106:107], v121 offset:0
    ds_read_b64_tr_b16 v[108:109], v121 offset:128
    v_exp_f32 v31, v31
    v_exp_f32 v32, v32
    v_exp_f32 v33, v33
    v_cvt_pk_bf16_f32 v86, v26, v27
    v_cvt_pk_bf16_f32 v87, v28, v29
    v_cvt_pk_bf16_f32 v88, v30, v31
    v_cvt_pk_bf16_f32 v89, v32, v33
    ds_read_b64_tr_b16 v[110:111], v121 offset:256
    ds_read_b64_tr_b16 v[112:113], v121 offset:384
    v_mfma_f32_32x32x16_bf16 v[50:65], v[102:105], v[86:89], v[50:65]
La2b_295:
    v_exp_f32 v34, v34
    v_exp_f32 v35, v35
    v_exp_f32 v36, v36
    v_exp_f32 v37, v37
    s_waitcnt lgkmcnt(4)
    v_mfma_f32_32x32x16_bf16 v[18:33], v[90:93], v[10:13], v[66:81]
    v_exp_f32 v38, v38
    v_exp_f32 v39, v39
    v_exp_f32 v40, v40
    v_exp_f32 v41, v41
    ds_read_b128 v[94:97], v120 offset:8064
    v_cvt_pk_bf16_f32 v82, v34, v35
    v_cvt_pk_bf16_f32 v83, v36, v37
    v_cvt_pk_bf16_f32 v84, v38, v39
    v_cvt_pk_bf16_f32 v85, v40, v41
    v_exp_f32 v42, v42
    v_exp_f32 v43, v43
    s_waitcnt lgkmcnt(1)
    v_mfma_f32_32x32x16_bf16 v[50:65], v[106:109], v[82:85], v[50:65]
    v_exp_f32 v44, v44
    v_exp_f32 v45, v45
    v_exp_f32 v46, v46
    v_add_u32 v121, v121, v122
    ds_read_b64_tr_b16 v[98:99], v121 offset:0
    ds_read_b64_tr_b16 v[100:101], v121 offset:128
    v_exp_f32 v47, v47
    v_exp_f32 v48, v48
    v_exp_f32 v49, v49
    v_cvt_pk_bf16_f32 v86, v42, v43
    v_cvt_pk_bf16_f32 v87, v44, v45
    v_cvt_pk_bf16_f32 v88, v46, v47
    v_cvt_pk_bf16_f32 v89, v48, v49
    ds_read_b64_tr_b16 v[102:103], v121 offset:256
    ds_read_b64_tr_b16 v[104:105], v121 offset:384
    v_mfma_f32_32x32x16_bf16 v[50:65], v[110:113], v[86:89], v[50:65]
La2b_296:
    v_exp_f32 v18, v18
    v_exp_f32 v19, v19
    v_exp_f32 v20, v20
    v_exp_f32 v21, v21
    s_waitcnt lgkmcnt(4)
    v_mfma_f32_32x32x16_bf16 v[34:49], v[94:97], v[10:13], v[66:81]
    v_exp_f32 v22, v22
    v_exp_f32 v23, v23
    v_exp_f32 v24, v24
    v_exp_f32 v25, v25
    ds_read_b128 v[90:93], v120 offset:9216
    v_cvt_pk_bf16_f32 v82, v18, v19
    v_cvt_pk_bf16_f32 v83, v20, v21
    v_cvt_pk_bf16_f32 v84, v22, v23
    v_cvt_pk_bf16_f32 v85, v24, v25
    v_exp_f32 v26, v26
    v_exp_f32 v27, v27
    s_waitcnt lgkmcnt(1)
    v_mfma_f32_32x32x16_bf16 v[50:65], v[98:101], v[82:85], v[50:65]
    v_exp_f32 v28, v28
    v_exp_f32 v29, v29
    v_exp_f32 v30, v30
    v_add_u32 v121, v121, v122
    ds_read_b64_tr_b16 v[106:107], v121 offset:0
    ds_read_b64_tr_b16 v[108:109], v121 offset:128
    v_exp_f32 v31, v31
    v_exp_f32 v32, v32
    v_exp_f32 v33, v33
    v_cvt_pk_bf16_f32 v86, v26, v27
    v_cvt_pk_bf16_f32 v87, v28, v29
    v_cvt_pk_bf16_f32 v88, v30, v31
    v_cvt_pk_bf16_f32 v89, v32, v33
    ds_read_b64_tr_b16 v[110:111], v121 offset:256
    ds_read_b64_tr_b16 v[112:113], v121 offset:384
    v_mfma_f32_32x32x16_bf16 v[50:65], v[102:105], v[86:89], v[50:65]
La2b_297:
    v_exp_f32 v34, v34
    v_exp_f32 v35, v35
    v_exp_f32 v36, v36
    v_exp_f32 v37, v37
    s_waitcnt lgkmcnt(4)
    v_mfma_f32_32x32x16_bf16 v[18:33], v[90:93], v[10:13], v[66:81]
    v_exp_f32 v38, v38
    v_exp_f32 v39, v39
    v_exp_f32 v40, v40
    v_exp_f32 v41, v41
    v_cvt_pk_bf16_f32 v82, v34, v35
    v_cvt_pk_bf16_f32 v83, v36, v37
    v_cvt_pk_bf16_f32 v84, v38, v39
    v_cvt_pk_bf16_f32 v85, v40, v41
    v_exp_f32 v42, v42
    v_exp_f32 v43, v43
    s_waitcnt lgkmcnt(0)
    v_mfma_f32_32x32x16_bf16 v[50:65], v[106:109], v[82:85], v[50:65]
    v_exp_f32 v44, v44
    v_exp_f32 v45, v45
    v_exp_f32 v46, v46
    v_add_u32 v121, v121, v122
    ds_read_b64_tr_b16 v[98:99], v121 offset:0
    ds_read_b64_tr_b16 v[100:101], v121 offset:128
    v_exp_f32 v47, v47
    v_exp_f32 v48, v48
    v_exp_f32 v49, v49
    v_cvt_pk_bf16_f32 v86, v42, v43
    v_cvt_pk_bf16_f32 v87, v44, v45
    v_cvt_pk_bf16_f32 v88, v46, v47
    v_cvt_pk_bf16_f32 v89, v48, v49
    ds_read_b64_tr_b16 v[102:103], v121 offset:256
    ds_read_b64_tr_b16 v[104:105], v121 offset:384
    v_mfma_f32_32x32x16_bf16 v[50:65], v[110:113], v[86:89], v[50:65]
La2b_298:
    v_exp_f32 v18, v18
    v_exp_f32 v19, v19
    v_exp_f32 v20, v20
    v_exp_f32 v21, v21
    v_exp_f32 v22, v22
    v_exp_f32 v23, v23
    v_exp_f32 v24, v24
    v_exp_f32 v25, v25
    v_cvt_pk_bf16_f32 v82, v18, v19
    v_cvt_pk_bf16_f32 v83, v20, v21
    v_cvt_pk_bf16_f32 v84, v22, v23
    v_cvt_pk_bf16_f32 v85, v24, v25
    v_and_b32 v82, v126, v82
    v_and_b32 v83, v127, v83
    v_and_b32 v84, v128, v84
    v_and_b32 v85, v129, v85
    v_exp_f32 v26, v26
    v_exp_f32 v27, v27
    s_waitcnt lgkmcnt(0)
    v_mfma_f32_32x32x16_bf16 v[50:65], v[98:101], v[82:85], v[50:65]
    v_exp_f32 v28, v28
    v_exp_f32 v29, v29
    v_exp_f32 v30, v30
    v_exp_f32 v31, v31
    v_exp_f32 v32, v32
    v_exp_f32 v33, v33
    v_cvt_pk_bf16_f32 v86, v26, v27
    v_cvt_pk_bf16_f32 v87, v28, v29
    v_cvt_pk_bf16_f32 v88, v30, v31
    v_cvt_pk_bf16_f32 v89, v32, v33
    v_and_b32 v86, v130, v86
    v_and_b32 v87, v131, v87
    v_and_b32 v88, v132, v88
    v_and_b32 v89, v133, v89
    s_nop 1
    v_mfma_f32_32x32x16_bf16 v[50:65], v[102:105], v[86:89], v[50:65]
    s_waitcnt lgkmcnt(0)
    s_nop 7
    s_nop 7
    s_branch Lredone_262
La1s_321:
    s_cmp_eq_u32 s83, 1
    s_cbranch_scc1 La1s_322
    s_cmp_eq_u32 s83, 2
    s_cbranch_scc1 La1s_323
    s_cmp_eq_u32 s83, 3
    s_cbranch_scc1 La1s_324
    s_cmp_eq_u32 s83, 4
    s_cbranch_scc1 La1s_325
    s_cmp_eq_u32 s83, 5
    s_cbranch_scc1 La1s_326
    s_cmp_eq_u32 s83, 6
    s_cbranch_scc1 La1s_327
    s_cmp_eq_u32 s83, 7
    s_cbranch_scc1 La1s_328
    s_cmp_eq_u32 s83, 8
    s_cbranch_scc1 La1s_329
    s_branch La1s_329
La1s_322:
    v_mfma_f32_32x32x16_bf16 v[34:49], v[70:73], v[14:17], 0
    v_mfma_f32_32x32x16_bf16 v[50:65], v[74:77], v[14:17], 0
    s_nop 7
    s_nop 1
    s_branch La1b_331
La1s_323:
    v_mfma_f32_32x32x16_bf16 v[50:65], v[74:77], v[14:17], 0
    v_mfma_f32_32x32x16_bf16 v[18:33], v[78:81], v[14:17], 0
    s_nop 7
    s_nop 1
    s_branch La1b_332
La1s_324:
    v_mfma_f32_32x32x16_bf16 v[18:33], v[78:81], v[14:17], 0
    v_mfma_f32_32x32x16_bf16 v[34:49], v[82:85], v[14:17], 0
    s_nop 7
    s_nop 1
    s_branch La1b_333
La1s_325:
    v_mfma_f32_32x32x16_bf16 v[34:49], v[82:85], v[14:17], 0
    v_mfma_f32_32x32x16_bf16 v[50:65], v[86:89], v[14:17], 0
    s_nop 7
    s_nop 1
    s_branch La1b_334
La1s_326:
    v_mfma_f32_32x32x16_bf16 v[50:65], v[86:89], v[14:17], 0
    v_mfma_f32_32x32x16_bf16 v[18:33], v[90:93], v[14:17], 0
    s_nop 7
    s_nop 1
    s_branch La1b_335
La1s_327:
    v_mfma_f32_32x32x16_bf16 v[18:33], v[90:93], v[14:17], 0
    v_mfma_f32_32x32x16_bf16 v[34:49], v[94:97], v[14:17], 0
    s_nop 7
    s_nop 1
    s_branch La1b_336
La1s_328:
    v_mfma_f32_32x32x16_bf16 v[34:49], v[94:97], v[14:17], 0
    v_mfma_f32_32x32x16_bf16 v[50:65], v[98:101], v[14:17], 0
    s_nop 7
    s_nop 1
    s_branch La1b_337
La1s_329:
    v_mfma_f32_32x32x16_bf16 v[50:65], v[98:101], v[14:17], 0
    s_nop 7
    s_nop 1
    s_branch La1b_338
La2s_339:
    s_cmp_eq_u32 s83, 1
    s_cbranch_scc1 La2s_340
    s_cmp_eq_u32 s83, 2
    s_cbranch_scc1 La2s_341
    s_cmp_eq_u32 s83, 3
    s_cbranch_scc1 La2s_342
    s_cmp_eq_u32 s83, 4
    s_cbranch_scc1 La2s_343
    s_cmp_eq_u32 s83, 5
    s_cbranch_scc1 La2s_344
    s_cmp_eq_u32 s83, 6
    s_cbranch_scc1 La2s_345
    s_cmp_eq_u32 s83, 7
    s_cbranch_scc1 La2s_346
    s_cmp_eq_u32 s83, 8
    s_cbranch_scc1 La2s_347
    s_branch La2s_347
La2s_340:
    v_mov_b32 v50, 0
    v_mov_b32 v51, 0
    v_mov_b32 v52, 0
    v_mov_b32 v53, 0
    v_mov_b32 v54, 0
    v_mov_b32 v55, 0
    v_mov_b32 v56, 0
    v_mov_b32 v57, 0
    v_mov_b32 v58, 0
    v_mov_b32 v59, 0
    v_mov_b32 v60, 0
    v_mov_b32 v61, 0
    v_mov_b32 v62, 0
    v_mov_b32 v63, 0
    v_mov_b32 v64, 0
    v_mov_b32 v65, 0
    ds_read_b128 v[94:97], v120 offset:14976
    ds_read_b128 v[90:93], v120 offset:16128
    ds_read_b64_tr_b16 v[106:107], v121 offset:0
    ds_read_b64_tr_b16 v[108:109], v121 offset:128
    ds_read_b64_tr_b16 v[110:111], v121 offset:256
    ds_read_b64_tr_b16 v[112:113], v121 offset:384
    s_waitcnt lgkmcnt(5)
    v_mfma_f32_32x32x16_bf16 v[34:49], v[94:97], v[14:17], v[66:81]
    s_nop 7
    s_nop 3
    s_branch La2b_349
La2s_341:
    v_mov_b32 v50, 0
    v_mov_b32 v51, 0
    v_mov_b32 v52, 0
    v_mov_b32 v53, 0
    v_mov_b32 v54, 0
    v_mov_b32 v55, 0
    v_mov_b32 v56, 0
    v_mov_b32 v57, 0
    v_mov_b32 v58, 0
    v_mov_b32 v59, 0
    v_mov_b32 v60, 0
    v_mov_b32 v61, 0
    v_mov_b32 v62, 0
    v_mov_b32 v63, 0
    v_mov_b32 v64, 0
    v_mov_b32 v65, 0
    ds_read_b128 v[90:93], v120 offset:16128
    ds_read_b128 v[94:97], v120 offset:17280
    ds_read_b64_tr_b16 v[98:99], v121 offset:0
    ds_read_b64_tr_b16 v[100:101], v121 offset:128
    ds_read_b64_tr_b16 v[102:103], v121 offset:256
    ds_read_b64_tr_b16 v[104:105], v121 offset:384
    s_waitcnt lgkmcnt(5)
    v_mfma_f32_32x32x16_bf16 v[18:33], v[90:93], v[14:17], v[66:81]
    s_nop 7
    s_nop 3
    s_branch La2b_350
La2s_342:
    v_mov_b32 v50, 0
    v_mov_b32 v51, 0
    v_mov_b32 v52, 0
    v_mov_b32 v53, 0
    v_mov_b32 v54, 0
    v_mov_b32 v55, 0
    v_mov_b32 v56, 0
    v_mov_b32 v57, 0
    v_mov_b32 v58, 0
    v_mov_b32 v59, 0
    v_mov_b32 v60, 0
    v_mov_b32 v61, 0
    v_mov_b32 v62, 0
    v_mov_b32 v63, 0
    v_mov_b32 v64, 0
    v_mov_b32 v65, 0
    ds_read_b128 v[94:97], v120 offset:17280
    ds_read_b128 v[90:93], v120 offset:18432
    ds_read_b64_tr_b16 v[106:107], v121 offset:0
    ds_read_b64_tr_b16 v[108:109], v121 offset:128
    ds_read_b64_tr_b16 v[110:111], v121 offset:256
    ds_read_b64_tr_b16 v[112:113], v121 offset:384
    s_waitcnt lgkmcnt(5)
    v_mfma_f32_32x32x16_bf16 v[34:49], v[94:97], v[14:17], v[66:81]
    s_nop 7
    s_nop 3
    s_branch La2b_351
La2s_343:
    v_mov_b32 v50, 0
    v_mov_b32 v51, 0
    v_mov_b32 v52, 0
    v_mov_b32 v53, 0
    v_mov_b32 v54, 0
    v_mov_b32 v55, 0
    v_mov_b32 v56, 0
    v_mov_b32 v57, 0
    v_mov_b32 v58, 0
    v_mov_b32 v59, 0
    v_mov_b32 v60, 0
    v_mov_b32 v61, 0
    v_mov_b32 v62, 0
    v_mov_b32 v63, 0
    v_mov_b32 v64, 0
    v_mov_b32 v65, 0
    ds_read_b128 v[90:93], v120 offset:18432
    ds_read_b128 v[94:97], v120 offset:19584
    ds_read_b64_tr_b16 v[98:99], v121 offset:0
    ds_read_b64_tr_b16 v[100:101], v121 offset:128
    ds_read_b64_tr_b16 v[102:103], v121 offset:256
    ds_read_b64_tr_b16 v[104:105], v121 offset:384
    s_waitcnt lgkmcnt(5)
    v_mfma_f32_32x32x16_bf16 v[18:33], v[90:93], v[14:17], v[66:81]
    s_nop 7
    s_nop 3
    s_branch La2b_352
La2s_344:
    v_mov_b32 v50, 0
    v_mov_b32 v51, 0
    v_mov_b32 v52, 0
    v_mov_b32 v53, 0
    v_mov_b32 v54, 0
    v_mov_b32 v55, 0
    v_mov_b32 v56, 0
    v_mov_b32 v57, 0
    v_mov_b32 v58, 0
    v_mov_b32 v59, 0
    v_mov_b32 v60, 0
    v_mov_b32 v61, 0
    v_mov_b32 v62, 0
    v_mov_b32 v63, 0
    v_mov_b32 v64, 0
    v_mov_b32 v65, 0
    ds_read_b128 v[94:97], v120 offset:19584
    ds_read_b128 v[90:93], v120 offset:20736
    ds_read_b64_tr_b16 v[106:107], v121 offset:0
    ds_read_b64_tr_b16 v[108:109], v121 offset:128
    ds_read_b64_tr_b16 v[110:111], v121 offset:256
    ds_read_b64_tr_b16 v[112:113], v121 offset:384
    s_waitcnt lgkmcnt(5)
    v_mfma_f32_32x32x16_bf16 v[34:49], v[94:97], v[14:17], v[66:81]
    s_nop 7
    s_nop 3
    s_branch La2b_353
La2s_345:
    v_mov_b32 v50, 0
    v_mov_b32 v51, 0
    v_mov_b32 v52, 0
    v_mov_b32 v53, 0
    v_mov_b32 v54, 0
    v_mov_b32 v55, 0
    v_mov_b32 v56, 0
    v_mov_b32 v57, 0
    v_mov_b32 v58, 0
    v_mov_b32 v59, 0
    v_mov_b32 v60, 0
    v_mov_b32 v61, 0
    v_mov_b32 v62, 0
    v_mov_b32 v63, 0
    v_mov_b32 v64, 0
    v_mov_b32 v65, 0
    ds_read_b128 v[90:93], v120 offset:20736
    ds_read_b128 v[94:97], v120 offset:21888
    ds_read_b64_tr_b16 v[98:99], v121 offset:0
    ds_read_b64_tr_b16 v[100:101], v121 offset:128
    ds_read_b64_tr_b16 v[102:103], v121 offset:256
    ds_read_b64_tr_b16 v[104:105], v121 offset:384
    s_waitcnt lgkmcnt(5)
    v_mfma_f32_32x32x16_bf16 v[18:33], v[90:93], v[14:17], v[66:81]
    s_nop 7
    s_nop 3
    s_branch La2b_354
La2s_346:
    v_mov_b32 v50, 0
    v_mov_b32 v51, 0
    v_mov_b32 v52, 0
    v_mov_b32 v53, 0
    v_mov_b32 v54, 0
    v_mov_b32 v55, 0
    v_mov_b32 v56, 0
    v_mov_b32 v57, 0
    v_mov_b32 v58, 0
    v_mov_b32 v59, 0
    v_mov_b32 v60, 0
    v_mov_b32 v61, 0
    v_mov_b32 v62, 0
    v_mov_b32 v63, 0
    v_mov_b32 v64, 0
    v_mov_b32 v65, 0
    ds_read_b128 v[94:97], v120 offset:21888
    ds_read_b128 v[90:93], v120 offset:23040
    ds_read_b64_tr_b16 v[106:107], v121 offset:0
    ds_read_b64_tr_b16 v[108:109], v121 offset:128
    ds_read_b64_tr_b16 v[110:111], v121 offset:256
    ds_read_b64_tr_b16 v[112:113], v121 offset:384
    s_waitcnt lgkmcnt(5)
    v_mfma_f32_32x32x16_bf16 v[34:49], v[94:97], v[14:17], v[66:81]
    s_nop 7
    s_nop 3
    s_branch La2b_355
La2s_347:
    v_mov_b32 v50, 0
    v_mov_b32 v51, 0
    v_mov_b32 v52, 0
    v_mov_b32 v53, 0
    v_mov_b32 v54, 0
    v_mov_b32 v55, 0
    v_mov_b32 v56, 0
    v_mov_b32 v57, 0
    v_mov_b32 v58, 0
    v_mov_b32 v59, 0
    v_mov_b32 v60, 0
    v_mov_b32 v61, 0
    v_mov_b32 v62, 0
    v_mov_b32 v63, 0
    v_mov_b32 v64, 0
    v_mov_b32 v65, 0
    ds_read_b128 v[90:93], v120 offset:23040
    ds_read_b64_tr_b16 v[98:99], v121 offset:0
    ds_read_b64_tr_b16 v[100:101], v121 offset:128
    ds_read_b64_tr_b16 v[102:103], v121 offset:256
    ds_read_b64_tr_b16 v[104:105], v121 offset:384
    s_waitcnt lgkmcnt(4)
    v_mfma_f32_32x32x16_bf16 v[18:33], v[90:93], v[14:17], v[66:81]
    s_nop 7
    s_nop 3
    s_branch La2b_356
Lredo_319:
    s_nop 7
    ds_read_b128 v[66:69], v120 offset:13824
    ds_read_b128 v[70:73], v120 offset:14976
    ds_read_b128 v[74:77], v120 offset:16128
    ds_read_b128 v[78:81], v120 offset:17280
    ds_read_b128 v[82:85], v120 offset:18432
    ds_read_b128 v[86:89], v120 offset:19584
    ds_read_b128 v[90:93], v120 offset:20736
    ds_read_b128 v[94:97], v120 offset:21888
    ds_read_b128 v[98:101], v120 offset:23040
    v_mov_b32 v114, v118
    v_mov_b32 v115, v118
    s_waitcnt lgkmcnt(0)
    s_cmp_lg_u32 s83, 0
    s_cbranch_scc1 La1s_321
    v_mfma_f32_32x32x16_bf16 v[18:33], v[66:69], v[14:17], 0
    v_mfma_f32_32x32x16_bf16 v[34:49], v[70:73], v[14:17], 0
    s_nop 7
    s_nop 1
La1b_330:
    v_mfma_f32_32x32x16_bf16 v[50:65], v[74:77], v[14:17], 0
    v_cndmask_b32 v18, v18, v118, s[44:45]
    v_cndmask_b32 v19, v19, v118, s[46:47]
    v_cndmask_b32 v20, v20, v118, s[48:49]
    v_cndmask_b32 v21, v21, v118, s[50:51]
    v_cndmask_b32 v22, v22, v118, s[52:53]
    v_cndmask_b32 v23, v23, v118, s[54:55]
    v_cndmask_b32 v24, v24, v118, s[56:57]
    v_cndmask_b32 v25, v25, v118, s[58:59]
    v_cndmask_b32 v26, v26, v118, s[60:61]
    v_cndmask_b32 v27, v27, v118, s[62:63]
    v_cndmask_b32 v28, v28, v118, s[64:65]
    v_cndmask_b32 v29, v29, v118, s[66:67]
    v_cndmask_b32 v30, v30, v118, s[68:69]
    v_cndmask_b32 v31, v31, v118, s[70:71]
    v_cndmask_b32 v32, v32, v118, s[72:73]
    v_cndmask_b32 v33, v33, v118, s[74:75]
    v_max3_f32 v114, v114, v18, v19
    v_max3_f32 v115, v115, v20, v21
    v_max3_f32 v114, v114, v22, v23
    v_max3_f32 v115, v115, v24, v25
    v_max3_f32 v114, v114, v26, v27
    v_max3_f32 v115, v115, v28, v29
    v_max3_f32 v114, v114, v30, v31
    v_max3_f32 v115, v115, v32, v33
La1b_331:
    v_mfma_f32_32x32x16_bf16 v[18:33], v[78:81], v[14:17], 0
    v_max3_f32 v114, v114, v34, v35
    v_max3_f32 v115, v115, v36, v37
    v_max3_f32 v114, v114, v38, v39
    v_max3_f32 v115, v115, v40, v41
    v_max3_f32 v114, v114, v42, v43
    v_max3_f32 v115, v115, v44, v45
    v_max3_f32 v114, v114, v46, v47
    v_max3_f32 v115, v115, v48, v49
La1b_332:
    v_mfma_f32_32x32x16_bf16 v[34:49], v[82:85], v[14:17], 0
    v_max3_f32 v114, v114, v50, v51
    v_max3_f32 v115, v115, v52, v53
    v_max3_f32 v114, v114, v54, v55
    v_max3_f32 v115, v115, v56, v57
    v_max3_f32 v114, v114, v58, v59
    v_max3_f32 v115, v115, v60, v61
    v_max3_f32 v114, v114, v62, v63
    v_max3_f32 v115, v115, v64, v65
La1b_333:
    v_mfma_f32_32x32x16_bf16 v[50:65], v[86:89], v[14:17], 0
    v_max3_f32 v114, v114, v18, v19
    v_max3_f32 v115, v115, v20, v21
    v_max3_f32 v114, v114, v22, v23
    v_max3_f32 v115, v115, v24, v25
    v_max3_f32 v114, v114, v26, v27
    v_max3_f32 v115, v115, v28, v29
    v_max3_f32 v114, v114, v30, v31
    v_max3_f32 v115, v115, v32, v33
La1b_334:
    v_mfma_f32_32x32x16_bf16 v[18:33], v[90:93], v[14:17], 0
    v_max3_f32 v114, v114, v34, v35
    v_max3_f32 v115, v115, v36, v37
    v_max3_f32 v114, v114, v38, v39
    v_max3_f32 v115, v115, v40, v41
    v_max3_f32 v114, v114, v42, v43
    v_max3_f32 v115, v115, v44, v45
    v_max3_f32 v114, v114, v46, v47
    v_max3_f32 v115, v115, v48, v49
La1b_335:
    v_mfma_f32_32x32x16_bf16 v[34:49], v[94:97], v[14:17], 0
    v_max3_f32 v114, v114, v50, v51
    v_max3_f32 v115, v115, v52, v53
    v_max3_f32 v114, v114, v54, v55
    v_max3_f32 v115, v115, v56, v57
    v_max3_f32 v114, v114, v58, v59
    v_max3_f32 v115, v115, v60, v61
    v_max3_f32 v114, v114, v62, v63
    v_max3_f32 v115, v115, v64, v65
La1b_336:
    v_mfma_f32_32x32x16_bf16 v[50:65], v[98:101], v[14:17], 0
    v_max3_f32 v114, v114, v18, v19
    v_max3_f32 v115, v115, v20, v21
    v_max3_f32 v114, v114, v22, v23
    v_max3_f32 v115, v115, v24, v25
    v_max3_f32 v114, v114, v26, v27
    v_max3_f32 v115, v115, v28, v29
    v_max3_f32 v114, v114, v30, v31
    v_max3_f32 v115, v115, v32, v33
La1b_337:
    v_max3_f32 v114, v114, v34, v35
    v_max3_f32 v115, v115, v36, v37
    v_max3_f32 v114, v114, v38, v39
    v_max3_f32 v115, v115, v40, v41
    v_max3_f32 v114, v114, v42, v43
    v_max3_f32 v115, v115, v44, v45
    v_max3_f32 v114, v114, v46, v47
    v_max3_f32 v115, v115, v48, v49
La1b_338:
    v_cndmask_b32 v50, v118, v50, s[44:45]
    v_cndmask_b32 v51, v118, v51, s[46:47]
    v_cndmask_b32 v52, v118, v52, s[48:49]
    v_cndmask_b32 v53, v118, v53, s[50:51]
    v_cndmask_b32 v54, v118, v54, s[52:53]
    v_cndmask_b32 v55, v118, v55, s[54:55]
    v_cndmask_b32 v56, v118, v56, s[56:57]
    v_cndmask_b32 v57, v118, v57, s[58:59]
    v_cndmask_b32 v58, v118, v58, s[60:61]
    v_cndmask_b32 v59, v118, v59, s[62:63]
    v_cndmask_b32 v60, v118, v60, s[64:65]
    v_cndmask_b32 v61, v118, v61, s[66:67]
    v_cndmask_b32 v62, v118, v62, s[68:69]
    v_cndmask_b32 v63, v118, v63, s[70:71]
    v_cndmask_b32 v64, v118, v64, s[72:73]
    v_cndmask_b32 v65, v118, v65, s[74:75]
    v_max3_f32 v114, v114, v50, v51
    v_max3_f32 v115, v115, v52, v53
    v_max3_f32 v114, v114, v54, v55
    v_max3_f32 v115, v115, v56, v57
    v_max3_f32 v114, v114, v58, v59
    v_max3_f32 v115, v115, v60, v61
    v_max3_f32 v114, v114, v62, v63
    v_max3_f32 v115, v115, v64, v65
    v_max_f32 v114, v114, v115
    v_mov_b32 v116, v114
    s_nop 1
    v_permlane32_swap_b32 v114, v116
    v_max_f32 v114, v114, v116
    v_mul_f32 v66, -1.0, v114
    v_mul_f32 v67, -1.0, v114
    v_mul_f32 v68, -1.0, v114
    v_mul_f32 v69, -1.0, v114
    v_mul_f32 v70, -1.0, v114
    v_mul_f32 v71, -1.0, v114
    v_mul_f32 v72, -1.0, v114
    v_mul_f32 v73, -1.0, v114
    v_mul_f32 v74, -1.0, v114
    v_mul_f32 v75, -1.0, v114
    v_mul_f32 v76, -1.0, v114
    v_mul_f32 v77, -1.0, v114
    v_mul_f32 v78, -1.0, v114
    v_mul_f32 v79, -1.0, v114
    v_mul_f32 v80, -1.0, v114
    v_mul_f32 v81, -1.0, v114
    v_mov_b32 v121, v123
    v_mov_b32 v116, 13824
    v_cmp_ne_u32 vcc, 0, v122
    v_mov_b32 v117, 0
    s_nop 0
    v_cndmask_b32 v116, v117, v116, vcc
    v_add_u32 v121, v121, v116
    s_cmp_lg_u32 s83, 0
    s_cbranch_scc1 La2s_339
    ds_read_b128 v[90:93], v120 offset:13824
    ds_read_b128 v[94:97], v120 offset:14976
    ds_read_b64_tr_b16 v[98:99], v121 offset:0
    ds_read_b64_tr_b16 v[100:101], v121 offset:128
    ds_read_b64_tr_b16 v[102:103], v121 offset:256
    ds_read_b64_tr_b16 v[104:105], v121 offset:384
    s_waitcnt lgkmcnt(5)
    v_mfma_f32_32x32x16_bf16 v[18:33], v[90:93], v[14:17], v[66:81]
    s_nop 7
    s_nop 3
La2b_348:
    v_exp_f32 v18, v18
    v_exp_f32 v19, v19
    v_exp_f32 v20, v20
    v_exp_f32 v21, v21
    s_waitcnt lgkmcnt(4)
    v_mfma_f32_32x32x16_bf16 v[34:49], v[94:97], v[14:17], v[66:81]
    v_exp_f32 v22, v22
    v_exp_f32 v23, v23
    v_exp_f32 v24, v24
    v_exp_f32 v25, v25
    ds_read_b128 v[90:93], v120 offset:16128
    v_cvt_pk_bf16_f32 v82, v18, v19
    v_cvt_pk_bf16_f32 v83, v20, v21
    v_cvt_pk_bf16_f32 v84, v22, v23
    v_cvt_pk_bf16_f32 v85, v24, v25
    v_bfi_b32 v82, v126, 0, v82
    v_bfi_b32 v83, v127, 0, v83
    v_bfi_b32 v84, v128, 0, v84
    v_bfi_b32 v85, v129, 0, v85
    v_exp_f32 v26, v26
    v_exp_f32 v27, v27
    s_waitcnt lgkmcnt(1)
    v_mfma_f32_32x32x16_bf16 v[50:65], v[98:101], v[82:85], 0
    v_exp_f32 v28, v28
    v_exp_f32 v29, v29
    v_exp_f32 v30, v30
    v_add_u32 v121, v121, v122
    ds_read_b64_tr_b16 v[106:107], v121 offset:0
    ds_read_b64_tr_b16 v[108:109], v121 offset:128
    v_exp_f32 v31, v31
    v_exp_f32 v32, v32
    v_exp_f32 v33, v33
    v_cvt_pk_bf16_f32 v86, v26, v27
    v_cvt_pk_bf16_f32 v87, v28, v29
    v_cvt_pk_bf16_f32 v88, v30, v31
    v_cvt_pk_bf16_f32 v89, v32, v33
    v_bfi_b32 v86, v130, 0, v86
    v_bfi_b32 v87, v131, 0, v87
    v_bfi_b32 v88, v132, 0, v88
    v_bfi_b32 v89, v133, 0, v89
    ds_read_b64_tr_b16 v[110:111], v121 offset:256
    ds_read_b64_tr_b16 v[112:113], v121 offset:384
    v_mfma_f32_32x32x16_bf16 v[50:65], v[102:105], v[86:89], v[50:65]
La2b_349:
    v_exp_f32 v34, v34
    v_exp_f32 v35, v35
    v_exp_f32 v36, v36
    v_exp_f32 v37, v37
    s_waitcnt lgkmcnt(4)
    v_mfma_f32_32x32x16_bf16 v[18:33], v[90:93], v[14:17], v[66:81]
    v_exp_f32 v38, v38
    v_exp_f32 v39, v39
    v_exp_f32 v40, v40
    v_exp_f32 v41, v41
    ds_read_b128 v[94:97], v120 offset:17280
    v_cvt_pk_bf16_f32 v82, v34, v35
    v_cvt_pk_bf16_f32 v83, v36, v37
    v_cvt_pk_bf16_f32 v84, v38, v39
    v_cvt_pk_bf16_f32 v85, v40, v41
    v_exp_f32 v42, v42
    v_exp_f32 v43, v43
    s_waitcnt lgkmcnt(1)
    v_mfma_f32_32x32x16_bf16 v[50:65], v[106:109], v[82:85], v[50:65]
    v_exp_f32 v44, v44
    v_exp_f32 v45, v45
    v_exp_f32 v46, v46
    v_add_u32 v121, v121, v122
    ds_read_b64_tr_b16 v[98:99], v121 offset:0
    ds_read_b64_tr_b16 v[100:101], v121 offset:128
    v_exp_f32 v47, v47
    v_exp_f32 v48, v48
    v_exp_f32 v49, v49
    v_cvt_pk_bf16_f32 v86, v42, v43
    v_cvt_pk_bf16_f32 v87, v44, v45
    v_cvt_pk_bf16_f32 v88, v46, v47
    v_cvt_pk_bf16_f32 v89, v48, v49
    ds_read_b64_tr_b16 v[102:103], v121 offset:256
    ds_read_b64_tr_b16 v[104:105], v121 offset:384
    v_mfma_f32_32x32x16_bf16 v[50:65], v[110:113], v[86:89], v[50:65]
La2b_350:
    v_exp_f32 v18, v18
    v_exp_f32 v19, v19
    v_exp_f32 v20, v20
    v_exp_f32 v21, v21
    s_waitcnt lgkmcnt(4)
    v_mfma_f32_32x32x16_bf16 v[34:49], v[94:97], v[14:17], v[66:81]
    v_exp_f32 v22, v22
    v_exp_f32 v23, v23
    v_exp_f32 v24, v24
    v_exp_f32 v25, v25
    ds_read_b128 v[90:93], v120 offset:18432
    v_cvt_pk_bf16_f32 v82, v18, v19
    v_cvt_pk_bf16_f32 v83, v20, v21
    v_cvt_pk_bf16_f32 v84, v22, v23
    v_cvt_pk_bf16_f32 v85, v24, v25
    v_exp_f32 v26, v26
    v_exp_f32 v27, v27
    s_waitcnt lgkmcnt(1)
    v_mfma_f32_32x32x16_bf16 v[50:65], v[98:101], v[82:85], v[50:65]
    v_exp_f32 v28, v28
    v_exp_f32 v29, v29
    v_exp_f32 v30, v30
    v_add_u32 v121, v121, v122
    ds_read_b64_tr_b16 v[106:107], v121 offset:0
    ds_read_b64_tr_b16 v[108:109], v121 offset:128
    v_exp_f32 v31, v31
    v_exp_f32 v32, v32
    v_exp_f32 v33, v33
    v_cvt_pk_bf16_f32 v86, v26, v27
    v_cvt_pk_bf16_f32 v87, v28, v29
    v_cvt_pk_bf16_f32 v88, v30, v31
    v_cvt_pk_bf16_f32 v89, v32, v33
    ds_read_b64_tr_b16 v[110:111], v121 offset:256
    ds_read_b64_tr_b16 v[112:113], v121 offset:384
    v_mfma_f32_32x32x16_bf16 v[50:65], v[102:105], v[86:89], v[50:65]
La2b_351:
    v_exp_f32 v34, v34
    v_exp_f32 v35, v35
    v_exp_f32 v36, v36
    v_exp_f32 v37, v37
    s_waitcnt lgkmcnt(4)
    v_mfma_f32_32x32x16_bf16 v[18:33], v[90:93], v[14:17], v[66:81]
    v_exp_f32 v38, v38
    v_exp_f32 v39, v39
    v_exp_f32 v40, v40
    v_exp_f32 v41, v41
    ds_read_b128 v[94:97], v120 offset:19584
    v_cvt_pk_bf16_f32 v82, v34, v35
    v_cvt_pk_bf16_f32 v83, v36, v37
    v_cvt_pk_bf16_f32 v84, v38, v39
    v_cvt_pk_bf16_f32 v85, v40, v41
    v_exp_f32 v42, v42
    v_exp_f32 v43, v43
    s_waitcnt lgkmcnt(1)
    v_mfma_f32_32x32x16_bf16 v[50:65], v[106:109], v[82:85], v[50:65]
    v_exp_f32 v44, v44
    v_exp_f32 v45, v45
    v_exp_f32 v46, v46
    v_add_u32 v121, v121, v122
    ds_read_b64_tr_b16 v[98:99], v121 offset:0
    ds_read_b64_tr_b16 v[100:101], v121 offset:128
    v_exp_f32 v47, v47
    v_exp_f32 v48, v48
    v_exp_f32 v49, v49
    v_cvt_pk_bf16_f32 v86, v42, v43
    v_cvt_pk_bf16_f32 v87, v44, v45
    v_cvt_pk_bf16_f32 v88, v46, v47
    v_cvt_pk_bf16_f32 v89, v48, v49
    ds_read_b64_tr_b16 v[102:103], v121 offset:256
    ds_read_b64_tr_b16 v[104:105], v121 offset:384
    v_mfma_f32_32x32x16_bf16 v[50:65], v[110:113], v[86:89], v[50:65]
La2b_352:
    v_exp_f32 v18, v18
    v_exp_f32 v19, v19
    v_exp_f32 v20, v20
    v_exp_f32 v21, v21
    s_waitcnt lgkmcnt(4)
    v_mfma_f32_32x32x16_bf16 v[34:49], v[94:97], v[14:17], v[66:81]
    v_exp_f32 v22, v22
    v_exp_f32 v23, v23
    v_exp_f32 v24, v24
    v_exp_f32 v25, v25
    ds_read_b128 v[90:93], v120 offset:20736
    v_cvt_pk_bf16_f32 v82, v18, v19
    v_cvt_pk_bf16_f32 v83, v20, v21
    v_cvt_pk_bf16_f32 v84, v22, v23
    v_cvt_pk_bf16_f32 v85, v24, v25
    v_exp_f32 v26, v26
    v_exp_f32 v27, v27
    s_waitcnt lgkmcnt(1)
    v_mfma_f32_32x32x16_bf16 v[50:65], v[98:101], v[82:85], v[50:65]
    v_exp_f32 v28, v28
    v_exp_f32 v29, v29
    v_exp_f32 v30, v30
    v_add_u32 v121, v121, v122
    ds_read_b64_tr_b16 v[106:107], v121 offset:0
    ds_read_b64_tr_b16 v[108:109], v121 offset:128
    v_exp_f32 v31, v31
    v_exp_f32 v32, v32
    v_exp_f32 v33, v33
    v_cvt_pk_bf16_f32 v86, v26, v27
    v_cvt_pk_bf16_f32 v87, v28, v29
    v_cvt_pk_bf16_f32 v88, v30, v31
    v_cvt_pk_bf16_f32 v89, v32, v33
    ds_read_b64_tr_b16 v[110:111], v121 offset:256
    ds_read_b64_tr_b16 v[112:113], v121 offset:384
    v_mfma_f32_32x32x16_bf16 v[50:65], v[102:105], v[86:89], v[50:65]
La2b_353:
    v_exp_f32 v34, v34
    v_exp_f32 v35, v35
    v_exp_f32 v36, v36
    v_exp_f32 v37, v37
    s_waitcnt lgkmcnt(4)
    v_mfma_f32_32x32x16_bf16 v[18:33], v[90:93], v[14:17], v[66:81]
    v_exp_f32 v38, v38
    v_exp_f32 v39, v39
    v_exp_f32 v40, v40
    v_exp_f32 v41, v41
    ds_read_b128 v[94:97], v120 offset:21888
    v_cvt_pk_bf16_f32 v82, v34, v35
    v_cvt_pk_bf16_f32 v83, v36, v37
    v_cvt_pk_bf16_f32 v84, v38, v39
    v_cvt_pk_bf16_f32 v85, v40, v41
    v_exp_f32 v42, v42
    v_exp_f32 v43, v43
    s_waitcnt lgkmcnt(1)
    v_mfma_f32_32x32x16_bf16 v[50:65], v[106:109], v[82:85], v[50:65]
    v_exp_f32 v44, v44
    v_exp_f32 v45, v45
    v_exp_f32 v46, v46
    v_add_u32 v121, v121, v122
    ds_read_b64_tr_b16 v[98:99], v121 offset:0
    ds_read_b64_tr_b16 v[100:101], v121 offset:128
    v_exp_f32 v47, v47
    v_exp_f32 v48, v48
    v_exp_f32 v49, v49
    v_cvt_pk_bf16_f32 v86, v42, v43
    v_cvt_pk_bf16_f32 v87, v44, v45
    v_cvt_pk_bf16_f32 v88, v46, v47
    v_cvt_pk_bf16_f32 v89, v48, v49
    ds_read_b64_tr_b16 v[102:103], v121 offset:256
    ds_read_b64_tr_b16 v[104:105], v121 offset:384
    v_mfma_f32_32x32x16_bf16 v[50:65], v[110:113], v[86:89], v[50:65]
La2b_354:
    v_exp_f32 v18, v18
    v_exp_f32 v19, v19
    v_exp_f32 v20, v20
    v_exp_f32 v21, v21
    s_waitcnt lgkmcnt(4)
    v_mfma_f32_32x32x16_bf16 v[34:49], v[94:97], v[14:17], v[66:81]
    v_exp_f32 v22, v22
    v_exp_f32 v23, v23
    v_exp_f32 v24, v24
    v_exp_f32 v25, v25
    ds_read_b128 v[90:93], v120 offset:23040
    v_cvt_pk_bf16_f32 v82, v18, v19
    v_cvt_pk_bf16_f32 v83, v20, v21
    v_cvt_pk_bf16_f32 v84, v22, v23
    v_cvt_pk_bf16_f32 v85, v24, v25
    v_exp_f32 v26, v26
    v_exp_f32 v27, v27
    s_waitcnt lgkmcnt(1)
    v_mfma_f32_32x32x16_bf16 v[50:65], v[98:101], v[82:85], v[50:65]
    v_exp_f32 v28, v28
    v_exp_f32 v29, v29
    v_exp_f32 v30, v30
    v_add_u32 v121, v121, v122
    ds_read_b64_tr_b16 v[106:107], v121 offset:0
    ds_read_b64_tr_b16 v[108:109], v121 offset:128
    v_exp_f32 v31, v31
    v_exp_f32 v32, v32
    v_exp_f32 v33, v33
    v_cvt_pk_bf16_f32 v86, v26, v27
    v_cvt_pk_bf16_f32 v87, v28, v29
    v_cvt_pk_bf16_f32 v88, v30, v31
    v_cvt_pk_bf16_f32 v89, v32, v33
    ds_read_b64_tr_b16 v[110:111], v121 offset:256
    ds_read_b64_tr_b16 v[112:113], v121 offset:384
    v_mfma_f32_32x32x16_bf16 v[50:65], v[102:105], v[86:89], v[50:65]
La2b_355:
    v_exp_f32 v34, v34
    v_exp_f32 v35, v35
    v_exp_f32 v36, v36
    v_exp_f32 v37, v37
    s_waitcnt lgkmcnt(4)
    v_mfma_f32_32x32x16_bf16 v[18:33], v[90:93], v[14:17], v[66:81]
    v_exp_f32 v38, v38
    v_exp_f32 v39, v39
    v_exp_f32 v40, v40
    v_exp_f32 v41, v41
    v_cvt_pk_bf16_f32 v82, v34, v35
    v_cvt_pk_bf16_f32 v83, v36, v37
    v_cvt_pk_bf16_f32 v84, v38, v39
    v_cvt_pk_bf16_f32 v85, v40, v41
    v_exp_f32 v42, v42
    v_exp_f32 v43, v43
    s_waitcnt lgkmcnt(0)
    v_mfma_f32_32x32x16_bf16 v[50:65], v[106:109], v[82:85], v[50:65]
    v_exp_f32 v44, v44
    v_exp_f32 v45, v45
    v_exp_f32 v46, v46
    v_add_u32 v121, v121, v122
    ds_read_b64_tr_b16 v[98:99], v121 offset:0
    ds_read_b64_tr_b16 v[100:101], v121 offset:128
    v_exp_f32 v47, v47
    v_exp_f32 v48, v48
    v_exp_f32 v49, v49
    v_cvt_pk_bf16_f32 v86, v42, v43
    v_cvt_pk_bf16_f32 v87, v44, v45
    v_cvt_pk_bf16_f32 v88, v46, v47
    v_cvt_pk_bf16_f32 v89, v48, v49
    ds_read_b64_tr_b16 v[102:103], v121 offset:256
    ds_read_b64_tr_b16 v[104:105], v121 offset:384
    v_mfma_f32_32x32x16_bf16 v[50:65], v[110:113], v[86:89], v[50:65]
La2b_356:
    v_exp_f32 v18, v18
    v_exp_f32 v19, v19
    v_exp_f32 v20, v20
    v_exp_f32 v21, v21
    v_exp_f32 v22, v22
    v_exp_f32 v23, v23
    v_exp_f32 v24, v24
    v_exp_f32 v25, v25
    v_cvt_pk_bf16_f32 v82, v18, v19
    v_cvt_pk_bf16_f32 v83, v20, v21
    v_cvt_pk_bf16_f32 v84, v22, v23
    v_cvt_pk_bf16_f32 v85, v24, v25
    v_and_b32 v82, v126, v82
    v_and_b32 v83, v127, v83
    v_and_b32 v84, v128, v84
    v_and_b32 v85, v129, v85
    v_exp_f32 v26, v26
    v_exp_f32 v27, v27
    s_waitcnt lgkmcnt(0)
    v_mfma_f32_32x32x16_bf16 v[50:65], v[98:101], v[82:85], v[50:65]
    v_exp_f32 v28, v28
    v_exp_f32 v29, v29
    v_exp_f32 v30, v30
    v_exp_f32 v31, v31
    v_exp_f32 v32, v32
    v_exp_f32 v33, v33
    v_cvt_pk_bf16_f32 v86, v26, v27
    v_cvt_pk_bf16_f32 v87, v28, v29
    v_cvt_pk_bf16_f32 v88, v30, v31
    v_cvt_pk_bf16_f32 v89, v32, v33
    v_and_b32 v86, v130, v86
    v_and_b32 v87, v131, v87
    v_and_b32 v88, v132, v88
    v_and_b32 v89, v133, v89
    s_nop 1
    v_mfma_f32_32x32x16_bf16 v[50:65], v[102:105], v[86:89], v[50:65]
    s_waitcnt lgkmcnt(0)
    s_nop 7
    s_nop 7
    s_branch Lredone_320
L_CODE_END:
.section .rodata,"a"
.p2align 6
.amdhsa_kernel interleave_layers__sliding_block__mixer_token_mlp__prompt_kernel
  .amdhsa_next_free_vgpr 512
  .amdhsa_next_free_sgpr 102
  .amdhsa_accum_offset 256
  .amdhsa_group_segment_fixed_size 0
  .amdhsa_kernarg_size 88
  .amdhsa_user_sgpr_count 2
  .amdhsa_user_sgpr_kernarg_segment_ptr 1
  .amdhsa_system_sgpr_workgroup_id_x 1
  .amdhsa_float_denorm_mode_32 3
.end_amdhsa_kernel
```
